```python
import torch

def _softmax(x, axis=-1):
    return torch.softmax(x, dim=axis)
def _gelu(x):
    return torch.nn.functional.gelu(x, approximate="tanh")
def _silu(x):
    return torch.nn.functional.silu(x)
def _sigmoid(x):
    return torch.sigmoid(x)
def _layernorm(x, axis=-1, eps=1e-5):
    m = x.mean(dim=axis, keepdim=True)
    v = x.var(dim=axis, keepdim=True, unbiased=False)
    return (x - m) / torch.sqrt(v + eps)
def _scatter_add(tgt, idx, src, axis=0):
    return tgt.clone().index_add_(axis, idx, src)
def _segment_sum(src, seg, n):
    out = torch.zeros((n,) + src.shape[1:], dtype=src.dtype)
    return out.index_add_(0, seg, src)
def _pad(x, pw):
    flat = tuple(v for pair in reversed(pw) for v in pair)
    return torch.nn.functional.pad(x, flat)

kernel_name = 'sequential_preLN__compressed_kv_cla__glu_gated_reglu__prompt'

def setup_inputs():

    _w = (lambda a: (lambda t: t.to(torch.bfloat16) if t.is_floating_point() else t)(torch.as_tensor(a)))
    def _A_setup():
        B, H, Sq, Sk, D, M = 1, 16, 2048, 2048, 256, 448
        Dc = 4 * D
        return {
            "x": _w((lambda *s: torch.randn(*s, dtype=torch.bfloat16) * 0.05)(B, Sq, M)),
            "c_kv": _w((lambda *s: torch.randn(*s, dtype=torch.bfloat16) * 0.4)(B, Sk, Dc)),
            "w_q": _w((lambda *s: torch.randn(*s, dtype=torch.bfloat16) * 1.6)(M, H, D) * (M ** -0.5)),
            "w_uk": _w((lambda *s: torch.randn(*s, dtype=torch.bfloat16) * 1.6)(Dc, H, D) * (Dc ** -0.5)),
            "w_uv": _w((lambda *s: torch.randn(*s, dtype=torch.bfloat16) * 0.4)(Dc, H, D) * (Dc ** -0.5)),
            "w_o": _w((lambda *s: torch.randn(*s, dtype=torch.bfloat16) * 0.4)(H, D, M) * ((H * D) ** -0.5)),
        }
    _A_in = _A_setup()

    def _B_setup():
        B, S, D, F = 1, 2048, 448, 1792
        return {
            "x": _w((lambda *s: torch.randn(*s, dtype=torch.bfloat16) * 0.05)(B, S, D)),
            "W_gate": _w((lambda *s: torch.randn(*s, dtype=torch.bfloat16) * 0.2)(D, F) * (2.0 / D) ** 0.5),
            "W_up": _w((lambda *s: torch.randn(*s, dtype=torch.bfloat16) * 0.2)(D, F) * (2.0 / D) ** 0.5),
            "W_down": _w((lambda *s: torch.randn(*s, dtype=torch.bfloat16) * 0.2)(F, D) * (1.0 / F) ** 0.5),
        }
    _B_in = _B_setup()

    return {
        "A_x": _A_in["x"],
        "A_c_kv": _A_in["c_kv"],
        "A_w_q": _A_in["w_q"],
        "A_w_uk": _A_in["w_uk"],
        "A_w_uv": _A_in["w_uv"],
        "A_w_o": _A_in["w_o"],
        "B_x": _B_in["x"],
        "B_W_gate": _B_in["W_gate"],
        "B_W_up": _B_in["W_up"],
        "B_W_down": _B_in["W_down"],
    }

def reference(A_x, A_c_kv, A_w_q, A_w_uk, A_w_uv, A_w_o, B_x, B_W_gate, B_W_up, B_W_down):
    def _A_ref(x, c_kv, w_q, w_uk, w_uv, w_o):
        B, Sq, M = x.shape[0], x.shape[1], x.shape[2]
        Sk = c_kv.shape[1]
        H, D = w_q.shape[1], w_q.shape[2]
        q = torch.einsum("bqm,mhd->bhqd", x, w_q)
        k = torch.einsum("bkc,chd->bhkd", c_kv, w_uk)
        v = torch.einsum("bkc,chd->bhkd", c_kv, w_uv)
        scores = torch.einsum("bhqd,bhkd->bhqk", q, k) * (D ** -0.5)
        off = Sk - Sq
        qi = torch.arange(Sq)[:, None]
        kj = torch.arange(Sk)[None, :]
        cmask = kj <= (qi + off)
        scores = torch.where(cmask[None, None], scores, -1e9)
        p = _softmax(scores, axis=-1)
        ctx = torch.einsum("bhqk,bhkd->bhqd", p, v)
        return torch.einsum("bhqd,hdm->bqm", ctx, w_o)

    def _B_ref(x, W_gate, W_up, W_down):
        gate = torch.einsum("bsd,df->bsf", x, W_gate)
        up = torch.einsum("bsd,df->bsf", x, W_up)
        gate = gate * (lambda x, dt: x.to(dt))(gate > 0, gate.dtype)
        h = gate * up
        return torch.einsum("bsf,fd->bsd", h, W_down)

    x = A_x
    h = x + _A_ref(_layernorm(x, axis=-1), A_c_kv, A_w_q, A_w_uk, A_w_uv, A_w_o)
    h2 = h + _B_ref(_layernorm(h, axis=-1), B_W_gate, B_W_up, B_W_down)
    return h2
```

```asm
; @launch kernel=k1_kernel grid=(256,1,1) block=(256,1,1) lds=163840
; @launch kernel=k2_kernel grid=(256,1,1) block=(256,1,1) lds=163840
.amdgcn_target "amdgcn-amd-amdhsa--gfx950"
.macro MF a:vararg
v_mfma_f32_16x16x32_bf16 \a
.endm
.macro DT a:vararg
ds_read_b64_tr_b16 \a
.endm
.macro DR a:vararg
ds_read_b128 \a
.endm
.macro BL a:vararg
buffer_load_dwordx4 \a
.endm
.macro BS a:vararg
buffer_store_dwordx4 \a
.endm
.macro AR a:vararg
v_accvgpr_read_b32 \a
.endm
.macro AW a:vararg
v_accvgpr_write_b32 \a
.endm
.macro CV a:vararg
v_cvt_pk_bf16_f32 \a
.endm
.macro EX a:vararg
v_exp_f32 \a
.endm
.macro FA a:vararg
v_add_f32 \a
.endm
.macro FM a:vararg
v_mul_f32 \a
.endm
.macro WT a:vararg
s_waitcnt \a
.endm
.macro CM a:vararg
v_cndmask_b32 \a
.endm
.macro SA a:vararg
s_add_u32 \a
.endm
.macro FS a:vararg
v_sub_f32 \a
.endm
.text
.globl k1_kernel
.p2align 8
.type k1_kernel,@function
k1_kernel:
s_cmp_ge_u32 s2,256
s_cbranch_scc1 k1_kernel_end
s_load_dwordx4 s[4:7],s[0:1],8
s_load_dwordx4 s[32:35],s[0:1],24
s_load_dwordx2 s[52:53],s[0:1],96
s_load_dwordx2 s[54:55],s[0:1],0
s_load_dwordx2 s[56:57],s[0:1],88
s_load_dwordx2 s[58:59],s[0:1],40
s_and_b32 s29,s2,7
s_lshr_b32 s30,s2,3
s_lshr_b32 s28,s30,2
s_and_b32 s31,s30,3
s_lshl_b32 s25,s29,2
SA s25,s25,s31
s_lshr_b32 s26,s25,4
s_and_b32 s27,s25,15
s_and_b32 s31,s30,1
s_lshl_b32 s29,s29,1
SA s50,s29,s31
s_lshr_b32 s51,s2,4
v_and_b32 v194,31,v0
v_lshrrev_b32 v192,5,v0
s_lshl_b32 s16,s2,3
v_add_u32 v192,s16,v192
v_mul_u32_u24 v192,896,v192
v_lshlrev_b32 v195,4,v194
v_add_u32 v192,v192,v195
v_add_u32 v193,512,v192
v_cmp_gt_u32 vcc,24,v194
v_mov_b32 v195,0x7ffffff0
s_nop 0
CM v193,v195,v193,vcc
v_and_b32 v1,63,v0
v_lshrrev_b32 v2,6,v0
s_nop 0
v_readfirstlane_b32 s20,v2
s_cmp_eq_u32 s26,0
s_cbranch_scc0 k1_kernel_cpv
s_cmp_lg_u32 s20,0
s_cbranch_scc1 cps_k1_kernel_a_skip
s_getpc_b64 s[72:73]
cpf_k1_kernel_a:
s_mov_b32 s74,k1_kernel-cpf_k1_kernel_a
s_ashr_i32 s75,s74,31
SA s72,s72,s74
s_addc_u32 s73,s73,s75
s_lshr_b32 s74,s2,3
s_lshl_b32 s74,s74,12
v_and_b32 v8,63,v0
v_lshlrev_b32 v8,6,v8
v_add_u32 v8,s74,v8
v_min_u32 v8,43004,v8
global_load_dword v9,v8,s[72:73]
cps_k1_kernel_a_skip:
s_branch k1_kernel_cpd
k1_kernel_cpv:
s_cmp_lg_u32 s20,0
s_cbranch_scc1 cps_k1_kernel_b_skip
s_getpc_b64 s[72:73]
cpf_k1_kernel_b:
s_mov_b32 s74,k1_kernel_v-cpf_k1_kernel_b
s_ashr_i32 s75,s74,31
SA s72,s72,s74
s_addc_u32 s73,s73,s75
s_lshr_b32 s74,s2,3
s_lshl_b32 s74,s74,12
v_and_b32 v8,63,v0
v_lshlrev_b32 v8,6,v8
v_add_u32 v8,s74,v8
v_min_u32 v8,43004,v8
global_load_dword v9,v8,s[72:73]
cps_k1_kernel_b_skip:
k1_kernel_cpd:
v_lshrrev_b32 v3,3,v1
v_lshlrev_b32 v4,5,v2
v_add_u32 v3,v3,v4
v_and_b32 v4,7,v1
v_lshrrev_b32 v5,4,v1
v_xor_b32 v4,v4,v5
v_xor_b32 v5,4,v4
v_lshlrev_b32 v4,4,v4
v_lshlrev_b32 v5,4,v5
v_lshlrev_b32 v6,11,v3
v_mul_u32_u24 v7,896,v3
v_add_u32 v8,v6,v4
v_add_u32 v22,0,v8
v_add_u32 v8,v7,v4
v_add_u32 v30,0,v8
v_add_u32 v8,v6,v5
v_add_u32 v23,15360,v8
v_add_u32 v8,v7,v5
v_add_u32 v31,6144,v8
v_add_u32 v8,v6,v4
v_add_u32 v24,30720,v8
v_add_u32 v8,v7,v4
v_add_u32 v32,12288,v8
v_add_u32 v8,v6,v5
v_add_u32 v25,46080,v8
v_add_u32 v8,v7,v5
v_add_u32 v33,18432,v8
v_lshrrev_b32 v3,5,v1
v_lshlrev_b32 v4,3,v2
v_add_u32 v4,v4,v3
v_lshlrev_b32 v4,13,v4
v_and_b32 v5,31,v1
v_and_b32 v7,1,v2
v_lshlrev_b32 v7,3,v7
v_xor_b32 v5,v5,v7
v_add_u32 v6,0,v3
v_and_b32 v6,3,v6
v_lshlrev_b32 v6,1,v6
v_xor_b32 v6,v6,v5
v_lshlrev_b32 v6,4,v6
v_add_u32 v6,v6,v4
v_add_u32 v26,0,v6
v_add_u32 v6,2,v3
v_and_b32 v6,3,v6
v_lshlrev_b32 v6,1,v6
v_xor_b32 v6,v6,v5
v_lshlrev_b32 v6,4,v6
v_add_u32 v6,v6,v4
v_add_u32 v27,15360,v6
v_add_u32 v6,4,v3
v_and_b32 v6,3,v6
v_lshlrev_b32 v6,1,v6
v_xor_b32 v6,v6,v5
v_lshlrev_b32 v6,4,v6
v_add_u32 v6,v6,v4
v_add_u32 v28,30720,v6
v_add_u32 v6,6,v3
v_and_b32 v6,3,v6
v_lshlrev_b32 v6,1,v6
v_xor_b32 v6,v6,v5
v_lshlrev_b32 v6,4,v6
v_add_u32 v6,v6,v4
v_add_u32 v29,46080,v6
WT lgkmcnt(0)
s_mov_b32 s60,s54
s_mov_b32 s61,s55
s_mov_b32 s62,1835008
s_mov_b32 s63,0x20000
BL v[196:199],v192,s[60:63],0 offen
BL v[200:203],v193,s[60:63],0 offen
s_lshl_b32 s29,s28,19
SA s8,s4,s29
s_addc_u32 s9,s5,0
s_mov_b32 s10,524288
s_mov_b32 s11,0x20000
s_cmp_eq_u32 s26,0
s_cselect_b32 s30,s32,s34
s_cselect_b32 s31,s33,s35
s_lshl_b32 s29,s27,9
SA s12,s30,s29
s_addc_u32 s13,s31,0
s_mov_b32 s14,8388608
s_mov_b32 s15,0x20000
s_sub_u32 s14,s14,s29
s_lshl_b32 s23,s20,12
s_mov_b32 s21,0
s_mov_b32 s22,0
SA m0,s23,0
s_mov_b32 s21,0
BL v22,s[8:11],s21 offen lds
BL v23,s[8:11],s21 offen offset:1024 lds
BL v24,s[8:11],s21 offen offset:2048 lds
BL v25,s[8:11],s21 offen offset:3072 lds
SA m0,s23,16384
s_mov_b32 s21,262144
BL v22,s[8:11],s21 offen lds
BL v23,s[8:11],s21 offen offset:1024 lds
BL v24,s[8:11],s21 offen offset:2048 lds
BL v25,s[8:11],s21 offen offset:3072 lds
SA m0,s23,98304
s_mov_b32 s22,0
BL v26,s[12:15],s22 offen nt lds
BL v27,s[12:15],s22 offen offset:1024 nt lds
BL v28,s[12:15],s22 offen offset:2048 nt lds
BL v29,s[12:15],s22 offen offset:3072 nt lds
SA m0,s23,114688
s_mov_b32 s22,262144
BL v26,s[12:15],s22 offen nt lds
BL v27,s[12:15],s22 offen offset:1024 nt lds
BL v28,s[12:15],s22 offen offset:2048 nt lds
BL v29,s[12:15],s22 offen offset:3072 nt lds
SA m0,s23,32768
s_mov_b32 s21,128
BL v22,s[8:11],s21 offen lds
BL v23,s[8:11],s21 offen offset:1024 lds
BL v24,s[8:11],s21 offen offset:2048 lds
BL v25,s[8:11],s21 offen offset:3072 lds
SA m0,s23,49152
s_mov_b32 s21,262272
BL v22,s[8:11],s21 offen lds
BL v23,s[8:11],s21 offen offset:1024 lds
BL v24,s[8:11],s21 offen offset:2048 lds
BL v25,s[8:11],s21 offen offset:3072 lds
SA m0,s23,131072
s_mov_b32 s22,524288
BL v26,s[12:15],s22 offen nt lds
BL v27,s[12:15],s22 offen offset:1024 nt lds
BL v28,s[12:15],s22 offen offset:2048 nt lds
BL v29,s[12:15],s22 offen offset:3072 nt lds
s_lshl_b32 s29,s26,24
s_lshl_b32 s30,s27,20
SA s29,s29,s30
SA s16,s52,s29
s_addc_u32 s17,s53,0
s_mov_b32 s18,1048576
s_mov_b32 s19,0x20000
s_mul_i32 s29,s51,114688
SA s29,s29,50331648
SA s36,s52,s29
s_addc_u32 s37,s53,0
s_mov_b32 s38,114688
s_mov_b32 s39,0x20000
s_lshl_b32 s29,s50,9
SA s40,s6,s29
s_addc_u32 s41,s7,0
s_mov_b32 s42,3670016
s_mov_b32 s43,0x20000
s_sub_u32 s42,s42,s29
s_lshl_b32 s29,s50,20
SA s29,s29,33554432
SA s44,s52,s29
s_addc_u32 s45,s53,0
s_mov_b32 s46,1048576
s_mov_b32 s47,0x20000
v_and_b32 v3,15,v1
v_lshrrev_b32 v4,4,v1
v_bfe_u32 v5,v1,1,3
v_xor_b32 v4,v4,v5
v_lshrrev_b32 v6,7,v0
v_lshlrev_b32 v6,7,v6
v_add_u32 v3,v3,v6
v_lshlrev_b32 v3,7,v3
v_xor_b32 v5,0,v4
v_lshlrev_b32 v5,4,v5
v_add_u32 v10,v3,v5
v_add_u32 v11,0x10000,v10
v_xor_b32 v5,4,v4
v_lshlrev_b32 v5,4,v5
v_add_u32 v12,v3,v5
v_add_u32 v13,0x10000,v12
v_bfe_u32 v3,v1,2,2
v_lshrrev_b32 v4,4,v1
v_lshlrev_b32 v5,3,v4
v_add_u32 v5,v5,v3
v_lshlrev_b32 v5,9,v5
v_and_b32 v4,1,v4
v_lshlrev_b32 v4,2,v4
v_or_b32 v3,v3,v4
v_and_b32 v6,3,v1
v_lshlrev_b32 v6,3,v6
v_add_u32 v5,v5,v6
v_bfe_u32 v6,v0,6,1
v_lshlrev_b32 v6,8,v6
v_add_u32 v5,v5,v6
v_add_u32 v5,98304,v5
v_xor_b32 v6,0,v3
v_lshlrev_b32 v6,5,v6
v_add_u32 v14,v5,v6
v_subrev_u32 v40,0x10000,v14
v_xor_b32 v6,1,v3
v_lshlrev_b32 v6,5,v6
v_add_u32 v15,v5,v6
v_subrev_u32 v41,0x10000,v15
v_xor_b32 v6,2,v3
v_lshlrev_b32 v6,5,v6
v_add_u32 v16,v5,v6
v_subrev_u32 v42,0x10000,v16
v_xor_b32 v6,3,v3
v_lshlrev_b32 v6,5,v6
v_add_u32 v17,v5,v6
v_subrev_u32 v43,0x10000,v17
v_xor_b32 v6,4,v3
v_lshlrev_b32 v6,5,v6
v_add_u32 v18,v5,v6
v_subrev_u32 v44,0x10000,v18
v_xor_b32 v6,5,v3
v_lshlrev_b32 v6,5,v6
v_add_u32 v19,v5,v6
v_subrev_u32 v45,0x10000,v19
v_xor_b32 v6,6,v3
v_lshlrev_b32 v6,5,v6
v_add_u32 v20,v5,v6
v_subrev_u32 v46,0x10000,v20
v_xor_b32 v6,7,v3
v_lshlrev_b32 v6,5,v6
v_add_u32 v21,v5,v6
v_subrev_u32 v47,0x10000,v21
SA s64,s52,50331648
s_addc_u32 s65,s53,0
s_mov_b32 s66,1835008
s_mov_b32 s67,0x20000
s_mov_b32 s68,s56
s_mov_b32 s69,s57
s_mov_b32 s70,256
s_mov_b32 s71,0x20000
s_lshr_b32 s29,s2,3
s_and_b32 s29,s29,3
s_lshl_b32 s29,s29,6
s_lshl_b32 s30,s20,4
SA s29,s29,s30
v_and_b32 v3,15,v1
v_add_u32 v3,s29,v3
v_lshlrev_b32 v3,11,v3
v_lshrrev_b32 v4,4,v1
v_lshlrev_b32 v4,5,v4
v_add_u32 v48,v3,v4
s_lshl_b32 s29,s28,3
s_lshl_b32 s30,s20,1
SA s29,s29,s30
v_bfe_u32 v3,v1,4,1
v_add_u32 v3,s29,v3
v_lshlrev_b32 v3,13,v3
v_and_b32 v4,15,v1
v_lshlrev_b32 v4,5,v4
v_add_u32 v49,v3,v4
s_lshr_b32 s29,s2,3
s_mul_i32 s30,s20,56
v_min_u32 v3,55,v1
v_add_u32 v3,s30,v3
v_lshrrev_b32 v4,4,v3
s_mul_i32 s30,s29,14
v_add_u32 v4,s30,v4
v_lshlrev_b32 v4,13,v4
v_and_b32 v3,15,v3
v_lshlrev_b32 v3,6,v3
v_add_u32 v4,v4,v3
s_and_b32 s30,s50,1
s_lshl_b32 s30,s30,9
v_subrev_u32 v4,s30,v4
v_max_i32 v34,0,v4
s_mul_i32 s30,s29,448
s_mul_i32 s31,s20,112
SA s30,s30,s31
v_add_u32 v3,s30,v1
v_lshlrev_b32 v35,7,v3
v_min_u32 v4,47,v1
v_add_u32 v4,64,v4
v_add_u32 v4,s30,v4
v_lshlrev_b32 v36,7,v4
WT vmcnt(16)
s_barrier
DR v[64:67],v10 offset:0
DT v[128:129],v14 offset:0
DT v[130:131],v14 offset:2048
DT v[132:133],v15 offset:0
DT v[134:135],v15 offset:2048
DT v[136:137],v16 offset:0
DT v[138:139],v16 offset:2048
DT v[140:141],v17 offset:0
DT v[142:143],v17 offset:2048
DT v[144:145],v18 offset:0
DT v[146:147],v18 offset:2048
DT v[148:149],v19 offset:0
DT v[150:151],v19 offset:2048
DT v[152:153],v20 offset:0
DT v[154:155],v20 offset:2048
DT v[156:157],v21 offset:0
DT v[158:159],v21 offset:2048
DR v[68:71],v10 offset:2048
DR v[72:75],v10 offset:4096
DR v[76:79],v10 offset:6144
DR v[80:83],v10 offset:8192
DR v[84:87],v10 offset:10240
DR v[88:91],v10 offset:12288
DR v[92:95],v10 offset:14336
s_cmp_eq_u32 s26,0
s_cbranch_scc0 k1_kernel_v
k1_kernel_k0:
WT vmcnt(12) lgkmcnt(0)
s_barrier
MF a[0:3],v[128:131],v[64:67],0
DR v[96:99],v12 offset:0
MF a[4:7],v[132:135],v[64:67],0
MF a[8:11],v[136:139],v[64:67],0
DT v[160:161],v14 offset:16384
MF a[12:15],v[140:143],v[64:67],0
MF a[16:19],v[144:147],v[64:67],0
DT v[162:163],v14 offset:18432
MF a[20:23],v[148:151],v[64:67],0
SA m0,s23,147456
s_mov_b32 s22,786432
BL v26,s[12:15],s22 offen nt lds
MF a[24:27],v[152:155],v[64:67],0
DT v[164:165],v15 offset:16384
MF a[28:31],v[156:159],v[64:67],0
MF a[32:35],v[128:131],v[68:71],0
DT v[166:167],v15 offset:18432
MF a[36:39],v[132:135],v[68:71],0
MF a[40:43],v[136:139],v[68:71],0
DT v[168:169],v16 offset:16384
MF a[44:47],v[140:143],v[68:71],0
BL v27,s[12:15],s22 offen offset:1024 nt lds
MF a[48:51],v[144:147],v[68:71],0
DT v[170:171],v16 offset:18432
MF a[52:55],v[148:151],v[68:71],0
MF a[56:59],v[152:155],v[68:71],0
DT v[172:173],v17 offset:16384
MF a[60:63],v[156:159],v[68:71],0
MF a[64:67],v[128:131],v[72:75],0
DT v[174:175],v17 offset:18432
MF a[68:71],v[132:135],v[72:75],0
BL v28,s[12:15],s22 offen offset:2048 nt lds
MF a[72:75],v[136:139],v[72:75],0
DT v[176:177],v18 offset:16384
MF a[76:79],v[140:143],v[72:75],0
MF a[80:83],v[144:147],v[72:75],0
DT v[178:179],v18 offset:18432
MF a[84:87],v[148:151],v[72:75],0
MF a[88:91],v[152:155],v[72:75],0
DT v[180:181],v19 offset:16384
MF a[92:95],v[156:159],v[72:75],0
BL v29,s[12:15],s22 offen offset:3072 nt lds
MF a[96:99],v[128:131],v[76:79],0
DT v[182:183],v19 offset:18432
MF a[100:103],v[132:135],v[76:79],0
MF a[104:107],v[136:139],v[76:79],0
DT v[184:185],v20 offset:16384
MF a[108:111],v[140:143],v[76:79],0
MF a[112:115],v[144:147],v[76:79],0
DT v[186:187],v20 offset:18432
MF a[116:119],v[148:151],v[76:79],0
SA m0,s23,65536
s_mov_b32 s21,256
BL v22,s[8:11],s21 offen lds
MF a[120:123],v[152:155],v[76:79],0
DT v[188:189],v21 offset:16384
MF a[124:127],v[156:159],v[76:79],0
MF a[128:131],v[128:131],v[80:83],0
DT v[190:191],v21 offset:18432
MF a[132:135],v[132:135],v[80:83],0
MF a[136:139],v[136:139],v[80:83],0
DR v[100:103],v12 offset:2048
MF a[140:143],v[140:143],v[80:83],0
BL v23,s[8:11],s21 offen offset:1024 lds
MF a[144:147],v[144:147],v[80:83],0
DR v[104:107],v12 offset:4096
MF a[148:151],v[148:151],v[80:83],0
MF a[152:155],v[152:155],v[80:83],0
DR v[108:111],v12 offset:6144
MF a[156:159],v[156:159],v[80:83],0
MF a[160:163],v[128:131],v[84:87],0
DR v[112:115],v12 offset:8192
MF a[164:167],v[132:135],v[84:87],0
BL v24,s[8:11],s21 offen offset:2048 lds
MF a[168:171],v[136:139],v[84:87],0
DR v[116:119],v12 offset:10240
MF a[172:175],v[140:143],v[84:87],0
MF a[176:179],v[144:147],v[84:87],0
DR v[120:123],v12 offset:12288
MF a[180:183],v[148:151],v[84:87],0
MF a[184:187],v[152:155],v[84:87],0
DR v[124:127],v12 offset:14336
MF a[188:191],v[156:159],v[84:87],0
BL v25,s[8:11],s21 offen offset:3072 lds
MF a[192:195],v[128:131],v[88:91],0
MF a[196:199],v[132:135],v[88:91],0
MF a[200:203],v[136:139],v[88:91],0
MF a[204:207],v[140:143],v[88:91],0
SA m0,s23,81920
s_mov_b32 s21,262400
BL v22,s[8:11],s21 offen lds
MF a[208:211],v[144:147],v[88:91],0
MF a[212:215],v[148:151],v[88:91],0
MF a[216:219],v[152:155],v[88:91],0
MF a[220:223],v[156:159],v[88:91],0
BL v23,s[8:11],s21 offen offset:1024 lds
MF a[224:227],v[128:131],v[92:95],0
MF a[228:231],v[132:135],v[92:95],0
MF a[232:235],v[136:139],v[92:95],0
MF a[236:239],v[140:143],v[92:95],0
BL v24,s[8:11],s21 offen offset:2048 lds
MF a[240:243],v[144:147],v[92:95],0
MF a[244:247],v[148:151],v[92:95],0
MF a[248:251],v[152:155],v[92:95],0
MF a[252:255],v[156:159],v[92:95],0
BL v25,s[8:11],s21 offen offset:3072 lds
WT vmcnt(12) lgkmcnt(0)
s_barrier
MF a[0:3],v[160:163],v[96:99],a[0:3]
DR v[64:67],v10 offset:32768
MF a[4:7],v[164:167],v[96:99],a[4:7]
MF a[8:11],v[168:171],v[96:99],a[8:11]
DT v[128:129],v14 offset:32768
MF a[12:15],v[172:175],v[96:99],a[12:15]
MF a[16:19],v[176:179],v[96:99],a[16:19]
DT v[130:131],v14 offset:34816
MF a[20:23],v[180:183],v[96:99],a[20:23]
SA m0,s23,98304
s_mov_b32 s22,1048576
BL v26,s[12:15],s22 offen nt lds
MF a[24:27],v[184:187],v[96:99],a[24:27]
DT v[132:133],v15 offset:32768
MF a[28:31],v[188:191],v[96:99],a[28:31]
MF a[32:35],v[160:163],v[100:103],a[32:35]
DT v[134:135],v15 offset:34816
MF a[36:39],v[164:167],v[100:103],a[36:39]
MF a[40:43],v[168:171],v[100:103],a[40:43]
DT v[136:137],v16 offset:32768
MF a[44:47],v[172:175],v[100:103],a[44:47]
BL v27,s[12:15],s22 offen offset:1024 nt lds
MF a[48:51],v[176:179],v[100:103],a[48:51]
DT v[138:139],v16 offset:34816
MF a[52:55],v[180:183],v[100:103],a[52:55]
MF a[56:59],v[184:187],v[100:103],a[56:59]
DT v[140:141],v17 offset:32768
MF a[60:63],v[188:191],v[100:103],a[60:63]
MF a[64:67],v[160:163],v[104:107],a[64:67]
DT v[142:143],v17 offset:34816
MF a[68:71],v[164:167],v[104:107],a[68:71]
BL v28,s[12:15],s22 offen offset:2048 nt lds
MF a[72:75],v[168:171],v[104:107],a[72:75]
DT v[144:145],v18 offset:32768
MF a[76:79],v[172:175],v[104:107],a[76:79]
MF a[80:83],v[176:179],v[104:107],a[80:83]
DT v[146:147],v18 offset:34816
MF a[84:87],v[180:183],v[104:107],a[84:87]
MF a[88:91],v[184:187],v[104:107],a[88:91]
DT v[148:149],v19 offset:32768
MF a[92:95],v[188:191],v[104:107],a[92:95]
BL v29,s[12:15],s22 offen offset:3072 nt lds
MF a[96:99],v[160:163],v[108:111],a[96:99]
DT v[150:151],v19 offset:34816
MF a[100:103],v[164:167],v[108:111],a[100:103]
MF a[104:107],v[168:171],v[108:111],a[104:107]
DT v[152:153],v20 offset:32768
MF a[108:111],v[172:175],v[108:111],a[108:111]
MF a[112:115],v[176:179],v[108:111],a[112:115]
DT v[154:155],v20 offset:34816
MF a[116:119],v[180:183],v[108:111],a[116:119]
SA m0,s23,114688
s_mov_b32 s22,1310720
BL v26,s[12:15],s22 offen nt lds
MF a[120:123],v[184:187],v[108:111],a[120:123]
DT v[156:157],v21 offset:32768
MF a[124:127],v[188:191],v[108:111],a[124:127]
MF a[128:131],v[160:163],v[112:115],a[128:131]
DT v[158:159],v21 offset:34816
MF a[132:135],v[164:167],v[112:115],a[132:135]
MF a[136:139],v[168:171],v[112:115],a[136:139]
DR v[68:71],v10 offset:34816
MF a[140:143],v[172:175],v[112:115],a[140:143]
BL v27,s[12:15],s22 offen offset:1024 nt lds
MF a[144:147],v[176:179],v[112:115],a[144:147]
DR v[72:75],v10 offset:36864
MF a[148:151],v[180:183],v[112:115],a[148:151]
MF a[152:155],v[184:187],v[112:115],a[152:155]
DR v[76:79],v10 offset:38912
MF a[156:159],v[188:191],v[112:115],a[156:159]
MF a[160:163],v[160:163],v[116:119],a[160:163]
DR v[80:83],v10 offset:40960
MF a[164:167],v[164:167],v[116:119],a[164:167]
BL v28,s[12:15],s22 offen offset:2048 nt lds
MF a[168:171],v[168:171],v[116:119],a[168:171]
DR v[84:87],v10 offset:43008
MF a[172:175],v[172:175],v[116:119],a[172:175]
MF a[176:179],v[176:179],v[116:119],a[176:179]
DR v[88:91],v10 offset:45056
MF a[180:183],v[180:183],v[116:119],a[180:183]
MF a[184:187],v[184:187],v[116:119],a[184:187]
DR v[92:95],v10 offset:47104
MF a[188:191],v[188:191],v[116:119],a[188:191]
BL v29,s[12:15],s22 offen offset:3072 nt lds
MF a[192:195],v[160:163],v[120:123],a[192:195]
MF a[196:199],v[164:167],v[120:123],a[196:199]
MF a[200:203],v[168:171],v[120:123],a[200:203]
MF a[204:207],v[172:175],v[120:123],a[204:207]
SA m0,s23,0
s_mov_b32 s21,384
BL v22,s[8:11],s21 offen lds
MF a[208:211],v[176:179],v[120:123],a[208:211]
MF a[212:215],v[180:183],v[120:123],a[212:215]
MF a[216:219],v[184:187],v[120:123],a[216:219]
MF a[220:223],v[188:191],v[120:123],a[220:223]
BL v23,s[8:11],s21 offen offset:1024 lds
MF a[224:227],v[160:163],v[124:127],a[224:227]
MF a[228:231],v[164:167],v[124:127],a[228:231]
MF a[232:235],v[168:171],v[124:127],a[232:235]
MF a[236:239],v[172:175],v[124:127],a[236:239]
BL v24,s[8:11],s21 offen offset:2048 lds
MF a[240:243],v[176:179],v[124:127],a[240:243]
MF a[244:247],v[180:183],v[124:127],a[244:247]
MF a[248:251],v[184:187],v[124:127],a[248:251]
MF a[252:255],v[188:191],v[124:127],a[252:255]
BL v25,s[8:11],s21 offen offset:3072 lds
WT vmcnt(20) lgkmcnt(0)
s_barrier
MF a[0:3],v[128:131],v[64:67],a[0:3]
DR v[96:99],v12 offset:32768
MF a[4:7],v[132:135],v[64:67],a[4:7]
MF a[8:11],v[136:139],v[64:67],a[8:11]
DT v[160:161],v14 offset:49152
MF a[12:15],v[140:143],v[64:67],a[12:15]
MF a[16:19],v[144:147],v[64:67],a[16:19]
DT v[162:163],v14 offset:51200
MF a[20:23],v[148:151],v[64:67],a[20:23]
SA m0,s23,131072
s_mov_b32 s22,1572864
BL v26,s[12:15],s22 offen nt lds
MF a[24:27],v[152:155],v[64:67],a[24:27]
DT v[164:165],v15 offset:49152
MF a[28:31],v[156:159],v[64:67],a[28:31]
MF a[32:35],v[128:131],v[68:71],a[32:35]
DT v[166:167],v15 offset:51200
MF a[36:39],v[132:135],v[68:71],a[36:39]
MF a[40:43],v[136:139],v[68:71],a[40:43]
DT v[168:169],v16 offset:49152
MF a[44:47],v[140:143],v[68:71],a[44:47]
BL v27,s[12:15],s22 offen offset:1024 nt lds
MF a[48:51],v[144:147],v[68:71],a[48:51]
DT v[170:171],v16 offset:51200
MF a[52:55],v[148:151],v[68:71],a[52:55]
MF a[56:59],v[152:155],v[68:71],a[56:59]
DT v[172:173],v17 offset:49152
MF a[60:63],v[156:159],v[68:71],a[60:63]
MF a[64:67],v[128:131],v[72:75],a[64:67]
DT v[174:175],v17 offset:51200
MF a[68:71],v[132:135],v[72:75],a[68:71]
BL v28,s[12:15],s22 offen offset:2048 nt lds
MF a[72:75],v[136:139],v[72:75],a[72:75]
DT v[176:177],v18 offset:49152
MF a[76:79],v[140:143],v[72:75],a[76:79]
MF a[80:83],v[144:147],v[72:75],a[80:83]
DT v[178:179],v18 offset:51200
MF a[84:87],v[148:151],v[72:75],a[84:87]
MF a[88:91],v[152:155],v[72:75],a[88:91]
DT v[180:181],v19 offset:49152
MF a[92:95],v[156:159],v[72:75],a[92:95]
BL v29,s[12:15],s22 offen offset:3072 nt lds
MF a[96:99],v[128:131],v[76:79],a[96:99]
DT v[182:183],v19 offset:51200
MF a[100:103],v[132:135],v[76:79],a[100:103]
MF a[104:107],v[136:139],v[76:79],a[104:107]
DT v[184:185],v20 offset:49152
MF a[108:111],v[140:143],v[76:79],a[108:111]
MF a[112:115],v[144:147],v[76:79],a[112:115]
DT v[186:187],v20 offset:51200
MF a[116:119],v[148:151],v[76:79],a[116:119]
SA m0,s23,16384
s_mov_b32 s21,262528
BL v22,s[8:11],s21 offen lds
MF a[120:123],v[152:155],v[76:79],a[120:123]
DT v[188:189],v21 offset:49152
MF a[124:127],v[156:159],v[76:79],a[124:127]
MF a[128:131],v[128:131],v[80:83],a[128:131]
DT v[190:191],v21 offset:51200
MF a[132:135],v[132:135],v[80:83],a[132:135]
MF a[136:139],v[136:139],v[80:83],a[136:139]
DR v[100:103],v12 offset:34816
MF a[140:143],v[140:143],v[80:83],a[140:143]
BL v23,s[8:11],s21 offen offset:1024 lds
MF a[144:147],v[144:147],v[80:83],a[144:147]
DR v[104:107],v12 offset:36864
MF a[148:151],v[148:151],v[80:83],a[148:151]
MF a[152:155],v[152:155],v[80:83],a[152:155]
DR v[108:111],v12 offset:38912
MF a[156:159],v[156:159],v[80:83],a[156:159]
MF a[160:163],v[128:131],v[84:87],a[160:163]
DR v[112:115],v12 offset:40960
MF a[164:167],v[132:135],v[84:87],a[164:167]
BL v24,s[8:11],s21 offen offset:2048 lds
MF a[168:171],v[136:139],v[84:87],a[168:171]
DR v[116:119],v12 offset:43008
MF a[172:175],v[140:143],v[84:87],a[172:175]
MF a[176:179],v[144:147],v[84:87],a[176:179]
DR v[120:123],v12 offset:45056
MF a[180:183],v[148:151],v[84:87],a[180:183]
MF a[184:187],v[152:155],v[84:87],a[184:187]
DR v[124:127],v12 offset:47104
MF a[188:191],v[156:159],v[84:87],a[188:191]
BL v25,s[8:11],s21 offen offset:3072 lds
MF a[192:195],v[128:131],v[88:91],a[192:195]
MF a[196:199],v[132:135],v[88:91],a[196:199]
MF a[200:203],v[136:139],v[88:91],a[200:203]
MF a[204:207],v[140:143],v[88:91],a[204:207]
MF a[208:211],v[144:147],v[88:91],a[208:211]
MF a[212:215],v[148:151],v[88:91],a[212:215]
MF a[216:219],v[152:155],v[88:91],a[216:219]
MF a[220:223],v[156:159],v[88:91],a[220:223]
MF a[224:227],v[128:131],v[92:95],a[224:227]
MF a[228:231],v[132:135],v[92:95],a[228:231]
MF a[232:235],v[136:139],v[92:95],a[232:235]
MF a[236:239],v[140:143],v[92:95],a[236:239]
MF a[240:243],v[144:147],v[92:95],a[240:243]
MF a[244:247],v[148:151],v[92:95],a[244:247]
MF a[248:251],v[152:155],v[92:95],a[248:251]
MF a[252:255],v[156:159],v[92:95],a[252:255]
WT vmcnt(16) lgkmcnt(0)
s_barrier
MF a[0:3],v[160:163],v[96:99],a[0:3]
DR v[64:67],v11 offset:0
MF a[4:7],v[164:167],v[96:99],a[4:7]
MF a[8:11],v[168:171],v[96:99],a[8:11]
DT v[128:129],v14 offset:0
MF a[12:15],v[172:175],v[96:99],a[12:15]
MF a[16:19],v[176:179],v[96:99],a[16:19]
DT v[130:131],v14 offset:2048
MF a[20:23],v[180:183],v[96:99],a[20:23]
SA m0,s23,147456
s_mov_b32 s22,1835008
BL v26,s[12:15],s22 offen nt lds
MF a[24:27],v[184:187],v[96:99],a[24:27]
DT v[132:133],v15 offset:0
MF a[28:31],v[188:191],v[96:99],a[28:31]
MF a[32:35],v[160:163],v[100:103],a[32:35]
DT v[134:135],v15 offset:2048
MF a[36:39],v[164:167],v[100:103],a[36:39]
MF a[40:43],v[168:171],v[100:103],a[40:43]
DT v[136:137],v16 offset:0
MF a[44:47],v[172:175],v[100:103],a[44:47]
BL v27,s[12:15],s22 offen offset:1024 nt lds
MF a[48:51],v[176:179],v[100:103],a[48:51]
DT v[138:139],v16 offset:2048
MF a[52:55],v[180:183],v[100:103],a[52:55]
MF a[56:59],v[184:187],v[100:103],a[56:59]
DT v[140:141],v17 offset:0
MF a[60:63],v[188:191],v[100:103],a[60:63]
MF a[64:67],v[160:163],v[104:107],a[64:67]
DT v[142:143],v17 offset:2048
MF a[68:71],v[164:167],v[104:107],a[68:71]
BL v28,s[12:15],s22 offen offset:2048 nt lds
MF a[72:75],v[168:171],v[104:107],a[72:75]
DT v[144:145],v18 offset:0
MF a[76:79],v[172:175],v[104:107],a[76:79]
MF a[80:83],v[176:179],v[104:107],a[80:83]
DT v[146:147],v18 offset:2048
MF a[84:87],v[180:183],v[104:107],a[84:87]
MF a[88:91],v[184:187],v[104:107],a[88:91]
DT v[148:149],v19 offset:0
MF a[92:95],v[188:191],v[104:107],a[92:95]
BL v29,s[12:15],s22 offen offset:3072 nt lds
MF a[96:99],v[160:163],v[108:111],a[96:99]
DT v[150:151],v19 offset:2048
MF a[100:103],v[164:167],v[108:111],a[100:103]
MF a[104:107],v[168:171],v[108:111],a[104:107]
DT v[152:153],v20 offset:0
MF a[108:111],v[172:175],v[108:111],a[108:111]
MF a[112:115],v[176:179],v[108:111],a[112:115]
DT v[154:155],v20 offset:2048
MF a[116:119],v[180:183],v[108:111],a[116:119]
SA m0,s23,32768
s_mov_b32 s21,512
BL v22,s[8:11],s21 offen lds
MF a[120:123],v[184:187],v[108:111],a[120:123]
DT v[156:157],v21 offset:0
MF a[124:127],v[188:191],v[108:111],a[124:127]
MF a[128:131],v[160:163],v[112:115],a[128:131]
DT v[158:159],v21 offset:2048
MF a[132:135],v[164:167],v[112:115],a[132:135]
MF a[136:139],v[168:171],v[112:115],a[136:139]
DR v[68:71],v11 offset:2048
MF a[140:143],v[172:175],v[112:115],a[140:143]
BL v23,s[8:11],s21 offen offset:1024 lds
MF a[144:147],v[176:179],v[112:115],a[144:147]
DR v[72:75],v11 offset:4096
MF a[148:151],v[180:183],v[112:115],a[148:151]
MF a[152:155],v[184:187],v[112:115],a[152:155]
DR v[76:79],v11 offset:6144
MF a[156:159],v[188:191],v[112:115],a[156:159]
MF a[160:163],v[160:163],v[116:119],a[160:163]
DR v[80:83],v11 offset:8192
MF a[164:167],v[164:167],v[116:119],a[164:167]
BL v24,s[8:11],s21 offen offset:2048 lds
MF a[168:171],v[168:171],v[116:119],a[168:171]
DR v[84:87],v11 offset:10240
MF a[172:175],v[172:175],v[116:119],a[172:175]
MF a[176:179],v[176:179],v[116:119],a[176:179]
DR v[88:91],v11 offset:12288
MF a[180:183],v[180:183],v[116:119],a[180:183]
MF a[184:187],v[184:187],v[116:119],a[184:187]
DR v[92:95],v11 offset:14336
MF a[188:191],v[188:191],v[116:119],a[188:191]
BL v25,s[8:11],s21 offen offset:3072 lds
MF a[192:195],v[160:163],v[120:123],a[192:195]
MF a[196:199],v[164:167],v[120:123],a[196:199]
MF a[200:203],v[168:171],v[120:123],a[200:203]
MF a[204:207],v[172:175],v[120:123],a[204:207]
MF a[208:211],v[176:179],v[120:123],a[208:211]
MF a[212:215],v[180:183],v[120:123],a[212:215]
MF a[216:219],v[184:187],v[120:123],a[216:219]
MF a[220:223],v[188:191],v[120:123],a[220:223]
MF a[224:227],v[160:163],v[124:127],a[224:227]
MF a[228:231],v[164:167],v[124:127],a[228:231]
MF a[232:235],v[168:171],v[124:127],a[232:235]
MF a[236:239],v[172:175],v[124:127],a[236:239]
MF a[240:243],v[176:179],v[124:127],a[240:243]
MF a[244:247],v[180:183],v[124:127],a[244:247]
MF a[248:251],v[184:187],v[124:127],a[248:251]
MF a[252:255],v[188:191],v[124:127],a[252:255]
WT vmcnt(20) lgkmcnt(0)
s_barrier
MF a[0:3],v[128:131],v[64:67],a[0:3]
DR v[96:99],v13 offset:0
MF a[4:7],v[132:135],v[64:67],a[4:7]
MF a[8:11],v[136:139],v[64:67],a[8:11]
DT v[160:161],v14 offset:16384
MF a[12:15],v[140:143],v[64:67],a[12:15]
MF a[16:19],v[144:147],v[64:67],a[16:19]
DT v[162:163],v14 offset:18432
MF a[20:23],v[148:151],v[64:67],a[20:23]
SA m0,s23,98304
s_mov_b32 s22,2097152
BL v26,s[12:15],s22 offen nt lds
MF a[24:27],v[152:155],v[64:67],a[24:27]
DT v[164:165],v15 offset:16384
MF a[28:31],v[156:159],v[64:67],a[28:31]
MF a[32:35],v[128:131],v[68:71],a[32:35]
DT v[166:167],v15 offset:18432
MF a[36:39],v[132:135],v[68:71],a[36:39]
MF a[40:43],v[136:139],v[68:71],a[40:43]
DT v[168:169],v16 offset:16384
MF a[44:47],v[140:143],v[68:71],a[44:47]
BL v27,s[12:15],s22 offen offset:1024 nt lds
MF a[48:51],v[144:147],v[68:71],a[48:51]
DT v[170:171],v16 offset:18432
MF a[52:55],v[148:151],v[68:71],a[52:55]
MF a[56:59],v[152:155],v[68:71],a[56:59]
DT v[172:173],v17 offset:16384
MF a[60:63],v[156:159],v[68:71],a[60:63]
MF a[64:67],v[128:131],v[72:75],a[64:67]
DT v[174:175],v17 offset:18432
MF a[68:71],v[132:135],v[72:75],a[68:71]
BL v28,s[12:15],s22 offen offset:2048 nt lds
MF a[72:75],v[136:139],v[72:75],a[72:75]
DT v[176:177],v18 offset:16384
MF a[76:79],v[140:143],v[72:75],a[76:79]
MF a[80:83],v[144:147],v[72:75],a[80:83]
DT v[178:179],v18 offset:18432
MF a[84:87],v[148:151],v[72:75],a[84:87]
MF a[88:91],v[152:155],v[72:75],a[88:91]
DT v[180:181],v19 offset:16384
MF a[92:95],v[156:159],v[72:75],a[92:95]
BL v29,s[12:15],s22 offen offset:3072 nt lds
MF a[96:99],v[128:131],v[76:79],a[96:99]
DT v[182:183],v19 offset:18432
MF a[100:103],v[132:135],v[76:79],a[100:103]
MF a[104:107],v[136:139],v[76:79],a[104:107]
DT v[184:185],v20 offset:16384
MF a[108:111],v[140:143],v[76:79],a[108:111]
MF a[112:115],v[144:147],v[76:79],a[112:115]
DT v[186:187],v20 offset:18432
MF a[116:119],v[148:151],v[76:79],a[116:119]
SA m0,s23,49152
s_mov_b32 s21,262656
BL v22,s[8:11],s21 offen lds
MF a[120:123],v[152:155],v[76:79],a[120:123]
DT v[188:189],v21 offset:16384
MF a[124:127],v[156:159],v[76:79],a[124:127]
MF a[128:131],v[128:131],v[80:83],a[128:131]
DT v[190:191],v21 offset:18432
MF a[132:135],v[132:135],v[80:83],a[132:135]
MF a[136:139],v[136:139],v[80:83],a[136:139]
DR v[100:103],v13 offset:2048
MF a[140:143],v[140:143],v[80:83],a[140:143]
BL v23,s[8:11],s21 offen offset:1024 lds
MF a[144:147],v[144:147],v[80:83],a[144:147]
DR v[104:107],v13 offset:4096
MF a[148:151],v[148:151],v[80:83],a[148:151]
MF a[152:155],v[152:155],v[80:83],a[152:155]
DR v[108:111],v13 offset:6144
MF a[156:159],v[156:159],v[80:83],a[156:159]
MF a[160:163],v[128:131],v[84:87],a[160:163]
DR v[112:115],v13 offset:8192
MF a[164:167],v[132:135],v[84:87],a[164:167]
BL v24,s[8:11],s21 offen offset:2048 lds
MF a[168:171],v[136:139],v[84:87],a[168:171]
DR v[116:119],v13 offset:10240
MF a[172:175],v[140:143],v[84:87],a[172:175]
MF a[176:179],v[144:147],v[84:87],a[176:179]
DR v[120:123],v13 offset:12288
MF a[180:183],v[148:151],v[84:87],a[180:183]
MF a[184:187],v[152:155],v[84:87],a[184:187]
DR v[124:127],v13 offset:14336
MF a[188:191],v[156:159],v[84:87],a[188:191]
BL v25,s[8:11],s21 offen offset:3072 lds
MF a[192:195],v[128:131],v[88:91],a[192:195]
MF a[196:199],v[132:135],v[88:91],a[196:199]
MF a[200:203],v[136:139],v[88:91],a[200:203]
MF a[204:207],v[140:143],v[88:91],a[204:207]
MF a[208:211],v[144:147],v[88:91],a[208:211]
MF a[212:215],v[148:151],v[88:91],a[212:215]
MF a[216:219],v[152:155],v[88:91],a[216:219]
MF a[220:223],v[156:159],v[88:91],a[220:223]
s_cmp_lg_u32 s20,0
s_cbranch_scc1 k1_kernel_k_nozero
SA s60,s52,125829120
s_addc_u32 s61,s53,0
s_mov_b32 s62,32768
s_mov_b32 s63,0x20000
s_lshl_b32 s30,s2,7
v_lshlrev_b32 v4,2,v1
v_mov_b32 v5,0
s_mov_b32 exec_hi,0
buffer_store_dword v5,v4,s[60:63],s30 offen
s_mov_b64 exec,-1
k1_kernel_k_nozero:
MF a[224:227],v[128:131],v[92:95],a[224:227]
MF a[228:231],v[132:135],v[92:95],a[228:231]
MF a[232:235],v[136:139],v[92:95],a[232:235]
MF a[236:239],v[140:143],v[92:95],a[236:239]
MF a[240:243],v[144:147],v[92:95],a[240:243]
MF a[244:247],v[148:151],v[92:95],a[244:247]
MF a[248:251],v[152:155],v[92:95],a[248:251]
MF a[252:255],v[156:159],v[92:95],a[252:255]
WT vmcnt(16) lgkmcnt(0)
s_barrier
MF a[0:3],v[160:163],v[96:99],a[0:3]
DR v[64:67],v10 offset:0
MF a[4:7],v[164:167],v[96:99],a[4:7]
MF a[8:11],v[168:171],v[96:99],a[8:11]
DT v[128:129],v14 offset:32768
MF a[12:15],v[172:175],v[96:99],a[12:15]
MF a[16:19],v[176:179],v[96:99],a[16:19]
DT v[130:131],v14 offset:34816
MF a[20:23],v[180:183],v[96:99],a[20:23]
SA m0,s23,114688
s_mov_b32 s22,2359296
BL v26,s[12:15],s22 offen nt lds
MF a[24:27],v[184:187],v[96:99],a[24:27]
DT v[132:133],v15 offset:32768
MF a[28:31],v[188:191],v[96:99],a[28:31]
MF a[32:35],v[160:163],v[100:103],a[32:35]
DT v[134:135],v15 offset:34816
MF a[36:39],v[164:167],v[100:103],a[36:39]
MF a[40:43],v[168:171],v[100:103],a[40:43]
DT v[136:137],v16 offset:32768
MF a[44:47],v[172:175],v[100:103],a[44:47]
BL v27,s[12:15],s22 offen offset:1024 nt lds
MF a[48:51],v[176:179],v[100:103],a[48:51]
DT v[138:139],v16 offset:34816
MF a[52:55],v[180:183],v[100:103],a[52:55]
MF a[56:59],v[184:187],v[100:103],a[56:59]
DT v[140:141],v17 offset:32768
MF a[60:63],v[188:191],v[100:103],a[60:63]
MF a[64:67],v[160:163],v[104:107],a[64:67]
DT v[142:143],v17 offset:34816
MF a[68:71],v[164:167],v[104:107],a[68:71]
BL v28,s[12:15],s22 offen offset:2048 nt lds
MF a[72:75],v[168:171],v[104:107],a[72:75]
DT v[144:145],v18 offset:32768
MF a[76:79],v[172:175],v[104:107],a[76:79]
MF a[80:83],v[176:179],v[104:107],a[80:83]
DT v[146:147],v18 offset:34816
MF a[84:87],v[180:183],v[104:107],a[84:87]
MF a[88:91],v[184:187],v[104:107],a[88:91]
DT v[148:149],v19 offset:32768
MF a[92:95],v[188:191],v[104:107],a[92:95]
BL v29,s[12:15],s22 offen offset:3072 nt lds
MF a[96:99],v[160:163],v[108:111],a[96:99]
DT v[150:151],v19 offset:34816
MF a[100:103],v[164:167],v[108:111],a[100:103]
MF a[104:107],v[168:171],v[108:111],a[104:107]
DT v[152:153],v20 offset:32768
MF a[108:111],v[172:175],v[108:111],a[108:111]
MF a[112:115],v[176:179],v[108:111],a[112:115]
DT v[154:155],v20 offset:34816
MF a[116:119],v[180:183],v[108:111],a[116:119]
SA m0,s23,65536
s_mov_b32 s21,640
BL v22,s[8:11],s21 offen lds
MF a[120:123],v[184:187],v[108:111],a[120:123]
DT v[156:157],v21 offset:32768
MF a[124:127],v[188:191],v[108:111],a[124:127]
MF a[128:131],v[160:163],v[112:115],a[128:131]
DT v[158:159],v21 offset:34816
MF a[132:135],v[164:167],v[112:115],a[132:135]
MF a[136:139],v[168:171],v[112:115],a[136:139]
DR v[68:71],v10 offset:2048
MF a[140:143],v[172:175],v[112:115],a[140:143]
BL v23,s[8:11],s21 offen offset:1024 lds
MF a[144:147],v[176:179],v[112:115],a[144:147]
DR v[72:75],v10 offset:4096
MF a[148:151],v[180:183],v[112:115],a[148:151]
MF a[152:155],v[184:187],v[112:115],a[152:155]
DR v[76:79],v10 offset:6144
MF a[156:159],v[188:191],v[112:115],a[156:159]
MF a[160:163],v[160:163],v[116:119],a[160:163]
DR v[80:83],v10 offset:8192
MF a[164:167],v[164:167],v[116:119],a[164:167]
BL v24,s[8:11],s21 offen offset:2048 lds
MF a[168:171],v[168:171],v[116:119],a[168:171]
DR v[84:87],v10 offset:10240
MF a[172:175],v[172:175],v[116:119],a[172:175]
MF a[176:179],v[176:179],v[116:119],a[176:179]
DR v[88:91],v10 offset:12288
MF a[180:183],v[180:183],v[116:119],a[180:183]
MF a[184:187],v[184:187],v[116:119],a[184:187]
DR v[92:95],v10 offset:14336
MF a[188:191],v[188:191],v[116:119],a[188:191]
BL v25,s[8:11],s21 offen offset:3072 lds
MF a[192:195],v[160:163],v[120:123],a[192:195]
MF a[196:199],v[164:167],v[120:123],a[196:199]
MF a[200:203],v[168:171],v[120:123],a[200:203]
MF a[204:207],v[172:175],v[120:123],a[204:207]
MF a[208:211],v[176:179],v[120:123],a[208:211]
MF a[212:215],v[180:183],v[120:123],a[212:215]
MF a[216:219],v[184:187],v[120:123],a[216:219]
MF a[220:223],v[188:191],v[120:123],a[220:223]
MF a[224:227],v[160:163],v[124:127],a[224:227]
MF a[228:231],v[164:167],v[124:127],a[228:231]
MF a[232:235],v[168:171],v[124:127],a[232:235]
MF a[236:239],v[172:175],v[124:127],a[236:239]
MF a[240:243],v[176:179],v[124:127],a[240:243]
MF a[244:247],v[180:183],v[124:127],a[244:247]
MF a[248:251],v[184:187],v[124:127],a[248:251]
MF a[252:255],v[188:191],v[124:127],a[252:255]
WT vmcnt(20) lgkmcnt(0)
s_barrier
MF a[0:3],v[128:131],v[64:67],a[0:3]
DR v[96:99],v12 offset:0
MF a[4:7],v[132:135],v[64:67],a[4:7]
MF a[8:11],v[136:139],v[64:67],a[8:11]
DT v[160:161],v14 offset:49152
MF a[12:15],v[140:143],v[64:67],a[12:15]
MF a[16:19],v[144:147],v[64:67],a[16:19]
DT v[162:163],v14 offset:51200
MF a[20:23],v[148:151],v[64:67],a[20:23]
SA m0,s23,131072
s_mov_b32 s22,2621440
BL v26,s[12:15],s22 offen nt lds
MF a[24:27],v[152:155],v[64:67],a[24:27]
DT v[164:165],v15 offset:49152
MF a[28:31],v[156:159],v[64:67],a[28:31]
MF a[32:35],v[128:131],v[68:71],a[32:35]
DT v[166:167],v15 offset:51200
MF a[36:39],v[132:135],v[68:71],a[36:39]
MF a[40:43],v[136:139],v[68:71],a[40:43]
DT v[168:169],v16 offset:49152
MF a[44:47],v[140:143],v[68:71],a[44:47]
BL v27,s[12:15],s22 offen offset:1024 nt lds
MF a[48:51],v[144:147],v[68:71],a[48:51]
DT v[170:171],v16 offset:51200
MF a[52:55],v[148:151],v[68:71],a[52:55]
MF a[56:59],v[152:155],v[68:71],a[56:59]
DT v[172:173],v17 offset:49152
MF a[60:63],v[156:159],v[68:71],a[60:63]
MF a[64:67],v[128:131],v[72:75],a[64:67]
DT v[174:175],v17 offset:51200
MF a[68:71],v[132:135],v[72:75],a[68:71]
BL v28,s[12:15],s22 offen offset:2048 nt lds
MF a[72:75],v[136:139],v[72:75],a[72:75]
DT v[176:177],v18 offset:49152
MF a[76:79],v[140:143],v[72:75],a[76:79]
MF a[80:83],v[144:147],v[72:75],a[80:83]
DT v[178:179],v18 offset:51200
MF a[84:87],v[148:151],v[72:75],a[84:87]
MF a[88:91],v[152:155],v[72:75],a[88:91]
DT v[180:181],v19 offset:49152
MF a[92:95],v[156:159],v[72:75],a[92:95]
BL v29,s[12:15],s22 offen offset:3072 nt lds
MF a[96:99],v[128:131],v[76:79],a[96:99]
DT v[182:183],v19 offset:51200
MF a[100:103],v[132:135],v[76:79],a[100:103]
MF a[104:107],v[136:139],v[76:79],a[104:107]
DT v[184:185],v20 offset:49152
MF a[108:111],v[140:143],v[76:79],a[108:111]
MF a[112:115],v[144:147],v[76:79],a[112:115]
DT v[186:187],v20 offset:51200
MF a[116:119],v[148:151],v[76:79],a[116:119]
SA m0,s23,81920
s_mov_b32 s21,262784
BL v22,s[8:11],s21 offen lds
MF a[120:123],v[152:155],v[76:79],a[120:123]
DT v[188:189],v21 offset:49152
MF a[124:127],v[156:159],v[76:79],a[124:127]
MF a[128:131],v[128:131],v[80:83],a[128:131]
DT v[190:191],v21 offset:51200
MF a[132:135],v[132:135],v[80:83],a[132:135]
MF a[136:139],v[136:139],v[80:83],a[136:139]
DR v[100:103],v12 offset:2048
MF a[140:143],v[140:143],v[80:83],a[140:143]
BL v23,s[8:11],s21 offen offset:1024 lds
MF a[144:147],v[144:147],v[80:83],a[144:147]
DR v[104:107],v12 offset:4096
MF a[148:151],v[148:151],v[80:83],a[148:151]
MF a[152:155],v[152:155],v[80:83],a[152:155]
DR v[108:111],v12 offset:6144
MF a[156:159],v[156:159],v[80:83],a[156:159]
MF a[160:163],v[128:131],v[84:87],a[160:163]
DR v[112:115],v12 offset:8192
MF a[164:167],v[132:135],v[84:87],a[164:167]
BL v24,s[8:11],s21 offen offset:2048 lds
MF a[168:171],v[136:139],v[84:87],a[168:171]
DR v[116:119],v12 offset:10240
MF a[172:175],v[140:143],v[84:87],a[172:175]
MF a[176:179],v[144:147],v[84:87],a[176:179]
DR v[120:123],v12 offset:12288
MF a[180:183],v[148:151],v[84:87],a[180:183]
MF a[184:187],v[152:155],v[84:87],a[184:187]
DR v[124:127],v12 offset:14336
MF a[188:191],v[156:159],v[84:87],a[188:191]
BL v25,s[8:11],s21 offen offset:3072 lds
MF a[192:195],v[128:131],v[88:91],a[192:195]
MF a[196:199],v[132:135],v[88:91],a[196:199]
MF a[200:203],v[136:139],v[88:91],a[200:203]
MF a[204:207],v[140:143],v[88:91],a[204:207]
MF a[208:211],v[144:147],v[88:91],a[208:211]
MF a[212:215],v[148:151],v[88:91],a[212:215]
MF a[216:219],v[152:155],v[88:91],a[216:219]
MF a[220:223],v[156:159],v[88:91],a[220:223]
MF a[224:227],v[128:131],v[92:95],a[224:227]
MF a[228:231],v[132:135],v[92:95],a[228:231]
MF a[232:235],v[136:139],v[92:95],a[232:235]
MF a[236:239],v[140:143],v[92:95],a[236:239]
MF a[240:243],v[144:147],v[92:95],a[240:243]
MF a[244:247],v[148:151],v[92:95],a[244:247]
MF a[248:251],v[152:155],v[92:95],a[248:251]
MF a[252:255],v[156:159],v[92:95],a[252:255]
WT vmcnt(16) lgkmcnt(0)
s_barrier
MF a[0:3],v[160:163],v[96:99],a[0:3]
DR v[64:67],v10 offset:32768
MF a[4:7],v[164:167],v[96:99],a[4:7]
MF a[8:11],v[168:171],v[96:99],a[8:11]
DT v[128:129],v14 offset:0
MF a[12:15],v[172:175],v[96:99],a[12:15]
MF a[16:19],v[176:179],v[96:99],a[16:19]
DT v[130:131],v14 offset:2048
MF a[20:23],v[180:183],v[96:99],a[20:23]
SA m0,s23,147456
s_mov_b32 s22,2883584
BL v26,s[12:15],s22 offen nt lds
MF a[24:27],v[184:187],v[96:99],a[24:27]
DT v[132:133],v15 offset:0
MF a[28:31],v[188:191],v[96:99],a[28:31]
MF a[32:35],v[160:163],v[100:103],a[32:35]
DT v[134:135],v15 offset:2048
MF a[36:39],v[164:167],v[100:103],a[36:39]
MF a[40:43],v[168:171],v[100:103],a[40:43]
DT v[136:137],v16 offset:0
MF a[44:47],v[172:175],v[100:103],a[44:47]
BL v27,s[12:15],s22 offen offset:1024 nt lds
MF a[48:51],v[176:179],v[100:103],a[48:51]
DT v[138:139],v16 offset:2048
MF a[52:55],v[180:183],v[100:103],a[52:55]
MF a[56:59],v[184:187],v[100:103],a[56:59]
DT v[140:141],v17 offset:0
MF a[60:63],v[188:191],v[100:103],a[60:63]
MF a[64:67],v[160:163],v[104:107],a[64:67]
DT v[142:143],v17 offset:2048
MF a[68:71],v[164:167],v[104:107],a[68:71]
BL v28,s[12:15],s22 offen offset:2048 nt lds
MF a[72:75],v[168:171],v[104:107],a[72:75]
DT v[144:145],v18 offset:0
MF a[76:79],v[172:175],v[104:107],a[76:79]
MF a[80:83],v[176:179],v[104:107],a[80:83]
DT v[146:147],v18 offset:2048
MF a[84:87],v[180:183],v[104:107],a[84:87]
MF a[88:91],v[184:187],v[104:107],a[88:91]
DT v[148:149],v19 offset:0
MF a[92:95],v[188:191],v[104:107],a[92:95]
BL v29,s[12:15],s22 offen offset:3072 nt lds
MF a[96:99],v[160:163],v[108:111],a[96:99]
DT v[150:151],v19 offset:2048
MF a[100:103],v[164:167],v[108:111],a[100:103]
MF a[104:107],v[168:171],v[108:111],a[104:107]
DT v[152:153],v20 offset:0
MF a[108:111],v[172:175],v[108:111],a[108:111]
MF a[112:115],v[176:179],v[108:111],a[112:115]
DT v[154:155],v20 offset:2048
MF a[116:119],v[180:183],v[108:111],a[116:119]
SA m0,s23,0
s_mov_b32 s21,768
BL v22,s[8:11],s21 offen lds
MF a[120:123],v[184:187],v[108:111],a[120:123]
DT v[156:157],v21 offset:0
MF a[124:127],v[188:191],v[108:111],a[124:127]
MF a[128:131],v[160:163],v[112:115],a[128:131]
DT v[158:159],v21 offset:2048
MF a[132:135],v[164:167],v[112:115],a[132:135]
MF a[136:139],v[168:171],v[112:115],a[136:139]
DR v[68:71],v10 offset:34816
MF a[140:143],v[172:175],v[112:115],a[140:143]
BL v23,s[8:11],s21 offen offset:1024 lds
MF a[144:147],v[176:179],v[112:115],a[144:147]
DR v[72:75],v10 offset:36864
MF a[148:151],v[180:183],v[112:115],a[148:151]
MF a[152:155],v[184:187],v[112:115],a[152:155]
DR v[76:79],v10 offset:38912
MF a[156:159],v[188:191],v[112:115],a[156:159]
MF a[160:163],v[160:163],v[116:119],a[160:163]
DR v[80:83],v10 offset:40960
MF a[164:167],v[164:167],v[116:119],a[164:167]
BL v24,s[8:11],s21 offen offset:2048 lds
MF a[168:171],v[168:171],v[116:119],a[168:171]
DR v[84:87],v10 offset:43008
MF a[172:175],v[172:175],v[116:119],a[172:175]
MF a[176:179],v[176:179],v[116:119],a[176:179]
DR v[88:91],v10 offset:45056
MF a[180:183],v[180:183],v[116:119],a[180:183]
MF a[184:187],v[184:187],v[116:119],a[184:187]
DR v[92:95],v10 offset:47104
MF a[188:191],v[188:191],v[116:119],a[188:191]
BL v25,s[8:11],s21 offen offset:3072 lds
MF a[192:195],v[160:163],v[120:123],a[192:195]
MF a[196:199],v[164:167],v[120:123],a[196:199]
MF a[200:203],v[168:171],v[120:123],a[200:203]
MF a[204:207],v[172:175],v[120:123],a[204:207]
MF a[208:211],v[176:179],v[120:123],a[208:211]
MF a[212:215],v[180:183],v[120:123],a[212:215]
MF a[216:219],v[184:187],v[120:123],a[216:219]
MF a[220:223],v[188:191],v[120:123],a[220:223]
MF a[224:227],v[160:163],v[124:127],a[224:227]
MF a[228:231],v[164:167],v[124:127],a[228:231]
MF a[232:235],v[168:171],v[124:127],a[232:235]
MF a[236:239],v[172:175],v[124:127],a[236:239]
MF a[240:243],v[176:179],v[124:127],a[240:243]
MF a[244:247],v[180:183],v[124:127],a[244:247]
MF a[248:251],v[184:187],v[124:127],a[248:251]
MF a[252:255],v[188:191],v[124:127],a[252:255]
WT vmcnt(20) lgkmcnt(0)
s_barrier
MF a[0:3],v[128:131],v[64:67],a[0:3]
DR v[96:99],v12 offset:32768
v_cmp_gt_u32 vcc,24,v194
MF a[4:7],v[132:135],v[64:67],a[4:7]
v_lshlrev_b32 v204,16,v196
v_and_b32 v205,0xffff0000,v196
MF a[8:11],v[136:139],v[64:67],a[8:11]
DT v[160:161],v14 offset:16384
v_lshlrev_b32 v206,16,v197
MF a[12:15],v[140:143],v[64:67],a[12:15]
v_and_b32 v207,0xffff0000,v197
v_lshlrev_b32 v208,16,v198
MF a[16:19],v[144:147],v[64:67],a[16:19]
DT v[162:163],v14 offset:18432
v_and_b32 v209,0xffff0000,v198
MF a[20:23],v[148:151],v[64:67],a[20:23]
SA m0,s23,98304
s_mov_b32 s22,3145728
BL v26,s[12:15],s22 offen nt lds
MF a[24:27],v[152:155],v[64:67],a[24:27]
DT v[164:165],v15 offset:16384
v_lshlrev_b32 v210,16,v199
MF a[28:31],v[156:159],v[64:67],a[28:31]
v_and_b32 v211,0xffff0000,v199
v_lshlrev_b32 v212,16,v200
MF a[32:35],v[128:131],v[68:71],a[32:35]
DT v[166:167],v15 offset:18432
v_and_b32 v213,0xffff0000,v200
MF a[36:39],v[132:135],v[68:71],a[36:39]
v_lshlrev_b32 v214,16,v201
v_and_b32 v215,0xffff0000,v201
MF a[40:43],v[136:139],v[68:71],a[40:43]
DT v[168:169],v16 offset:16384
v_lshlrev_b32 v216,16,v202
MF a[44:47],v[140:143],v[68:71],a[44:47]
BL v27,s[12:15],s22 offen offset:1024 nt lds
MF a[48:51],v[144:147],v[68:71],a[48:51]
DT v[170:171],v16 offset:18432
v_and_b32 v217,0xffff0000,v202
MF a[52:55],v[148:151],v[68:71],a[52:55]
v_lshlrev_b32 v218,16,v203
v_and_b32 v219,0xffff0000,v203
MF a[56:59],v[152:155],v[68:71],a[56:59]
DT v[172:173],v17 offset:16384
FA v220,v204,v205
MF a[60:63],v[156:159],v[68:71],a[60:63]
FA v220,v220,v206
FA v220,v220,v207
MF a[64:67],v[128:131],v[72:75],a[64:67]
DT v[174:175],v17 offset:18432
FA v220,v220,v208
MF a[68:71],v[132:135],v[72:75],a[68:71]
BL v28,s[12:15],s22 offen offset:2048 nt lds
MF a[72:75],v[136:139],v[72:75],a[72:75]
DT v[176:177],v18 offset:16384
FA v220,v220,v209
MF a[76:79],v[140:143],v[72:75],a[76:79]
FA v220,v220,v210
FA v220,v220,v211
MF a[80:83],v[144:147],v[72:75],a[80:83]
DT v[178:179],v18 offset:18432
FA v220,v220,v212
MF a[84:87],v[148:151],v[72:75],a[84:87]
FA v220,v220,v213
FA v220,v220,v214
MF a[88:91],v[152:155],v[72:75],a[88:91]
DT v[180:181],v19 offset:16384
FA v220,v220,v215
MF a[92:95],v[156:159],v[72:75],a[92:95]
BL v29,s[12:15],s22 offen offset:3072 nt lds
MF a[96:99],v[128:131],v[76:79],a[96:99]
DT v[182:183],v19 offset:18432
FA v220,v220,v216
MF a[100:103],v[132:135],v[76:79],a[100:103]
FA v220,v220,v217
FA v220,v220,v218
MF a[104:107],v[136:139],v[76:79],a[104:107]
DT v[184:185],v20 offset:16384
FA v220,v220,v219
s_nop 1
MF a[108:111],v[140:143],v[76:79],a[108:111]
v_add_f32_dpp v220,v220,v220 row_ror:8 row_mask:0xf bank_mask:0xf
s_nop 1
v_add_f32_dpp v220,v220,v220 row_ror:4 row_mask:0xf bank_mask:0xf
s_nop 1
MF a[112:115],v[144:147],v[76:79],a[112:115]
DT v[186:187],v20 offset:18432
v_add_f32_dpp v220,v220,v220 row_ror:2 row_mask:0xf bank_mask:0xf
s_nop 1
MF a[116:119],v[148:151],v[76:79],a[116:119]
SA m0,s23,16384
s_mov_b32 s21,262912
BL v22,s[8:11],s21 offen lds
MF a[120:123],v[152:155],v[76:79],a[120:123]
DT v[188:189],v21 offset:16384
v_add_f32_dpp v220,v220,v220 row_ror:1 row_mask:0xf bank_mask:0xf
s_nop 1
MF a[124:127],v[156:159],v[76:79],a[124:127]
v_mov_b32 v222,v220
s_nop 1
v_permlane16_swap_b32 v220,v222
s_nop 1
MF a[128:131],v[128:131],v[80:83],a[128:131]
DT v[190:191],v21 offset:18432
FA v220,v220,v222
MF a[132:135],v[132:135],v[80:83],a[132:135]
FM v220,0x3b124925,v220
FS v204,v204,v220
MF a[136:139],v[136:139],v[80:83],a[136:139]
DR v[100:103],v12 offset:34816
FS v205,v205,v220
MF a[140:143],v[140:143],v[80:83],a[140:143]
BL v23,s[8:11],s21 offen offset:1024 lds
MF a[144:147],v[144:147],v[80:83],a[144:147]
DR v[104:107],v12 offset:36864
FS v206,v206,v220
MF a[148:151],v[148:151],v[80:83],a[148:151]
FS v207,v207,v220
FS v208,v208,v220
MF a[152:155],v[152:155],v[80:83],a[152:155]
DR v[108:111],v12 offset:38912
FS v209,v209,v220
MF a[156:159],v[156:159],v[80:83],a[156:159]
FS v210,v210,v220
FS v211,v211,v220
MF a[160:163],v[128:131],v[84:87],a[160:163]
DR v[112:115],v12 offset:40960
FS v212,v212,v220
MF a[164:167],v[132:135],v[84:87],a[164:167]
BL v24,s[8:11],s21 offen offset:2048 lds
MF a[168:171],v[136:139],v[84:87],a[168:171]
DR v[116:119],v12 offset:43008
FS v213,v213,v220
MF a[172:175],v[140:143],v[84:87],a[172:175]
FS v214,v214,v220
FS v215,v215,v220
MF a[176:179],v[144:147],v[84:87],a[176:179]
DR v[120:123],v12 offset:45056
FS v216,v216,v220
MF a[180:183],v[148:151],v[84:87],a[180:183]
FS v217,v217,v220
FS v218,v218,v220
MF a[184:187],v[152:155],v[84:87],a[184:187]
DR v[124:127],v12 offset:47104
FS v219,v219,v220
MF a[188:191],v[156:159],v[84:87],a[188:191]
BL v25,s[8:11],s21 offen offset:3072 lds
MF a[192:195],v[128:131],v[88:91],a[192:195]
CM v212,0,v212,vcc
CM v213,0,v213,vcc
MF a[196:199],v[132:135],v[88:91],a[196:199]
CM v214,0,v214,vcc
CM v215,0,v215,vcc
MF a[200:203],v[136:139],v[88:91],a[200:203]
CM v216,0,v216,vcc
CM v217,0,v217,vcc
MF a[204:207],v[140:143],v[88:91],a[204:207]
CM v218,0,v218,vcc
CM v219,0,v219,vcc
MF a[208:211],v[144:147],v[88:91],a[208:211]
FM v221,v204,v204
v_fmac_f32 v221,v205,v205
MF a[212:215],v[148:151],v[88:91],a[212:215]
v_fmac_f32 v221,v206,v206
v_fmac_f32 v221,v207,v207
MF a[216:219],v[152:155],v[88:91],a[216:219]
v_fmac_f32 v221,v208,v208
v_fmac_f32 v221,v209,v209
MF a[220:223],v[156:159],v[88:91],a[220:223]
v_fmac_f32 v221,v210,v210
v_fmac_f32 v221,v211,v211
MF a[224:227],v[128:131],v[92:95],a[224:227]
v_fmac_f32 v221,v212,v212
v_fmac_f32 v221,v213,v213
MF a[228:231],v[132:135],v[92:95],a[228:231]
v_fmac_f32 v221,v214,v214
v_fmac_f32 v221,v215,v215
MF a[232:235],v[136:139],v[92:95],a[232:235]
v_fmac_f32 v221,v216,v216
v_fmac_f32 v221,v217,v217
MF a[236:239],v[140:143],v[92:95],a[236:239]
v_fmac_f32 v221,v218,v218
v_fmac_f32 v221,v219,v219
s_nop 1
MF a[240:243],v[144:147],v[92:95],a[240:243]
v_add_f32_dpp v221,v221,v221 row_ror:8 row_mask:0xf bank_mask:0xf
s_nop 1
v_add_f32_dpp v221,v221,v221 row_ror:4 row_mask:0xf bank_mask:0xf
s_nop 1
MF a[244:247],v[148:151],v[92:95],a[244:247]
v_add_f32_dpp v221,v221,v221 row_ror:2 row_mask:0xf bank_mask:0xf
s_nop 1
v_add_f32_dpp v221,v221,v221 row_ror:1 row_mask:0xf bank_mask:0xf
s_nop 1
MF a[248:251],v[152:155],v[92:95],a[248:251]
v_mov_b32 v222,v221
s_nop 1
v_permlane16_swap_b32 v221,v222
s_nop 1
MF a[252:255],v[156:159],v[92:95],a[252:255]
FA v221,v221,v222
v_mov_b32 v222,0x3727c5ac
WT vmcnt(16) lgkmcnt(0)
s_barrier
MF a[0:3],v[160:163],v[96:99],a[0:3]
DR v[64:67],v11 offset:0
v_fmac_f32 v222,0x3b124925,v221
MF a[4:7],v[164:167],v[96:99],a[4:7]
v_rsq_f32 v222,v222
s_nop 0
MF a[8:11],v[168:171],v[96:99],a[8:11]
DT v[128:129],v14 offset:32768
FM v204,v204,v222
MF a[12:15],v[172:175],v[96:99],a[12:15]
FM v205,v205,v222
FM v206,v206,v222
MF a[16:19],v[176:179],v[96:99],a[16:19]
DT v[130:131],v14 offset:34816
FM v207,v207,v222
MF a[20:23],v[180:183],v[96:99],a[20:23]
SA m0,s23,114688
s_mov_b32 s22,3407872
BL v26,s[12:15],s22 offen nt lds
MF a[24:27],v[184:187],v[96:99],a[24:27]
DT v[132:133],v15 offset:32768
FM v208,v208,v222
MF a[28:31],v[188:191],v[96:99],a[28:31]
FM v209,v209,v222
FM v210,v210,v222
MF a[32:35],v[160:163],v[100:103],a[32:35]
DT v[134:135],v15 offset:34816
FM v211,v211,v222
MF a[36:39],v[164:167],v[100:103],a[36:39]
FM v212,v212,v222
FM v213,v213,v222
MF a[40:43],v[168:171],v[100:103],a[40:43]
DT v[136:137],v16 offset:32768
FM v214,v214,v222
MF a[44:47],v[172:175],v[100:103],a[44:47]
BL v27,s[12:15],s22 offen offset:1024 nt lds
MF a[48:51],v[176:179],v[100:103],a[48:51]
DT v[138:139],v16 offset:34816
FM v215,v215,v222
MF a[52:55],v[180:183],v[100:103],a[52:55]
FM v216,v216,v222
FM v217,v217,v222
MF a[56:59],v[184:187],v[100:103],a[56:59]
DT v[140:141],v17 offset:32768
FM v218,v218,v222
MF a[60:63],v[188:191],v[100:103],a[60:63]
FM v219,v219,v222
CV v196,v204,v205
MF a[64:67],v[160:163],v[104:107],a[64:67]
DT v[142:143],v17 offset:34816
CV v197,v206,v207
MF a[68:71],v[164:167],v[104:107],a[68:71]
BL v28,s[12:15],s22 offen offset:2048 nt lds
MF a[72:75],v[168:171],v[104:107],a[72:75]
DT v[144:145],v18 offset:32768
CV v198,v208,v209
MF a[76:79],v[172:175],v[104:107],a[76:79]
CV v199,v210,v211
CV v200,v212,v213
MF a[80:83],v[176:179],v[104:107],a[80:83]
DT v[146:147],v18 offset:34816
CV v201,v214,v215
MF a[84:87],v[180:183],v[104:107],a[84:87]
CV v202,v216,v217
CV v203,v218,v219
MF a[88:91],v[184:187],v[104:107],a[88:91]
DT v[148:149],v19 offset:32768
MF a[92:95],v[188:191],v[104:107],a[92:95]
BL v29,s[12:15],s22 offen offset:3072 nt lds
MF a[96:99],v[160:163],v[108:111],a[96:99]
DT v[150:151],v19 offset:34816
MF a[100:103],v[164:167],v[108:111],a[100:103]
BS v[196:199],v192,s[64:67],0 offen sc1
MF a[104:107],v[168:171],v[108:111],a[104:107]
DT v[152:153],v20 offset:32768
MF a[108:111],v[172:175],v[108:111],a[108:111]
BS v[200:203],v193,s[64:67],0 offen sc1
MF a[112:115],v[176:179],v[108:111],a[112:115]
DT v[154:155],v20 offset:34816
MF a[116:119],v[180:183],v[108:111],a[116:119]
SA m0,s23,32768
s_mov_b32 s21,896
BL v22,s[8:11],s21 offen lds
MF a[120:123],v[184:187],v[108:111],a[120:123]
DT v[156:157],v21 offset:32768
MF a[124:127],v[188:191],v[108:111],a[124:127]
MF a[128:131],v[160:163],v[112:115],a[128:131]
DT v[158:159],v21 offset:34816
MF a[132:135],v[164:167],v[112:115],a[132:135]
MF a[136:139],v[168:171],v[112:115],a[136:139]
DR v[68:71],v11 offset:2048
MF a[140:143],v[172:175],v[112:115],a[140:143]
BL v23,s[8:11],s21 offen offset:1024 lds
MF a[144:147],v[176:179],v[112:115],a[144:147]
DR v[72:75],v11 offset:4096
MF a[148:151],v[180:183],v[112:115],a[148:151]
MF a[152:155],v[184:187],v[112:115],a[152:155]
DR v[76:79],v11 offset:6144
MF a[156:159],v[188:191],v[112:115],a[156:159]
MF a[160:163],v[160:163],v[116:119],a[160:163]
DR v[80:83],v11 offset:8192
MF a[164:167],v[164:167],v[116:119],a[164:167]
BL v24,s[8:11],s21 offen offset:2048 lds
MF a[168:171],v[168:171],v[116:119],a[168:171]
DR v[84:87],v11 offset:10240
MF a[172:175],v[172:175],v[116:119],a[172:175]
MF a[176:179],v[176:179],v[116:119],a[176:179]
DR v[88:91],v11 offset:12288
MF a[180:183],v[180:183],v[116:119],a[180:183]
MF a[184:187],v[184:187],v[116:119],a[184:187]
DR v[92:95],v11 offset:14336
MF a[188:191],v[188:191],v[116:119],a[188:191]
BL v25,s[8:11],s21 offen offset:3072 lds
MF a[192:195],v[160:163],v[120:123],a[192:195]
MF a[196:199],v[164:167],v[120:123],a[196:199]
MF a[200:203],v[168:171],v[120:123],a[200:203]
MF a[204:207],v[172:175],v[120:123],a[204:207]
MF a[208:211],v[176:179],v[120:123],a[208:211]
MF a[212:215],v[180:183],v[120:123],a[212:215]
MF a[216:219],v[184:187],v[120:123],a[216:219]
MF a[220:223],v[188:191],v[120:123],a[220:223]
MF a[224:227],v[160:163],v[124:127],a[224:227]
MF a[228:231],v[164:167],v[124:127],a[228:231]
MF a[232:235],v[168:171],v[124:127],a[232:235]
MF a[236:239],v[172:175],v[124:127],a[236:239]
MF a[240:243],v[176:179],v[124:127],a[240:243]
MF a[244:247],v[180:183],v[124:127],a[244:247]
MF a[248:251],v[184:187],v[124:127],a[248:251]
MF a[252:255],v[188:191],v[124:127],a[252:255]
WT vmcnt(22) lgkmcnt(0)
s_barrier
MF a[0:3],v[128:131],v[64:67],a[0:3]
DR v[96:99],v13 offset:0
MF a[4:7],v[132:135],v[64:67],a[4:7]
MF a[8:11],v[136:139],v[64:67],a[8:11]
DT v[160:161],v14 offset:49152
MF a[12:15],v[140:143],v[64:67],a[12:15]
MF a[16:19],v[144:147],v[64:67],a[16:19]
DT v[162:163],v14 offset:51200
MF a[20:23],v[148:151],v[64:67],a[20:23]
SA m0,s23,131072
s_mov_b32 s22,3670016
BL v26,s[12:15],s22 offen nt lds
MF a[24:27],v[152:155],v[64:67],a[24:27]
DT v[164:165],v15 offset:49152
MF a[28:31],v[156:159],v[64:67],a[28:31]
MF a[32:35],v[128:131],v[68:71],a[32:35]
DT v[166:167],v15 offset:51200
MF a[36:39],v[132:135],v[68:71],a[36:39]
MF a[40:43],v[136:139],v[68:71],a[40:43]
DT v[168:169],v16 offset:49152
MF a[44:47],v[140:143],v[68:71],a[44:47]
BL v27,s[12:15],s22 offen offset:1024 nt lds
MF a[48:51],v[144:147],v[68:71],a[48:51]
DT v[170:171],v16 offset:51200
MF a[52:55],v[148:151],v[68:71],a[52:55]
MF a[56:59],v[152:155],v[68:71],a[56:59]
DT v[172:173],v17 offset:49152
MF a[60:63],v[156:159],v[68:71],a[60:63]
MF a[64:67],v[128:131],v[72:75],a[64:67]
DT v[174:175],v17 offset:51200
MF a[68:71],v[132:135],v[72:75],a[68:71]
BL v28,s[12:15],s22 offen offset:2048 nt lds
MF a[72:75],v[136:139],v[72:75],a[72:75]
DT v[176:177],v18 offset:49152
MF a[76:79],v[140:143],v[72:75],a[76:79]
MF a[80:83],v[144:147],v[72:75],a[80:83]
DT v[178:179],v18 offset:51200
MF a[84:87],v[148:151],v[72:75],a[84:87]
MF a[88:91],v[152:155],v[72:75],a[88:91]
DT v[180:181],v19 offset:49152
MF a[92:95],v[156:159],v[72:75],a[92:95]
BL v29,s[12:15],s22 offen offset:3072 nt lds
MF a[96:99],v[128:131],v[76:79],a[96:99]
DT v[182:183],v19 offset:51200
MF a[100:103],v[132:135],v[76:79],a[100:103]
MF a[104:107],v[136:139],v[76:79],a[104:107]
DT v[184:185],v20 offset:49152
MF a[108:111],v[140:143],v[76:79],a[108:111]
MF a[112:115],v[144:147],v[76:79],a[112:115]
DT v[186:187],v20 offset:51200
MF a[116:119],v[148:151],v[76:79],a[116:119]
SA m0,s23,49152
s_mov_b32 s21,263040
BL v22,s[8:11],s21 offen lds
MF a[120:123],v[152:155],v[76:79],a[120:123]
DT v[188:189],v21 offset:49152
MF a[124:127],v[156:159],v[76:79],a[124:127]
MF a[128:131],v[128:131],v[80:83],a[128:131]
DT v[190:191],v21 offset:51200
MF a[132:135],v[132:135],v[80:83],a[132:135]
MF a[136:139],v[136:139],v[80:83],a[136:139]
DR v[100:103],v13 offset:2048
MF a[140:143],v[140:143],v[80:83],a[140:143]
BL v23,s[8:11],s21 offen offset:1024 lds
MF a[144:147],v[144:147],v[80:83],a[144:147]
DR v[104:107],v13 offset:4096
MF a[148:151],v[148:151],v[80:83],a[148:151]
MF a[152:155],v[152:155],v[80:83],a[152:155]
DR v[108:111],v13 offset:6144
MF a[156:159],v[156:159],v[80:83],a[156:159]
MF a[160:163],v[128:131],v[84:87],a[160:163]
DR v[112:115],v13 offset:8192
MF a[164:167],v[132:135],v[84:87],a[164:167]
BL v24,s[8:11],s21 offen offset:2048 lds
MF a[168:171],v[136:139],v[84:87],a[168:171]
DR v[116:119],v13 offset:10240
MF a[172:175],v[140:143],v[84:87],a[172:175]
MF a[176:179],v[144:147],v[84:87],a[176:179]
DR v[120:123],v13 offset:12288
MF a[180:183],v[148:151],v[84:87],a[180:183]
MF a[184:187],v[152:155],v[84:87],a[184:187]
DR v[124:127],v13 offset:14336
MF a[188:191],v[156:159],v[84:87],a[188:191]
BL v25,s[8:11],s21 offen offset:3072 lds
MF a[192:195],v[128:131],v[88:91],a[192:195]
MF a[196:199],v[132:135],v[88:91],a[196:199]
MF a[200:203],v[136:139],v[88:91],a[200:203]
MF a[204:207],v[140:143],v[88:91],a[204:207]
MF a[208:211],v[144:147],v[88:91],a[208:211]
MF a[212:215],v[148:151],v[88:91],a[212:215]
MF a[216:219],v[152:155],v[88:91],a[216:219]
MF a[220:223],v[156:159],v[88:91],a[220:223]
MF a[224:227],v[128:131],v[92:95],a[224:227]
MF a[228:231],v[132:135],v[92:95],a[228:231]
MF a[232:235],v[136:139],v[92:95],a[232:235]
MF a[236:239],v[140:143],v[92:95],a[236:239]
MF a[240:243],v[144:147],v[92:95],a[240:243]
MF a[244:247],v[148:151],v[92:95],a[244:247]
MF a[248:251],v[152:155],v[92:95],a[248:251]
MF a[252:255],v[156:159],v[92:95],a[252:255]
WT vmcnt(18) lgkmcnt(0)
s_barrier
MF a[0:3],v[160:163],v[96:99],a[0:3]
DR v[64:67],v10 offset:0
MF a[4:7],v[164:167],v[96:99],a[4:7]
MF a[8:11],v[168:171],v[96:99],a[8:11]
DT v[128:129],v14 offset:0
MF a[12:15],v[172:175],v[96:99],a[12:15]
MF a[16:19],v[176:179],v[96:99],a[16:19]
DT v[130:131],v14 offset:2048
MF a[20:23],v[180:183],v[96:99],a[20:23]
SA m0,s23,147456
s_mov_b32 s22,3932160
BL v26,s[12:15],s22 offen nt lds
MF a[24:27],v[184:187],v[96:99],a[24:27]
DT v[132:133],v15 offset:0
MF a[28:31],v[188:191],v[96:99],a[28:31]
MF a[32:35],v[160:163],v[100:103],a[32:35]
DT v[134:135],v15 offset:2048
MF a[36:39],v[164:167],v[100:103],a[36:39]
MF a[40:43],v[168:171],v[100:103],a[40:43]
DT v[136:137],v16 offset:0
MF a[44:47],v[172:175],v[100:103],a[44:47]
BL v27,s[12:15],s22 offen offset:1024 nt lds
MF a[48:51],v[176:179],v[100:103],a[48:51]
DT v[138:139],v16 offset:2048
MF a[52:55],v[180:183],v[100:103],a[52:55]
MF a[56:59],v[184:187],v[100:103],a[56:59]
DT v[140:141],v17 offset:0
MF a[60:63],v[188:191],v[100:103],a[60:63]
MF a[64:67],v[160:163],v[104:107],a[64:67]
DT v[142:143],v17 offset:2048
MF a[68:71],v[164:167],v[104:107],a[68:71]
BL v28,s[12:15],s22 offen offset:2048 nt lds
MF a[72:75],v[168:171],v[104:107],a[72:75]
DT v[144:145],v18 offset:0
MF a[76:79],v[172:175],v[104:107],a[76:79]
MF a[80:83],v[176:179],v[104:107],a[80:83]
DT v[146:147],v18 offset:2048
MF a[84:87],v[180:183],v[104:107],a[84:87]
MF a[88:91],v[184:187],v[104:107],a[88:91]
DT v[148:149],v19 offset:0
MF a[92:95],v[188:191],v[104:107],a[92:95]
BL v29,s[12:15],s22 offen offset:3072 nt lds
MF a[96:99],v[160:163],v[108:111],a[96:99]
DT v[150:151],v19 offset:2048
MF a[100:103],v[164:167],v[108:111],a[100:103]
MF a[104:107],v[168:171],v[108:111],a[104:107]
DT v[152:153],v20 offset:0
MF a[108:111],v[172:175],v[108:111],a[108:111]
MF a[112:115],v[176:179],v[108:111],a[112:115]
DT v[154:155],v20 offset:2048
MF a[116:119],v[180:183],v[108:111],a[116:119]
SA m0,s23,65536
s_mov_b32 s21,1024
BL v22,s[8:11],s21 offen lds
MF a[120:123],v[184:187],v[108:111],a[120:123]
DT v[156:157],v21 offset:0
MF a[124:127],v[188:191],v[108:111],a[124:127]
MF a[128:131],v[160:163],v[112:115],a[128:131]
DT v[158:159],v21 offset:2048
MF a[132:135],v[164:167],v[112:115],a[132:135]
MF a[136:139],v[168:171],v[112:115],a[136:139]
DR v[68:71],v10 offset:2048
MF a[140:143],v[172:175],v[112:115],a[140:143]
BL v23,s[8:11],s21 offen offset:1024 lds
MF a[144:147],v[176:179],v[112:115],a[144:147]
DR v[72:75],v10 offset:4096
MF a[148:151],v[180:183],v[112:115],a[148:151]
MF a[152:155],v[184:187],v[112:115],a[152:155]
DR v[76:79],v10 offset:6144
MF a[156:159],v[188:191],v[112:115],a[156:159]
MF a[160:163],v[160:163],v[116:119],a[160:163]
DR v[80:83],v10 offset:8192
MF a[164:167],v[164:167],v[116:119],a[164:167]
BL v24,s[8:11],s21 offen offset:2048 lds
MF a[168:171],v[168:171],v[116:119],a[168:171]
DR v[84:87],v10 offset:10240
MF a[172:175],v[172:175],v[116:119],a[172:175]
MF a[176:179],v[176:179],v[116:119],a[176:179]
DR v[88:91],v10 offset:12288
MF a[180:183],v[180:183],v[116:119],a[180:183]
MF a[184:187],v[184:187],v[116:119],a[184:187]
DR v[92:95],v10 offset:14336
MF a[188:191],v[188:191],v[116:119],a[188:191]
BL v25,s[8:11],s21 offen offset:3072 lds
MF a[192:195],v[160:163],v[120:123],a[192:195]
MF a[196:199],v[164:167],v[120:123],a[196:199]
MF a[200:203],v[168:171],v[120:123],a[200:203]
MF a[204:207],v[172:175],v[120:123],a[204:207]
MF a[208:211],v[176:179],v[120:123],a[208:211]
MF a[212:215],v[180:183],v[120:123],a[212:215]
MF a[216:219],v[184:187],v[120:123],a[216:219]
MF a[220:223],v[188:191],v[120:123],a[220:223]
MF a[224:227],v[160:163],v[124:127],a[224:227]
MF a[228:231],v[164:167],v[124:127],a[228:231]
MF a[232:235],v[168:171],v[124:127],a[232:235]
MF a[236:239],v[172:175],v[124:127],a[236:239]
MF a[240:243],v[176:179],v[124:127],a[240:243]
MF a[244:247],v[180:183],v[124:127],a[244:247]
MF a[248:251],v[184:187],v[124:127],a[248:251]
MF a[252:255],v[188:191],v[124:127],a[252:255]
WT vmcnt(22) lgkmcnt(0)
s_barrier
MF a[0:3],v[128:131],v[64:67],a[0:3]
DR v[96:99],v12 offset:0
MF a[4:7],v[132:135],v[64:67],a[4:7]
MF a[8:11],v[136:139],v[64:67],a[8:11]
DT v[160:161],v14 offset:16384
MF a[12:15],v[140:143],v[64:67],a[12:15]
MF a[16:19],v[144:147],v[64:67],a[16:19]
DT v[162:163],v14 offset:18432
MF a[20:23],v[148:151],v[64:67],a[20:23]
SA m0,s23,98304
s_mov_b32 s22,4194304
BL v26,s[12:15],s22 offen nt lds
MF a[24:27],v[152:155],v[64:67],a[24:27]
DT v[164:165],v15 offset:16384
MF a[28:31],v[156:159],v[64:67],a[28:31]
MF a[32:35],v[128:131],v[68:71],a[32:35]
DT v[166:167],v15 offset:18432
MF a[36:39],v[132:135],v[68:71],a[36:39]
MF a[40:43],v[136:139],v[68:71],a[40:43]
DT v[168:169],v16 offset:16384
MF a[44:47],v[140:143],v[68:71],a[44:47]
BL v27,s[12:15],s22 offen offset:1024 nt lds
MF a[48:51],v[144:147],v[68:71],a[48:51]
DT v[170:171],v16 offset:18432
MF a[52:55],v[148:151],v[68:71],a[52:55]
MF a[56:59],v[152:155],v[68:71],a[56:59]
DT v[172:173],v17 offset:16384
MF a[60:63],v[156:159],v[68:71],a[60:63]
MF a[64:67],v[128:131],v[72:75],a[64:67]
DT v[174:175],v17 offset:18432
MF a[68:71],v[132:135],v[72:75],a[68:71]
BL v28,s[12:15],s22 offen offset:2048 nt lds
MF a[72:75],v[136:139],v[72:75],a[72:75]
DT v[176:177],v18 offset:16384
MF a[76:79],v[140:143],v[72:75],a[76:79]
MF a[80:83],v[144:147],v[72:75],a[80:83]
DT v[178:179],v18 offset:18432
MF a[84:87],v[148:151],v[72:75],a[84:87]
MF a[88:91],v[152:155],v[72:75],a[88:91]
DT v[180:181],v19 offset:16384
MF a[92:95],v[156:159],v[72:75],a[92:95]
BL v29,s[12:15],s22 offen offset:3072 nt lds
MF a[96:99],v[128:131],v[76:79],a[96:99]
DT v[182:183],v19 offset:18432
MF a[100:103],v[132:135],v[76:79],a[100:103]
MF a[104:107],v[136:139],v[76:79],a[104:107]
DT v[184:185],v20 offset:16384
MF a[108:111],v[140:143],v[76:79],a[108:111]
MF a[112:115],v[144:147],v[76:79],a[112:115]
DT v[186:187],v20 offset:18432
MF a[116:119],v[148:151],v[76:79],a[116:119]
SA m0,s23,81920
s_mov_b32 s21,263168
BL v22,s[8:11],s21 offen lds
MF a[120:123],v[152:155],v[76:79],a[120:123]
DT v[188:189],v21 offset:16384
MF a[124:127],v[156:159],v[76:79],a[124:127]
MF a[128:131],v[128:131],v[80:83],a[128:131]
DT v[190:191],v21 offset:18432
MF a[132:135],v[132:135],v[80:83],a[132:135]
MF a[136:139],v[136:139],v[80:83],a[136:139]
DR v[100:103],v12 offset:2048
MF a[140:143],v[140:143],v[80:83],a[140:143]
BL v23,s[8:11],s21 offen offset:1024 lds
MF a[144:147],v[144:147],v[80:83],a[144:147]
DR v[104:107],v12 offset:4096
MF a[148:151],v[148:151],v[80:83],a[148:151]
MF a[152:155],v[152:155],v[80:83],a[152:155]
DR v[108:111],v12 offset:6144
MF a[156:159],v[156:159],v[80:83],a[156:159]
MF a[160:163],v[128:131],v[84:87],a[160:163]
DR v[112:115],v12 offset:8192
MF a[164:167],v[132:135],v[84:87],a[164:167]
BL v24,s[8:11],s21 offen offset:2048 lds
MF a[168:171],v[136:139],v[84:87],a[168:171]
DR v[116:119],v12 offset:10240
MF a[172:175],v[140:143],v[84:87],a[172:175]
MF a[176:179],v[144:147],v[84:87],a[176:179]
DR v[120:123],v12 offset:12288
MF a[180:183],v[148:151],v[84:87],a[180:183]
MF a[184:187],v[152:155],v[84:87],a[184:187]
DR v[124:127],v12 offset:14336
MF a[188:191],v[156:159],v[84:87],a[188:191]
BL v25,s[8:11],s21 offen offset:3072 lds
MF a[192:195],v[128:131],v[88:91],a[192:195]
MF a[196:199],v[132:135],v[88:91],a[196:199]
MF a[200:203],v[136:139],v[88:91],a[200:203]
MF a[204:207],v[140:143],v[88:91],a[204:207]
MF a[208:211],v[144:147],v[88:91],a[208:211]
MF a[212:215],v[148:151],v[88:91],a[212:215]
MF a[216:219],v[152:155],v[88:91],a[216:219]
MF a[220:223],v[156:159],v[88:91],a[220:223]
MF a[224:227],v[128:131],v[92:95],a[224:227]
MF a[228:231],v[132:135],v[92:95],a[228:231]
MF a[232:235],v[136:139],v[92:95],a[232:235]
MF a[236:239],v[140:143],v[92:95],a[236:239]
MF a[240:243],v[144:147],v[92:95],a[240:243]
MF a[244:247],v[148:151],v[92:95],a[244:247]
MF a[248:251],v[152:155],v[92:95],a[248:251]
MF a[252:255],v[156:159],v[92:95],a[252:255]
WT vmcnt(16) lgkmcnt(0)
s_barrier
MF a[0:3],v[160:163],v[96:99],a[0:3]
DR v[64:67],v10 offset:32768
MF a[4:7],v[164:167],v[96:99],a[4:7]
MF a[8:11],v[168:171],v[96:99],a[8:11]
DT v[128:129],v14 offset:32768
MF a[12:15],v[172:175],v[96:99],a[12:15]
MF a[16:19],v[176:179],v[96:99],a[16:19]
DT v[130:131],v14 offset:34816
MF a[20:23],v[180:183],v[96:99],a[20:23]
SA m0,s23,114688
s_mov_b32 s22,4456448
BL v26,s[12:15],s22 offen nt lds
MF a[24:27],v[184:187],v[96:99],a[24:27]
DT v[132:133],v15 offset:32768
MF a[28:31],v[188:191],v[96:99],a[28:31]
MF a[32:35],v[160:163],v[100:103],a[32:35]
DT v[134:135],v15 offset:34816
MF a[36:39],v[164:167],v[100:103],a[36:39]
MF a[40:43],v[168:171],v[100:103],a[40:43]
DT v[136:137],v16 offset:32768
MF a[44:47],v[172:175],v[100:103],a[44:47]
BL v27,s[12:15],s22 offen offset:1024 nt lds
MF a[48:51],v[176:179],v[100:103],a[48:51]
DT v[138:139],v16 offset:34816
MF a[52:55],v[180:183],v[100:103],a[52:55]
MF a[56:59],v[184:187],v[100:103],a[56:59]
DT v[140:141],v17 offset:32768
MF a[60:63],v[188:191],v[100:103],a[60:63]
MF a[64:67],v[160:163],v[104:107],a[64:67]
DT v[142:143],v17 offset:34816
MF a[68:71],v[164:167],v[104:107],a[68:71]
BL v28,s[12:15],s22 offen offset:2048 nt lds
MF a[72:75],v[168:171],v[104:107],a[72:75]
DT v[144:145],v18 offset:32768
MF a[76:79],v[172:175],v[104:107],a[76:79]
MF a[80:83],v[176:179],v[104:107],a[80:83]
DT v[146:147],v18 offset:34816
MF a[84:87],v[180:183],v[104:107],a[84:87]
MF a[88:91],v[184:187],v[104:107],a[88:91]
DT v[148:149],v19 offset:32768
MF a[92:95],v[188:191],v[104:107],a[92:95]
BL v29,s[12:15],s22 offen offset:3072 nt lds
MF a[96:99],v[160:163],v[108:111],a[96:99]
DT v[150:151],v19 offset:34816
MF a[100:103],v[164:167],v[108:111],a[100:103]
MF a[104:107],v[168:171],v[108:111],a[104:107]
DT v[152:153],v20 offset:32768
MF a[108:111],v[172:175],v[108:111],a[108:111]
MF a[112:115],v[176:179],v[108:111],a[112:115]
DT v[154:155],v20 offset:34816
MF a[116:119],v[180:183],v[108:111],a[116:119]
SA m0,s23,0
s_mov_b32 s21,1152
BL v22,s[8:11],s21 offen lds
MF a[120:123],v[184:187],v[108:111],a[120:123]
DT v[156:157],v21 offset:32768
MF a[124:127],v[188:191],v[108:111],a[124:127]
MF a[128:131],v[160:163],v[112:115],a[128:131]
DT v[158:159],v21 offset:34816
MF a[132:135],v[164:167],v[112:115],a[132:135]
MF a[136:139],v[168:171],v[112:115],a[136:139]
DR v[68:71],v10 offset:34816
MF a[140:143],v[172:175],v[112:115],a[140:143]
BL v23,s[8:11],s21 offen offset:1024 lds
MF a[144:147],v[176:179],v[112:115],a[144:147]
DR v[72:75],v10 offset:36864
MF a[148:151],v[180:183],v[112:115],a[148:151]
MF a[152:155],v[184:187],v[112:115],a[152:155]
DR v[76:79],v10 offset:38912
MF a[156:159],v[188:191],v[112:115],a[156:159]
MF a[160:163],v[160:163],v[116:119],a[160:163]
DR v[80:83],v10 offset:40960
MF a[164:167],v[164:167],v[116:119],a[164:167]
BL v24,s[8:11],s21 offen offset:2048 lds
MF a[168:171],v[168:171],v[116:119],a[168:171]
DR v[84:87],v10 offset:43008
MF a[172:175],v[172:175],v[116:119],a[172:175]
MF a[176:179],v[176:179],v[116:119],a[176:179]
DR v[88:91],v10 offset:45056
MF a[180:183],v[180:183],v[116:119],a[180:183]
MF a[184:187],v[184:187],v[116:119],a[184:187]
DR v[92:95],v10 offset:47104
MF a[188:191],v[188:191],v[116:119],a[188:191]
BL v25,s[8:11],s21 offen offset:3072 lds
MF a[192:195],v[160:163],v[120:123],a[192:195]
MF a[196:199],v[164:167],v[120:123],a[196:199]
MF a[200:203],v[168:171],v[120:123],a[200:203]
MF a[204:207],v[172:175],v[120:123],a[204:207]
MF a[208:211],v[176:179],v[120:123],a[208:211]
MF a[212:215],v[180:183],v[120:123],a[212:215]
MF a[216:219],v[184:187],v[120:123],a[216:219]
MF a[220:223],v[188:191],v[120:123],a[220:223]
MF a[224:227],v[160:163],v[124:127],a[224:227]
MF a[228:231],v[164:167],v[124:127],a[228:231]
MF a[232:235],v[168:171],v[124:127],a[232:235]
MF a[236:239],v[172:175],v[124:127],a[236:239]
MF a[240:243],v[176:179],v[124:127],a[240:243]
MF a[244:247],v[180:183],v[124:127],a[244:247]
MF a[248:251],v[184:187],v[124:127],a[248:251]
MF a[252:255],v[188:191],v[124:127],a[252:255]
WT vmcnt(20) lgkmcnt(0)
s_barrier
MF a[0:3],v[128:131],v[64:67],a[0:3]
DR v[96:99],v12 offset:32768
MF a[4:7],v[132:135],v[64:67],a[4:7]
MF a[8:11],v[136:139],v[64:67],a[8:11]
DT v[160:161],v14 offset:49152
MF a[12:15],v[140:143],v[64:67],a[12:15]
MF a[16:19],v[144:147],v[64:67],a[16:19]
DT v[162:163],v14 offset:51200
MF a[20:23],v[148:151],v[64:67],a[20:23]
SA m0,s23,131072
s_mov_b32 s22,4718592
BL v26,s[12:15],s22 offen nt lds
MF a[24:27],v[152:155],v[64:67],a[24:27]
DT v[164:165],v15 offset:49152
MF a[28:31],v[156:159],v[64:67],a[28:31]
MF a[32:35],v[128:131],v[68:71],a[32:35]
DT v[166:167],v15 offset:51200
MF a[36:39],v[132:135],v[68:71],a[36:39]
MF a[40:43],v[136:139],v[68:71],a[40:43]
DT v[168:169],v16 offset:49152
MF a[44:47],v[140:143],v[68:71],a[44:47]
BL v27,s[12:15],s22 offen offset:1024 nt lds
MF a[48:51],v[144:147],v[68:71],a[48:51]
DT v[170:171],v16 offset:51200
MF a[52:55],v[148:151],v[68:71],a[52:55]
MF a[56:59],v[152:155],v[68:71],a[56:59]
DT v[172:173],v17 offset:49152
MF a[60:63],v[156:159],v[68:71],a[60:63]
MF a[64:67],v[128:131],v[72:75],a[64:67]
DT v[174:175],v17 offset:51200
MF a[68:71],v[132:135],v[72:75],a[68:71]
BL v28,s[12:15],s22 offen offset:2048 nt lds
MF a[72:75],v[136:139],v[72:75],a[72:75]
DT v[176:177],v18 offset:49152
MF a[76:79],v[140:143],v[72:75],a[76:79]
MF a[80:83],v[144:147],v[72:75],a[80:83]
DT v[178:179],v18 offset:51200
MF a[84:87],v[148:151],v[72:75],a[84:87]
MF a[88:91],v[152:155],v[72:75],a[88:91]
DT v[180:181],v19 offset:49152
MF a[92:95],v[156:159],v[72:75],a[92:95]
BL v29,s[12:15],s22 offen offset:3072 nt lds
MF a[96:99],v[128:131],v[76:79],a[96:99]
DT v[182:183],v19 offset:51200
MF a[100:103],v[132:135],v[76:79],a[100:103]
MF a[104:107],v[136:139],v[76:79],a[104:107]
DT v[184:185],v20 offset:49152
MF a[108:111],v[140:143],v[76:79],a[108:111]
MF a[112:115],v[144:147],v[76:79],a[112:115]
DT v[186:187],v20 offset:51200
MF a[116:119],v[148:151],v[76:79],a[116:119]
SA m0,s23,16384
s_mov_b32 s21,263296
BL v22,s[8:11],s21 offen lds
MF a[120:123],v[152:155],v[76:79],a[120:123]
DT v[188:189],v21 offset:49152
MF a[124:127],v[156:159],v[76:79],a[124:127]
MF a[128:131],v[128:131],v[80:83],a[128:131]
DT v[190:191],v21 offset:51200
MF a[132:135],v[132:135],v[80:83],a[132:135]
MF a[136:139],v[136:139],v[80:83],a[136:139]
DR v[100:103],v12 offset:34816
MF a[140:143],v[140:143],v[80:83],a[140:143]
BL v23,s[8:11],s21 offen offset:1024 lds
MF a[144:147],v[144:147],v[80:83],a[144:147]
DR v[104:107],v12 offset:36864
MF a[148:151],v[148:151],v[80:83],a[148:151]
MF a[152:155],v[152:155],v[80:83],a[152:155]
DR v[108:111],v12 offset:38912
MF a[156:159],v[156:159],v[80:83],a[156:159]
MF a[160:163],v[128:131],v[84:87],a[160:163]
DR v[112:115],v12 offset:40960
MF a[164:167],v[132:135],v[84:87],a[164:167]
BL v24,s[8:11],s21 offen offset:2048 lds
MF a[168:171],v[136:139],v[84:87],a[168:171]
DR v[116:119],v12 offset:43008
MF a[172:175],v[140:143],v[84:87],a[172:175]
MF a[176:179],v[144:147],v[84:87],a[176:179]
DR v[120:123],v12 offset:45056
MF a[180:183],v[148:151],v[84:87],a[180:183]
MF a[184:187],v[152:155],v[84:87],a[184:187]
DR v[124:127],v12 offset:47104
MF a[188:191],v[156:159],v[84:87],a[188:191]
BL v25,s[8:11],s21 offen offset:3072 lds
MF a[192:195],v[128:131],v[88:91],a[192:195]
MF a[196:199],v[132:135],v[88:91],a[196:199]
MF a[200:203],v[136:139],v[88:91],a[200:203]
MF a[204:207],v[140:143],v[88:91],a[204:207]
MF a[208:211],v[144:147],v[88:91],a[208:211]
MF a[212:215],v[148:151],v[88:91],a[212:215]
MF a[216:219],v[152:155],v[88:91],a[216:219]
MF a[220:223],v[156:159],v[88:91],a[220:223]
MF a[224:227],v[128:131],v[92:95],a[224:227]
MF a[228:231],v[132:135],v[92:95],a[228:231]
MF a[232:235],v[136:139],v[92:95],a[232:235]
MF a[236:239],v[140:143],v[92:95],a[236:239]
MF a[240:243],v[144:147],v[92:95],a[240:243]
MF a[244:247],v[148:151],v[92:95],a[244:247]
MF a[248:251],v[152:155],v[92:95],a[248:251]
MF a[252:255],v[156:159],v[92:95],a[252:255]
WT vmcnt(16) lgkmcnt(0)
s_barrier
MF a[0:3],v[160:163],v[96:99],a[0:3]
DR v[64:67],v11 offset:0
MF a[4:7],v[164:167],v[96:99],a[4:7]
MF a[8:11],v[168:171],v[96:99],a[8:11]
DT v[128:129],v14 offset:0
MF a[12:15],v[172:175],v[96:99],a[12:15]
MF a[16:19],v[176:179],v[96:99],a[16:19]
DT v[130:131],v14 offset:2048
MF a[20:23],v[180:183],v[96:99],a[20:23]
SA m0,s23,147456
s_mov_b32 s22,4980736
BL v26,s[12:15],s22 offen nt lds
MF a[24:27],v[184:187],v[96:99],a[24:27]
DT v[132:133],v15 offset:0
MF a[28:31],v[188:191],v[96:99],a[28:31]
MF a[32:35],v[160:163],v[100:103],a[32:35]
DT v[134:135],v15 offset:2048
MF a[36:39],v[164:167],v[100:103],a[36:39]
MF a[40:43],v[168:171],v[100:103],a[40:43]
DT v[136:137],v16 offset:0
MF a[44:47],v[172:175],v[100:103],a[44:47]
BL v27,s[12:15],s22 offen offset:1024 nt lds
MF a[48:51],v[176:179],v[100:103],a[48:51]
DT v[138:139],v16 offset:2048
MF a[52:55],v[180:183],v[100:103],a[52:55]
MF a[56:59],v[184:187],v[100:103],a[56:59]
DT v[140:141],v17 offset:0
MF a[60:63],v[188:191],v[100:103],a[60:63]
MF a[64:67],v[160:163],v[104:107],a[64:67]
DT v[142:143],v17 offset:2048
MF a[68:71],v[164:167],v[104:107],a[68:71]
BL v28,s[12:15],s22 offen offset:2048 nt lds
MF a[72:75],v[168:171],v[104:107],a[72:75]
DT v[144:145],v18 offset:0
MF a[76:79],v[172:175],v[104:107],a[76:79]
MF a[80:83],v[176:179],v[104:107],a[80:83]
DT v[146:147],v18 offset:2048
MF a[84:87],v[180:183],v[104:107],a[84:87]
MF a[88:91],v[184:187],v[104:107],a[88:91]
DT v[148:149],v19 offset:0
MF a[92:95],v[188:191],v[104:107],a[92:95]
BL v29,s[12:15],s22 offen offset:3072 nt lds
MF a[96:99],v[160:163],v[108:111],a[96:99]
DT v[150:151],v19 offset:2048
MF a[100:103],v[164:167],v[108:111],a[100:103]
MF a[104:107],v[168:171],v[108:111],a[104:107]
DT v[152:153],v20 offset:0
MF a[108:111],v[172:175],v[108:111],a[108:111]
MF a[112:115],v[176:179],v[108:111],a[112:115]
DT v[154:155],v20 offset:2048
MF a[116:119],v[180:183],v[108:111],a[116:119]
SA m0,s23,32768
s_mov_b32 s21,1280
BL v22,s[8:11],s21 offen lds
MF a[120:123],v[184:187],v[108:111],a[120:123]
DT v[156:157],v21 offset:0
MF a[124:127],v[188:191],v[108:111],a[124:127]
MF a[128:131],v[160:163],v[112:115],a[128:131]
DT v[158:159],v21 offset:2048
MF a[132:135],v[164:167],v[112:115],a[132:135]
MF a[136:139],v[168:171],v[112:115],a[136:139]
DR v[68:71],v11 offset:2048
MF a[140:143],v[172:175],v[112:115],a[140:143]
BL v23,s[8:11],s21 offen offset:1024 lds
MF a[144:147],v[176:179],v[112:115],a[144:147]
DR v[72:75],v11 offset:4096
MF a[148:151],v[180:183],v[112:115],a[148:151]
MF a[152:155],v[184:187],v[112:115],a[152:155]
DR v[76:79],v11 offset:6144
MF a[156:159],v[188:191],v[112:115],a[156:159]
MF a[160:163],v[160:163],v[116:119],a[160:163]
DR v[80:83],v11 offset:8192
MF a[164:167],v[164:167],v[116:119],a[164:167]
BL v24,s[8:11],s21 offen offset:2048 lds
MF a[168:171],v[168:171],v[116:119],a[168:171]
DR v[84:87],v11 offset:10240
MF a[172:175],v[172:175],v[116:119],a[172:175]
MF a[176:179],v[176:179],v[116:119],a[176:179]
DR v[88:91],v11 offset:12288
MF a[180:183],v[180:183],v[116:119],a[180:183]
MF a[184:187],v[184:187],v[116:119],a[184:187]
DR v[92:95],v11 offset:14336
MF a[188:191],v[188:191],v[116:119],a[188:191]
BL v25,s[8:11],s21 offen offset:3072 lds
MF a[192:195],v[160:163],v[120:123],a[192:195]
MF a[196:199],v[164:167],v[120:123],a[196:199]
MF a[200:203],v[168:171],v[120:123],a[200:203]
MF a[204:207],v[172:175],v[120:123],a[204:207]
s_cmp_lg_u32 s20,0
s_cbranch_scc1 k1_kernel_k_nosig
s_lshr_b32 s30,s2,4
s_lshl_b32 s30,s30,2
v_mov_b32 v4,1
v_mov_b32 v5,s30
s_mov_b64 exec,1
buffer_atomic_add v4,v5,s[68:71],0 offen sc1
s_mov_b64 exec,-1
k1_kernel_k_nosig:
MF a[208:211],v[176:179],v[120:123],a[208:211]
MF a[212:215],v[180:183],v[120:123],a[212:215]
MF a[216:219],v[184:187],v[120:123],a[216:219]
MF a[220:223],v[188:191],v[120:123],a[220:223]
MF a[224:227],v[160:163],v[124:127],a[224:227]
MF a[228:231],v[164:167],v[124:127],a[228:231]
MF a[232:235],v[168:171],v[124:127],a[232:235]
MF a[236:239],v[172:175],v[124:127],a[236:239]
MF a[240:243],v[176:179],v[124:127],a[240:243]
MF a[244:247],v[180:183],v[124:127],a[244:247]
MF a[248:251],v[184:187],v[124:127],a[248:251]
MF a[252:255],v[188:191],v[124:127],a[252:255]
WT vmcnt(20) lgkmcnt(0)
s_barrier
MF a[0:3],v[128:131],v[64:67],a[0:3]
DR v[96:99],v13 offset:0
MF a[4:7],v[132:135],v[64:67],a[4:7]
MF a[8:11],v[136:139],v[64:67],a[8:11]
DT v[160:161],v14 offset:16384
MF a[12:15],v[140:143],v[64:67],a[12:15]
MF a[16:19],v[144:147],v[64:67],a[16:19]
DT v[162:163],v14 offset:18432
MF a[20:23],v[148:151],v[64:67],a[20:23]
SA m0,s23,98304
s_mov_b32 s22,5242880
BL v26,s[12:15],s22 offen nt lds
MF a[24:27],v[152:155],v[64:67],a[24:27]
DT v[164:165],v15 offset:16384
MF a[28:31],v[156:159],v[64:67],a[28:31]
MF a[32:35],v[128:131],v[68:71],a[32:35]
DT v[166:167],v15 offset:18432
MF a[36:39],v[132:135],v[68:71],a[36:39]
MF a[40:43],v[136:139],v[68:71],a[40:43]
DT v[168:169],v16 offset:16384
MF a[44:47],v[140:143],v[68:71],a[44:47]
BL v27,s[12:15],s22 offen offset:1024 nt lds
MF a[48:51],v[144:147],v[68:71],a[48:51]
DT v[170:171],v16 offset:18432
MF a[52:55],v[148:151],v[68:71],a[52:55]
MF a[56:59],v[152:155],v[68:71],a[56:59]
DT v[172:173],v17 offset:16384
MF a[60:63],v[156:159],v[68:71],a[60:63]
MF a[64:67],v[128:131],v[72:75],a[64:67]
DT v[174:175],v17 offset:18432
MF a[68:71],v[132:135],v[72:75],a[68:71]
BL v28,s[12:15],s22 offen offset:2048 nt lds
MF a[72:75],v[136:139],v[72:75],a[72:75]
DT v[176:177],v18 offset:16384
MF a[76:79],v[140:143],v[72:75],a[76:79]
MF a[80:83],v[144:147],v[72:75],a[80:83]
DT v[178:179],v18 offset:18432
MF a[84:87],v[148:151],v[72:75],a[84:87]
MF a[88:91],v[152:155],v[72:75],a[88:91]
DT v[180:181],v19 offset:16384
MF a[92:95],v[156:159],v[72:75],a[92:95]
BL v29,s[12:15],s22 offen offset:3072 nt lds
MF a[96:99],v[128:131],v[76:79],a[96:99]
DT v[182:183],v19 offset:18432
MF a[100:103],v[132:135],v[76:79],a[100:103]
MF a[104:107],v[136:139],v[76:79],a[104:107]
DT v[184:185],v20 offset:16384
MF a[108:111],v[140:143],v[76:79],a[108:111]
MF a[112:115],v[144:147],v[76:79],a[112:115]
DT v[186:187],v20 offset:18432
MF a[116:119],v[148:151],v[76:79],a[116:119]
SA m0,s23,49152
s_mov_b32 s21,263424
BL v22,s[8:11],s21 offen lds
MF a[120:123],v[152:155],v[76:79],a[120:123]
DT v[188:189],v21 offset:16384
MF a[124:127],v[156:159],v[76:79],a[124:127]
MF a[128:131],v[128:131],v[80:83],a[128:131]
DT v[190:191],v21 offset:18432
MF a[132:135],v[132:135],v[80:83],a[132:135]
MF a[136:139],v[136:139],v[80:83],a[136:139]
DR v[100:103],v13 offset:2048
MF a[140:143],v[140:143],v[80:83],a[140:143]
BL v23,s[8:11],s21 offen offset:1024 lds
MF a[144:147],v[144:147],v[80:83],a[144:147]
DR v[104:107],v13 offset:4096
MF a[148:151],v[148:151],v[80:83],a[148:151]
MF a[152:155],v[152:155],v[80:83],a[152:155]
DR v[108:111],v13 offset:6144
MF a[156:159],v[156:159],v[80:83],a[156:159]
MF a[160:163],v[128:131],v[84:87],a[160:163]
DR v[112:115],v13 offset:8192
MF a[164:167],v[132:135],v[84:87],a[164:167]
BL v24,s[8:11],s21 offen offset:2048 lds
MF a[168:171],v[136:139],v[84:87],a[168:171]
DR v[116:119],v13 offset:10240
MF a[172:175],v[140:143],v[84:87],a[172:175]
MF a[176:179],v[144:147],v[84:87],a[176:179]
DR v[120:123],v13 offset:12288
MF a[180:183],v[148:151],v[84:87],a[180:183]
MF a[184:187],v[152:155],v[84:87],a[184:187]
DR v[124:127],v13 offset:14336
MF a[188:191],v[156:159],v[84:87],a[188:191]
BL v25,s[8:11],s21 offen offset:3072 lds
MF a[192:195],v[128:131],v[88:91],a[192:195]
MF a[196:199],v[132:135],v[88:91],a[196:199]
MF a[200:203],v[136:139],v[88:91],a[200:203]
MF a[204:207],v[140:143],v[88:91],a[204:207]
MF a[208:211],v[144:147],v[88:91],a[208:211]
MF a[212:215],v[148:151],v[88:91],a[212:215]
MF a[216:219],v[152:155],v[88:91],a[216:219]
MF a[220:223],v[156:159],v[88:91],a[220:223]
MF a[224:227],v[128:131],v[92:95],a[224:227]
MF a[228:231],v[132:135],v[92:95],a[228:231]
MF a[232:235],v[136:139],v[92:95],a[232:235]
MF a[236:239],v[140:143],v[92:95],a[236:239]
MF a[240:243],v[144:147],v[92:95],a[240:243]
MF a[244:247],v[148:151],v[92:95],a[244:247]
MF a[248:251],v[152:155],v[92:95],a[248:251]
MF a[252:255],v[156:159],v[92:95],a[252:255]
WT vmcnt(16) lgkmcnt(0)
s_barrier
MF a[0:3],v[160:163],v[96:99],a[0:3]
DR v[64:67],v10 offset:0
MF a[4:7],v[164:167],v[96:99],a[4:7]
MF a[8:11],v[168:171],v[96:99],a[8:11]
DT v[128:129],v14 offset:32768
MF a[12:15],v[172:175],v[96:99],a[12:15]
MF a[16:19],v[176:179],v[96:99],a[16:19]
DT v[130:131],v14 offset:34816
MF a[20:23],v[180:183],v[96:99],a[20:23]
SA m0,s23,114688
s_mov_b32 s22,5505024
BL v26,s[12:15],s22 offen nt lds
MF a[24:27],v[184:187],v[96:99],a[24:27]
DT v[132:133],v15 offset:32768
MF a[28:31],v[188:191],v[96:99],a[28:31]
MF a[32:35],v[160:163],v[100:103],a[32:35]
DT v[134:135],v15 offset:34816
MF a[36:39],v[164:167],v[100:103],a[36:39]
MF a[40:43],v[168:171],v[100:103],a[40:43]
DT v[136:137],v16 offset:32768
MF a[44:47],v[172:175],v[100:103],a[44:47]
BL v27,s[12:15],s22 offen offset:1024 nt lds
MF a[48:51],v[176:179],v[100:103],a[48:51]
DT v[138:139],v16 offset:34816
MF a[52:55],v[180:183],v[100:103],a[52:55]
MF a[56:59],v[184:187],v[100:103],a[56:59]
DT v[140:141],v17 offset:32768
MF a[60:63],v[188:191],v[100:103],a[60:63]
MF a[64:67],v[160:163],v[104:107],a[64:67]
DT v[142:143],v17 offset:34816
MF a[68:71],v[164:167],v[104:107],a[68:71]
BL v28,s[12:15],s22 offen offset:2048 nt lds
MF a[72:75],v[168:171],v[104:107],a[72:75]
DT v[144:145],v18 offset:32768
MF a[76:79],v[172:175],v[104:107],a[76:79]
MF a[80:83],v[176:179],v[104:107],a[80:83]
DT v[146:147],v18 offset:34816
MF a[84:87],v[180:183],v[104:107],a[84:87]
MF a[88:91],v[184:187],v[104:107],a[88:91]
DT v[148:149],v19 offset:32768
MF a[92:95],v[188:191],v[104:107],a[92:95]
BL v29,s[12:15],s22 offen offset:3072 nt lds
MF a[96:99],v[160:163],v[108:111],a[96:99]
DT v[150:151],v19 offset:34816
MF a[100:103],v[164:167],v[108:111],a[100:103]
MF a[104:107],v[168:171],v[108:111],a[104:107]
DT v[152:153],v20 offset:32768
MF a[108:111],v[172:175],v[108:111],a[108:111]
MF a[112:115],v[176:179],v[108:111],a[112:115]
DT v[154:155],v20 offset:34816
MF a[116:119],v[180:183],v[108:111],a[116:119]
SA m0,s23,65536
s_mov_b32 s21,1408
BL v22,s[8:11],s21 offen lds
MF a[120:123],v[184:187],v[108:111],a[120:123]
DT v[156:157],v21 offset:32768
MF a[124:127],v[188:191],v[108:111],a[124:127]
MF a[128:131],v[160:163],v[112:115],a[128:131]
DT v[158:159],v21 offset:34816
MF a[132:135],v[164:167],v[112:115],a[132:135]
MF a[136:139],v[168:171],v[112:115],a[136:139]
DR v[68:71],v10 offset:2048
MF a[140:143],v[172:175],v[112:115],a[140:143]
BL v23,s[8:11],s21 offen offset:1024 lds
MF a[144:147],v[176:179],v[112:115],a[144:147]
DR v[72:75],v10 offset:4096
MF a[148:151],v[180:183],v[112:115],a[148:151]
MF a[152:155],v[184:187],v[112:115],a[152:155]
DR v[76:79],v10 offset:6144
MF a[156:159],v[188:191],v[112:115],a[156:159]
MF a[160:163],v[160:163],v[116:119],a[160:163]
DR v[80:83],v10 offset:8192
MF a[164:167],v[164:167],v[116:119],a[164:167]
BL v24,s[8:11],s21 offen offset:2048 lds
MF a[168:171],v[168:171],v[116:119],a[168:171]
DR v[84:87],v10 offset:10240
MF a[172:175],v[172:175],v[116:119],a[172:175]
MF a[176:179],v[176:179],v[116:119],a[176:179]
DR v[88:91],v10 offset:12288
MF a[180:183],v[180:183],v[116:119],a[180:183]
MF a[184:187],v[184:187],v[116:119],a[184:187]
DR v[92:95],v10 offset:14336
MF a[188:191],v[188:191],v[116:119],a[188:191]
BL v25,s[8:11],s21 offen offset:3072 lds
MF a[192:195],v[160:163],v[120:123],a[192:195]
MF a[196:199],v[164:167],v[120:123],a[196:199]
MF a[200:203],v[168:171],v[120:123],a[200:203]
MF a[204:207],v[172:175],v[120:123],a[204:207]
MF a[208:211],v[176:179],v[120:123],a[208:211]
MF a[212:215],v[180:183],v[120:123],a[212:215]
MF a[216:219],v[184:187],v[120:123],a[216:219]
MF a[220:223],v[188:191],v[120:123],a[220:223]
MF a[224:227],v[160:163],v[124:127],a[224:227]
MF a[228:231],v[164:167],v[124:127],a[228:231]
MF a[232:235],v[168:171],v[124:127],a[232:235]
MF a[236:239],v[172:175],v[124:127],a[236:239]
MF a[240:243],v[176:179],v[124:127],a[240:243]
MF a[244:247],v[180:183],v[124:127],a[244:247]
MF a[248:251],v[184:187],v[124:127],a[248:251]
MF a[252:255],v[188:191],v[124:127],a[252:255]
WT vmcnt(20) lgkmcnt(0)
s_barrier
MF a[0:3],v[128:131],v[64:67],a[0:3]
DR v[96:99],v12 offset:0
MF a[4:7],v[132:135],v[64:67],a[4:7]
MF a[8:11],v[136:139],v[64:67],a[8:11]
DT v[160:161],v14 offset:49152
MF a[12:15],v[140:143],v[64:67],a[12:15]
MF a[16:19],v[144:147],v[64:67],a[16:19]
DT v[162:163],v14 offset:51200
MF a[20:23],v[148:151],v[64:67],a[20:23]
SA m0,s23,131072
s_mov_b32 s22,5767168
BL v26,s[12:15],s22 offen nt lds
MF a[24:27],v[152:155],v[64:67],a[24:27]
DT v[164:165],v15 offset:49152
MF a[28:31],v[156:159],v[64:67],a[28:31]
MF a[32:35],v[128:131],v[68:71],a[32:35]
DT v[166:167],v15 offset:51200
MF a[36:39],v[132:135],v[68:71],a[36:39]
MF a[40:43],v[136:139],v[68:71],a[40:43]
DT v[168:169],v16 offset:49152
MF a[44:47],v[140:143],v[68:71],a[44:47]
BL v27,s[12:15],s22 offen offset:1024 nt lds
MF a[48:51],v[144:147],v[68:71],a[48:51]
DT v[170:171],v16 offset:51200
MF a[52:55],v[148:151],v[68:71],a[52:55]
MF a[56:59],v[152:155],v[68:71],a[56:59]
DT v[172:173],v17 offset:49152
MF a[60:63],v[156:159],v[68:71],a[60:63]
MF a[64:67],v[128:131],v[72:75],a[64:67]
DT v[174:175],v17 offset:51200
MF a[68:71],v[132:135],v[72:75],a[68:71]
BL v28,s[12:15],s22 offen offset:2048 nt lds
MF a[72:75],v[136:139],v[72:75],a[72:75]
DT v[176:177],v18 offset:49152
MF a[76:79],v[140:143],v[72:75],a[76:79]
MF a[80:83],v[144:147],v[72:75],a[80:83]
DT v[178:179],v18 offset:51200
MF a[84:87],v[148:151],v[72:75],a[84:87]
MF a[88:91],v[152:155],v[72:75],a[88:91]
DT v[180:181],v19 offset:49152
MF a[92:95],v[156:159],v[72:75],a[92:95]
BL v29,s[12:15],s22 offen offset:3072 nt lds
MF a[96:99],v[128:131],v[76:79],a[96:99]
DT v[182:183],v19 offset:51200
MF a[100:103],v[132:135],v[76:79],a[100:103]
MF a[104:107],v[136:139],v[76:79],a[104:107]
DT v[184:185],v20 offset:49152
MF a[108:111],v[140:143],v[76:79],a[108:111]
MF a[112:115],v[144:147],v[76:79],a[112:115]
DT v[186:187],v20 offset:51200
MF a[116:119],v[148:151],v[76:79],a[116:119]
SA m0,s23,81920
s_mov_b32 s21,263552
BL v22,s[8:11],s21 offen lds
MF a[120:123],v[152:155],v[76:79],a[120:123]
DT v[188:189],v21 offset:49152
MF a[124:127],v[156:159],v[76:79],a[124:127]
MF a[128:131],v[128:131],v[80:83],a[128:131]
DT v[190:191],v21 offset:51200
MF a[132:135],v[132:135],v[80:83],a[132:135]
MF a[136:139],v[136:139],v[80:83],a[136:139]
DR v[100:103],v12 offset:2048
MF a[140:143],v[140:143],v[80:83],a[140:143]
BL v23,s[8:11],s21 offen offset:1024 lds
MF a[144:147],v[144:147],v[80:83],a[144:147]
DR v[104:107],v12 offset:4096
MF a[148:151],v[148:151],v[80:83],a[148:151]
MF a[152:155],v[152:155],v[80:83],a[152:155]
DR v[108:111],v12 offset:6144
MF a[156:159],v[156:159],v[80:83],a[156:159]
MF a[160:163],v[128:131],v[84:87],a[160:163]
DR v[112:115],v12 offset:8192
MF a[164:167],v[132:135],v[84:87],a[164:167]
BL v24,s[8:11],s21 offen offset:2048 lds
MF a[168:171],v[136:139],v[84:87],a[168:171]
DR v[116:119],v12 offset:10240
MF a[172:175],v[140:143],v[84:87],a[172:175]
MF a[176:179],v[144:147],v[84:87],a[176:179]
DR v[120:123],v12 offset:12288
MF a[180:183],v[148:151],v[84:87],a[180:183]
MF a[184:187],v[152:155],v[84:87],a[184:187]
DR v[124:127],v12 offset:14336
MF a[188:191],v[156:159],v[84:87],a[188:191]
BL v25,s[8:11],s21 offen offset:3072 lds
MF a[192:195],v[128:131],v[88:91],a[192:195]
MF a[196:199],v[132:135],v[88:91],a[196:199]
MF a[200:203],v[136:139],v[88:91],a[200:203]
MF a[204:207],v[140:143],v[88:91],a[204:207]
MF a[208:211],v[144:147],v[88:91],a[208:211]
MF a[212:215],v[148:151],v[88:91],a[212:215]
s_lshl_b32 s30,s51,2
v_mov_b32 v5,s30
buffer_load_dword v6,v5,s[68:71],0 offen sc1
buffer_load_dword v7,v34,s[40:43],0 offen
MF a[216:219],v[152:155],v[88:91],a[216:219]
MF a[220:223],v[156:159],v[88:91],a[220:223]
MF a[224:227],v[128:131],v[92:95],a[224:227]
MF a[228:231],v[132:135],v[92:95],a[228:231]
MF a[232:235],v[136:139],v[92:95],a[232:235]
MF a[236:239],v[140:143],v[92:95],a[236:239]
MF a[240:243],v[144:147],v[92:95],a[240:243]
MF a[244:247],v[148:151],v[92:95],a[244:247]
MF a[248:251],v[152:155],v[92:95],a[248:251]
MF a[252:255],v[156:159],v[92:95],a[252:255]
WT vmcnt(18) lgkmcnt(0)
s_barrier
MF a[0:3],v[160:163],v[96:99],a[0:3]
DR v[64:67],v10 offset:32768
MF a[4:7],v[164:167],v[96:99],a[4:7]
MF a[8:11],v[168:171],v[96:99],a[8:11]
DT v[128:129],v14 offset:0
MF a[12:15],v[172:175],v[96:99],a[12:15]
MF a[16:19],v[176:179],v[96:99],a[16:19]
DT v[130:131],v14 offset:2048
MF a[20:23],v[180:183],v[96:99],a[20:23]
SA m0,s23,147456
s_mov_b32 s22,6029312
BL v26,s[12:15],s22 offen nt lds
MF a[24:27],v[184:187],v[96:99],a[24:27]
DT v[132:133],v15 offset:0
MF a[28:31],v[188:191],v[96:99],a[28:31]
MF a[32:35],v[160:163],v[100:103],a[32:35]
DT v[134:135],v15 offset:2048
MF a[36:39],v[164:167],v[100:103],a[36:39]
MF a[40:43],v[168:171],v[100:103],a[40:43]
DT v[136:137],v16 offset:0
MF a[44:47],v[172:175],v[100:103],a[44:47]
BL v27,s[12:15],s22 offen offset:1024 nt lds
MF a[48:51],v[176:179],v[100:103],a[48:51]
DT v[138:139],v16 offset:2048
MF a[52:55],v[180:183],v[100:103],a[52:55]
MF a[56:59],v[184:187],v[100:103],a[56:59]
DT v[140:141],v17 offset:0
MF a[60:63],v[188:191],v[100:103],a[60:63]
MF a[64:67],v[160:163],v[104:107],a[64:67]
DT v[142:143],v17 offset:2048
MF a[68:71],v[164:167],v[104:107],a[68:71]
BL v28,s[12:15],s22 offen offset:2048 nt lds
MF a[72:75],v[168:171],v[104:107],a[72:75]
DT v[144:145],v18 offset:0
MF a[76:79],v[172:175],v[104:107],a[76:79]
MF a[80:83],v[176:179],v[104:107],a[80:83]
DT v[146:147],v18 offset:2048
MF a[84:87],v[180:183],v[104:107],a[84:87]
MF a[88:91],v[184:187],v[104:107],a[88:91]
DT v[148:149],v19 offset:0
MF a[92:95],v[188:191],v[104:107],a[92:95]
BL v29,s[12:15],s22 offen offset:3072 nt lds
MF a[96:99],v[160:163],v[108:111],a[96:99]
DT v[150:151],v19 offset:2048
MF a[100:103],v[164:167],v[108:111],a[100:103]
MF a[104:107],v[168:171],v[108:111],a[104:107]
DT v[152:153],v20 offset:0
MF a[108:111],v[172:175],v[108:111],a[108:111]
MF a[112:115],v[176:179],v[108:111],a[112:115]
DT v[154:155],v20 offset:2048
MF a[116:119],v[180:183],v[108:111],a[116:119]
SA m0,s23,0
s_mov_b32 s21,1536
BL v22,s[8:11],s21 offen lds
MF a[120:123],v[184:187],v[108:111],a[120:123]
DT v[156:157],v21 offset:0
MF a[124:127],v[188:191],v[108:111],a[124:127]
MF a[128:131],v[160:163],v[112:115],a[128:131]
DT v[158:159],v21 offset:2048
MF a[132:135],v[164:167],v[112:115],a[132:135]
MF a[136:139],v[168:171],v[112:115],a[136:139]
DR v[68:71],v10 offset:34816
MF a[140:143],v[172:175],v[112:115],a[140:143]
BL v23,s[8:11],s21 offen offset:1024 lds
MF a[144:147],v[176:179],v[112:115],a[144:147]
DR v[72:75],v10 offset:36864
MF a[148:151],v[180:183],v[112:115],a[148:151]
MF a[152:155],v[184:187],v[112:115],a[152:155]
DR v[76:79],v10 offset:38912
MF a[156:159],v[188:191],v[112:115],a[156:159]
MF a[160:163],v[160:163],v[116:119],a[160:163]
DR v[80:83],v10 offset:40960
MF a[164:167],v[164:167],v[116:119],a[164:167]
BL v24,s[8:11],s21 offen offset:2048 lds
MF a[168:171],v[168:171],v[116:119],a[168:171]
DR v[84:87],v10 offset:43008
MF a[172:175],v[172:175],v[116:119],a[172:175]
MF a[176:179],v[176:179],v[116:119],a[176:179]
DR v[88:91],v10 offset:45056
MF a[180:183],v[180:183],v[116:119],a[180:183]
MF a[184:187],v[184:187],v[116:119],a[184:187]
DR v[92:95],v10 offset:47104
MF a[188:191],v[188:191],v[116:119],a[188:191]
BL v25,s[8:11],s21 offen offset:3072 lds
MF a[192:195],v[160:163],v[120:123],a[192:195]
MF a[196:199],v[164:167],v[120:123],a[196:199]
MF a[200:203],v[168:171],v[120:123],a[200:203]
MF a[204:207],v[172:175],v[120:123],a[204:207]
MF a[208:211],v[176:179],v[120:123],a[208:211]
MF a[212:215],v[180:183],v[120:123],a[212:215]
MF a[216:219],v[184:187],v[120:123],a[216:219]
MF a[220:223],v[188:191],v[120:123],a[220:223]
MF a[224:227],v[160:163],v[124:127],a[224:227]
MF a[228:231],v[164:167],v[124:127],a[228:231]
MF a[232:235],v[168:171],v[124:127],a[232:235]
MF a[236:239],v[172:175],v[124:127],a[236:239]
MF a[240:243],v[176:179],v[124:127],a[240:243]
MF a[244:247],v[180:183],v[124:127],a[244:247]
MF a[248:251],v[184:187],v[124:127],a[248:251]
MF a[252:255],v[188:191],v[124:127],a[252:255]
WT vmcnt(22) lgkmcnt(0)
s_barrier
MF a[0:3],v[128:131],v[64:67],a[0:3]
DR v[96:99],v12 offset:32768
MF a[4:7],v[132:135],v[64:67],a[4:7]
MF a[8:11],v[136:139],v[64:67],a[8:11]
DT v[160:161],v14 offset:16384
MF a[12:15],v[140:143],v[64:67],a[12:15]
MF a[16:19],v[144:147],v[64:67],a[16:19]
DT v[162:163],v14 offset:18432
MF a[20:23],v[148:151],v[64:67],a[20:23]
SA m0,s23,98304
s_mov_b32 s22,6291456
BL v26,s[12:15],s22 offen nt lds
MF a[24:27],v[152:155],v[64:67],a[24:27]
DT v[164:165],v15 offset:16384
MF a[28:31],v[156:159],v[64:67],a[28:31]
MF a[32:35],v[128:131],v[68:71],a[32:35]
DT v[166:167],v15 offset:18432
MF a[36:39],v[132:135],v[68:71],a[36:39]
MF a[40:43],v[136:139],v[68:71],a[40:43]
DT v[168:169],v16 offset:16384
MF a[44:47],v[140:143],v[68:71],a[44:47]
BL v27,s[12:15],s22 offen offset:1024 nt lds
MF a[48:51],v[144:147],v[68:71],a[48:51]
DT v[170:171],v16 offset:18432
MF a[52:55],v[148:151],v[68:71],a[52:55]
MF a[56:59],v[152:155],v[68:71],a[56:59]
DT v[172:173],v17 offset:16384
MF a[60:63],v[156:159],v[68:71],a[60:63]
MF a[64:67],v[128:131],v[72:75],a[64:67]
DT v[174:175],v17 offset:18432
MF a[68:71],v[132:135],v[72:75],a[68:71]
BL v28,s[12:15],s22 offen offset:2048 nt lds
MF a[72:75],v[136:139],v[72:75],a[72:75]
DT v[176:177],v18 offset:16384
MF a[76:79],v[140:143],v[72:75],a[76:79]
MF a[80:83],v[144:147],v[72:75],a[80:83]
DT v[178:179],v18 offset:18432
MF a[84:87],v[148:151],v[72:75],a[84:87]
MF a[88:91],v[152:155],v[72:75],a[88:91]
DT v[180:181],v19 offset:16384
MF a[92:95],v[156:159],v[72:75],a[92:95]
BL v29,s[12:15],s22 offen offset:3072 nt lds
MF a[96:99],v[128:131],v[76:79],a[96:99]
DT v[182:183],v19 offset:18432
MF a[100:103],v[132:135],v[76:79],a[100:103]
MF a[104:107],v[136:139],v[76:79],a[104:107]
DT v[184:185],v20 offset:16384
MF a[108:111],v[140:143],v[76:79],a[108:111]
MF a[112:115],v[144:147],v[76:79],a[112:115]
DT v[186:187],v20 offset:18432
MF a[116:119],v[148:151],v[76:79],a[116:119]
SA m0,s23,16384
s_mov_b32 s21,263680
BL v22,s[8:11],s21 offen lds
MF a[120:123],v[152:155],v[76:79],a[120:123]
DT v[188:189],v21 offset:16384
MF a[124:127],v[156:159],v[76:79],a[124:127]
MF a[128:131],v[128:131],v[80:83],a[128:131]
DT v[190:191],v21 offset:18432
MF a[132:135],v[132:135],v[80:83],a[132:135]
MF a[136:139],v[136:139],v[80:83],a[136:139]
DR v[100:103],v12 offset:34816
MF a[140:143],v[140:143],v[80:83],a[140:143]
BL v23,s[8:11],s21 offen offset:1024 lds
MF a[144:147],v[144:147],v[80:83],a[144:147]
DR v[104:107],v12 offset:36864
MF a[148:151],v[148:151],v[80:83],a[148:151]
MF a[152:155],v[152:155],v[80:83],a[152:155]
DR v[108:111],v12 offset:38912
MF a[156:159],v[156:159],v[80:83],a[156:159]
MF a[160:163],v[128:131],v[84:87],a[160:163]
DR v[112:115],v12 offset:40960
MF a[164:167],v[132:135],v[84:87],a[164:167]
BL v24,s[8:11],s21 offen offset:2048 lds
MF a[168:171],v[136:139],v[84:87],a[168:171]
DR v[116:119],v12 offset:43008
MF a[172:175],v[140:143],v[84:87],a[172:175]
MF a[176:179],v[144:147],v[84:87],a[176:179]
DR v[120:123],v12 offset:45056
MF a[180:183],v[148:151],v[84:87],a[180:183]
MF a[184:187],v[152:155],v[84:87],a[184:187]
DR v[124:127],v12 offset:47104
MF a[188:191],v[156:159],v[84:87],a[188:191]
BL v25,s[8:11],s21 offen offset:3072 lds
MF a[192:195],v[128:131],v[88:91],a[192:195]
MF a[196:199],v[132:135],v[88:91],a[196:199]
MF a[200:203],v[136:139],v[88:91],a[200:203]
MF a[204:207],v[140:143],v[88:91],a[204:207]
MF a[208:211],v[144:147],v[88:91],a[208:211]
MF a[212:215],v[148:151],v[88:91],a[212:215]
MF a[216:219],v[152:155],v[88:91],a[216:219]
MF a[220:223],v[156:159],v[88:91],a[220:223]
MF a[224:227],v[128:131],v[92:95],a[224:227]
MF a[228:231],v[132:135],v[92:95],a[228:231]
MF a[232:235],v[136:139],v[92:95],a[232:235]
MF a[236:239],v[140:143],v[92:95],a[236:239]
MF a[240:243],v[144:147],v[92:95],a[240:243]
MF a[244:247],v[148:151],v[92:95],a[244:247]
MF a[248:251],v[152:155],v[92:95],a[248:251]
MF a[252:255],v[156:159],v[92:95],a[252:255]
WT vmcnt(18) lgkmcnt(0)
s_barrier
MF a[0:3],v[160:163],v[96:99],a[0:3]
DR v[64:67],v11 offset:0
MF a[4:7],v[164:167],v[96:99],a[4:7]
MF a[8:11],v[168:171],v[96:99],a[8:11]
DT v[128:129],v14 offset:32768
MF a[12:15],v[172:175],v[96:99],a[12:15]
MF a[16:19],v[176:179],v[96:99],a[16:19]
DT v[130:131],v14 offset:34816
MF a[20:23],v[180:183],v[96:99],a[20:23]
SA m0,s23,114688
s_mov_b32 s22,6553600
BL v26,s[12:15],s22 offen nt lds
MF a[24:27],v[184:187],v[96:99],a[24:27]
DT v[132:133],v15 offset:32768
MF a[28:31],v[188:191],v[96:99],a[28:31]
MF a[32:35],v[160:163],v[100:103],a[32:35]
DT v[134:135],v15 offset:34816
MF a[36:39],v[164:167],v[100:103],a[36:39]
MF a[40:43],v[168:171],v[100:103],a[40:43]
DT v[136:137],v16 offset:32768
MF a[44:47],v[172:175],v[100:103],a[44:47]
BL v27,s[12:15],s22 offen offset:1024 nt lds
MF a[48:51],v[176:179],v[100:103],a[48:51]
DT v[138:139],v16 offset:34816
MF a[52:55],v[180:183],v[100:103],a[52:55]
MF a[56:59],v[184:187],v[100:103],a[56:59]
DT v[140:141],v17 offset:32768
MF a[60:63],v[188:191],v[100:103],a[60:63]
MF a[64:67],v[160:163],v[104:107],a[64:67]
DT v[142:143],v17 offset:34816
MF a[68:71],v[164:167],v[104:107],a[68:71]
BL v28,s[12:15],s22 offen offset:2048 nt lds
MF a[72:75],v[168:171],v[104:107],a[72:75]
DT v[144:145],v18 offset:32768
MF a[76:79],v[172:175],v[104:107],a[76:79]
MF a[80:83],v[176:179],v[104:107],a[80:83]
DT v[146:147],v18 offset:34816
MF a[84:87],v[180:183],v[104:107],a[84:87]
MF a[88:91],v[184:187],v[104:107],a[88:91]
DT v[148:149],v19 offset:32768
MF a[92:95],v[188:191],v[104:107],a[92:95]
BL v29,s[12:15],s22 offen offset:3072 nt lds
MF a[96:99],v[160:163],v[108:111],a[96:99]
DT v[150:151],v19 offset:34816
MF a[100:103],v[164:167],v[108:111],a[100:103]
MF a[104:107],v[168:171],v[108:111],a[104:107]
DT v[152:153],v20 offset:32768
MF a[108:111],v[172:175],v[108:111],a[108:111]
MF a[112:115],v[176:179],v[108:111],a[112:115]
DT v[154:155],v20 offset:34816
MF a[116:119],v[180:183],v[108:111],a[116:119]
SA m0,s23,32768
s_mov_b32 s21,1664
BL v22,s[8:11],s21 offen lds
MF a[120:123],v[184:187],v[108:111],a[120:123]
DT v[156:157],v21 offset:32768
MF a[124:127],v[188:191],v[108:111],a[124:127]
MF a[128:131],v[160:163],v[112:115],a[128:131]
DT v[158:159],v21 offset:34816
MF a[132:135],v[164:167],v[112:115],a[132:135]
MF a[136:139],v[168:171],v[112:115],a[136:139]
DR v[68:71],v11 offset:2048
MF a[140:143],v[172:175],v[112:115],a[140:143]
BL v23,s[8:11],s21 offen offset:1024 lds
MF a[144:147],v[176:179],v[112:115],a[144:147]
DR v[72:75],v11 offset:4096
MF a[148:151],v[180:183],v[112:115],a[148:151]
MF a[152:155],v[184:187],v[112:115],a[152:155]
DR v[76:79],v11 offset:6144
MF a[156:159],v[188:191],v[112:115],a[156:159]
MF a[160:163],v[160:163],v[116:119],a[160:163]
DR v[80:83],v11 offset:8192
MF a[164:167],v[164:167],v[116:119],a[164:167]
BL v24,s[8:11],s21 offen offset:2048 lds
MF a[168:171],v[168:171],v[116:119],a[168:171]
DR v[84:87],v11 offset:10240
MF a[172:175],v[172:175],v[116:119],a[172:175]
MF a[176:179],v[176:179],v[116:119],a[176:179]
DR v[88:91],v11 offset:12288
MF a[180:183],v[180:183],v[116:119],a[180:183]
MF a[184:187],v[184:187],v[116:119],a[184:187]
DR v[92:95],v11 offset:14336
MF a[188:191],v[188:191],v[116:119],a[188:191]
BL v25,s[8:11],s21 offen offset:3072 lds
MF a[192:195],v[160:163],v[120:123],a[192:195]
MF a[196:199],v[164:167],v[120:123],a[196:199]
MF a[200:203],v[168:171],v[120:123],a[200:203]
MF a[204:207],v[172:175],v[120:123],a[204:207]
MF a[208:211],v[176:179],v[120:123],a[208:211]
MF a[212:215],v[180:183],v[120:123],a[212:215]
MF a[216:219],v[184:187],v[120:123],a[216:219]
MF a[220:223],v[188:191],v[120:123],a[220:223]
MF a[224:227],v[160:163],v[124:127],a[224:227]
MF a[228:231],v[164:167],v[124:127],a[228:231]
MF a[232:235],v[168:171],v[124:127],a[232:235]
MF a[236:239],v[172:175],v[124:127],a[236:239]
MF a[240:243],v[176:179],v[124:127],a[240:243]
MF a[244:247],v[180:183],v[124:127],a[244:247]
MF a[248:251],v[184:187],v[124:127],a[248:251]
MF a[252:255],v[188:191],v[124:127],a[252:255]
WT vmcnt(20) lgkmcnt(0)
s_barrier
MF a[0:3],v[128:131],v[64:67],a[0:3]
DR v[96:99],v13 offset:0
MF a[4:7],v[132:135],v[64:67],a[4:7]
MF a[8:11],v[136:139],v[64:67],a[8:11]
DT v[160:161],v14 offset:49152
MF a[12:15],v[140:143],v[64:67],a[12:15]
MF a[16:19],v[144:147],v[64:67],a[16:19]
DT v[162:163],v14 offset:51200
MF a[20:23],v[148:151],v[64:67],a[20:23]
SA m0,s23,131072
s_mov_b32 s22,6815744
BL v26,s[12:15],s22 offen nt lds
MF a[24:27],v[152:155],v[64:67],a[24:27]
DT v[164:165],v15 offset:49152
MF a[28:31],v[156:159],v[64:67],a[28:31]
MF a[32:35],v[128:131],v[68:71],a[32:35]
DT v[166:167],v15 offset:51200
MF a[36:39],v[132:135],v[68:71],a[36:39]
MF a[40:43],v[136:139],v[68:71],a[40:43]
DT v[168:169],v16 offset:49152
MF a[44:47],v[140:143],v[68:71],a[44:47]
BL v27,s[12:15],s22 offen offset:1024 nt lds
MF a[48:51],v[144:147],v[68:71],a[48:51]
DT v[170:171],v16 offset:51200
MF a[52:55],v[148:151],v[68:71],a[52:55]
MF a[56:59],v[152:155],v[68:71],a[56:59]
DT v[172:173],v17 offset:49152
MF a[60:63],v[156:159],v[68:71],a[60:63]
MF a[64:67],v[128:131],v[72:75],a[64:67]
DT v[174:175],v17 offset:51200
MF a[68:71],v[132:135],v[72:75],a[68:71]
BL v28,s[12:15],s22 offen offset:2048 nt lds
MF a[72:75],v[136:139],v[72:75],a[72:75]
DT v[176:177],v18 offset:49152
MF a[76:79],v[140:143],v[72:75],a[76:79]
MF a[80:83],v[144:147],v[72:75],a[80:83]
DT v[178:179],v18 offset:51200
MF a[84:87],v[148:151],v[72:75],a[84:87]
MF a[88:91],v[152:155],v[72:75],a[88:91]
DT v[180:181],v19 offset:49152
MF a[92:95],v[156:159],v[72:75],a[92:95]
BL v29,s[12:15],s22 offen offset:3072 nt lds
MF a[96:99],v[128:131],v[76:79],a[96:99]
DT v[182:183],v19 offset:51200
MF a[100:103],v[132:135],v[76:79],a[100:103]
MF a[104:107],v[136:139],v[76:79],a[104:107]
DT v[184:185],v20 offset:49152
MF a[108:111],v[140:143],v[76:79],a[108:111]
MF a[112:115],v[144:147],v[76:79],a[112:115]
DT v[186:187],v20 offset:51200
MF a[116:119],v[148:151],v[76:79],a[116:119]
SA m0,s23,49152
s_mov_b32 s21,263808
BL v22,s[8:11],s21 offen lds
MF a[120:123],v[152:155],v[76:79],a[120:123]
DT v[188:189],v21 offset:49152
MF a[124:127],v[156:159],v[76:79],a[124:127]
MF a[128:131],v[128:131],v[80:83],a[128:131]
DT v[190:191],v21 offset:51200
MF a[132:135],v[132:135],v[80:83],a[132:135]
MF a[136:139],v[136:139],v[80:83],a[136:139]
DR v[100:103],v13 offset:2048
MF a[140:143],v[140:143],v[80:83],a[140:143]
BL v23,s[8:11],s21 offen offset:1024 lds
MF a[144:147],v[144:147],v[80:83],a[144:147]
DR v[104:107],v13 offset:4096
MF a[148:151],v[148:151],v[80:83],a[148:151]
MF a[152:155],v[152:155],v[80:83],a[152:155]
DR v[108:111],v13 offset:6144
MF a[156:159],v[156:159],v[80:83],a[156:159]
MF a[160:163],v[128:131],v[84:87],a[160:163]
DR v[112:115],v13 offset:8192
MF a[164:167],v[132:135],v[84:87],a[164:167]
BL v24,s[8:11],s21 offen offset:2048 lds
MF a[168:171],v[136:139],v[84:87],a[168:171]
DR v[116:119],v13 offset:10240
MF a[172:175],v[140:143],v[84:87],a[172:175]
MF a[176:179],v[144:147],v[84:87],a[176:179]
DR v[120:123],v13 offset:12288
MF a[180:183],v[148:151],v[84:87],a[180:183]
MF a[184:187],v[152:155],v[84:87],a[184:187]
DR v[124:127],v13 offset:14336
MF a[188:191],v[156:159],v[84:87],a[188:191]
BL v25,s[8:11],s21 offen offset:3072 lds
MF a[192:195],v[128:131],v[88:91],a[192:195]
MF a[196:199],v[132:135],v[88:91],a[196:199]
MF a[200:203],v[136:139],v[88:91],a[200:203]
MF a[204:207],v[140:143],v[88:91],a[204:207]
MF a[208:211],v[144:147],v[88:91],a[208:211]
MF a[212:215],v[148:151],v[88:91],a[212:215]
v_readfirstlane_b32 s30,v6
s_cmp_ge_u32 s30,16
s_cbranch_scc1 k1_kernel_k_xnok
s_mov_b32 s31,0
k1_kernel_k_xnpoll:
s_sleep 1
buffer_load_dword v6,v5,s[68:71],0 offen sc1
WT vmcnt(0)
v_readfirstlane_b32 s30,v6
SA s31,s31,1
s_cmp_ge_u32 s31,262144
s_cbranch_scc1 k1_kernel_k_xnto
s_cmp_ge_u32 s30,16
s_cbranch_scc0 k1_kernel_k_xnpoll
s_branch k1_kernel_k_xnok
k1_kernel_k_xnto:
v_mov_b32 v6,0xbad1
v_mov_b32 v7,128
buffer_store_dword v6,v7,s[68:71],0 offen
k1_kernel_k_xnok:
MF a[216:219],v[152:155],v[88:91],a[216:219]
MF a[220:223],v[156:159],v[88:91],a[220:223]
MF a[224:227],v[128:131],v[92:95],a[224:227]
MF a[228:231],v[132:135],v[92:95],a[228:231]
MF a[232:235],v[136:139],v[92:95],a[232:235]
MF a[236:239],v[140:143],v[92:95],a[236:239]
MF a[240:243],v[144:147],v[92:95],a[240:243]
MF a[244:247],v[148:151],v[92:95],a[244:247]
MF a[248:251],v[152:155],v[92:95],a[248:251]
MF a[252:255],v[156:159],v[92:95],a[252:255]
WT vmcnt(16) lgkmcnt(0)
s_barrier
MF a[0:3],v[160:163],v[96:99],a[0:3]
DR v[64:67],v10 offset:0
MF a[4:7],v[164:167],v[96:99],a[4:7]
MF a[8:11],v[168:171],v[96:99],a[8:11]
DT v[128:129],v14 offset:0
MF a[12:15],v[172:175],v[96:99],a[12:15]
MF a[16:19],v[176:179],v[96:99],a[16:19]
DT v[130:131],v14 offset:2048
MF a[20:23],v[180:183],v[96:99],a[20:23]
SA m0,s23,147456
s_mov_b32 s22,7077888
BL v26,s[12:15],s22 offen nt lds
MF a[24:27],v[184:187],v[96:99],a[24:27]
DT v[132:133],v15 offset:0
MF a[28:31],v[188:191],v[96:99],a[28:31]
MF a[32:35],v[160:163],v[100:103],a[32:35]
DT v[134:135],v15 offset:2048
MF a[36:39],v[164:167],v[100:103],a[36:39]
MF a[40:43],v[168:171],v[100:103],a[40:43]
DT v[136:137],v16 offset:0
MF a[44:47],v[172:175],v[100:103],a[44:47]
BL v27,s[12:15],s22 offen offset:1024 nt lds
MF a[48:51],v[176:179],v[100:103],a[48:51]
DT v[138:139],v16 offset:2048
MF a[52:55],v[180:183],v[100:103],a[52:55]
MF a[56:59],v[184:187],v[100:103],a[56:59]
DT v[140:141],v17 offset:0
MF a[60:63],v[188:191],v[100:103],a[60:63]
MF a[64:67],v[160:163],v[104:107],a[64:67]
DT v[142:143],v17 offset:2048
MF a[68:71],v[164:167],v[104:107],a[68:71]
BL v28,s[12:15],s22 offen offset:2048 nt lds
MF a[72:75],v[168:171],v[104:107],a[72:75]
DT v[144:145],v18 offset:0
MF a[76:79],v[172:175],v[104:107],a[76:79]
MF a[80:83],v[176:179],v[104:107],a[80:83]
DT v[146:147],v18 offset:2048
MF a[84:87],v[180:183],v[104:107],a[84:87]
MF a[88:91],v[184:187],v[104:107],a[88:91]
DT v[148:149],v19 offset:0
MF a[92:95],v[188:191],v[104:107],a[92:95]
BL v29,s[12:15],s22 offen offset:3072 nt lds
MF a[96:99],v[160:163],v[108:111],a[96:99]
DT v[150:151],v19 offset:2048
MF a[100:103],v[164:167],v[108:111],a[100:103]
MF a[104:107],v[168:171],v[108:111],a[104:107]
DT v[152:153],v20 offset:0
MF a[108:111],v[172:175],v[108:111],a[108:111]
MF a[112:115],v[176:179],v[108:111],a[112:115]
DT v[154:155],v20 offset:2048
MF a[116:119],v[180:183],v[108:111],a[116:119]
SA m0,s23,65536
s_mov_b32 s21,1792
BL v22,s[8:11],s21 offen lds
MF a[120:123],v[184:187],v[108:111],a[120:123]
DT v[156:157],v21 offset:0
MF a[124:127],v[188:191],v[108:111],a[124:127]
MF a[128:131],v[160:163],v[112:115],a[128:131]
DT v[158:159],v21 offset:2048
MF a[132:135],v[164:167],v[112:115],a[132:135]
MF a[136:139],v[168:171],v[112:115],a[136:139]
DR v[68:71],v10 offset:2048
MF a[140:143],v[172:175],v[112:115],a[140:143]
BL v23,s[8:11],s21 offen offset:1024 lds
MF a[144:147],v[176:179],v[112:115],a[144:147]
DR v[72:75],v10 offset:4096
MF a[148:151],v[180:183],v[112:115],a[148:151]
MF a[152:155],v[184:187],v[112:115],a[152:155]
DR v[76:79],v10 offset:6144
MF a[156:159],v[188:191],v[112:115],a[156:159]
MF a[160:163],v[160:163],v[116:119],a[160:163]
DR v[80:83],v10 offset:8192
MF a[164:167],v[164:167],v[116:119],a[164:167]
BL v24,s[8:11],s21 offen offset:2048 lds
MF a[168:171],v[168:171],v[116:119],a[168:171]
DR v[84:87],v10 offset:10240
MF a[172:175],v[172:175],v[116:119],a[172:175]
MF a[176:179],v[176:179],v[116:119],a[176:179]
DR v[88:91],v10 offset:12288
MF a[180:183],v[180:183],v[116:119],a[180:183]
MF a[184:187],v[184:187],v[116:119],a[184:187]
DR v[92:95],v10 offset:14336
MF a[188:191],v[188:191],v[116:119],a[188:191]
BL v25,s[8:11],s21 offen offset:3072 lds
MF a[192:195],v[160:163],v[120:123],a[192:195]
MF a[196:199],v[164:167],v[120:123],a[196:199]
MF a[200:203],v[168:171],v[120:123],a[200:203]
MF a[204:207],v[172:175],v[120:123],a[204:207]
MF a[208:211],v[176:179],v[120:123],a[208:211]
MF a[212:215],v[180:183],v[120:123],a[212:215]
MF a[216:219],v[184:187],v[120:123],a[216:219]
MF a[220:223],v[188:191],v[120:123],a[220:223]
MF a[224:227],v[160:163],v[124:127],a[224:227]
MF a[228:231],v[164:167],v[124:127],a[228:231]
MF a[232:235],v[168:171],v[124:127],a[232:235]
MF a[236:239],v[172:175],v[124:127],a[236:239]
MF a[240:243],v[176:179],v[124:127],a[240:243]
MF a[244:247],v[180:183],v[124:127],a[244:247]
MF a[248:251],v[184:187],v[124:127],a[248:251]
MF a[252:255],v[188:191],v[124:127],a[252:255]
WT vmcnt(20) lgkmcnt(0)
s_barrier
MF a[0:3],v[128:131],v[64:67],a[0:3]
DR v[96:99],v12 offset:0
MF a[4:7],v[132:135],v[64:67],a[4:7]
MF a[8:11],v[136:139],v[64:67],a[8:11]
DT v[160:161],v14 offset:16384
MF a[12:15],v[140:143],v[64:67],a[12:15]
MF a[16:19],v[144:147],v[64:67],a[16:19]
DT v[162:163],v14 offset:18432
MF a[20:23],v[148:151],v[64:67],a[20:23]
SA m0,s23,98304
s_mov_b32 s22,7340032
BL v26,s[12:15],s22 offen nt lds
MF a[24:27],v[152:155],v[64:67],a[24:27]
DT v[164:165],v15 offset:16384
MF a[28:31],v[156:159],v[64:67],a[28:31]
MF a[32:35],v[128:131],v[68:71],a[32:35]
DT v[166:167],v15 offset:18432
MF a[36:39],v[132:135],v[68:71],a[36:39]
MF a[40:43],v[136:139],v[68:71],a[40:43]
DT v[168:169],v16 offset:16384
MF a[44:47],v[140:143],v[68:71],a[44:47]
BL v27,s[12:15],s22 offen offset:1024 nt lds
MF a[48:51],v[144:147],v[68:71],a[48:51]
DT v[170:171],v16 offset:18432
MF a[52:55],v[148:151],v[68:71],a[52:55]
MF a[56:59],v[152:155],v[68:71],a[56:59]
DT v[172:173],v17 offset:16384
MF a[60:63],v[156:159],v[68:71],a[60:63]
MF a[64:67],v[128:131],v[72:75],a[64:67]
DT v[174:175],v17 offset:18432
MF a[68:71],v[132:135],v[72:75],a[68:71]
BL v28,s[12:15],s22 offen offset:2048 nt lds
MF a[72:75],v[136:139],v[72:75],a[72:75]
DT v[176:177],v18 offset:16384
MF a[76:79],v[140:143],v[72:75],a[76:79]
MF a[80:83],v[144:147],v[72:75],a[80:83]
DT v[178:179],v18 offset:18432
MF a[84:87],v[148:151],v[72:75],a[84:87]
MF a[88:91],v[152:155],v[72:75],a[88:91]
DT v[180:181],v19 offset:16384
MF a[92:95],v[156:159],v[72:75],a[92:95]
BL v29,s[12:15],s22 offen offset:3072 nt lds
MF a[96:99],v[128:131],v[76:79],a[96:99]
DT v[182:183],v19 offset:18432
MF a[100:103],v[132:135],v[76:79],a[100:103]
MF a[104:107],v[136:139],v[76:79],a[104:107]
DT v[184:185],v20 offset:16384
MF a[108:111],v[140:143],v[76:79],a[108:111]
MF a[112:115],v[144:147],v[76:79],a[112:115]
DT v[186:187],v20 offset:18432
MF a[116:119],v[148:151],v[76:79],a[116:119]
SA m0,s23,81920
s_mov_b32 s21,263936
BL v22,s[8:11],s21 offen lds
MF a[120:123],v[152:155],v[76:79],a[120:123]
DT v[188:189],v21 offset:16384
MF a[124:127],v[156:159],v[76:79],a[124:127]
MF a[128:131],v[128:131],v[80:83],a[128:131]
DT v[190:191],v21 offset:18432
MF a[132:135],v[132:135],v[80:83],a[132:135]
MF a[136:139],v[136:139],v[80:83],a[136:139]
DR v[100:103],v12 offset:2048
MF a[140:143],v[140:143],v[80:83],a[140:143]
BL v23,s[8:11],s21 offen offset:1024 lds
MF a[144:147],v[144:147],v[80:83],a[144:147]
DR v[104:107],v12 offset:4096
MF a[148:151],v[148:151],v[80:83],a[148:151]
MF a[152:155],v[152:155],v[80:83],a[152:155]
DR v[108:111],v12 offset:6144
MF a[156:159],v[156:159],v[80:83],a[156:159]
MF a[160:163],v[128:131],v[84:87],a[160:163]
DR v[112:115],v12 offset:8192
MF a[164:167],v[132:135],v[84:87],a[164:167]
BL v24,s[8:11],s21 offen offset:2048 lds
MF a[168:171],v[136:139],v[84:87],a[168:171]
DR v[116:119],v12 offset:10240
MF a[172:175],v[140:143],v[84:87],a[172:175]
MF a[176:179],v[144:147],v[84:87],a[176:179]
DR v[120:123],v12 offset:12288
MF a[180:183],v[148:151],v[84:87],a[180:183]
MF a[184:187],v[152:155],v[84:87],a[184:187]
DR v[124:127],v12 offset:14336
MF a[188:191],v[156:159],v[84:87],a[188:191]
BL v25,s[8:11],s21 offen offset:3072 lds
MF a[192:195],v[128:131],v[88:91],a[192:195]
MF a[196:199],v[132:135],v[88:91],a[196:199]
MF a[200:203],v[136:139],v[88:91],a[200:203]
MF a[204:207],v[140:143],v[88:91],a[204:207]
MF a[208:211],v[144:147],v[88:91],a[208:211]
MF a[212:215],v[148:151],v[88:91],a[212:215]
MF a[216:219],v[152:155],v[88:91],a[216:219]
MF a[220:223],v[156:159],v[88:91],a[220:223]
MF a[224:227],v[128:131],v[92:95],a[224:227]
MF a[228:231],v[132:135],v[92:95],a[228:231]
MF a[232:235],v[136:139],v[92:95],a[232:235]
MF a[236:239],v[140:143],v[92:95],a[236:239]
MF a[240:243],v[144:147],v[92:95],a[240:243]
MF a[244:247],v[148:151],v[92:95],a[244:247]
MF a[248:251],v[152:155],v[92:95],a[248:251]
MF a[252:255],v[156:159],v[92:95],a[252:255]
WT vmcnt(16) lgkmcnt(0)
s_barrier
MF a[0:3],v[160:163],v[96:99],a[0:3]
DR v[64:67],v10 offset:32768
MF a[4:7],v[164:167],v[96:99],a[4:7]
MF a[8:11],v[168:171],v[96:99],a[8:11]
DT v[128:129],v14 offset:32768
MF a[12:15],v[172:175],v[96:99],a[12:15]
MF a[16:19],v[176:179],v[96:99],a[16:19]
DT v[130:131],v14 offset:34816
MF a[20:23],v[180:183],v[96:99],a[20:23]
SA m0,s23,114688
s_mov_b32 s22,7602176
BL v26,s[12:15],s22 offen nt lds
MF a[24:27],v[184:187],v[96:99],a[24:27]
DT v[132:133],v15 offset:32768
MF a[28:31],v[188:191],v[96:99],a[28:31]
MF a[32:35],v[160:163],v[100:103],a[32:35]
DT v[134:135],v15 offset:34816
MF a[36:39],v[164:167],v[100:103],a[36:39]
MF a[40:43],v[168:171],v[100:103],a[40:43]
DT v[136:137],v16 offset:32768
MF a[44:47],v[172:175],v[100:103],a[44:47]
BL v27,s[12:15],s22 offen offset:1024 nt lds
MF a[48:51],v[176:179],v[100:103],a[48:51]
DT v[138:139],v16 offset:34816
MF a[52:55],v[180:183],v[100:103],a[52:55]
MF a[56:59],v[184:187],v[100:103],a[56:59]
DT v[140:141],v17 offset:32768
MF a[60:63],v[188:191],v[100:103],a[60:63]
MF a[64:67],v[160:163],v[104:107],a[64:67]
DT v[142:143],v17 offset:34816
MF a[68:71],v[164:167],v[104:107],a[68:71]
BL v28,s[12:15],s22 offen offset:2048 nt lds
MF a[72:75],v[168:171],v[104:107],a[72:75]
DT v[144:145],v18 offset:32768
MF a[76:79],v[172:175],v[104:107],a[76:79]
MF a[80:83],v[176:179],v[104:107],a[80:83]
DT v[146:147],v18 offset:34816
MF a[84:87],v[180:183],v[104:107],a[84:87]
MF a[88:91],v[184:187],v[104:107],a[88:91]
DT v[148:149],v19 offset:32768
MF a[92:95],v[188:191],v[104:107],a[92:95]
BL v29,s[12:15],s22 offen offset:3072 nt lds
MF a[96:99],v[160:163],v[108:111],a[96:99]
DT v[150:151],v19 offset:34816
MF a[100:103],v[164:167],v[108:111],a[100:103]
MF a[104:107],v[168:171],v[108:111],a[104:107]
DT v[152:153],v20 offset:32768
MF a[108:111],v[172:175],v[108:111],a[108:111]
MF a[112:115],v[176:179],v[108:111],a[112:115]
DT v[154:155],v20 offset:34816
MF a[116:119],v[180:183],v[108:111],a[116:119]
SA m0,s23,0
s_mov_b32 s21,1920
BL v22,s[8:11],s21 offen lds
MF a[120:123],v[184:187],v[108:111],a[120:123]
DT v[156:157],v21 offset:32768
MF a[124:127],v[188:191],v[108:111],a[124:127]
MF a[128:131],v[160:163],v[112:115],a[128:131]
DT v[158:159],v21 offset:34816
MF a[132:135],v[164:167],v[112:115],a[132:135]
MF a[136:139],v[168:171],v[112:115],a[136:139]
DR v[68:71],v10 offset:34816
MF a[140:143],v[172:175],v[112:115],a[140:143]
BL v23,s[8:11],s21 offen offset:1024 lds
MF a[144:147],v[176:179],v[112:115],a[144:147]
DR v[72:75],v10 offset:36864
MF a[148:151],v[180:183],v[112:115],a[148:151]
MF a[152:155],v[184:187],v[112:115],a[152:155]
DR v[76:79],v10 offset:38912
MF a[156:159],v[188:191],v[112:115],a[156:159]
MF a[160:163],v[160:163],v[116:119],a[160:163]
DR v[80:83],v10 offset:40960
MF a[164:167],v[164:167],v[116:119],a[164:167]
BL v24,s[8:11],s21 offen offset:2048 lds
MF a[168:171],v[168:171],v[116:119],a[168:171]
DR v[84:87],v10 offset:43008
MF a[172:175],v[172:175],v[116:119],a[172:175]
MF a[176:179],v[176:179],v[116:119],a[176:179]
DR v[88:91],v10 offset:45056
MF a[180:183],v[180:183],v[116:119],a[180:183]
MF a[184:187],v[184:187],v[116:119],a[184:187]
DR v[92:95],v10 offset:47104
MF a[188:191],v[188:191],v[116:119],a[188:191]
BL v25,s[8:11],s21 offen offset:3072 lds
MF a[192:195],v[160:163],v[120:123],a[192:195]
MF a[196:199],v[164:167],v[120:123],a[196:199]
MF a[200:203],v[168:171],v[120:123],a[200:203]
MF a[204:207],v[172:175],v[120:123],a[204:207]
MF a[208:211],v[176:179],v[120:123],a[208:211]
MF a[212:215],v[180:183],v[120:123],a[212:215]
MF a[216:219],v[184:187],v[120:123],a[216:219]
MF a[220:223],v[188:191],v[120:123],a[220:223]
MF a[224:227],v[160:163],v[124:127],a[224:227]
MF a[228:231],v[164:167],v[124:127],a[228:231]
MF a[232:235],v[168:171],v[124:127],a[232:235]
MF a[236:239],v[172:175],v[124:127],a[236:239]
MF a[240:243],v[176:179],v[124:127],a[240:243]
MF a[244:247],v[180:183],v[124:127],a[244:247]
MF a[248:251],v[184:187],v[124:127],a[248:251]
MF a[252:255],v[188:191],v[124:127],a[252:255]
WT vmcnt(20) lgkmcnt(0)
s_barrier
MF a[0:3],v[128:131],v[64:67],a[0:3]
DR v[96:99],v12 offset:32768
MF a[4:7],v[132:135],v[64:67],a[4:7]
MF a[8:11],v[136:139],v[64:67],a[8:11]
DT v[160:161],v14 offset:49152
MF a[12:15],v[140:143],v[64:67],a[12:15]
MF a[16:19],v[144:147],v[64:67],a[16:19]
DT v[162:163],v14 offset:51200
MF a[20:23],v[148:151],v[64:67],a[20:23]
SA m0,s23,131072
s_mov_b32 s22,7864320
BL v26,s[12:15],s22 offen nt lds
MF a[24:27],v[152:155],v[64:67],a[24:27]
DT v[164:165],v15 offset:49152
MF a[28:31],v[156:159],v[64:67],a[28:31]
MF a[32:35],v[128:131],v[68:71],a[32:35]
DT v[166:167],v15 offset:51200
MF a[36:39],v[132:135],v[68:71],a[36:39]
MF a[40:43],v[136:139],v[68:71],a[40:43]
DT v[168:169],v16 offset:49152
MF a[44:47],v[140:143],v[68:71],a[44:47]
BL v27,s[12:15],s22 offen offset:1024 nt lds
MF a[48:51],v[144:147],v[68:71],a[48:51]
DT v[170:171],v16 offset:51200
MF a[52:55],v[148:151],v[68:71],a[52:55]
MF a[56:59],v[152:155],v[68:71],a[56:59]
DT v[172:173],v17 offset:49152
MF a[60:63],v[156:159],v[68:71],a[60:63]
MF a[64:67],v[128:131],v[72:75],a[64:67]
DT v[174:175],v17 offset:51200
MF a[68:71],v[132:135],v[72:75],a[68:71]
BL v28,s[12:15],s22 offen offset:2048 nt lds
MF a[72:75],v[136:139],v[72:75],a[72:75]
DT v[176:177],v18 offset:49152
MF a[76:79],v[140:143],v[72:75],a[76:79]
MF a[80:83],v[144:147],v[72:75],a[80:83]
DT v[178:179],v18 offset:51200
MF a[84:87],v[148:151],v[72:75],a[84:87]
MF a[88:91],v[152:155],v[72:75],a[88:91]
DT v[180:181],v19 offset:49152
MF a[92:95],v[156:159],v[72:75],a[92:95]
BL v29,s[12:15],s22 offen offset:3072 nt lds
MF a[96:99],v[128:131],v[76:79],a[96:99]
DT v[182:183],v19 offset:51200
MF a[100:103],v[132:135],v[76:79],a[100:103]
MF a[104:107],v[136:139],v[76:79],a[104:107]
DT v[184:185],v20 offset:49152
MF a[108:111],v[140:143],v[76:79],a[108:111]
MF a[112:115],v[144:147],v[76:79],a[112:115]
DT v[186:187],v20 offset:51200
MF a[116:119],v[148:151],v[76:79],a[116:119]
SA m0,s23,16384
s_mov_b32 s21,264064
BL v22,s[8:11],s21 offen lds
MF a[120:123],v[152:155],v[76:79],a[120:123]
DT v[188:189],v21 offset:49152
MF a[124:127],v[156:159],v[76:79],a[124:127]
MF a[128:131],v[128:131],v[80:83],a[128:131]
DT v[190:191],v21 offset:51200
MF a[132:135],v[132:135],v[80:83],a[132:135]
MF a[136:139],v[136:139],v[80:83],a[136:139]
DR v[100:103],v12 offset:34816
MF a[140:143],v[140:143],v[80:83],a[140:143]
BL v23,s[8:11],s21 offen offset:1024 lds
MF a[144:147],v[144:147],v[80:83],a[144:147]
DR v[104:107],v12 offset:36864
MF a[148:151],v[148:151],v[80:83],a[148:151]
MF a[152:155],v[152:155],v[80:83],a[152:155]
DR v[108:111],v12 offset:38912
MF a[156:159],v[156:159],v[80:83],a[156:159]
MF a[160:163],v[128:131],v[84:87],a[160:163]
DR v[112:115],v12 offset:40960
MF a[164:167],v[132:135],v[84:87],a[164:167]
BL v24,s[8:11],s21 offen offset:2048 lds
MF a[168:171],v[136:139],v[84:87],a[168:171]
DR v[116:119],v12 offset:43008
MF a[172:175],v[140:143],v[84:87],a[172:175]
MF a[176:179],v[144:147],v[84:87],a[176:179]
DR v[120:123],v12 offset:45056
MF a[180:183],v[148:151],v[84:87],a[180:183]
MF a[184:187],v[152:155],v[84:87],a[184:187]
DR v[124:127],v12 offset:47104
MF a[188:191],v[156:159],v[84:87],a[188:191]
BL v25,s[8:11],s21 offen offset:3072 lds
MF a[192:195],v[128:131],v[88:91],a[192:195]
MF a[196:199],v[132:135],v[88:91],a[196:199]
MF a[200:203],v[136:139],v[88:91],a[200:203]
MF a[204:207],v[140:143],v[88:91],a[204:207]
MF a[208:211],v[144:147],v[88:91],a[208:211]
MF a[212:215],v[148:151],v[88:91],a[212:215]
MF a[216:219],v[152:155],v[88:91],a[216:219]
MF a[220:223],v[156:159],v[88:91],a[220:223]
MF a[224:227],v[128:131],v[92:95],a[224:227]
MF a[228:231],v[132:135],v[92:95],a[228:231]
MF a[232:235],v[136:139],v[92:95],a[232:235]
MF a[236:239],v[140:143],v[92:95],a[236:239]
MF a[240:243],v[144:147],v[92:95],a[240:243]
MF a[244:247],v[148:151],v[92:95],a[244:247]
MF a[248:251],v[152:155],v[92:95],a[248:251]
MF a[252:255],v[156:159],v[92:95],a[252:255]
WT vmcnt(16) lgkmcnt(0)
s_barrier
MF a[0:3],v[160:163],v[96:99],a[0:3]
DR v[64:67],v11 offset:0
MF a[4:7],v[164:167],v[96:99],a[4:7]
MF a[8:11],v[168:171],v[96:99],a[8:11]
DT v[128:129],v14 offset:0
MF a[12:15],v[172:175],v[96:99],a[12:15]
MF a[16:19],v[176:179],v[96:99],a[16:19]
DT v[130:131],v14 offset:2048
MF a[20:23],v[180:183],v[96:99],a[20:23]
SA m0,s23,147456
s_mov_b32 s22,8126464
BL v26,s[12:15],s22 offen nt lds
MF a[24:27],v[184:187],v[96:99],a[24:27]
DT v[132:133],v15 offset:0
MF a[28:31],v[188:191],v[96:99],a[28:31]
MF a[32:35],v[160:163],v[100:103],a[32:35]
DT v[134:135],v15 offset:2048
MF a[36:39],v[164:167],v[100:103],a[36:39]
MF a[40:43],v[168:171],v[100:103],a[40:43]
DT v[136:137],v16 offset:0
MF a[44:47],v[172:175],v[100:103],a[44:47]
BL v27,s[12:15],s22 offen offset:1024 nt lds
MF a[48:51],v[176:179],v[100:103],a[48:51]
DT v[138:139],v16 offset:2048
MF a[52:55],v[180:183],v[100:103],a[52:55]
MF a[56:59],v[184:187],v[100:103],a[56:59]
DT v[140:141],v17 offset:0
MF a[60:63],v[188:191],v[100:103],a[60:63]
MF a[64:67],v[160:163],v[104:107],a[64:67]
DT v[142:143],v17 offset:2048
MF a[68:71],v[164:167],v[104:107],a[68:71]
BL v28,s[12:15],s22 offen offset:2048 nt lds
MF a[72:75],v[168:171],v[104:107],a[72:75]
DT v[144:145],v18 offset:0
MF a[76:79],v[172:175],v[104:107],a[76:79]
MF a[80:83],v[176:179],v[104:107],a[80:83]
DT v[146:147],v18 offset:2048
MF a[84:87],v[180:183],v[104:107],a[84:87]
MF a[88:91],v[184:187],v[104:107],a[88:91]
DT v[148:149],v19 offset:0
MF a[92:95],v[188:191],v[104:107],a[92:95]
BL v29,s[12:15],s22 offen offset:3072 nt lds
MF a[96:99],v[160:163],v[108:111],a[96:99]
DT v[150:151],v19 offset:2048
MF a[100:103],v[164:167],v[108:111],a[100:103]
MF a[104:107],v[168:171],v[108:111],a[104:107]
DT v[152:153],v20 offset:0
MF a[108:111],v[172:175],v[108:111],a[108:111]
MF a[112:115],v[176:179],v[108:111],a[112:115]
DT v[154:155],v20 offset:2048
MF a[116:119],v[180:183],v[108:111],a[116:119]
SA m0,s23,32768
s_mov_b32 s21,0
BL v30,s[36:39],s21 offen lds
MF a[120:123],v[184:187],v[108:111],a[120:123]
DT v[156:157],v21 offset:0
MF a[124:127],v[188:191],v[108:111],a[124:127]
MF a[128:131],v[160:163],v[112:115],a[128:131]
DT v[158:159],v21 offset:2048
MF a[132:135],v[164:167],v[112:115],a[132:135]
MF a[136:139],v[168:171],v[112:115],a[136:139]
DR v[68:71],v11 offset:2048
MF a[140:143],v[172:175],v[112:115],a[140:143]
BL v31,s[36:39],s21 offen offset:1024 lds
MF a[144:147],v[176:179],v[112:115],a[144:147]
DR v[72:75],v11 offset:4096
MF a[148:151],v[180:183],v[112:115],a[148:151]
MF a[152:155],v[184:187],v[112:115],a[152:155]
DR v[76:79],v11 offset:6144
MF a[156:159],v[188:191],v[112:115],a[156:159]
MF a[160:163],v[160:163],v[116:119],a[160:163]
DR v[80:83],v11 offset:8192
MF a[164:167],v[164:167],v[116:119],a[164:167]
BL v32,s[36:39],s21 offen offset:2048 lds
MF a[168:171],v[168:171],v[116:119],a[168:171]
DR v[84:87],v11 offset:10240
MF a[172:175],v[172:175],v[116:119],a[172:175]
MF a[176:179],v[176:179],v[116:119],a[176:179]
DR v[88:91],v11 offset:12288
MF a[180:183],v[180:183],v[116:119],a[180:183]
MF a[184:187],v[184:187],v[116:119],a[184:187]
DR v[92:95],v11 offset:14336
MF a[188:191],v[188:191],v[116:119],a[188:191]
BL v33,s[36:39],s21 offen offset:3072 lds
MF a[192:195],v[160:163],v[120:123],a[192:195]
MF a[196:199],v[164:167],v[120:123],a[196:199]
MF a[200:203],v[168:171],v[120:123],a[200:203]
MF a[204:207],v[172:175],v[120:123],a[204:207]
MF a[208:211],v[176:179],v[120:123],a[208:211]
MF a[212:215],v[180:183],v[120:123],a[212:215]
MF a[216:219],v[184:187],v[120:123],a[216:219]
MF a[220:223],v[188:191],v[120:123],a[220:223]
MF a[224:227],v[160:163],v[124:127],a[224:227]
MF a[228:231],v[164:167],v[124:127],a[228:231]
MF a[232:235],v[168:171],v[124:127],a[232:235]
MF a[236:239],v[172:175],v[124:127],a[236:239]
MF a[240:243],v[176:179],v[124:127],a[240:243]
MF a[244:247],v[180:183],v[124:127],a[244:247]
MF a[248:251],v[184:187],v[124:127],a[248:251]
MF a[252:255],v[188:191],v[124:127],a[252:255]
WT vmcnt(20) lgkmcnt(0)
s_barrier
MF a[0:3],v[128:131],v[64:67],a[0:3]
DR v[96:99],v13 offset:0
MF a[4:7],v[132:135],v[64:67],a[4:7]
MF a[8:11],v[136:139],v[64:67],a[8:11]
DT v[160:161],v14 offset:16384
MF a[12:15],v[140:143],v[64:67],a[12:15]
MF a[16:19],v[144:147],v[64:67],a[16:19]
DT v[162:163],v14 offset:18432
MF a[20:23],v[148:151],v[64:67],a[20:23]
SA m0,s23,98304
s_mov_b32 s22,0
BL v26,s[40:43],s22 offen nt lds
MF a[24:27],v[152:155],v[64:67],a[24:27]
DT v[164:165],v15 offset:16384
MF a[28:31],v[156:159],v[64:67],a[28:31]
MF a[32:35],v[128:131],v[68:71],a[32:35]
DT v[166:167],v15 offset:18432
MF a[36:39],v[132:135],v[68:71],a[36:39]
MF a[40:43],v[136:139],v[68:71],a[40:43]
DT v[168:169],v16 offset:16384
MF a[44:47],v[140:143],v[68:71],a[44:47]
BL v27,s[40:43],s22 offen offset:1024 nt lds
MF a[48:51],v[144:147],v[68:71],a[48:51]
DT v[170:171],v16 offset:18432
MF a[52:55],v[148:151],v[68:71],a[52:55]
MF a[56:59],v[152:155],v[68:71],a[56:59]
DT v[172:173],v17 offset:16384
MF a[60:63],v[156:159],v[68:71],a[60:63]
MF a[64:67],v[128:131],v[72:75],a[64:67]
DT v[174:175],v17 offset:18432
MF a[68:71],v[132:135],v[72:75],a[68:71]
BL v28,s[40:43],s22 offen offset:2048 nt lds
MF a[72:75],v[136:139],v[72:75],a[72:75]
DT v[176:177],v18 offset:16384
MF a[76:79],v[140:143],v[72:75],a[76:79]
MF a[80:83],v[144:147],v[72:75],a[80:83]
DT v[178:179],v18 offset:18432
MF a[84:87],v[148:151],v[72:75],a[84:87]
MF a[88:91],v[152:155],v[72:75],a[88:91]
DT v[180:181],v19 offset:16384
MF a[92:95],v[156:159],v[72:75],a[92:95]
BL v29,s[40:43],s22 offen offset:3072 nt lds
MF a[96:99],v[128:131],v[76:79],a[96:99]
DT v[182:183],v19 offset:18432
MF a[100:103],v[132:135],v[76:79],a[100:103]
MF a[104:107],v[136:139],v[76:79],a[104:107]
DT v[184:185],v20 offset:16384
MF a[108:111],v[140:143],v[76:79],a[108:111]
MF a[112:115],v[144:147],v[76:79],a[112:115]
DT v[186:187],v20 offset:18432
MF a[116:119],v[148:151],v[76:79],a[116:119]
SA m0,s23,49152
s_mov_b32 s22,1048576
BL v26,s[40:43],s22 offen nt lds
MF a[120:123],v[152:155],v[76:79],a[120:123]
DT v[188:189],v21 offset:16384
MF a[124:127],v[156:159],v[76:79],a[124:127]
MF a[128:131],v[128:131],v[80:83],a[128:131]
DT v[190:191],v21 offset:18432
MF a[132:135],v[132:135],v[80:83],a[132:135]
MF a[136:139],v[136:139],v[80:83],a[136:139]
DR v[100:103],v13 offset:2048
MF a[140:143],v[140:143],v[80:83],a[140:143]
BL v27,s[40:43],s22 offen offset:1024 nt lds
MF a[144:147],v[144:147],v[80:83],a[144:147]
DR v[104:107],v13 offset:4096
MF a[148:151],v[148:151],v[80:83],a[148:151]
MF a[152:155],v[152:155],v[80:83],a[152:155]
DR v[108:111],v13 offset:6144
MF a[156:159],v[156:159],v[80:83],a[156:159]
MF a[160:163],v[128:131],v[84:87],a[160:163]
DR v[112:115],v13 offset:8192
MF a[164:167],v[132:135],v[84:87],a[164:167]
BL v28,s[40:43],s22 offen offset:2048 nt lds
MF a[168:171],v[136:139],v[84:87],a[168:171]
DR v[116:119],v13 offset:10240
MF a[172:175],v[140:143],v[84:87],a[172:175]
MF a[176:179],v[144:147],v[84:87],a[176:179]
DR v[120:123],v13 offset:12288
MF a[180:183],v[148:151],v[84:87],a[180:183]
MF a[184:187],v[152:155],v[84:87],a[184:187]
DR v[124:127],v13 offset:14336
MF a[188:191],v[156:159],v[84:87],a[188:191]
BL v29,s[40:43],s22 offen offset:3072 nt lds
MF a[192:195],v[128:131],v[88:91],a[192:195]
MF a[196:199],v[132:135],v[88:91],a[196:199]
MF a[200:203],v[136:139],v[88:91],a[200:203]
MF a[204:207],v[140:143],v[88:91],a[204:207]
MF a[208:211],v[144:147],v[88:91],a[208:211]
MF a[212:215],v[148:151],v[88:91],a[212:215]
MF a[216:219],v[152:155],v[88:91],a[216:219]
MF a[220:223],v[156:159],v[88:91],a[220:223]
MF a[224:227],v[128:131],v[92:95],a[224:227]
MF a[228:231],v[132:135],v[92:95],a[228:231]
MF a[232:235],v[136:139],v[92:95],a[232:235]
MF a[236:239],v[140:143],v[92:95],a[236:239]
MF a[240:243],v[144:147],v[92:95],a[240:243]
MF a[244:247],v[148:151],v[92:95],a[244:247]
MF a[248:251],v[152:155],v[92:95],a[248:251]
MF a[252:255],v[156:159],v[92:95],a[252:255]
WT vmcnt(16) lgkmcnt(0)
s_barrier
MF a[0:3],v[160:163],v[96:99],a[0:3]
DR v[64:67],v10 offset:0
MF a[4:7],v[164:167],v[96:99],a[4:7]
MF a[8:11],v[168:171],v[96:99],a[8:11]
DT v[128:129],v14 offset:32768
MF a[12:15],v[172:175],v[96:99],a[12:15]
MF a[16:19],v[176:179],v[96:99],a[16:19]
DT v[130:131],v14 offset:34816
MF a[20:23],v[180:183],v[96:99],a[20:23]
SA m0,s23,114688
s_mov_b32 s22,262144
BL v26,s[40:43],s22 offen nt lds
MF a[24:27],v[184:187],v[96:99],a[24:27]
DT v[132:133],v15 offset:32768
MF a[28:31],v[188:191],v[96:99],a[28:31]
MF a[32:35],v[160:163],v[100:103],a[32:35]
DT v[134:135],v15 offset:34816
MF a[36:39],v[164:167],v[100:103],a[36:39]
MF a[40:43],v[168:171],v[100:103],a[40:43]
DT v[136:137],v16 offset:32768
MF a[44:47],v[172:175],v[100:103],a[44:47]
BL v27,s[40:43],s22 offen offset:1024 nt lds
MF a[48:51],v[176:179],v[100:103],a[48:51]
DT v[138:139],v16 offset:34816
MF a[52:55],v[180:183],v[100:103],a[52:55]
MF a[56:59],v[184:187],v[100:103],a[56:59]
DT v[140:141],v17 offset:32768
MF a[60:63],v[188:191],v[100:103],a[60:63]
MF a[64:67],v[160:163],v[104:107],a[64:67]
DT v[142:143],v17 offset:34816
MF a[68:71],v[164:167],v[104:107],a[68:71]
BL v28,s[40:43],s22 offen offset:2048 nt lds
MF a[72:75],v[168:171],v[104:107],a[72:75]
DT v[144:145],v18 offset:32768
MF a[76:79],v[172:175],v[104:107],a[76:79]
MF a[80:83],v[176:179],v[104:107],a[80:83]
DT v[146:147],v18 offset:34816
MF a[84:87],v[180:183],v[104:107],a[84:87]
MF a[88:91],v[184:187],v[104:107],a[88:91]
DT v[148:149],v19 offset:32768
MF a[92:95],v[188:191],v[104:107],a[92:95]
BL v29,s[40:43],s22 offen offset:3072 nt lds
MF a[96:99],v[160:163],v[108:111],a[96:99]
DT v[150:151],v19 offset:34816
MF a[100:103],v[164:167],v[108:111],a[100:103]
MF a[104:107],v[168:171],v[108:111],a[104:107]
DT v[152:153],v20 offset:32768
MF a[108:111],v[172:175],v[108:111],a[108:111]
MF a[112:115],v[176:179],v[108:111],a[112:115]
DT v[154:155],v20 offset:34816
MF a[116:119],v[180:183],v[108:111],a[116:119]
SA m0,s23,65536
s_mov_b32 s21,128
BL v30,s[36:39],s21 offen lds
MF a[120:123],v[184:187],v[108:111],a[120:123]
DT v[156:157],v21 offset:32768
MF a[124:127],v[188:191],v[108:111],a[124:127]
MF a[128:131],v[160:163],v[112:115],a[128:131]
DT v[158:159],v21 offset:34816
MF a[132:135],v[164:167],v[112:115],a[132:135]
MF a[136:139],v[168:171],v[112:115],a[136:139]
DR v[68:71],v10 offset:2048
MF a[140:143],v[172:175],v[112:115],a[140:143]
BL v31,s[36:39],s21 offen offset:1024 lds
MF a[144:147],v[176:179],v[112:115],a[144:147]
DR v[72:75],v10 offset:4096
MF a[148:151],v[180:183],v[112:115],a[148:151]
MF a[152:155],v[184:187],v[112:115],a[152:155]
DR v[76:79],v10 offset:6144
MF a[156:159],v[188:191],v[112:115],a[156:159]
MF a[160:163],v[160:163],v[116:119],a[160:163]
DR v[80:83],v10 offset:8192
MF a[164:167],v[164:167],v[116:119],a[164:167]
BL v32,s[36:39],s21 offen offset:2048 lds
MF a[168:171],v[168:171],v[116:119],a[168:171]
DR v[84:87],v10 offset:10240
MF a[172:175],v[172:175],v[116:119],a[172:175]
MF a[176:179],v[176:179],v[116:119],a[176:179]
DR v[88:91],v10 offset:12288
MF a[180:183],v[180:183],v[116:119],a[180:183]
MF a[184:187],v[184:187],v[116:119],a[184:187]
DR v[92:95],v10 offset:14336
MF a[188:191],v[188:191],v[116:119],a[188:191]
BL v33,s[36:39],s21 offen offset:3072 lds
MF a[192:195],v[160:163],v[120:123],a[192:195]
MF a[196:199],v[164:167],v[120:123],a[196:199]
MF a[200:203],v[168:171],v[120:123],a[200:203]
MF a[204:207],v[172:175],v[120:123],a[204:207]
MF a[208:211],v[176:179],v[120:123],a[208:211]
MF a[212:215],v[180:183],v[120:123],a[212:215]
MF a[216:219],v[184:187],v[120:123],a[216:219]
MF a[220:223],v[188:191],v[120:123],a[220:223]
MF a[224:227],v[160:163],v[124:127],a[224:227]
MF a[228:231],v[164:167],v[124:127],a[228:231]
MF a[232:235],v[168:171],v[124:127],a[232:235]
MF a[236:239],v[172:175],v[124:127],a[236:239]
MF a[240:243],v[176:179],v[124:127],a[240:243]
MF a[244:247],v[180:183],v[124:127],a[244:247]
MF a[248:251],v[184:187],v[124:127],a[248:251]
MF a[252:255],v[188:191],v[124:127],a[252:255]
WT vmcnt(20) lgkmcnt(0)
s_barrier
MF a[0:3],v[128:131],v[64:67],a[0:3]
DR v[96:99],v12 offset:0
MF a[4:7],v[132:135],v[64:67],a[4:7]
MF a[8:11],v[136:139],v[64:67],a[8:11]
DT v[160:161],v14 offset:49152
MF a[12:15],v[140:143],v[64:67],a[12:15]
MF a[16:19],v[144:147],v[64:67],a[16:19]
DT v[162:163],v14 offset:51200
MF a[20:23],v[148:151],v[64:67],a[20:23]
SA m0,s23,131072
s_mov_b32 s22,524288
BL v26,s[40:43],s22 offen nt lds
MF a[24:27],v[152:155],v[64:67],a[24:27]
DT v[164:165],v15 offset:49152
MF a[28:31],v[156:159],v[64:67],a[28:31]
MF a[32:35],v[128:131],v[68:71],a[32:35]
DT v[166:167],v15 offset:51200
MF a[36:39],v[132:135],v[68:71],a[36:39]
MF a[40:43],v[136:139],v[68:71],a[40:43]
DT v[168:169],v16 offset:49152
MF a[44:47],v[140:143],v[68:71],a[44:47]
BL v27,s[40:43],s22 offen offset:1024 nt lds
MF a[48:51],v[144:147],v[68:71],a[48:51]
DT v[170:171],v16 offset:51200
MF a[52:55],v[148:151],v[68:71],a[52:55]
MF a[56:59],v[152:155],v[68:71],a[56:59]
DT v[172:173],v17 offset:49152
MF a[60:63],v[156:159],v[68:71],a[60:63]
MF a[64:67],v[128:131],v[72:75],a[64:67]
DT v[174:175],v17 offset:51200
MF a[68:71],v[132:135],v[72:75],a[68:71]
BL v28,s[40:43],s22 offen offset:2048 nt lds
MF a[72:75],v[136:139],v[72:75],a[72:75]
DT v[176:177],v18 offset:49152
MF a[76:79],v[140:143],v[72:75],a[76:79]
MF a[80:83],v[144:147],v[72:75],a[80:83]
DT v[178:179],v18 offset:51200
MF a[84:87],v[148:151],v[72:75],a[84:87]
MF a[88:91],v[152:155],v[72:75],a[88:91]
DT v[180:181],v19 offset:49152
MF a[92:95],v[156:159],v[72:75],a[92:95]
BL v29,s[40:43],s22 offen offset:3072 nt lds
MF a[96:99],v[128:131],v[76:79],a[96:99]
DT v[182:183],v19 offset:51200
MF a[100:103],v[132:135],v[76:79],a[100:103]
MF a[104:107],v[136:139],v[76:79],a[104:107]
DT v[184:185],v20 offset:49152
MF a[108:111],v[140:143],v[76:79],a[108:111]
MF a[112:115],v[144:147],v[76:79],a[112:115]
DT v[186:187],v20 offset:51200
MF a[116:119],v[148:151],v[76:79],a[116:119]
SA m0,s23,81920
s_mov_b32 s22,1310720
BL v26,s[40:43],s22 offen nt lds
MF a[120:123],v[152:155],v[76:79],a[120:123]
DT v[188:189],v21 offset:49152
MF a[124:127],v[156:159],v[76:79],a[124:127]
MF a[128:131],v[128:131],v[80:83],a[128:131]
DT v[190:191],v21 offset:51200
MF a[132:135],v[132:135],v[80:83],a[132:135]
MF a[136:139],v[136:139],v[80:83],a[136:139]
DR v[100:103],v12 offset:2048
MF a[140:143],v[140:143],v[80:83],a[140:143]
BL v27,s[40:43],s22 offen offset:1024 nt lds
MF a[144:147],v[144:147],v[80:83],a[144:147]
DR v[104:107],v12 offset:4096
MF a[148:151],v[148:151],v[80:83],a[148:151]
MF a[152:155],v[152:155],v[80:83],a[152:155]
DR v[108:111],v12 offset:6144
MF a[156:159],v[156:159],v[80:83],a[156:159]
MF a[160:163],v[128:131],v[84:87],a[160:163]
DR v[112:115],v12 offset:8192
MF a[164:167],v[132:135],v[84:87],a[164:167]
BL v28,s[40:43],s22 offen offset:2048 nt lds
MF a[168:171],v[136:139],v[84:87],a[168:171]
DR v[116:119],v12 offset:10240
MF a[172:175],v[140:143],v[84:87],a[172:175]
MF a[176:179],v[144:147],v[84:87],a[176:179]
DR v[120:123],v12 offset:12288
MF a[180:183],v[148:151],v[84:87],a[180:183]
MF a[184:187],v[152:155],v[84:87],a[184:187]
DR v[124:127],v12 offset:14336
MF a[188:191],v[156:159],v[84:87],a[188:191]
BL v29,s[40:43],s22 offen offset:3072 nt lds
MF a[192:195],v[128:131],v[88:91],a[192:195]
MF a[196:199],v[132:135],v[88:91],a[196:199]
MF a[200:203],v[136:139],v[88:91],a[200:203]
MF a[204:207],v[140:143],v[88:91],a[204:207]
MF a[208:211],v[144:147],v[88:91],a[208:211]
MF a[212:215],v[148:151],v[88:91],a[212:215]
MF a[216:219],v[152:155],v[88:91],a[216:219]
MF a[220:223],v[156:159],v[88:91],a[220:223]
MF a[224:227],v[128:131],v[92:95],a[224:227]
MF a[228:231],v[132:135],v[92:95],a[228:231]
MF a[232:235],v[136:139],v[92:95],a[232:235]
MF a[236:239],v[140:143],v[92:95],a[236:239]
MF a[240:243],v[144:147],v[92:95],a[240:243]
MF a[244:247],v[148:151],v[92:95],a[244:247]
MF a[248:251],v[152:155],v[92:95],a[248:251]
MF a[252:255],v[156:159],v[92:95],a[252:255]
WT vmcnt(20) lgkmcnt(0)
s_barrier
MF a[0:3],v[160:163],v[96:99],a[0:3]
MF a[4:7],v[164:167],v[96:99],a[4:7]
MF a[8:11],v[168:171],v[96:99],a[8:11]
MF a[12:15],v[172:175],v[96:99],a[12:15]
MF a[16:19],v[176:179],v[96:99],a[16:19]
MF a[20:23],v[180:183],v[96:99],a[20:23]
SA m0,s23,147456
s_mov_b32 s22,786432
BL v26,s[40:43],s22 offen nt lds
MF a[24:27],v[184:187],v[96:99],a[24:27]
MF a[28:31],v[188:191],v[96:99],a[28:31]
MF a[32:35],v[160:163],v[100:103],a[32:35]
MF a[36:39],v[164:167],v[100:103],a[36:39]
MF a[40:43],v[168:171],v[100:103],a[40:43]
MF a[44:47],v[172:175],v[100:103],a[44:47]
BL v27,s[40:43],s22 offen offset:1024 nt lds
MF a[48:51],v[176:179],v[100:103],a[48:51]
MF a[52:55],v[180:183],v[100:103],a[52:55]
MF a[56:59],v[184:187],v[100:103],a[56:59]
MF a[60:63],v[188:191],v[100:103],a[60:63]
MF a[64:67],v[160:163],v[104:107],a[64:67]
MF a[68:71],v[164:167],v[104:107],a[68:71]
BL v28,s[40:43],s22 offen offset:2048 nt lds
MF a[72:75],v[168:171],v[104:107],a[72:75]
MF a[76:79],v[172:175],v[104:107],a[76:79]
MF a[80:83],v[176:179],v[104:107],a[80:83]
MF a[84:87],v[180:183],v[104:107],a[84:87]
MF a[88:91],v[184:187],v[104:107],a[88:91]
MF a[92:95],v[188:191],v[104:107],a[92:95]
BL v29,s[40:43],s22 offen offset:3072 nt lds
MF a[96:99],v[160:163],v[108:111],a[96:99]
MF a[100:103],v[164:167],v[108:111],a[100:103]
MF a[104:107],v[168:171],v[108:111],a[104:107]
MF a[108:111],v[172:175],v[108:111],a[108:111]
MF a[112:115],v[176:179],v[108:111],a[112:115]
MF a[116:119],v[180:183],v[108:111],a[116:119]
SA m0,s23,0
s_mov_b32 s21,256
BL v30,s[36:39],s21 offen lds
MF a[120:123],v[184:187],v[108:111],a[120:123]
MF a[124:127],v[188:191],v[108:111],a[124:127]
MF a[128:131],v[160:163],v[112:115],a[128:131]
MF a[132:135],v[164:167],v[112:115],a[132:135]
MF a[136:139],v[168:171],v[112:115],a[136:139]
MF a[140:143],v[172:175],v[112:115],a[140:143]
BL v31,s[36:39],s21 offen offset:1024 lds
MF a[144:147],v[176:179],v[112:115],a[144:147]
MF a[148:151],v[180:183],v[112:115],a[148:151]
MF a[152:155],v[184:187],v[112:115],a[152:155]
MF a[156:159],v[188:191],v[112:115],a[156:159]
MF a[160:163],v[160:163],v[116:119],a[160:163]
MF a[164:167],v[164:167],v[116:119],a[164:167]
BL v32,s[36:39],s21 offen offset:2048 lds
MF a[168:171],v[168:171],v[116:119],a[168:171]
MF a[172:175],v[172:175],v[116:119],a[172:175]
MF a[176:179],v[176:179],v[116:119],a[176:179]
MF a[180:183],v[180:183],v[116:119],a[180:183]
MF a[184:187],v[184:187],v[116:119],a[184:187]
MF a[188:191],v[188:191],v[116:119],a[188:191]
BL v33,s[36:39],s21 offen offset:3072 lds
MF a[192:195],v[160:163],v[120:123],a[192:195]
MF a[196:199],v[164:167],v[120:123],a[196:199]
MF a[200:203],v[168:171],v[120:123],a[200:203]
MF a[204:207],v[172:175],v[120:123],a[204:207]
MF a[208:211],v[176:179],v[120:123],a[208:211]
MF a[212:215],v[180:183],v[120:123],a[212:215]
MF a[216:219],v[184:187],v[120:123],a[216:219]
MF a[220:223],v[188:191],v[120:123],a[220:223]
MF a[224:227],v[160:163],v[124:127],a[224:227]
MF a[228:231],v[164:167],v[124:127],a[228:231]
MF a[232:235],v[168:171],v[124:127],a[232:235]
MF a[236:239],v[172:175],v[124:127],a[236:239]
MF a[240:243],v[176:179],v[124:127],a[240:243]
MF a[244:247],v[180:183],v[124:127],a[244:247]
MF a[248:251],v[184:187],v[124:127],a[248:251]
MF a[252:255],v[188:191],v[124:127],a[252:255]
v_lshrrev_b32 v4,7,v0
v_lshlrev_b32 v4,13,v4
v_sub_u32 v10,v10,v4
v_sub_u32 v11,v11,v4
v_sub_u32 v12,v12,v4
v_sub_u32 v13,v13,v4
DR v[64:67],v10 offset:32768
DT v[128:129],v14 offset:0
DT v[130:131],v14 offset:2048
DT v[132:133],v15 offset:0
DT v[134:135],v15 offset:2048
DT v[136:137],v16 offset:0
DT v[138:139],v16 offset:2048
DT v[140:141],v17 offset:0
DT v[142:143],v17 offset:2048
DT v[144:145],v18 offset:0
DT v[146:147],v18 offset:2048
DT v[148:149],v19 offset:0
DT v[150:151],v19 offset:2048
DT v[152:153],v20 offset:0
DT v[154:155],v20 offset:2048
DT v[156:157],v21 offset:0
DT v[158:159],v21 offset:2048
DR v[68:71],v10 offset:34816
DR v[72:75],v10 offset:36864
DR v[76:79],v10 offset:38912
s_nop 4
v_lshlrev_b32 v3,4,v1
v_lshrrev_b32 v4,7,v0
v_lshlrev_b32 v4,16,v4
v_add_u32 v3,v3,v4
v_bfe_u32 v4,v0,6,1
v_lshlrev_b32 v4,12,v4
v_add_u32 v3,v3,v4
s_lshl_b32 s29,s28,17
AR v192,a0
AR v193,a1
AR v194,a2
AR v195,a3
AR v196,a4
AR v197,a5
AR v198,a6
AR v199,a7
CV v200,v192,v193
CV v201,v194,v195
CV v202,v196,v197
CV v203,v198,v199
SA s30,s29,0
BS v[200:203],v3,s[16:19],s30 offen sc1
AR v204,a8
AR v205,a9
AR v206,a10
AR v207,a11
AR v208,a12
AR v209,a13
AR v210,a14
AR v211,a15
CV v212,v204,v205
CV v213,v206,v207
CV v214,v208,v209
CV v215,v210,v211
SA s30,s29,1024
BS v[212:215],v3,s[16:19],s30 offen sc1
AR v216,a16
AR v217,a17
AR v218,a18
AR v219,a19
AR v220,a20
AR v221,a21
AR v222,a22
AR v223,a23
CV v224,v216,v217
CV v225,v218,v219
CV v226,v220,v221
CV v227,v222,v223
SA s30,s29,2048
BS v[224:227],v3,s[16:19],s30 offen sc1
AR v228,a24
AR v229,a25
AR v230,a26
AR v231,a27
AR v232,a28
AR v233,a29
AR v234,a30
AR v235,a31
CV v236,v228,v229
CV v237,v230,v231
CV v238,v232,v233
CV v239,v234,v235
SA s30,s29,3072
BS v[236:239],v3,s[16:19],s30 offen sc1
AR v192,a32
AR v193,a33
AR v194,a34
AR v195,a35
AR v196,a36
AR v197,a37
AR v198,a38
AR v199,a39
CV v200,v192,v193
CV v201,v194,v195
CV v202,v196,v197
CV v203,v198,v199
SA s30,s29,8192
BS v[200:203],v3,s[16:19],s30 offen sc1
AR v204,a40
AR v205,a41
AR v206,a42
AR v207,a43
AR v208,a44
AR v209,a45
AR v210,a46
AR v211,a47
CV v212,v204,v205
CV v213,v206,v207
CV v214,v208,v209
CV v215,v210,v211
SA s30,s29,9216
BS v[212:215],v3,s[16:19],s30 offen sc1
AR v216,a48
AR v217,a49
AR v218,a50
AR v219,a51
AR v220,a52
AR v221,a53
AR v222,a54
AR v223,a55
CV v224,v216,v217
CV v225,v218,v219
CV v226,v220,v221
CV v227,v222,v223
SA s30,s29,10240
BS v[224:227],v3,s[16:19],s30 offen sc1
AR v228,a56
AR v229,a57
AR v230,a58
AR v231,a59
AR v232,a60
AR v233,a61
AR v234,a62
AR v235,a63
CV v236,v228,v229
CV v237,v230,v231
CV v238,v232,v233
CV v239,v234,v235
SA s30,s29,11264
BS v[236:239],v3,s[16:19],s30 offen sc1
AR v192,a64
AR v193,a65
AR v194,a66
AR v195,a67
AR v196,a68
AR v197,a69
AR v198,a70
AR v199,a71
CV v200,v192,v193
CV v201,v194,v195
CV v202,v196,v197
CV v203,v198,v199
SA s30,s29,16384
BS v[200:203],v3,s[16:19],s30 offen sc1
AR v204,a72
AR v205,a73
AR v206,a74
AR v207,a75
AR v208,a76
AR v209,a77
AR v210,a78
AR v211,a79
CV v212,v204,v205
CV v213,v206,v207
CV v214,v208,v209
CV v215,v210,v211
SA s30,s29,17408
BS v[212:215],v3,s[16:19],s30 offen sc1
AR v216,a80
AR v217,a81
AR v218,a82
AR v219,a83
AR v220,a84
AR v221,a85
AR v222,a86
AR v223,a87
CV v224,v216,v217
CV v225,v218,v219
CV v226,v220,v221
CV v227,v222,v223
SA s30,s29,18432
BS v[224:227],v3,s[16:19],s30 offen sc1
AR v228,a88
AR v229,a89
AR v230,a90
AR v231,a91
AR v232,a92
AR v233,a93
AR v234,a94
AR v235,a95
CV v236,v228,v229
CV v237,v230,v231
CV v238,v232,v233
CV v239,v234,v235
SA s30,s29,19456
BS v[236:239],v3,s[16:19],s30 offen sc1
AR v192,a96
AR v193,a97
AR v194,a98
AR v195,a99
AR v196,a100
AR v197,a101
AR v198,a102
AR v199,a103
CV v200,v192,v193
CV v201,v194,v195
CV v202,v196,v197
CV v203,v198,v199
SA s30,s29,24576
BS v[200:203],v3,s[16:19],s30 offen sc1
AR v204,a104
AR v205,a105
AR v206,a106
AR v207,a107
AR v208,a108
AR v209,a109
AR v210,a110
AR v211,a111
CV v212,v204,v205
CV v213,v206,v207
CV v214,v208,v209
CV v215,v210,v211
SA s30,s29,25600
BS v[212:215],v3,s[16:19],s30 offen sc1
AR v216,a112
AR v217,a113
AR v218,a114
AR v219,a115
AR v220,a116
AR v221,a117
AR v222,a118
AR v223,a119
CV v224,v216,v217
CV v225,v218,v219
CV v226,v220,v221
CV v227,v222,v223
SA s30,s29,26624
BS v[224:227],v3,s[16:19],s30 offen sc1
AR v228,a120
AR v229,a121
AR v230,a122
AR v231,a123
AR v232,a124
AR v233,a125
AR v234,a126
AR v235,a127
CV v236,v228,v229
CV v237,v230,v231
CV v238,v232,v233
CV v239,v234,v235
SA s30,s29,27648
BS v[236:239],v3,s[16:19],s30 offen sc1
WT vmcnt(36) lgkmcnt(0)
s_barrier
MF a[0:3],v[128:131],v[64:67],0
DR v[96:99],v12 offset:32768
AR v192,a128
MF a[4:7],v[132:135],v[64:67],0
DT v[160:161],v14 offset:16384
AR v193,a129
MF a[8:11],v[136:139],v[64:67],0
DT v[162:163],v14 offset:18432
AR v194,a130
MF a[12:15],v[140:143],v[64:67],0
DT v[164:165],v15 offset:16384
AR v195,a131
MF a[16:19],v[144:147],v[64:67],0
DT v[166:167],v15 offset:18432
AR v196,a132
MF a[20:23],v[148:151],v[64:67],0
DT v[168:169],v16 offset:16384
AR v197,a133
MF a[24:27],v[152:155],v[64:67],0
DT v[170:171],v16 offset:18432
AR v198,a134
MF a[28:31],v[156:159],v[64:67],0
DT v[172:173],v17 offset:16384
AR v199,a135
MF a[32:35],v[128:131],v[68:71],0
DT v[174:175],v17 offset:18432
CV v200,v192,v193
MF a[36:39],v[132:135],v[68:71],0
DT v[176:177],v18 offset:16384
CV v201,v194,v195
MF a[40:43],v[136:139],v[68:71],0
DT v[178:179],v18 offset:18432
CV v202,v196,v197
MF a[44:47],v[140:143],v[68:71],0
DT v[180:181],v19 offset:16384
CV v203,v198,v199
MF a[48:51],v[144:147],v[68:71],0
DT v[182:183],v19 offset:18432
MF a[52:55],v[148:151],v[68:71],0
DT v[184:185],v20 offset:16384
MF a[56:59],v[152:155],v[68:71],0
DT v[186:187],v20 offset:18432
MF a[60:63],v[156:159],v[68:71],0
DT v[188:189],v21 offset:16384
MF a[64:67],v[128:131],v[72:75],0
DT v[190:191],v21 offset:18432
MF a[68:71],v[132:135],v[72:75],0
DR v[100:103],v12 offset:34816
MF a[72:75],v[136:139],v[72:75],0
DR v[104:107],v12 offset:36864
MF a[76:79],v[140:143],v[72:75],0
DR v[108:111],v12 offset:38912
MF a[80:83],v[144:147],v[72:75],0
SA s30,s29,32768
BS v[200:203],v3,s[16:19],s30 offen sc1
MF a[84:87],v[148:151],v[72:75],0
SA m0,s23,98304
s_mov_b32 s22,1572864
BL v26,s[40:43],s22 offen nt lds
MF a[88:91],v[152:155],v[72:75],0
AR v204,a136
AR v205,a137
MF a[92:95],v[156:159],v[72:75],0
AR v206,a138
AR v207,a139
MF a[96:99],v[128:131],v[76:79],0
BL v27,s[40:43],s22 offen offset:1024 nt lds
MF a[100:103],v[132:135],v[76:79],0
AR v208,a140
AR v209,a141
MF a[104:107],v[136:139],v[76:79],0
AR v210,a142
AR v211,a143
MF a[108:111],v[140:143],v[76:79],0
BL v28,s[40:43],s22 offen offset:2048 nt lds
MF a[112:115],v[144:147],v[76:79],0
CV v212,v204,v205
CV v213,v206,v207
MF a[116:119],v[148:151],v[76:79],0
CV v214,v208,v209
CV v215,v210,v211
MF a[120:123],v[152:155],v[76:79],0
BL v29,s[40:43],s22 offen offset:3072 nt lds
MF a[124:127],v[156:159],v[76:79],0
SA s30,s29,33792
BS v[212:215],v3,s[16:19],s30 offen sc1
WT vmcnt(34) lgkmcnt(0)
s_barrier
MF a[0:3],v[160:163],v[96:99],a[0:3]
DR v[64:67],v11 offset:0
AR v216,a144
MF a[4:7],v[164:167],v[96:99],a[4:7]
DT v[128:129],v14 offset:32768
AR v217,a145
MF a[8:11],v[168:171],v[96:99],a[8:11]
DT v[130:131],v14 offset:34816
AR v218,a146
MF a[12:15],v[172:175],v[96:99],a[12:15]
DT v[132:133],v15 offset:32768
AR v219,a147
MF a[16:19],v[176:179],v[96:99],a[16:19]
DT v[134:135],v15 offset:34816
AR v220,a148
MF a[20:23],v[180:183],v[96:99],a[20:23]
DT v[136:137],v16 offset:32768
AR v221,a149
MF a[24:27],v[184:187],v[96:99],a[24:27]
DT v[138:139],v16 offset:34816
AR v222,a150
MF a[28:31],v[188:191],v[96:99],a[28:31]
DT v[140:141],v17 offset:32768
AR v223,a151
MF a[32:35],v[160:163],v[100:103],a[32:35]
DT v[142:143],v17 offset:34816
CV v224,v216,v217
MF a[36:39],v[164:167],v[100:103],a[36:39]
DT v[144:145],v18 offset:32768
CV v225,v218,v219
MF a[40:43],v[168:171],v[100:103],a[40:43]
DT v[146:147],v18 offset:34816
CV v226,v220,v221
MF a[44:47],v[172:175],v[100:103],a[44:47]
DT v[148:149],v19 offset:32768
CV v227,v222,v223
MF a[48:51],v[176:179],v[100:103],a[48:51]
DT v[150:151],v19 offset:34816
MF a[52:55],v[180:183],v[100:103],a[52:55]
DT v[152:153],v20 offset:32768
MF a[56:59],v[184:187],v[100:103],a[56:59]
DT v[154:155],v20 offset:34816
MF a[60:63],v[188:191],v[100:103],a[60:63]
DT v[156:157],v21 offset:32768
MF a[64:67],v[160:163],v[104:107],a[64:67]
DT v[158:159],v21 offset:34816
MF a[68:71],v[164:167],v[104:107],a[68:71]
DR v[68:71],v11 offset:2048
MF a[72:75],v[168:171],v[104:107],a[72:75]
DR v[72:75],v11 offset:4096
MF a[76:79],v[172:175],v[104:107],a[76:79]
DR v[76:79],v11 offset:6144
MF a[80:83],v[176:179],v[104:107],a[80:83]
SA m0,s23,32768
s_mov_b32 s21,384
BL v30,s[36:39],s21 offen lds
MF a[84:87],v[180:183],v[104:107],a[84:87]
BL v31,s[36:39],s21 offen offset:1024 lds
MF a[88:91],v[184:187],v[104:107],a[88:91]
BL v32,s[36:39],s21 offen offset:2048 lds
MF a[92:95],v[188:191],v[104:107],a[92:95]
SA s30,s29,34816
BS v[224:227],v3,s[16:19],s30 offen sc1
MF a[96:99],v[160:163],v[108:111],a[96:99]
BL v33,s[36:39],s21 offen offset:3072 lds
MF a[100:103],v[164:167],v[108:111],a[100:103]
SA m0,s23,114688
s_mov_b32 s22,1835008
BL v26,s[40:43],s22 offen nt lds
MF a[104:107],v[168:171],v[108:111],a[104:107]
AR v228,a152
AR v229,a153
MF a[108:111],v[172:175],v[108:111],a[108:111]
BL v27,s[40:43],s22 offen offset:1024 nt lds
MF a[112:115],v[176:179],v[108:111],a[112:115]
AR v230,a154
AR v231,a155
MF a[116:119],v[180:183],v[108:111],a[116:119]
BL v28,s[40:43],s22 offen offset:2048 nt lds
MF a[120:123],v[184:187],v[108:111],a[120:123]
AR v232,a156
AR v233,a157
MF a[124:127],v[188:191],v[108:111],a[124:127]
BL v29,s[40:43],s22 offen offset:3072 nt lds
WT vmcnt(35) lgkmcnt(0)
s_barrier
MF a[0:3],v[128:131],v[64:67],a[0:3]
DR v[96:99],v13 offset:0
AR v234,a158
MF a[4:7],v[132:135],v[64:67],a[4:7]
DT v[160:161],v14 offset:49152
AR v235,a159
MF a[8:11],v[136:139],v[64:67],a[8:11]
DT v[162:163],v14 offset:51200
CV v236,v228,v229
MF a[12:15],v[140:143],v[64:67],a[12:15]
DT v[164:165],v15 offset:49152
CV v237,v230,v231
MF a[16:19],v[144:147],v[64:67],a[16:19]
DT v[166:167],v15 offset:51200
CV v238,v232,v233
MF a[20:23],v[148:151],v[64:67],a[20:23]
DT v[168:169],v16 offset:49152
CV v239,v234,v235
MF a[24:27],v[152:155],v[64:67],a[24:27]
DT v[170:171],v16 offset:51200
MF a[28:31],v[156:159],v[64:67],a[28:31]
DT v[172:173],v17 offset:49152
MF a[32:35],v[128:131],v[68:71],a[32:35]
DT v[174:175],v17 offset:51200
MF a[36:39],v[132:135],v[68:71],a[36:39]
DT v[176:177],v18 offset:49152
MF a[40:43],v[136:139],v[68:71],a[40:43]
DT v[178:179],v18 offset:51200
MF a[44:47],v[140:143],v[68:71],a[44:47]
DT v[180:181],v19 offset:49152
MF a[48:51],v[144:147],v[68:71],a[48:51]
DT v[182:183],v19 offset:51200
MF a[52:55],v[148:151],v[68:71],a[52:55]
DT v[184:185],v20 offset:49152
MF a[56:59],v[152:155],v[68:71],a[56:59]
DT v[186:187],v20 offset:51200
MF a[60:63],v[156:159],v[68:71],a[60:63]
DT v[188:189],v21 offset:49152
MF a[64:67],v[128:131],v[72:75],a[64:67]
DT v[190:191],v21 offset:51200
MF a[68:71],v[132:135],v[72:75],a[68:71]
DR v[100:103],v13 offset:2048
MF a[72:75],v[136:139],v[72:75],a[72:75]
DR v[104:107],v13 offset:4096
MF a[76:79],v[140:143],v[72:75],a[76:79]
DR v[108:111],v13 offset:6144
MF a[80:83],v[144:147],v[72:75],a[80:83]
SA s30,s29,35840
BS v[236:239],v3,s[16:19],s30 offen sc1
MF a[84:87],v[148:151],v[72:75],a[84:87]
SA m0,s23,131072
s_mov_b32 s22,2097152
BL v26,s[40:43],s22 offen nt lds
MF a[88:91],v[152:155],v[72:75],a[88:91]
AR v192,a160
AR v193,a161
MF a[92:95],v[156:159],v[72:75],a[92:95]
AR v194,a162
AR v195,a163
MF a[96:99],v[128:131],v[76:79],a[96:99]
BL v27,s[40:43],s22 offen offset:1024 nt lds
MF a[100:103],v[132:135],v[76:79],a[100:103]
AR v196,a164
AR v197,a165
MF a[104:107],v[136:139],v[76:79],a[104:107]
AR v198,a166
AR v199,a167
MF a[108:111],v[140:143],v[76:79],a[108:111]
BL v28,s[40:43],s22 offen offset:2048 nt lds
MF a[112:115],v[144:147],v[76:79],a[112:115]
CV v200,v192,v193
CV v201,v194,v195
MF a[116:119],v[148:151],v[76:79],a[116:119]
CV v202,v196,v197
CV v203,v198,v199
MF a[120:123],v[152:155],v[76:79],a[120:123]
BL v29,s[40:43],s22 offen offset:3072 nt lds
MF a[124:127],v[156:159],v[76:79],a[124:127]
SA s30,s29,40960
BS v[200:203],v3,s[16:19],s30 offen sc1
WT vmcnt(37) lgkmcnt(0)
s_barrier
MF a[0:3],v[160:163],v[96:99],a[0:3]
DR v[64:67],v10 offset:0
AR v204,a168
MF a[4:7],v[164:167],v[96:99],a[4:7]
DT v[128:129],v40 offset:16384
AR v205,a169
MF a[8:11],v[168:171],v[96:99],a[8:11]
DT v[130:131],v40 offset:18432
AR v206,a170
MF a[12:15],v[172:175],v[96:99],a[12:15]
DT v[132:133],v41 offset:16384
AR v207,a171
MF a[16:19],v[176:179],v[96:99],a[16:19]
DT v[134:135],v41 offset:18432
AR v208,a172
MF a[20:23],v[180:183],v[96:99],a[20:23]
DT v[136:137],v42 offset:16384
AR v209,a173
MF a[24:27],v[184:187],v[96:99],a[24:27]
DT v[138:139],v42 offset:18432
AR v210,a174
MF a[28:31],v[188:191],v[96:99],a[28:31]
DT v[140:141],v43 offset:16384
AR v211,a175
MF a[32:35],v[160:163],v[100:103],a[32:35]
DT v[142:143],v43 offset:18432
CV v212,v204,v205
MF a[36:39],v[164:167],v[100:103],a[36:39]
DT v[144:145],v44 offset:16384
CV v213,v206,v207
MF a[40:43],v[168:171],v[100:103],a[40:43]
DT v[146:147],v44 offset:18432
CV v214,v208,v209
MF a[44:47],v[172:175],v[100:103],a[44:47]
DT v[148:149],v45 offset:16384
CV v215,v210,v211
MF a[48:51],v[176:179],v[100:103],a[48:51]
DT v[150:151],v45 offset:18432
MF a[52:55],v[180:183],v[100:103],a[52:55]
DT v[152:153],v46 offset:16384
MF a[56:59],v[184:187],v[100:103],a[56:59]
DT v[154:155],v46 offset:18432
MF a[60:63],v[188:191],v[100:103],a[60:63]
DT v[156:157],v47 offset:16384
MF a[64:67],v[160:163],v[104:107],a[64:67]
DT v[158:159],v47 offset:18432
MF a[68:71],v[164:167],v[104:107],a[68:71]
DR v[68:71],v10 offset:2048
MF a[72:75],v[168:171],v[104:107],a[72:75]
DR v[72:75],v10 offset:4096
MF a[76:79],v[172:175],v[104:107],a[76:79]
DR v[76:79],v10 offset:6144
MF a[80:83],v[176:179],v[104:107],a[80:83]
SA m0,s23,65536
s_mov_b32 s21,512
BL v30,s[36:39],s21 offen lds
MF a[84:87],v[180:183],v[104:107],a[84:87]
BL v31,s[36:39],s21 offen offset:1024 lds
MF a[88:91],v[184:187],v[104:107],a[88:91]
BL v32,s[36:39],s21 offen offset:2048 lds
MF a[92:95],v[188:191],v[104:107],a[92:95]
SA s30,s29,41984
BS v[212:215],v3,s[16:19],s30 offen sc1
MF a[96:99],v[160:163],v[108:111],a[96:99]
BL v33,s[36:39],s21 offen offset:3072 lds
MF a[100:103],v[164:167],v[108:111],a[100:103]
SA m0,s23,147456
s_mov_b32 s22,2359296
BL v26,s[40:43],s22 offen nt lds
MF a[104:107],v[168:171],v[108:111],a[104:107]
AR v216,a176
AR v217,a177
MF a[108:111],v[172:175],v[108:111],a[108:111]
BL v27,s[40:43],s22 offen offset:1024 nt lds
MF a[112:115],v[176:179],v[108:111],a[112:115]
AR v218,a178
AR v219,a179
MF a[116:119],v[180:183],v[108:111],a[116:119]
BL v28,s[40:43],s22 offen offset:2048 nt lds
MF a[120:123],v[184:187],v[108:111],a[120:123]
AR v220,a180
AR v221,a181
MF a[124:127],v[188:191],v[108:111],a[124:127]
BL v29,s[40:43],s22 offen offset:3072 nt lds
WT vmcnt(46) lgkmcnt(0)
s_barrier
MF a[0:3],v[128:131],v[64:67],a[0:3]
DR v[96:99],v12 offset:0
AR v222,a182
MF a[4:7],v[132:135],v[64:67],a[4:7]
DT v[160:161],v40 offset:49152
AR v223,a183
MF a[8:11],v[136:139],v[64:67],a[8:11]
DT v[162:163],v40 offset:51200
CV v224,v216,v217
MF a[12:15],v[140:143],v[64:67],a[12:15]
DT v[164:165],v41 offset:49152
CV v225,v218,v219
MF a[16:19],v[144:147],v[64:67],a[16:19]
DT v[166:167],v41 offset:51200
CV v226,v220,v221
MF a[20:23],v[148:151],v[64:67],a[20:23]
DT v[168:169],v42 offset:49152
CV v227,v222,v223
MF a[24:27],v[152:155],v[64:67],a[24:27]
DT v[170:171],v42 offset:51200
MF a[28:31],v[156:159],v[64:67],a[28:31]
DT v[172:173],v43 offset:49152
MF a[32:35],v[128:131],v[68:71],a[32:35]
DT v[174:175],v43 offset:51200
MF a[36:39],v[132:135],v[68:71],a[36:39]
DT v[176:177],v44 offset:49152
MF a[40:43],v[136:139],v[68:71],a[40:43]
DT v[178:179],v44 offset:51200
MF a[44:47],v[140:143],v[68:71],a[44:47]
DT v[180:181],v45 offset:49152
MF a[48:51],v[144:147],v[68:71],a[48:51]
DT v[182:183],v45 offset:51200
MF a[52:55],v[148:151],v[68:71],a[52:55]
DT v[184:185],v46 offset:49152
MF a[56:59],v[152:155],v[68:71],a[56:59]
DT v[186:187],v46 offset:51200
MF a[60:63],v[156:159],v[68:71],a[60:63]
DT v[188:189],v47 offset:49152
MF a[64:67],v[128:131],v[72:75],a[64:67]
DT v[190:191],v47 offset:51200
MF a[68:71],v[132:135],v[72:75],a[68:71]
DR v[100:103],v12 offset:2048
MF a[72:75],v[136:139],v[72:75],a[72:75]
DR v[104:107],v12 offset:4096
MF a[76:79],v[140:143],v[72:75],a[76:79]
DR v[108:111],v12 offset:6144
MF a[80:83],v[144:147],v[72:75],a[80:83]
SA s30,s29,43008
BS v[224:227],v3,s[16:19],s30 offen sc1
MF a[84:87],v[148:151],v[72:75],a[84:87]
SA m0,s23,49152
s_mov_b32 s22,2621440
BL v26,s[40:43],s22 offen nt lds
MF a[88:91],v[152:155],v[72:75],a[88:91]
AR v228,a184
AR v229,a185
MF a[92:95],v[156:159],v[72:75],a[92:95]
AR v230,a186
AR v231,a187
MF a[96:99],v[128:131],v[76:79],a[96:99]
BL v27,s[40:43],s22 offen offset:1024 nt lds
MF a[100:103],v[132:135],v[76:79],a[100:103]
AR v232,a188
AR v233,a189
MF a[104:107],v[136:139],v[76:79],a[104:107]
AR v234,a190
AR v235,a191
MF a[108:111],v[140:143],v[76:79],a[108:111]
BL v28,s[40:43],s22 offen offset:2048 nt lds
MF a[112:115],v[144:147],v[76:79],a[112:115]
CV v236,v228,v229
CV v237,v230,v231
MF a[116:119],v[148:151],v[76:79],a[116:119]
CV v238,v232,v233
CV v239,v234,v235
MF a[120:123],v[152:155],v[76:79],a[120:123]
BL v29,s[40:43],s22 offen offset:3072 nt lds
MF a[124:127],v[156:159],v[76:79],a[124:127]
SA s30,s29,44032
BS v[236:239],v3,s[16:19],s30 offen sc1
WT vmcnt(25) lgkmcnt(0)
s_barrier
MF a[0:3],v[160:163],v[96:99],a[0:3]
DR v[64:67],v10 offset:32768
AR v192,a192
MF a[4:7],v[164:167],v[96:99],a[4:7]
DT v[128:129],v14 offset:0
AR v193,a193
MF a[8:11],v[168:171],v[96:99],a[8:11]
DT v[130:131],v14 offset:2048
AR v194,a194
MF a[12:15],v[172:175],v[96:99],a[12:15]
DT v[132:133],v15 offset:0
AR v195,a195
MF a[16:19],v[176:179],v[96:99],a[16:19]
DT v[134:135],v15 offset:2048
AR v196,a196
MF a[20:23],v[180:183],v[96:99],a[20:23]
DT v[136:137],v16 offset:0
AR v197,a197
MF a[24:27],v[184:187],v[96:99],a[24:27]
DT v[138:139],v16 offset:2048
AR v198,a198
MF a[28:31],v[188:191],v[96:99],a[28:31]
DT v[140:141],v17 offset:0
AR v199,a199
MF a[32:35],v[160:163],v[100:103],a[32:35]
DT v[142:143],v17 offset:2048
CV v200,v192,v193
MF a[36:39],v[164:167],v[100:103],a[36:39]
DT v[144:145],v18 offset:0
CV v201,v194,v195
MF a[40:43],v[168:171],v[100:103],a[40:43]
DT v[146:147],v18 offset:2048
CV v202,v196,v197
MF a[44:47],v[172:175],v[100:103],a[44:47]
DT v[148:149],v19 offset:0
CV v203,v198,v199
MF a[48:51],v[176:179],v[100:103],a[48:51]
DT v[150:151],v19 offset:2048
MF a[52:55],v[180:183],v[100:103],a[52:55]
DT v[152:153],v20 offset:0
MF a[56:59],v[184:187],v[100:103],a[56:59]
DT v[154:155],v20 offset:2048
MF a[60:63],v[188:191],v[100:103],a[60:63]
DT v[156:157],v21 offset:0
MF a[64:67],v[160:163],v[104:107],a[64:67]
DT v[158:159],v21 offset:2048
MF a[68:71],v[164:167],v[104:107],a[68:71]
DR v[68:71],v10 offset:34816
MF a[72:75],v[168:171],v[104:107],a[72:75]
DR v[72:75],v10 offset:36864
MF a[76:79],v[172:175],v[104:107],a[76:79]
DR v[76:79],v10 offset:38912
MF a[80:83],v[176:179],v[104:107],a[80:83]
SA m0,s23,0
s_mov_b32 s21,640
BL v30,s[36:39],s21 offen lds
MF a[84:87],v[180:183],v[104:107],a[84:87]
BL v31,s[36:39],s21 offen offset:1024 lds
MF a[88:91],v[184:187],v[104:107],a[88:91]
BL v32,s[36:39],s21 offen offset:2048 lds
MF a[92:95],v[188:191],v[104:107],a[92:95]
SA s30,s29,49152
BS v[200:203],v3,s[16:19],s30 offen sc1
MF a[96:99],v[160:163],v[108:111],a[96:99]
BL v33,s[36:39],s21 offen offset:3072 lds
MF a[100:103],v[164:167],v[108:111],a[100:103]
SA m0,s23,81920
s_mov_b32 s22,2883584
BL v26,s[40:43],s22 offen nt lds
MF a[104:107],v[168:171],v[108:111],a[104:107]
AR v204,a200
AR v205,a201
MF a[108:111],v[172:175],v[108:111],a[108:111]
BL v27,s[40:43],s22 offen offset:1024 nt lds
MF a[112:115],v[176:179],v[108:111],a[112:115]
AR v206,a202
AR v207,a203
MF a[116:119],v[180:183],v[108:111],a[116:119]
BL v28,s[40:43],s22 offen offset:2048 nt lds
MF a[120:123],v[184:187],v[108:111],a[120:123]
AR v208,a204
AR v209,a205
MF a[124:127],v[188:191],v[108:111],a[124:127]
BL v29,s[40:43],s22 offen offset:3072 nt lds
WT vmcnt(30) lgkmcnt(0)
s_barrier
MF a[0:3],v[128:131],v[64:67],a[0:3]
DR v[96:99],v12 offset:32768
AR v210,a206
MF a[4:7],v[132:135],v[64:67],a[4:7]
DT v[160:161],v14 offset:16384
AR v211,a207
MF a[8:11],v[136:139],v[64:67],a[8:11]
DT v[162:163],v14 offset:18432
CV v212,v204,v205
MF a[12:15],v[140:143],v[64:67],a[12:15]
DT v[164:165],v15 offset:16384
CV v213,v206,v207
MF a[16:19],v[144:147],v[64:67],a[16:19]
DT v[166:167],v15 offset:18432
CV v214,v208,v209
MF a[20:23],v[148:151],v[64:67],a[20:23]
DT v[168:169],v16 offset:16384
CV v215,v210,v211
MF a[24:27],v[152:155],v[64:67],a[24:27]
DT v[170:171],v16 offset:18432
MF a[28:31],v[156:159],v[64:67],a[28:31]
DT v[172:173],v17 offset:16384
MF a[32:35],v[128:131],v[68:71],a[32:35]
DT v[174:175],v17 offset:18432
MF a[36:39],v[132:135],v[68:71],a[36:39]
DT v[176:177],v18 offset:16384
MF a[40:43],v[136:139],v[68:71],a[40:43]
DT v[178:179],v18 offset:18432
MF a[44:47],v[140:143],v[68:71],a[44:47]
DT v[180:181],v19 offset:16384
MF a[48:51],v[144:147],v[68:71],a[48:51]
DT v[182:183],v19 offset:18432
MF a[52:55],v[148:151],v[68:71],a[52:55]
DT v[184:185],v20 offset:16384
MF a[56:59],v[152:155],v[68:71],a[56:59]
DT v[186:187],v20 offset:18432
MF a[60:63],v[156:159],v[68:71],a[60:63]
DT v[188:189],v21 offset:16384
MF a[64:67],v[128:131],v[72:75],a[64:67]
DT v[190:191],v21 offset:18432
MF a[68:71],v[132:135],v[72:75],a[68:71]
DR v[100:103],v12 offset:34816
MF a[72:75],v[136:139],v[72:75],a[72:75]
DR v[104:107],v12 offset:36864
MF a[76:79],v[140:143],v[72:75],a[76:79]
DR v[108:111],v12 offset:38912
MF a[80:83],v[144:147],v[72:75],a[80:83]
SA s30,s29,50176
BS v[212:215],v3,s[16:19],s30 offen sc1
MF a[84:87],v[148:151],v[72:75],a[84:87]
SA m0,s23,98304
s_mov_b32 s22,3145728
BL v26,s[40:43],s22 offen nt lds
MF a[88:91],v[152:155],v[72:75],a[88:91]
AR v216,a208
AR v217,a209
MF a[92:95],v[156:159],v[72:75],a[92:95]
AR v218,a210
AR v219,a211
MF a[96:99],v[128:131],v[76:79],a[96:99]
BL v27,s[40:43],s22 offen offset:1024 nt lds
MF a[100:103],v[132:135],v[76:79],a[100:103]
AR v220,a212
AR v221,a213
MF a[104:107],v[136:139],v[76:79],a[104:107]
AR v222,a214
AR v223,a215
MF a[108:111],v[140:143],v[76:79],a[108:111]
BL v28,s[40:43],s22 offen offset:2048 nt lds
MF a[112:115],v[144:147],v[76:79],a[112:115]
CV v224,v216,v217
CV v225,v218,v219
MF a[116:119],v[148:151],v[76:79],a[116:119]
CV v226,v220,v221
CV v227,v222,v223
MF a[120:123],v[152:155],v[76:79],a[120:123]
BL v29,s[40:43],s22 offen offset:3072 nt lds
MF a[124:127],v[156:159],v[76:79],a[124:127]
SA s30,s29,51200
BS v[224:227],v3,s[16:19],s30 offen sc1
WT vmcnt(25) lgkmcnt(0)
s_barrier
MF a[0:3],v[160:163],v[96:99],a[0:3]
DR v[64:67],v11 offset:0
AR v228,a216
MF a[4:7],v[164:167],v[96:99],a[4:7]
DT v[128:129],v14 offset:32768
AR v229,a217
MF a[8:11],v[168:171],v[96:99],a[8:11]
DT v[130:131],v14 offset:34816
AR v230,a218
MF a[12:15],v[172:175],v[96:99],a[12:15]
DT v[132:133],v15 offset:32768
AR v231,a219
MF a[16:19],v[176:179],v[96:99],a[16:19]
DT v[134:135],v15 offset:34816
AR v232,a220
MF a[20:23],v[180:183],v[96:99],a[20:23]
DT v[136:137],v16 offset:32768
AR v233,a221
MF a[24:27],v[184:187],v[96:99],a[24:27]
DT v[138:139],v16 offset:34816
AR v234,a222
MF a[28:31],v[188:191],v[96:99],a[28:31]
DT v[140:141],v17 offset:32768
AR v235,a223
MF a[32:35],v[160:163],v[100:103],a[32:35]
DT v[142:143],v17 offset:34816
CV v236,v228,v229
MF a[36:39],v[164:167],v[100:103],a[36:39]
DT v[144:145],v18 offset:32768
CV v237,v230,v231
MF a[40:43],v[168:171],v[100:103],a[40:43]
DT v[146:147],v18 offset:34816
CV v238,v232,v233
MF a[44:47],v[172:175],v[100:103],a[44:47]
DT v[148:149],v19 offset:32768
CV v239,v234,v235
MF a[48:51],v[176:179],v[100:103],a[48:51]
DT v[150:151],v19 offset:34816
MF a[52:55],v[180:183],v[100:103],a[52:55]
DT v[152:153],v20 offset:32768
MF a[56:59],v[184:187],v[100:103],a[56:59]
DT v[154:155],v20 offset:34816
MF a[60:63],v[188:191],v[100:103],a[60:63]
DT v[156:157],v21 offset:32768
MF a[64:67],v[160:163],v[104:107],a[64:67]
DT v[158:159],v21 offset:34816
MF a[68:71],v[164:167],v[104:107],a[68:71]
DR v[68:71],v11 offset:2048
MF a[72:75],v[168:171],v[104:107],a[72:75]
DR v[72:75],v11 offset:4096
MF a[76:79],v[172:175],v[104:107],a[76:79]
DR v[76:79],v11 offset:6144
MF a[80:83],v[176:179],v[104:107],a[80:83]
SA m0,s23,32768
s_mov_b32 s21,768
BL v30,s[36:39],s21 offen lds
MF a[84:87],v[180:183],v[104:107],a[84:87]
BL v31,s[36:39],s21 offen offset:1024 lds
MF a[88:91],v[184:187],v[104:107],a[88:91]
BL v32,s[36:39],s21 offen offset:2048 lds
MF a[92:95],v[188:191],v[104:107],a[92:95]
SA s30,s29,52224
BS v[236:239],v3,s[16:19],s30 offen sc1
MF a[96:99],v[160:163],v[108:111],a[96:99]
BL v33,s[36:39],s21 offen offset:3072 lds
MF a[100:103],v[164:167],v[108:111],a[100:103]
SA m0,s23,114688
s_mov_b32 s22,3407872
BL v26,s[40:43],s22 offen nt lds
MF a[104:107],v[168:171],v[108:111],a[104:107]
AR v192,a224
AR v193,a225
MF a[108:111],v[172:175],v[108:111],a[108:111]
BL v27,s[40:43],s22 offen offset:1024 nt lds
MF a[112:115],v[176:179],v[108:111],a[112:115]
AR v194,a226
AR v195,a227
MF a[116:119],v[180:183],v[108:111],a[116:119]
BL v28,s[40:43],s22 offen offset:2048 nt lds
MF a[120:123],v[184:187],v[108:111],a[120:123]
AR v196,a228
AR v197,a229
MF a[124:127],v[188:191],v[108:111],a[124:127]
BL v29,s[40:43],s22 offen offset:3072 nt lds
WT vmcnt(30) lgkmcnt(0)
s_barrier
MF a[0:3],v[128:131],v[64:67],a[0:3]
DR v[96:99],v13 offset:0
AR v198,a230
MF a[4:7],v[132:135],v[64:67],a[4:7]
DT v[160:161],v14 offset:49152
AR v199,a231
MF a[8:11],v[136:139],v[64:67],a[8:11]
DT v[162:163],v14 offset:51200
CV v200,v192,v193
MF a[12:15],v[140:143],v[64:67],a[12:15]
DT v[164:165],v15 offset:49152
CV v201,v194,v195
MF a[16:19],v[144:147],v[64:67],a[16:19]
DT v[166:167],v15 offset:51200
CV v202,v196,v197
MF a[20:23],v[148:151],v[64:67],a[20:23]
DT v[168:169],v16 offset:49152
CV v203,v198,v199
MF a[24:27],v[152:155],v[64:67],a[24:27]
DT v[170:171],v16 offset:51200
MF a[28:31],v[156:159],v[64:67],a[28:31]
DT v[172:173],v17 offset:49152
MF a[32:35],v[128:131],v[68:71],a[32:35]
DT v[174:175],v17 offset:51200
MF a[36:39],v[132:135],v[68:71],a[36:39]
DT v[176:177],v18 offset:49152
MF a[40:43],v[136:139],v[68:71],a[40:43]
DT v[178:179],v18 offset:51200
MF a[44:47],v[140:143],v[68:71],a[44:47]
DT v[180:181],v19 offset:49152
MF a[48:51],v[144:147],v[68:71],a[48:51]
DT v[182:183],v19 offset:51200
MF a[52:55],v[148:151],v[68:71],a[52:55]
DT v[184:185],v20 offset:49152
MF a[56:59],v[152:155],v[68:71],a[56:59]
DT v[186:187],v20 offset:51200
MF a[60:63],v[156:159],v[68:71],a[60:63]
DT v[188:189],v21 offset:49152
MF a[64:67],v[128:131],v[72:75],a[64:67]
DT v[190:191],v21 offset:51200
MF a[68:71],v[132:135],v[72:75],a[68:71]
DR v[100:103],v13 offset:2048
MF a[72:75],v[136:139],v[72:75],a[72:75]
DR v[104:107],v13 offset:4096
MF a[76:79],v[140:143],v[72:75],a[76:79]
DR v[108:111],v13 offset:6144
MF a[80:83],v[144:147],v[72:75],a[80:83]
SA s30,s29,57344
BS v[200:203],v3,s[16:19],s30 offen sc1
MF a[84:87],v[148:151],v[72:75],a[84:87]
AR v204,a232
AR v205,a233
MF a[88:91],v[152:155],v[72:75],a[88:91]
AR v206,a234
AR v207,a235
MF a[92:95],v[156:159],v[72:75],a[92:95]
AR v208,a236
AR v209,a237
MF a[96:99],v[128:131],v[76:79],a[96:99]
AR v210,a238
AR v211,a239
MF a[100:103],v[132:135],v[76:79],a[100:103]
CV v212,v204,v205
CV v213,v206,v207
MF a[104:107],v[136:139],v[76:79],a[104:107]
CV v214,v208,v209
CV v215,v210,v211
MF a[108:111],v[140:143],v[76:79],a[108:111]
SA s30,s29,58368
BS v[212:215],v3,s[16:19],s30 offen sc1
MF a[112:115],v[144:147],v[76:79],a[112:115]
AR v216,a240
AR v217,a241
MF a[116:119],v[148:151],v[76:79],a[116:119]
AR v218,a242
AR v219,a243
MF a[120:123],v[152:155],v[76:79],a[120:123]
AR v220,a244
AR v221,a245
MF a[124:127],v[156:159],v[76:79],a[124:127]
AR v222,a246
AR v223,a247
WT vmcnt(21) lgkmcnt(0)
s_barrier
MF a[0:3],v[160:163],v[96:99],a[0:3]
DR v[64:67],v10 offset:0
CV v224,v216,v217
MF a[4:7],v[164:167],v[96:99],a[4:7]
DT v[128:129],v40 offset:16384
CV v225,v218,v219
MF a[8:11],v[168:171],v[96:99],a[8:11]
DT v[130:131],v40 offset:18432
CV v226,v220,v221
MF a[12:15],v[172:175],v[96:99],a[12:15]
DT v[132:133],v41 offset:16384
CV v227,v222,v223
MF a[16:19],v[176:179],v[96:99],a[16:19]
DT v[134:135],v41 offset:18432
MF a[20:23],v[180:183],v[96:99],a[20:23]
DT v[136:137],v42 offset:16384
MF a[24:27],v[184:187],v[96:99],a[24:27]
DT v[138:139],v42 offset:18432
MF a[28:31],v[188:191],v[96:99],a[28:31]
DT v[140:141],v43 offset:16384
MF a[32:35],v[160:163],v[100:103],a[32:35]
DT v[142:143],v43 offset:18432
MF a[36:39],v[164:167],v[100:103],a[36:39]
DT v[144:145],v44 offset:16384
MF a[40:43],v[168:171],v[100:103],a[40:43]
DT v[146:147],v44 offset:18432
MF a[44:47],v[172:175],v[100:103],a[44:47]
DT v[148:149],v45 offset:16384
MF a[48:51],v[176:179],v[100:103],a[48:51]
DT v[150:151],v45 offset:18432
MF a[52:55],v[180:183],v[100:103],a[52:55]
DT v[152:153],v46 offset:16384
MF a[56:59],v[184:187],v[100:103],a[56:59]
DT v[154:155],v46 offset:18432
MF a[60:63],v[188:191],v[100:103],a[60:63]
DT v[156:157],v47 offset:16384
MF a[64:67],v[160:163],v[104:107],a[64:67]
DT v[158:159],v47 offset:18432
MF a[68:71],v[164:167],v[104:107],a[68:71]
DR v[68:71],v10 offset:2048
MF a[72:75],v[168:171],v[104:107],a[72:75]
DR v[72:75],v10 offset:4096
MF a[76:79],v[172:175],v[104:107],a[76:79]
DR v[76:79],v10 offset:6144
MF a[80:83],v[176:179],v[104:107],a[80:83]
SA s30,s29,59392
BS v[224:227],v3,s[16:19],s30 offen sc1
MF a[84:87],v[180:183],v[104:107],a[84:87]
AR v228,a248
AR v229,a249
MF a[88:91],v[184:187],v[104:107],a[88:91]
AR v230,a250
AR v231,a251
MF a[92:95],v[188:191],v[104:107],a[92:95]
AR v232,a252
AR v233,a253
MF a[96:99],v[160:163],v[108:111],a[96:99]
AR v234,a254
AR v235,a255
MF a[100:103],v[164:167],v[108:111],a[100:103]
CV v236,v228,v229
CV v237,v230,v231
MF a[104:107],v[168:171],v[108:111],a[104:107]
CV v238,v232,v233
CV v239,v234,v235
MF a[108:111],v[172:175],v[108:111],a[108:111]
SA s30,s29,60416
BS v[236:239],v3,s[16:19],s30 offen sc1
MF a[112:115],v[176:179],v[108:111],a[112:115]
MF a[116:119],v[180:183],v[108:111],a[116:119]
MF a[120:123],v[184:187],v[108:111],a[120:123]
MF a[124:127],v[188:191],v[108:111],a[124:127]
WT vmcnt(19) lgkmcnt(0)
s_barrier
MF a[0:3],v[128:131],v[64:67],a[0:3]
DR v[96:99],v12 offset:0
MF a[4:7],v[132:135],v[64:67],a[4:7]
DT v[160:161],v40 offset:49152
MF a[8:11],v[136:139],v[64:67],a[8:11]
DT v[162:163],v40 offset:51200
MF a[12:15],v[140:143],v[64:67],a[12:15]
DT v[164:165],v41 offset:49152
MF a[16:19],v[144:147],v[64:67],a[16:19]
DT v[166:167],v41 offset:51200
MF a[20:23],v[148:151],v[64:67],a[20:23]
DT v[168:169],v42 offset:49152
MF a[24:27],v[152:155],v[64:67],a[24:27]
DT v[170:171],v42 offset:51200
MF a[28:31],v[156:159],v[64:67],a[28:31]
DT v[172:173],v43 offset:49152
MF a[32:35],v[128:131],v[68:71],a[32:35]
DT v[174:175],v43 offset:51200
MF a[36:39],v[132:135],v[68:71],a[36:39]
DT v[176:177],v44 offset:49152
MF a[40:43],v[136:139],v[68:71],a[40:43]
DT v[178:179],v44 offset:51200
MF a[44:47],v[140:143],v[68:71],a[44:47]
DT v[180:181],v45 offset:49152
MF a[48:51],v[144:147],v[68:71],a[48:51]
DT v[182:183],v45 offset:51200
MF a[52:55],v[148:151],v[68:71],a[52:55]
DT v[184:185],v46 offset:49152
MF a[56:59],v[152:155],v[68:71],a[56:59]
DT v[186:187],v46 offset:51200
MF a[60:63],v[156:159],v[68:71],a[60:63]
DT v[188:189],v47 offset:49152
MF a[64:67],v[128:131],v[72:75],a[64:67]
DT v[190:191],v47 offset:51200
MF a[68:71],v[132:135],v[72:75],a[68:71]
DR v[100:103],v12 offset:2048
MF a[72:75],v[136:139],v[72:75],a[72:75]
DR v[104:107],v12 offset:4096
MF a[76:79],v[140:143],v[72:75],a[76:79]
DR v[108:111],v12 offset:6144
MF a[80:83],v[144:147],v[72:75],a[80:83]
MF a[84:87],v[148:151],v[72:75],a[84:87]
MF a[88:91],v[152:155],v[72:75],a[88:91]
MF a[92:95],v[156:159],v[72:75],a[92:95]
MF a[96:99],v[128:131],v[76:79],a[96:99]
MF a[100:103],v[132:135],v[76:79],a[100:103]
MF a[104:107],v[136:139],v[76:79],a[104:107]
MF a[108:111],v[140:143],v[76:79],a[108:111]
MF a[112:115],v[144:147],v[76:79],a[112:115]
MF a[116:119],v[148:151],v[76:79],a[116:119]
MF a[120:123],v[152:155],v[76:79],a[120:123]
MF a[124:127],v[156:159],v[76:79],a[124:127]
WT vmcnt(8) lgkmcnt(0)
s_barrier
MF a[0:3],v[160:163],v[96:99],a[0:3]
DR v[64:67],v10 offset:32768
MF a[4:7],v[164:167],v[96:99],a[4:7]
DT v[128:129],v14 offset:0
MF a[8:11],v[168:171],v[96:99],a[8:11]
DT v[130:131],v14 offset:2048
MF a[12:15],v[172:175],v[96:99],a[12:15]
DT v[132:133],v15 offset:0
MF a[16:19],v[176:179],v[96:99],a[16:19]
DT v[134:135],v15 offset:2048
MF a[20:23],v[180:183],v[96:99],a[20:23]
DT v[136:137],v16 offset:0
MF a[24:27],v[184:187],v[96:99],a[24:27]
DT v[138:139],v16 offset:2048
MF a[28:31],v[188:191],v[96:99],a[28:31]
DT v[140:141],v17 offset:0
MF a[32:35],v[160:163],v[100:103],a[32:35]
DT v[142:143],v17 offset:2048
MF a[36:39],v[164:167],v[100:103],a[36:39]
DT v[144:145],v18 offset:0
MF a[40:43],v[168:171],v[100:103],a[40:43]
DT v[146:147],v18 offset:2048
MF a[44:47],v[172:175],v[100:103],a[44:47]
DT v[148:149],v19 offset:0
MF a[48:51],v[176:179],v[100:103],a[48:51]
DT v[150:151],v19 offset:2048
MF a[52:55],v[180:183],v[100:103],a[52:55]
DT v[152:153],v20 offset:0
MF a[56:59],v[184:187],v[100:103],a[56:59]
DT v[154:155],v20 offset:2048
MF a[60:63],v[188:191],v[100:103],a[60:63]
DT v[156:157],v21 offset:0
MF a[64:67],v[160:163],v[104:107],a[64:67]
DT v[158:159],v21 offset:2048
MF a[68:71],v[164:167],v[104:107],a[68:71]
DR v[68:71],v10 offset:34816
MF a[72:75],v[168:171],v[104:107],a[72:75]
DR v[72:75],v10 offset:36864
MF a[76:79],v[172:175],v[104:107],a[76:79]
DR v[76:79],v10 offset:38912
MF a[80:83],v[176:179],v[104:107],a[80:83]
MF a[84:87],v[180:183],v[104:107],a[84:87]
MF a[88:91],v[184:187],v[104:107],a[88:91]
MF a[92:95],v[188:191],v[104:107],a[92:95]
MF a[96:99],v[160:163],v[108:111],a[96:99]
MF a[100:103],v[164:167],v[108:111],a[100:103]
MF a[104:107],v[168:171],v[108:111],a[104:107]
MF a[108:111],v[172:175],v[108:111],a[108:111]
MF a[112:115],v[176:179],v[108:111],a[112:115]
MF a[116:119],v[180:183],v[108:111],a[116:119]
MF a[120:123],v[184:187],v[108:111],a[120:123]
MF a[124:127],v[188:191],v[108:111],a[124:127]
WT vmcnt(4) lgkmcnt(0)
s_barrier
MF a[0:3],v[128:131],v[64:67],a[0:3]
DR v[96:99],v12 offset:32768
MF a[4:7],v[132:135],v[64:67],a[4:7]
DT v[160:161],v14 offset:16384
MF a[8:11],v[136:139],v[64:67],a[8:11]
DT v[162:163],v14 offset:18432
MF a[12:15],v[140:143],v[64:67],a[12:15]
DT v[164:165],v15 offset:16384
MF a[16:19],v[144:147],v[64:67],a[16:19]
DT v[166:167],v15 offset:18432
MF a[20:23],v[148:151],v[64:67],a[20:23]
DT v[168:169],v16 offset:16384
MF a[24:27],v[152:155],v[64:67],a[24:27]
DT v[170:171],v16 offset:18432
MF a[28:31],v[156:159],v[64:67],a[28:31]
DT v[172:173],v17 offset:16384
MF a[32:35],v[128:131],v[68:71],a[32:35]
DT v[174:175],v17 offset:18432
MF a[36:39],v[132:135],v[68:71],a[36:39]
DT v[176:177],v18 offset:16384
MF a[40:43],v[136:139],v[68:71],a[40:43]
DT v[178:179],v18 offset:18432
MF a[44:47],v[140:143],v[68:71],a[44:47]
DT v[180:181],v19 offset:16384
MF a[48:51],v[144:147],v[68:71],a[48:51]
DT v[182:183],v19 offset:18432
MF a[52:55],v[148:151],v[68:71],a[52:55]
DT v[184:185],v20 offset:16384
MF a[56:59],v[152:155],v[68:71],a[56:59]
DT v[186:187],v20 offset:18432
MF a[60:63],v[156:159],v[68:71],a[60:63]
DT v[188:189],v21 offset:16384
MF a[64:67],v[128:131],v[72:75],a[64:67]
DT v[190:191],v21 offset:18432
MF a[68:71],v[132:135],v[72:75],a[68:71]
DR v[100:103],v12 offset:34816
MF a[72:75],v[136:139],v[72:75],a[72:75]
DR v[104:107],v12 offset:36864
MF a[76:79],v[140:143],v[72:75],a[76:79]
DR v[108:111],v12 offset:38912
MF a[80:83],v[144:147],v[72:75],a[80:83]
MF a[84:87],v[148:151],v[72:75],a[84:87]
MF a[88:91],v[152:155],v[72:75],a[88:91]
MF a[92:95],v[156:159],v[72:75],a[92:95]
MF a[96:99],v[128:131],v[76:79],a[96:99]
MF a[100:103],v[132:135],v[76:79],a[100:103]
MF a[104:107],v[136:139],v[76:79],a[104:107]
MF a[108:111],v[140:143],v[76:79],a[108:111]
MF a[112:115],v[144:147],v[76:79],a[112:115]
MF a[116:119],v[148:151],v[76:79],a[116:119]
MF a[120:123],v[152:155],v[76:79],a[120:123]
MF a[124:127],v[156:159],v[76:79],a[124:127]
WT lgkmcnt(0)
MF a[0:3],v[160:163],v[96:99],a[0:3]
MF a[4:7],v[164:167],v[96:99],a[4:7]
MF a[8:11],v[168:171],v[96:99],a[8:11]
MF a[12:15],v[172:175],v[96:99],a[12:15]
MF a[16:19],v[176:179],v[96:99],a[16:19]
MF a[20:23],v[180:183],v[96:99],a[20:23]
MF a[24:27],v[184:187],v[96:99],a[24:27]
MF a[28:31],v[188:191],v[96:99],a[28:31]
MF a[32:35],v[160:163],v[100:103],a[32:35]
MF a[36:39],v[164:167],v[100:103],a[36:39]
MF a[40:43],v[168:171],v[100:103],a[40:43]
MF a[44:47],v[172:175],v[100:103],a[44:47]
MF a[48:51],v[176:179],v[100:103],a[48:51]
MF a[52:55],v[180:183],v[100:103],a[52:55]
MF a[56:59],v[184:187],v[100:103],a[56:59]
MF a[60:63],v[188:191],v[100:103],a[60:63]
MF a[64:67],v[160:163],v[104:107],a[64:67]
MF a[68:71],v[164:167],v[104:107],a[68:71]
MF a[72:75],v[168:171],v[104:107],a[72:75]
MF a[76:79],v[172:175],v[104:107],a[76:79]
MF a[80:83],v[176:179],v[104:107],a[80:83]
MF a[84:87],v[180:183],v[104:107],a[84:87]
MF a[88:91],v[184:187],v[104:107],a[88:91]
MF a[92:95],v[188:191],v[104:107],a[92:95]
MF a[96:99],v[160:163],v[108:111],a[96:99]
MF a[100:103],v[164:167],v[108:111],a[100:103]
MF a[104:107],v[168:171],v[108:111],a[104:107]
MF a[108:111],v[172:175],v[108:111],a[108:111]
MF a[112:115],v[176:179],v[108:111],a[112:115]
MF a[116:119],v[180:183],v[108:111],a[116:119]
MF a[120:123],v[184:187],v[108:111],a[120:123]
MF a[124:127],v[188:191],v[108:111],a[124:127]
s_cmp_lg_u32 s20,0
s_cbranch_scc1 cps_k1_kernel_k_n_skip
s_getpc_b64 s[72:73]
cpf_k1_kernel_k_n:
s_mov_b32 s74,k2_kernel-cpf_k1_kernel_k_n
s_ashr_i32 s75,s74,31
SA s72,s72,s74
s_addc_u32 s73,s73,s75
s_lshr_b32 s74,s2,3
s_lshl_b32 s74,s74,12
v_and_b32 v8,63,v0
v_lshlrev_b32 v8,6,v8
v_add_u32 v8,s74,v8
v_min_u32 v8,54780,v8
global_load_dword v9,v8,s[72:73]
cps_k1_kernel_k_n_skip:
s_nop 7
v_lshlrev_b32 v3,4,v1
v_lshrrev_b32 v4,7,v0
v_lshlrev_b32 v4,15,v4
v_add_u32 v3,v3,v4
v_bfe_u32 v4,v0,6,1
v_lshlrev_b32 v4,12,v4
v_add_u32 v3,v3,v4
s_lshl_b32 s29,s51,16
s_mov_b32 s31,0x3db8aa3b
AR v192,a0
AR v193,a1
AR v194,a2
AR v195,a3
AR v196,a4
AR v197,a5
AR v198,a6
AR v199,a7
FM v192,s31,v192
FM v193,s31,v193
FM v194,s31,v194
FM v195,s31,v195
FM v196,s31,v196
FM v197,s31,v197
FM v198,s31,v198
FM v199,s31,v199
CV v200,v192,v193
CV v201,v194,v195
CV v202,v196,v197
CV v203,v198,v199
SA s30,s29,0
BS v[200:203],v3,s[44:47],s30 offen sc1
AR v204,a8
AR v205,a9
AR v206,a10
AR v207,a11
AR v208,a12
AR v209,a13
AR v210,a14
AR v211,a15
FM v204,s31,v204
FM v205,s31,v205
FM v206,s31,v206
FM v207,s31,v207
FM v208,s31,v208
FM v209,s31,v209
FM v210,s31,v210
FM v211,s31,v211
CV v212,v204,v205
CV v213,v206,v207
CV v214,v208,v209
CV v215,v210,v211
SA s30,s29,1024
BS v[212:215],v3,s[44:47],s30 offen sc1
AR v216,a16
AR v217,a17
AR v218,a18
AR v219,a19
AR v220,a20
AR v221,a21
AR v222,a22
AR v223,a23
FM v216,s31,v216
FM v217,s31,v217
FM v218,s31,v218
FM v219,s31,v219
FM v220,s31,v220
FM v221,s31,v221
FM v222,s31,v222
FM v223,s31,v223
CV v224,v216,v217
CV v225,v218,v219
CV v226,v220,v221
CV v227,v222,v223
SA s30,s29,2048
BS v[224:227],v3,s[44:47],s30 offen sc1
AR v228,a24
AR v229,a25
AR v230,a26
AR v231,a27
AR v232,a28
AR v233,a29
AR v234,a30
AR v235,a31
FM v228,s31,v228
FM v229,s31,v229
FM v230,s31,v230
FM v231,s31,v231
FM v232,s31,v232
FM v233,s31,v233
FM v234,s31,v234
FM v235,s31,v235
CV v236,v228,v229
CV v237,v230,v231
CV v238,v232,v233
CV v239,v234,v235
SA s30,s29,3072
BS v[236:239],v3,s[44:47],s30 offen sc1
AR v192,a32
AR v193,a33
AR v194,a34
AR v195,a35
AR v196,a36
AR v197,a37
AR v198,a38
AR v199,a39
FM v192,s31,v192
FM v193,s31,v193
FM v194,s31,v194
FM v195,s31,v195
FM v196,s31,v196
FM v197,s31,v197
FM v198,s31,v198
FM v199,s31,v199
CV v200,v192,v193
CV v201,v194,v195
CV v202,v196,v197
CV v203,v198,v199
SA s30,s29,8192
BS v[200:203],v3,s[44:47],s30 offen sc1
AR v204,a40
AR v205,a41
AR v206,a42
AR v207,a43
AR v208,a44
AR v209,a45
AR v210,a46
AR v211,a47
FM v204,s31,v204
FM v205,s31,v205
FM v206,s31,v206
FM v207,s31,v207
FM v208,s31,v208
FM v209,s31,v209
FM v210,s31,v210
FM v211,s31,v211
CV v212,v204,v205
CV v213,v206,v207
CV v214,v208,v209
CV v215,v210,v211
SA s30,s29,9216
BS v[212:215],v3,s[44:47],s30 offen sc1
AR v216,a48
AR v217,a49
AR v218,a50
AR v219,a51
AR v220,a52
AR v221,a53
AR v222,a54
AR v223,a55
FM v216,s31,v216
FM v217,s31,v217
FM v218,s31,v218
FM v219,s31,v219
FM v220,s31,v220
FM v221,s31,v221
FM v222,s31,v222
FM v223,s31,v223
CV v224,v216,v217
CV v225,v218,v219
CV v226,v220,v221
CV v227,v222,v223
SA s30,s29,10240
BS v[224:227],v3,s[44:47],s30 offen sc1
AR v228,a56
AR v229,a57
AR v230,a58
AR v231,a59
AR v232,a60
AR v233,a61
AR v234,a62
AR v235,a63
FM v228,s31,v228
FM v229,s31,v229
FM v230,s31,v230
FM v231,s31,v231
FM v232,s31,v232
FM v233,s31,v233
FM v234,s31,v234
FM v235,s31,v235
CV v236,v228,v229
CV v237,v230,v231
CV v238,v232,v233
CV v239,v234,v235
SA s30,s29,11264
BS v[236:239],v3,s[44:47],s30 offen sc1
AR v192,a64
AR v193,a65
AR v194,a66
AR v195,a67
AR v196,a68
AR v197,a69
AR v198,a70
AR v199,a71
FM v192,s31,v192
FM v193,s31,v193
FM v194,s31,v194
FM v195,s31,v195
FM v196,s31,v196
FM v197,s31,v197
FM v198,s31,v198
FM v199,s31,v199
CV v200,v192,v193
CV v201,v194,v195
CV v202,v196,v197
CV v203,v198,v199
SA s30,s29,16384
BS v[200:203],v3,s[44:47],s30 offen sc1
AR v204,a72
AR v205,a73
AR v206,a74
AR v207,a75
AR v208,a76
AR v209,a77
AR v210,a78
AR v211,a79
FM v204,s31,v204
FM v205,s31,v205
FM v206,s31,v206
FM v207,s31,v207
FM v208,s31,v208
FM v209,s31,v209
FM v210,s31,v210
FM v211,s31,v211
CV v212,v204,v205
CV v213,v206,v207
CV v214,v208,v209
CV v215,v210,v211
SA s30,s29,17408
BS v[212:215],v3,s[44:47],s30 offen sc1
AR v216,a80
AR v217,a81
AR v218,a82
AR v219,a83
AR v220,a84
AR v221,a85
AR v222,a86
AR v223,a87
FM v216,s31,v216
FM v217,s31,v217
FM v218,s31,v218
FM v219,s31,v219
FM v220,s31,v220
FM v221,s31,v221
FM v222,s31,v222
FM v223,s31,v223
CV v224,v216,v217
CV v225,v218,v219
CV v226,v220,v221
CV v227,v222,v223
SA s30,s29,18432
BS v[224:227],v3,s[44:47],s30 offen sc1
AR v228,a88
AR v229,a89
AR v230,a90
AR v231,a91
AR v232,a92
AR v233,a93
AR v234,a94
AR v235,a95
FM v228,s31,v228
FM v229,s31,v229
FM v230,s31,v230
FM v231,s31,v231
FM v232,s31,v232
FM v233,s31,v233
FM v234,s31,v234
FM v235,s31,v235
CV v236,v228,v229
CV v237,v230,v231
CV v238,v232,v233
CV v239,v234,v235
SA s30,s29,19456
BS v[236:239],v3,s[44:47],s30 offen sc1
AR v192,a96
AR v193,a97
AR v194,a98
AR v195,a99
AR v196,a100
AR v197,a101
AR v198,a102
AR v199,a103
FM v192,s31,v192
FM v193,s31,v193
FM v194,s31,v194
FM v195,s31,v195
FM v196,s31,v196
FM v197,s31,v197
FM v198,s31,v198
FM v199,s31,v199
CV v200,v192,v193
CV v201,v194,v195
CV v202,v196,v197
CV v203,v198,v199
SA s30,s29,24576
BS v[200:203],v3,s[44:47],s30 offen sc1
AR v204,a104
AR v205,a105
AR v206,a106
AR v207,a107
AR v208,a108
AR v209,a109
AR v210,a110
AR v211,a111
FM v204,s31,v204
FM v205,s31,v205
FM v206,s31,v206
FM v207,s31,v207
FM v208,s31,v208
FM v209,s31,v209
FM v210,s31,v210
FM v211,s31,v211
CV v212,v204,v205
CV v213,v206,v207
CV v214,v208,v209
CV v215,v210,v211
SA s30,s29,25600
BS v[212:215],v3,s[44:47],s30 offen sc1
AR v216,a112
AR v217,a113
AR v218,a114
AR v219,a115
AR v220,a116
AR v221,a117
AR v222,a118
AR v223,a119
FM v216,s31,v216
FM v217,s31,v217
FM v218,s31,v218
FM v219,s31,v219
FM v220,s31,v220
FM v221,s31,v221
FM v222,s31,v222
FM v223,s31,v223
CV v224,v216,v217
CV v225,v218,v219
CV v226,v220,v221
CV v227,v222,v223
SA s30,s29,26624
BS v[224:227],v3,s[44:47],s30 offen sc1
AR v228,a120
AR v229,a121
AR v230,a122
AR v231,a123
AR v232,a124
AR v233,a125
AR v234,a126
AR v235,a127
FM v228,s31,v228
FM v229,s31,v229
FM v230,s31,v230
FM v231,s31,v231
FM v232,s31,v232
FM v233,s31,v233
FM v234,s31,v234
FM v235,s31,v235
CV v236,v228,v229
CV v237,v230,v231
CV v238,v232,v233
CV v239,v234,v235
SA s30,s29,27648
BS v[236:239],v3,s[44:47],s30 offen sc1
s_endpgm
k1_kernel_v:
WT vmcnt(12) lgkmcnt(0)
s_barrier
MF a[0:3],v[64:67],v[128:131],0
DR v[96:99],v12 offset:0
MF a[4:7],v[64:67],v[132:135],0
MF a[8:11],v[64:67],v[136:139],0
DT v[160:161],v14 offset:16384
MF a[12:15],v[64:67],v[140:143],0
MF a[16:19],v[64:67],v[144:147],0
DT v[162:163],v14 offset:18432
MF a[20:23],v[64:67],v[148:151],0
SA m0,s23,147456
s_mov_b32 s22,786432
BL v26,s[12:15],s22 offen nt lds
MF a[24:27],v[64:67],v[152:155],0
DT v[164:165],v15 offset:16384
MF a[28:31],v[64:67],v[156:159],0
MF a[32:35],v[68:71],v[128:131],0
DT v[166:167],v15 offset:18432
MF a[36:39],v[68:71],v[132:135],0
MF a[40:43],v[68:71],v[136:139],0
DT v[168:169],v16 offset:16384
MF a[44:47],v[68:71],v[140:143],0
BL v27,s[12:15],s22 offen offset:1024 nt lds
MF a[48:51],v[68:71],v[144:147],0
DT v[170:171],v16 offset:18432
MF a[52:55],v[68:71],v[148:151],0
MF a[56:59],v[68:71],v[152:155],0
DT v[172:173],v17 offset:16384
MF a[60:63],v[68:71],v[156:159],0
MF a[64:67],v[72:75],v[128:131],0
DT v[174:175],v17 offset:18432
MF a[68:71],v[72:75],v[132:135],0
BL v28,s[12:15],s22 offen offset:2048 nt lds
MF a[72:75],v[72:75],v[136:139],0
DT v[176:177],v18 offset:16384
MF a[76:79],v[72:75],v[140:143],0
MF a[80:83],v[72:75],v[144:147],0
DT v[178:179],v18 offset:18432
MF a[84:87],v[72:75],v[148:151],0
MF a[88:91],v[72:75],v[152:155],0
DT v[180:181],v19 offset:16384
MF a[92:95],v[72:75],v[156:159],0
BL v29,s[12:15],s22 offen offset:3072 nt lds
MF a[96:99],v[76:79],v[128:131],0
DT v[182:183],v19 offset:18432
MF a[100:103],v[76:79],v[132:135],0
MF a[104:107],v[76:79],v[136:139],0
DT v[184:185],v20 offset:16384
MF a[108:111],v[76:79],v[140:143],0
MF a[112:115],v[76:79],v[144:147],0
DT v[186:187],v20 offset:18432
MF a[116:119],v[76:79],v[148:151],0
SA m0,s23,65536
s_mov_b32 s21,256
BL v22,s[8:11],s21 offen lds
MF a[120:123],v[76:79],v[152:155],0
DT v[188:189],v21 offset:16384
MF a[124:127],v[76:79],v[156:159],0
MF a[128:131],v[80:83],v[128:131],0
DT v[190:191],v21 offset:18432
MF a[132:135],v[80:83],v[132:135],0
MF a[136:139],v[80:83],v[136:139],0
DR v[100:103],v12 offset:2048
MF a[140:143],v[80:83],v[140:143],0
BL v23,s[8:11],s21 offen offset:1024 lds
MF a[144:147],v[80:83],v[144:147],0
DR v[104:107],v12 offset:4096
MF a[148:151],v[80:83],v[148:151],0
MF a[152:155],v[80:83],v[152:155],0
DR v[108:111],v12 offset:6144
MF a[156:159],v[80:83],v[156:159],0
MF a[160:163],v[84:87],v[128:131],0
DR v[112:115],v12 offset:8192
MF a[164:167],v[84:87],v[132:135],0
BL v24,s[8:11],s21 offen offset:2048 lds
MF a[168:171],v[84:87],v[136:139],0
DR v[116:119],v12 offset:10240
MF a[172:175],v[84:87],v[140:143],0
MF a[176:179],v[84:87],v[144:147],0
DR v[120:123],v12 offset:12288
MF a[180:183],v[84:87],v[148:151],0
MF a[184:187],v[84:87],v[152:155],0
DR v[124:127],v12 offset:14336
MF a[188:191],v[84:87],v[156:159],0
BL v25,s[8:11],s21 offen offset:3072 lds
MF a[192:195],v[88:91],v[128:131],0
MF a[196:199],v[88:91],v[132:135],0
MF a[200:203],v[88:91],v[136:139],0
MF a[204:207],v[88:91],v[140:143],0
SA m0,s23,81920
s_mov_b32 s21,262400
BL v22,s[8:11],s21 offen lds
MF a[208:211],v[88:91],v[144:147],0
MF a[212:215],v[88:91],v[148:151],0
MF a[216:219],v[88:91],v[152:155],0
MF a[220:223],v[88:91],v[156:159],0
BL v23,s[8:11],s21 offen offset:1024 lds
MF a[224:227],v[92:95],v[128:131],0
MF a[228:231],v[92:95],v[132:135],0
MF a[232:235],v[92:95],v[136:139],0
MF a[236:239],v[92:95],v[140:143],0
BL v24,s[8:11],s21 offen offset:2048 lds
MF a[240:243],v[92:95],v[144:147],0
MF a[244:247],v[92:95],v[148:151],0
MF a[248:251],v[92:95],v[152:155],0
MF a[252:255],v[92:95],v[156:159],0
BL v25,s[8:11],s21 offen offset:3072 lds
WT vmcnt(12) lgkmcnt(0)
s_barrier
MF a[0:3],v[96:99],v[160:163],a[0:3]
DR v[64:67],v10 offset:32768
MF a[4:7],v[96:99],v[164:167],a[4:7]
MF a[8:11],v[96:99],v[168:171],a[8:11]
DT v[128:129],v14 offset:32768
MF a[12:15],v[96:99],v[172:175],a[12:15]
MF a[16:19],v[96:99],v[176:179],a[16:19]
DT v[130:131],v14 offset:34816
MF a[20:23],v[96:99],v[180:183],a[20:23]
SA m0,s23,98304
s_mov_b32 s22,1048576
BL v26,s[12:15],s22 offen nt lds
MF a[24:27],v[96:99],v[184:187],a[24:27]
DT v[132:133],v15 offset:32768
MF a[28:31],v[96:99],v[188:191],a[28:31]
MF a[32:35],v[100:103],v[160:163],a[32:35]
DT v[134:135],v15 offset:34816
MF a[36:39],v[100:103],v[164:167],a[36:39]
MF a[40:43],v[100:103],v[168:171],a[40:43]
DT v[136:137],v16 offset:32768
MF a[44:47],v[100:103],v[172:175],a[44:47]
BL v27,s[12:15],s22 offen offset:1024 nt lds
MF a[48:51],v[100:103],v[176:179],a[48:51]
DT v[138:139],v16 offset:34816
MF a[52:55],v[100:103],v[180:183],a[52:55]
MF a[56:59],v[100:103],v[184:187],a[56:59]
DT v[140:141],v17 offset:32768
MF a[60:63],v[100:103],v[188:191],a[60:63]
MF a[64:67],v[104:107],v[160:163],a[64:67]
DT v[142:143],v17 offset:34816
MF a[68:71],v[104:107],v[164:167],a[68:71]
BL v28,s[12:15],s22 offen offset:2048 nt lds
MF a[72:75],v[104:107],v[168:171],a[72:75]
DT v[144:145],v18 offset:32768
MF a[76:79],v[104:107],v[172:175],a[76:79]
MF a[80:83],v[104:107],v[176:179],a[80:83]
DT v[146:147],v18 offset:34816
MF a[84:87],v[104:107],v[180:183],a[84:87]
MF a[88:91],v[104:107],v[184:187],a[88:91]
DT v[148:149],v19 offset:32768
MF a[92:95],v[104:107],v[188:191],a[92:95]
BL v29,s[12:15],s22 offen offset:3072 nt lds
MF a[96:99],v[108:111],v[160:163],a[96:99]
DT v[150:151],v19 offset:34816
MF a[100:103],v[108:111],v[164:167],a[100:103]
MF a[104:107],v[108:111],v[168:171],a[104:107]
DT v[152:153],v20 offset:32768
MF a[108:111],v[108:111],v[172:175],a[108:111]
MF a[112:115],v[108:111],v[176:179],a[112:115]
DT v[154:155],v20 offset:34816
MF a[116:119],v[108:111],v[180:183],a[116:119]
SA m0,s23,114688
s_mov_b32 s22,1310720
BL v26,s[12:15],s22 offen nt lds
MF a[120:123],v[108:111],v[184:187],a[120:123]
DT v[156:157],v21 offset:32768
MF a[124:127],v[108:111],v[188:191],a[124:127]
MF a[128:131],v[112:115],v[160:163],a[128:131]
DT v[158:159],v21 offset:34816
MF a[132:135],v[112:115],v[164:167],a[132:135]
MF a[136:139],v[112:115],v[168:171],a[136:139]
DR v[68:71],v10 offset:34816
MF a[140:143],v[112:115],v[172:175],a[140:143]
BL v27,s[12:15],s22 offen offset:1024 nt lds
MF a[144:147],v[112:115],v[176:179],a[144:147]
DR v[72:75],v10 offset:36864
MF a[148:151],v[112:115],v[180:183],a[148:151]
MF a[152:155],v[112:115],v[184:187],a[152:155]
DR v[76:79],v10 offset:38912
MF a[156:159],v[112:115],v[188:191],a[156:159]
MF a[160:163],v[116:119],v[160:163],a[160:163]
DR v[80:83],v10 offset:40960
MF a[164:167],v[116:119],v[164:167],a[164:167]
BL v28,s[12:15],s22 offen offset:2048 nt lds
MF a[168:171],v[116:119],v[168:171],a[168:171]
DR v[84:87],v10 offset:43008
MF a[172:175],v[116:119],v[172:175],a[172:175]
MF a[176:179],v[116:119],v[176:179],a[176:179]
DR v[88:91],v10 offset:45056
MF a[180:183],v[116:119],v[180:183],a[180:183]
MF a[184:187],v[116:119],v[184:187],a[184:187]
DR v[92:95],v10 offset:47104
MF a[188:191],v[116:119],v[188:191],a[188:191]
BL v29,s[12:15],s22 offen offset:3072 nt lds
MF a[192:195],v[120:123],v[160:163],a[192:195]
MF a[196:199],v[120:123],v[164:167],a[196:199]
MF a[200:203],v[120:123],v[168:171],a[200:203]
MF a[204:207],v[120:123],v[172:175],a[204:207]
SA m0,s23,0
s_mov_b32 s21,384
BL v22,s[8:11],s21 offen lds
MF a[208:211],v[120:123],v[176:179],a[208:211]
MF a[212:215],v[120:123],v[180:183],a[212:215]
MF a[216:219],v[120:123],v[184:187],a[216:219]
MF a[220:223],v[120:123],v[188:191],a[220:223]
BL v23,s[8:11],s21 offen offset:1024 lds
MF a[224:227],v[124:127],v[160:163],a[224:227]
MF a[228:231],v[124:127],v[164:167],a[228:231]
MF a[232:235],v[124:127],v[168:171],a[232:235]
MF a[236:239],v[124:127],v[172:175],a[236:239]
BL v24,s[8:11],s21 offen offset:2048 lds
MF a[240:243],v[124:127],v[176:179],a[240:243]
MF a[244:247],v[124:127],v[180:183],a[244:247]
MF a[248:251],v[124:127],v[184:187],a[248:251]
MF a[252:255],v[124:127],v[188:191],a[252:255]
BL v25,s[8:11],s21 offen offset:3072 lds
WT vmcnt(20) lgkmcnt(0)
s_barrier
MF a[0:3],v[64:67],v[128:131],a[0:3]
DR v[96:99],v12 offset:32768
MF a[4:7],v[64:67],v[132:135],a[4:7]
MF a[8:11],v[64:67],v[136:139],a[8:11]
DT v[160:161],v14 offset:49152
MF a[12:15],v[64:67],v[140:143],a[12:15]
MF a[16:19],v[64:67],v[144:147],a[16:19]
DT v[162:163],v14 offset:51200
MF a[20:23],v[64:67],v[148:151],a[20:23]
SA m0,s23,131072
s_mov_b32 s22,1572864
BL v26,s[12:15],s22 offen nt lds
MF a[24:27],v[64:67],v[152:155],a[24:27]
DT v[164:165],v15 offset:49152
MF a[28:31],v[64:67],v[156:159],a[28:31]
MF a[32:35],v[68:71],v[128:131],a[32:35]
DT v[166:167],v15 offset:51200
MF a[36:39],v[68:71],v[132:135],a[36:39]
MF a[40:43],v[68:71],v[136:139],a[40:43]
DT v[168:169],v16 offset:49152
MF a[44:47],v[68:71],v[140:143],a[44:47]
BL v27,s[12:15],s22 offen offset:1024 nt lds
MF a[48:51],v[68:71],v[144:147],a[48:51]
DT v[170:171],v16 offset:51200
MF a[52:55],v[68:71],v[148:151],a[52:55]
MF a[56:59],v[68:71],v[152:155],a[56:59]
DT v[172:173],v17 offset:49152
MF a[60:63],v[68:71],v[156:159],a[60:63]
MF a[64:67],v[72:75],v[128:131],a[64:67]
DT v[174:175],v17 offset:51200
MF a[68:71],v[72:75],v[132:135],a[68:71]
BL v28,s[12:15],s22 offen offset:2048 nt lds
MF a[72:75],v[72:75],v[136:139],a[72:75]
DT v[176:177],v18 offset:49152
MF a[76:79],v[72:75],v[140:143],a[76:79]
MF a[80:83],v[72:75],v[144:147],a[80:83]
DT v[178:179],v18 offset:51200
MF a[84:87],v[72:75],v[148:151],a[84:87]
MF a[88:91],v[72:75],v[152:155],a[88:91]
DT v[180:181],v19 offset:49152
MF a[92:95],v[72:75],v[156:159],a[92:95]
BL v29,s[12:15],s22 offen offset:3072 nt lds
MF a[96:99],v[76:79],v[128:131],a[96:99]
DT v[182:183],v19 offset:51200
MF a[100:103],v[76:79],v[132:135],a[100:103]
MF a[104:107],v[76:79],v[136:139],a[104:107]
DT v[184:185],v20 offset:49152
MF a[108:111],v[76:79],v[140:143],a[108:111]
MF a[112:115],v[76:79],v[144:147],a[112:115]
DT v[186:187],v20 offset:51200
MF a[116:119],v[76:79],v[148:151],a[116:119]
SA m0,s23,16384
s_mov_b32 s21,262528
BL v22,s[8:11],s21 offen lds
MF a[120:123],v[76:79],v[152:155],a[120:123]
DT v[188:189],v21 offset:49152
MF a[124:127],v[76:79],v[156:159],a[124:127]
MF a[128:131],v[80:83],v[128:131],a[128:131]
DT v[190:191],v21 offset:51200
MF a[132:135],v[80:83],v[132:135],a[132:135]
MF a[136:139],v[80:83],v[136:139],a[136:139]
DR v[100:103],v12 offset:34816
MF a[140:143],v[80:83],v[140:143],a[140:143]
BL v23,s[8:11],s21 offen offset:1024 lds
MF a[144:147],v[80:83],v[144:147],a[144:147]
DR v[104:107],v12 offset:36864
MF a[148:151],v[80:83],v[148:151],a[148:151]
MF a[152:155],v[80:83],v[152:155],a[152:155]
DR v[108:111],v12 offset:38912
MF a[156:159],v[80:83],v[156:159],a[156:159]
MF a[160:163],v[84:87],v[128:131],a[160:163]
DR v[112:115],v12 offset:40960
MF a[164:167],v[84:87],v[132:135],a[164:167]
BL v24,s[8:11],s21 offen offset:2048 lds
MF a[168:171],v[84:87],v[136:139],a[168:171]
DR v[116:119],v12 offset:43008
MF a[172:175],v[84:87],v[140:143],a[172:175]
MF a[176:179],v[84:87],v[144:147],a[176:179]
DR v[120:123],v12 offset:45056
MF a[180:183],v[84:87],v[148:151],a[180:183]
MF a[184:187],v[84:87],v[152:155],a[184:187]
DR v[124:127],v12 offset:47104
MF a[188:191],v[84:87],v[156:159],a[188:191]
BL v25,s[8:11],s21 offen offset:3072 lds
MF a[192:195],v[88:91],v[128:131],a[192:195]
MF a[196:199],v[88:91],v[132:135],a[196:199]
MF a[200:203],v[88:91],v[136:139],a[200:203]
MF a[204:207],v[88:91],v[140:143],a[204:207]
MF a[208:211],v[88:91],v[144:147],a[208:211]
MF a[212:215],v[88:91],v[148:151],a[212:215]
MF a[216:219],v[88:91],v[152:155],a[216:219]
MF a[220:223],v[88:91],v[156:159],a[220:223]
MF a[224:227],v[92:95],v[128:131],a[224:227]
MF a[228:231],v[92:95],v[132:135],a[228:231]
MF a[232:235],v[92:95],v[136:139],a[232:235]
MF a[236:239],v[92:95],v[140:143],a[236:239]
MF a[240:243],v[92:95],v[144:147],a[240:243]
MF a[244:247],v[92:95],v[148:151],a[244:247]
MF a[248:251],v[92:95],v[152:155],a[248:251]
MF a[252:255],v[92:95],v[156:159],a[252:255]
WT vmcnt(16) lgkmcnt(0)
s_barrier
MF a[0:3],v[96:99],v[160:163],a[0:3]
DR v[64:67],v11 offset:0
MF a[4:7],v[96:99],v[164:167],a[4:7]
MF a[8:11],v[96:99],v[168:171],a[8:11]
DT v[128:129],v14 offset:0
MF a[12:15],v[96:99],v[172:175],a[12:15]
MF a[16:19],v[96:99],v[176:179],a[16:19]
DT v[130:131],v14 offset:2048
MF a[20:23],v[96:99],v[180:183],a[20:23]
SA m0,s23,147456
s_mov_b32 s22,1835008
BL v26,s[12:15],s22 offen nt lds
MF a[24:27],v[96:99],v[184:187],a[24:27]
DT v[132:133],v15 offset:0
MF a[28:31],v[96:99],v[188:191],a[28:31]
MF a[32:35],v[100:103],v[160:163],a[32:35]
DT v[134:135],v15 offset:2048
MF a[36:39],v[100:103],v[164:167],a[36:39]
MF a[40:43],v[100:103],v[168:171],a[40:43]
DT v[136:137],v16 offset:0
MF a[44:47],v[100:103],v[172:175],a[44:47]
BL v27,s[12:15],s22 offen offset:1024 nt lds
MF a[48:51],v[100:103],v[176:179],a[48:51]
DT v[138:139],v16 offset:2048
MF a[52:55],v[100:103],v[180:183],a[52:55]
MF a[56:59],v[100:103],v[184:187],a[56:59]
DT v[140:141],v17 offset:0
MF a[60:63],v[100:103],v[188:191],a[60:63]
MF a[64:67],v[104:107],v[160:163],a[64:67]
DT v[142:143],v17 offset:2048
MF a[68:71],v[104:107],v[164:167],a[68:71]
BL v28,s[12:15],s22 offen offset:2048 nt lds
MF a[72:75],v[104:107],v[168:171],a[72:75]
DT v[144:145],v18 offset:0
MF a[76:79],v[104:107],v[172:175],a[76:79]
MF a[80:83],v[104:107],v[176:179],a[80:83]
DT v[146:147],v18 offset:2048
MF a[84:87],v[104:107],v[180:183],a[84:87]
MF a[88:91],v[104:107],v[184:187],a[88:91]
DT v[148:149],v19 offset:0
MF a[92:95],v[104:107],v[188:191],a[92:95]
BL v29,s[12:15],s22 offen offset:3072 nt lds
MF a[96:99],v[108:111],v[160:163],a[96:99]
DT v[150:151],v19 offset:2048
MF a[100:103],v[108:111],v[164:167],a[100:103]
MF a[104:107],v[108:111],v[168:171],a[104:107]
DT v[152:153],v20 offset:0
MF a[108:111],v[108:111],v[172:175],a[108:111]
MF a[112:115],v[108:111],v[176:179],a[112:115]
DT v[154:155],v20 offset:2048
MF a[116:119],v[108:111],v[180:183],a[116:119]
SA m0,s23,32768
s_mov_b32 s21,512
BL v22,s[8:11],s21 offen lds
MF a[120:123],v[108:111],v[184:187],a[120:123]
DT v[156:157],v21 offset:0
MF a[124:127],v[108:111],v[188:191],a[124:127]
MF a[128:131],v[112:115],v[160:163],a[128:131]
DT v[158:159],v21 offset:2048
MF a[132:135],v[112:115],v[164:167],a[132:135]
MF a[136:139],v[112:115],v[168:171],a[136:139]
DR v[68:71],v11 offset:2048
MF a[140:143],v[112:115],v[172:175],a[140:143]
BL v23,s[8:11],s21 offen offset:1024 lds
MF a[144:147],v[112:115],v[176:179],a[144:147]
DR v[72:75],v11 offset:4096
MF a[148:151],v[112:115],v[180:183],a[148:151]
MF a[152:155],v[112:115],v[184:187],a[152:155]
DR v[76:79],v11 offset:6144
MF a[156:159],v[112:115],v[188:191],a[156:159]
MF a[160:163],v[116:119],v[160:163],a[160:163]
DR v[80:83],v11 offset:8192
MF a[164:167],v[116:119],v[164:167],a[164:167]
BL v24,s[8:11],s21 offen offset:2048 lds
MF a[168:171],v[116:119],v[168:171],a[168:171]
DR v[84:87],v11 offset:10240
MF a[172:175],v[116:119],v[172:175],a[172:175]
MF a[176:179],v[116:119],v[176:179],a[176:179]
DR v[88:91],v11 offset:12288
MF a[180:183],v[116:119],v[180:183],a[180:183]
MF a[184:187],v[116:119],v[184:187],a[184:187]
DR v[92:95],v11 offset:14336
MF a[188:191],v[116:119],v[188:191],a[188:191]
BL v25,s[8:11],s21 offen offset:3072 lds
MF a[192:195],v[120:123],v[160:163],a[192:195]
MF a[196:199],v[120:123],v[164:167],a[196:199]
MF a[200:203],v[120:123],v[168:171],a[200:203]
MF a[204:207],v[120:123],v[172:175],a[204:207]
MF a[208:211],v[120:123],v[176:179],a[208:211]
MF a[212:215],v[120:123],v[180:183],a[212:215]
MF a[216:219],v[120:123],v[184:187],a[216:219]
MF a[220:223],v[120:123],v[188:191],a[220:223]
MF a[224:227],v[124:127],v[160:163],a[224:227]
MF a[228:231],v[124:127],v[164:167],a[228:231]
MF a[232:235],v[124:127],v[168:171],a[232:235]
MF a[236:239],v[124:127],v[172:175],a[236:239]
MF a[240:243],v[124:127],v[176:179],a[240:243]
MF a[244:247],v[124:127],v[180:183],a[244:247]
MF a[248:251],v[124:127],v[184:187],a[248:251]
MF a[252:255],v[124:127],v[188:191],a[252:255]
WT vmcnt(20) lgkmcnt(0)
s_barrier
MF a[0:3],v[64:67],v[128:131],a[0:3]
DR v[96:99],v13 offset:0
MF a[4:7],v[64:67],v[132:135],a[4:7]
MF a[8:11],v[64:67],v[136:139],a[8:11]
DT v[160:161],v14 offset:16384
MF a[12:15],v[64:67],v[140:143],a[12:15]
MF a[16:19],v[64:67],v[144:147],a[16:19]
DT v[162:163],v14 offset:18432
MF a[20:23],v[64:67],v[148:151],a[20:23]
SA m0,s23,98304
s_mov_b32 s22,2097152
BL v26,s[12:15],s22 offen nt lds
MF a[24:27],v[64:67],v[152:155],a[24:27]
DT v[164:165],v15 offset:16384
MF a[28:31],v[64:67],v[156:159],a[28:31]
MF a[32:35],v[68:71],v[128:131],a[32:35]
DT v[166:167],v15 offset:18432
MF a[36:39],v[68:71],v[132:135],a[36:39]
MF a[40:43],v[68:71],v[136:139],a[40:43]
DT v[168:169],v16 offset:16384
MF a[44:47],v[68:71],v[140:143],a[44:47]
BL v27,s[12:15],s22 offen offset:1024 nt lds
MF a[48:51],v[68:71],v[144:147],a[48:51]
DT v[170:171],v16 offset:18432
MF a[52:55],v[68:71],v[148:151],a[52:55]
MF a[56:59],v[68:71],v[152:155],a[56:59]
DT v[172:173],v17 offset:16384
MF a[60:63],v[68:71],v[156:159],a[60:63]
MF a[64:67],v[72:75],v[128:131],a[64:67]
DT v[174:175],v17 offset:18432
MF a[68:71],v[72:75],v[132:135],a[68:71]
BL v28,s[12:15],s22 offen offset:2048 nt lds
MF a[72:75],v[72:75],v[136:139],a[72:75]
DT v[176:177],v18 offset:16384
MF a[76:79],v[72:75],v[140:143],a[76:79]
MF a[80:83],v[72:75],v[144:147],a[80:83]
DT v[178:179],v18 offset:18432
MF a[84:87],v[72:75],v[148:151],a[84:87]
MF a[88:91],v[72:75],v[152:155],a[88:91]
DT v[180:181],v19 offset:16384
MF a[92:95],v[72:75],v[156:159],a[92:95]
BL v29,s[12:15],s22 offen offset:3072 nt lds
MF a[96:99],v[76:79],v[128:131],a[96:99]
DT v[182:183],v19 offset:18432
MF a[100:103],v[76:79],v[132:135],a[100:103]
MF a[104:107],v[76:79],v[136:139],a[104:107]
DT v[184:185],v20 offset:16384
MF a[108:111],v[76:79],v[140:143],a[108:111]
MF a[112:115],v[76:79],v[144:147],a[112:115]
DT v[186:187],v20 offset:18432
MF a[116:119],v[76:79],v[148:151],a[116:119]
SA m0,s23,49152
s_mov_b32 s21,262656
BL v22,s[8:11],s21 offen lds
MF a[120:123],v[76:79],v[152:155],a[120:123]
DT v[188:189],v21 offset:16384
MF a[124:127],v[76:79],v[156:159],a[124:127]
MF a[128:131],v[80:83],v[128:131],a[128:131]
DT v[190:191],v21 offset:18432
MF a[132:135],v[80:83],v[132:135],a[132:135]
MF a[136:139],v[80:83],v[136:139],a[136:139]
DR v[100:103],v13 offset:2048
MF a[140:143],v[80:83],v[140:143],a[140:143]
BL v23,s[8:11],s21 offen offset:1024 lds
MF a[144:147],v[80:83],v[144:147],a[144:147]
DR v[104:107],v13 offset:4096
MF a[148:151],v[80:83],v[148:151],a[148:151]
MF a[152:155],v[80:83],v[152:155],a[152:155]
DR v[108:111],v13 offset:6144
MF a[156:159],v[80:83],v[156:159],a[156:159]
MF a[160:163],v[84:87],v[128:131],a[160:163]
DR v[112:115],v13 offset:8192
MF a[164:167],v[84:87],v[132:135],a[164:167]
BL v24,s[8:11],s21 offen offset:2048 lds
MF a[168:171],v[84:87],v[136:139],a[168:171]
DR v[116:119],v13 offset:10240
MF a[172:175],v[84:87],v[140:143],a[172:175]
MF a[176:179],v[84:87],v[144:147],a[176:179]
DR v[120:123],v13 offset:12288
MF a[180:183],v[84:87],v[148:151],a[180:183]
MF a[184:187],v[84:87],v[152:155],a[184:187]
DR v[124:127],v13 offset:14336
MF a[188:191],v[84:87],v[156:159],a[188:191]
BL v25,s[8:11],s21 offen offset:3072 lds
MF a[192:195],v[88:91],v[128:131],a[192:195]
MF a[196:199],v[88:91],v[132:135],a[196:199]
MF a[200:203],v[88:91],v[136:139],a[200:203]
MF a[204:207],v[88:91],v[140:143],a[204:207]
MF a[208:211],v[88:91],v[144:147],a[208:211]
MF a[212:215],v[88:91],v[148:151],a[212:215]
MF a[216:219],v[88:91],v[152:155],a[216:219]
MF a[220:223],v[88:91],v[156:159],a[220:223]
s_cmp_lg_u32 s20,0
s_cbranch_scc1 k1_kernel_v_nozero
SA s60,s52,125829120
s_addc_u32 s61,s53,0
s_mov_b32 s62,32768
s_mov_b32 s63,0x20000
s_lshl_b32 s30,s2,7
v_lshlrev_b32 v4,2,v1
v_mov_b32 v5,0
s_mov_b32 exec_hi,0
buffer_store_dword v5,v4,s[60:63],s30 offen
s_mov_b64 exec,-1
k1_kernel_v_nozero:
MF a[224:227],v[92:95],v[128:131],a[224:227]
MF a[228:231],v[92:95],v[132:135],a[228:231]
MF a[232:235],v[92:95],v[136:139],a[232:235]
MF a[236:239],v[92:95],v[140:143],a[236:239]
MF a[240:243],v[92:95],v[144:147],a[240:243]
MF a[244:247],v[92:95],v[148:151],a[244:247]
MF a[248:251],v[92:95],v[152:155],a[248:251]
MF a[252:255],v[92:95],v[156:159],a[252:255]
WT vmcnt(16) lgkmcnt(0)
s_barrier
MF a[0:3],v[96:99],v[160:163],a[0:3]
DR v[64:67],v10 offset:0
MF a[4:7],v[96:99],v[164:167],a[4:7]
MF a[8:11],v[96:99],v[168:171],a[8:11]
DT v[128:129],v14 offset:32768
MF a[12:15],v[96:99],v[172:175],a[12:15]
MF a[16:19],v[96:99],v[176:179],a[16:19]
DT v[130:131],v14 offset:34816
MF a[20:23],v[96:99],v[180:183],a[20:23]
SA m0,s23,114688
s_mov_b32 s22,2359296
BL v26,s[12:15],s22 offen nt lds
MF a[24:27],v[96:99],v[184:187],a[24:27]
DT v[132:133],v15 offset:32768
MF a[28:31],v[96:99],v[188:191],a[28:31]
MF a[32:35],v[100:103],v[160:163],a[32:35]
DT v[134:135],v15 offset:34816
MF a[36:39],v[100:103],v[164:167],a[36:39]
MF a[40:43],v[100:103],v[168:171],a[40:43]
DT v[136:137],v16 offset:32768
MF a[44:47],v[100:103],v[172:175],a[44:47]
BL v27,s[12:15],s22 offen offset:1024 nt lds
MF a[48:51],v[100:103],v[176:179],a[48:51]
DT v[138:139],v16 offset:34816
MF a[52:55],v[100:103],v[180:183],a[52:55]
MF a[56:59],v[100:103],v[184:187],a[56:59]
DT v[140:141],v17 offset:32768
MF a[60:63],v[100:103],v[188:191],a[60:63]
MF a[64:67],v[104:107],v[160:163],a[64:67]
DT v[142:143],v17 offset:34816
MF a[68:71],v[104:107],v[164:167],a[68:71]
BL v28,s[12:15],s22 offen offset:2048 nt lds
MF a[72:75],v[104:107],v[168:171],a[72:75]
DT v[144:145],v18 offset:32768
MF a[76:79],v[104:107],v[172:175],a[76:79]
MF a[80:83],v[104:107],v[176:179],a[80:83]
DT v[146:147],v18 offset:34816
MF a[84:87],v[104:107],v[180:183],a[84:87]
MF a[88:91],v[104:107],v[184:187],a[88:91]
DT v[148:149],v19 offset:32768
MF a[92:95],v[104:107],v[188:191],a[92:95]
BL v29,s[12:15],s22 offen offset:3072 nt lds
MF a[96:99],v[108:111],v[160:163],a[96:99]
DT v[150:151],v19 offset:34816
MF a[100:103],v[108:111],v[164:167],a[100:103]
MF a[104:107],v[108:111],v[168:171],a[104:107]
DT v[152:153],v20 offset:32768
MF a[108:111],v[108:111],v[172:175],a[108:111]
MF a[112:115],v[108:111],v[176:179],a[112:115]
DT v[154:155],v20 offset:34816
MF a[116:119],v[108:111],v[180:183],a[116:119]
SA m0,s23,65536
s_mov_b32 s21,640
BL v22,s[8:11],s21 offen lds
MF a[120:123],v[108:111],v[184:187],a[120:123]
DT v[156:157],v21 offset:32768
MF a[124:127],v[108:111],v[188:191],a[124:127]
MF a[128:131],v[112:115],v[160:163],a[128:131]
DT v[158:159],v21 offset:34816
MF a[132:135],v[112:115],v[164:167],a[132:135]
MF a[136:139],v[112:115],v[168:171],a[136:139]
DR v[68:71],v10 offset:2048
MF a[140:143],v[112:115],v[172:175],a[140:143]
BL v23,s[8:11],s21 offen offset:1024 lds
MF a[144:147],v[112:115],v[176:179],a[144:147]
DR v[72:75],v10 offset:4096
MF a[148:151],v[112:115],v[180:183],a[148:151]
MF a[152:155],v[112:115],v[184:187],a[152:155]
DR v[76:79],v10 offset:6144
MF a[156:159],v[112:115],v[188:191],a[156:159]
MF a[160:163],v[116:119],v[160:163],a[160:163]
DR v[80:83],v10 offset:8192
MF a[164:167],v[116:119],v[164:167],a[164:167]
BL v24,s[8:11],s21 offen offset:2048 lds
MF a[168:171],v[116:119],v[168:171],a[168:171]
DR v[84:87],v10 offset:10240
MF a[172:175],v[116:119],v[172:175],a[172:175]
MF a[176:179],v[116:119],v[176:179],a[176:179]
DR v[88:91],v10 offset:12288
MF a[180:183],v[116:119],v[180:183],a[180:183]
MF a[184:187],v[116:119],v[184:187],a[184:187]
DR v[92:95],v10 offset:14336
MF a[188:191],v[116:119],v[188:191],a[188:191]
BL v25,s[8:11],s21 offen offset:3072 lds
MF a[192:195],v[120:123],v[160:163],a[192:195]
MF a[196:199],v[120:123],v[164:167],a[196:199]
MF a[200:203],v[120:123],v[168:171],a[200:203]
MF a[204:207],v[120:123],v[172:175],a[204:207]
MF a[208:211],v[120:123],v[176:179],a[208:211]
MF a[212:215],v[120:123],v[180:183],a[212:215]
MF a[216:219],v[120:123],v[184:187],a[216:219]
MF a[220:223],v[120:123],v[188:191],a[220:223]
MF a[224:227],v[124:127],v[160:163],a[224:227]
MF a[228:231],v[124:127],v[164:167],a[228:231]
MF a[232:235],v[124:127],v[168:171],a[232:235]
MF a[236:239],v[124:127],v[172:175],a[236:239]
MF a[240:243],v[124:127],v[176:179],a[240:243]
MF a[244:247],v[124:127],v[180:183],a[244:247]
MF a[248:251],v[124:127],v[184:187],a[248:251]
MF a[252:255],v[124:127],v[188:191],a[252:255]
WT vmcnt(20) lgkmcnt(0)
s_barrier
MF a[0:3],v[64:67],v[128:131],a[0:3]
DR v[96:99],v12 offset:0
MF a[4:7],v[64:67],v[132:135],a[4:7]
MF a[8:11],v[64:67],v[136:139],a[8:11]
DT v[160:161],v14 offset:49152
MF a[12:15],v[64:67],v[140:143],a[12:15]
MF a[16:19],v[64:67],v[144:147],a[16:19]
DT v[162:163],v14 offset:51200
MF a[20:23],v[64:67],v[148:151],a[20:23]
SA m0,s23,131072
s_mov_b32 s22,2621440
BL v26,s[12:15],s22 offen nt lds
MF a[24:27],v[64:67],v[152:155],a[24:27]
DT v[164:165],v15 offset:49152
MF a[28:31],v[64:67],v[156:159],a[28:31]
MF a[32:35],v[68:71],v[128:131],a[32:35]
DT v[166:167],v15 offset:51200
MF a[36:39],v[68:71],v[132:135],a[36:39]
MF a[40:43],v[68:71],v[136:139],a[40:43]
DT v[168:169],v16 offset:49152
MF a[44:47],v[68:71],v[140:143],a[44:47]
BL v27,s[12:15],s22 offen offset:1024 nt lds
MF a[48:51],v[68:71],v[144:147],a[48:51]
DT v[170:171],v16 offset:51200
MF a[52:55],v[68:71],v[148:151],a[52:55]
MF a[56:59],v[68:71],v[152:155],a[56:59]
DT v[172:173],v17 offset:49152
MF a[60:63],v[68:71],v[156:159],a[60:63]
MF a[64:67],v[72:75],v[128:131],a[64:67]
DT v[174:175],v17 offset:51200
MF a[68:71],v[72:75],v[132:135],a[68:71]
BL v28,s[12:15],s22 offen offset:2048 nt lds
MF a[72:75],v[72:75],v[136:139],a[72:75]
DT v[176:177],v18 offset:49152
MF a[76:79],v[72:75],v[140:143],a[76:79]
MF a[80:83],v[72:75],v[144:147],a[80:83]
DT v[178:179],v18 offset:51200
MF a[84:87],v[72:75],v[148:151],a[84:87]
MF a[88:91],v[72:75],v[152:155],a[88:91]
DT v[180:181],v19 offset:49152
MF a[92:95],v[72:75],v[156:159],a[92:95]
BL v29,s[12:15],s22 offen offset:3072 nt lds
MF a[96:99],v[76:79],v[128:131],a[96:99]
DT v[182:183],v19 offset:51200
MF a[100:103],v[76:79],v[132:135],a[100:103]
MF a[104:107],v[76:79],v[136:139],a[104:107]
DT v[184:185],v20 offset:49152
MF a[108:111],v[76:79],v[140:143],a[108:111]
MF a[112:115],v[76:79],v[144:147],a[112:115]
DT v[186:187],v20 offset:51200
MF a[116:119],v[76:79],v[148:151],a[116:119]
SA m0,s23,81920
s_mov_b32 s21,262784
BL v22,s[8:11],s21 offen lds
MF a[120:123],v[76:79],v[152:155],a[120:123]
DT v[188:189],v21 offset:49152
MF a[124:127],v[76:79],v[156:159],a[124:127]
MF a[128:131],v[80:83],v[128:131],a[128:131]
DT v[190:191],v21 offset:51200
MF a[132:135],v[80:83],v[132:135],a[132:135]
MF a[136:139],v[80:83],v[136:139],a[136:139]
DR v[100:103],v12 offset:2048
MF a[140:143],v[80:83],v[140:143],a[140:143]
BL v23,s[8:11],s21 offen offset:1024 lds
MF a[144:147],v[80:83],v[144:147],a[144:147]
DR v[104:107],v12 offset:4096
MF a[148:151],v[80:83],v[148:151],a[148:151]
MF a[152:155],v[80:83],v[152:155],a[152:155]
DR v[108:111],v12 offset:6144
MF a[156:159],v[80:83],v[156:159],a[156:159]
MF a[160:163],v[84:87],v[128:131],a[160:163]
DR v[112:115],v12 offset:8192
MF a[164:167],v[84:87],v[132:135],a[164:167]
BL v24,s[8:11],s21 offen offset:2048 lds
MF a[168:171],v[84:87],v[136:139],a[168:171]
DR v[116:119],v12 offset:10240
MF a[172:175],v[84:87],v[140:143],a[172:175]
MF a[176:179],v[84:87],v[144:147],a[176:179]
DR v[120:123],v12 offset:12288
MF a[180:183],v[84:87],v[148:151],a[180:183]
MF a[184:187],v[84:87],v[152:155],a[184:187]
DR v[124:127],v12 offset:14336
MF a[188:191],v[84:87],v[156:159],a[188:191]
BL v25,s[8:11],s21 offen offset:3072 lds
MF a[192:195],v[88:91],v[128:131],a[192:195]
MF a[196:199],v[88:91],v[132:135],a[196:199]
MF a[200:203],v[88:91],v[136:139],a[200:203]
MF a[204:207],v[88:91],v[140:143],a[204:207]
MF a[208:211],v[88:91],v[144:147],a[208:211]
MF a[212:215],v[88:91],v[148:151],a[212:215]
MF a[216:219],v[88:91],v[152:155],a[216:219]
MF a[220:223],v[88:91],v[156:159],a[220:223]
MF a[224:227],v[92:95],v[128:131],a[224:227]
MF a[228:231],v[92:95],v[132:135],a[228:231]
MF a[232:235],v[92:95],v[136:139],a[232:235]
MF a[236:239],v[92:95],v[140:143],a[236:239]
MF a[240:243],v[92:95],v[144:147],a[240:243]
MF a[244:247],v[92:95],v[148:151],a[244:247]
MF a[248:251],v[92:95],v[152:155],a[248:251]
MF a[252:255],v[92:95],v[156:159],a[252:255]
WT vmcnt(16) lgkmcnt(0)
s_barrier
MF a[0:3],v[96:99],v[160:163],a[0:3]
DR v[64:67],v10 offset:32768
MF a[4:7],v[96:99],v[164:167],a[4:7]
MF a[8:11],v[96:99],v[168:171],a[8:11]
DT v[128:129],v14 offset:0
MF a[12:15],v[96:99],v[172:175],a[12:15]
MF a[16:19],v[96:99],v[176:179],a[16:19]
DT v[130:131],v14 offset:2048
MF a[20:23],v[96:99],v[180:183],a[20:23]
SA m0,s23,147456
s_mov_b32 s22,2883584
BL v26,s[12:15],s22 offen nt lds
MF a[24:27],v[96:99],v[184:187],a[24:27]
DT v[132:133],v15 offset:0
MF a[28:31],v[96:99],v[188:191],a[28:31]
MF a[32:35],v[100:103],v[160:163],a[32:35]
DT v[134:135],v15 offset:2048
MF a[36:39],v[100:103],v[164:167],a[36:39]
MF a[40:43],v[100:103],v[168:171],a[40:43]
DT v[136:137],v16 offset:0
MF a[44:47],v[100:103],v[172:175],a[44:47]
BL v27,s[12:15],s22 offen offset:1024 nt lds
MF a[48:51],v[100:103],v[176:179],a[48:51]
DT v[138:139],v16 offset:2048
MF a[52:55],v[100:103],v[180:183],a[52:55]
MF a[56:59],v[100:103],v[184:187],a[56:59]
DT v[140:141],v17 offset:0
MF a[60:63],v[100:103],v[188:191],a[60:63]
MF a[64:67],v[104:107],v[160:163],a[64:67]
DT v[142:143],v17 offset:2048
MF a[68:71],v[104:107],v[164:167],a[68:71]
BL v28,s[12:15],s22 offen offset:2048 nt lds
MF a[72:75],v[104:107],v[168:171],a[72:75]
DT v[144:145],v18 offset:0
MF a[76:79],v[104:107],v[172:175],a[76:79]
MF a[80:83],v[104:107],v[176:179],a[80:83]
DT v[146:147],v18 offset:2048
MF a[84:87],v[104:107],v[180:183],a[84:87]
MF a[88:91],v[104:107],v[184:187],a[88:91]
DT v[148:149],v19 offset:0
MF a[92:95],v[104:107],v[188:191],a[92:95]
BL v29,s[12:15],s22 offen offset:3072 nt lds
MF a[96:99],v[108:111],v[160:163],a[96:99]
DT v[150:151],v19 offset:2048
MF a[100:103],v[108:111],v[164:167],a[100:103]
MF a[104:107],v[108:111],v[168:171],a[104:107]
DT v[152:153],v20 offset:0
MF a[108:111],v[108:111],v[172:175],a[108:111]
MF a[112:115],v[108:111],v[176:179],a[112:115]
DT v[154:155],v20 offset:2048
MF a[116:119],v[108:111],v[180:183],a[116:119]
SA m0,s23,0
s_mov_b32 s21,768
BL v22,s[8:11],s21 offen lds
MF a[120:123],v[108:111],v[184:187],a[120:123]
DT v[156:157],v21 offset:0
MF a[124:127],v[108:111],v[188:191],a[124:127]
MF a[128:131],v[112:115],v[160:163],a[128:131]
DT v[158:159],v21 offset:2048
MF a[132:135],v[112:115],v[164:167],a[132:135]
MF a[136:139],v[112:115],v[168:171],a[136:139]
DR v[68:71],v10 offset:34816
MF a[140:143],v[112:115],v[172:175],a[140:143]
BL v23,s[8:11],s21 offen offset:1024 lds
MF a[144:147],v[112:115],v[176:179],a[144:147]
DR v[72:75],v10 offset:36864
MF a[148:151],v[112:115],v[180:183],a[148:151]
MF a[152:155],v[112:115],v[184:187],a[152:155]
DR v[76:79],v10 offset:38912
MF a[156:159],v[112:115],v[188:191],a[156:159]
MF a[160:163],v[116:119],v[160:163],a[160:163]
DR v[80:83],v10 offset:40960
MF a[164:167],v[116:119],v[164:167],a[164:167]
BL v24,s[8:11],s21 offen offset:2048 lds
MF a[168:171],v[116:119],v[168:171],a[168:171]
DR v[84:87],v10 offset:43008
MF a[172:175],v[116:119],v[172:175],a[172:175]
MF a[176:179],v[116:119],v[176:179],a[176:179]
DR v[88:91],v10 offset:45056
MF a[180:183],v[116:119],v[180:183],a[180:183]
MF a[184:187],v[116:119],v[184:187],a[184:187]
DR v[92:95],v10 offset:47104
MF a[188:191],v[116:119],v[188:191],a[188:191]
BL v25,s[8:11],s21 offen offset:3072 lds
MF a[192:195],v[120:123],v[160:163],a[192:195]
MF a[196:199],v[120:123],v[164:167],a[196:199]
MF a[200:203],v[120:123],v[168:171],a[200:203]
MF a[204:207],v[120:123],v[172:175],a[204:207]
MF a[208:211],v[120:123],v[176:179],a[208:211]
MF a[212:215],v[120:123],v[180:183],a[212:215]
MF a[216:219],v[120:123],v[184:187],a[216:219]
MF a[220:223],v[120:123],v[188:191],a[220:223]
MF a[224:227],v[124:127],v[160:163],a[224:227]
MF a[228:231],v[124:127],v[164:167],a[228:231]
MF a[232:235],v[124:127],v[168:171],a[232:235]
MF a[236:239],v[124:127],v[172:175],a[236:239]
MF a[240:243],v[124:127],v[176:179],a[240:243]
MF a[244:247],v[124:127],v[180:183],a[244:247]
MF a[248:251],v[124:127],v[184:187],a[248:251]
MF a[252:255],v[124:127],v[188:191],a[252:255]
WT vmcnt(20) lgkmcnt(0)
s_barrier
MF a[0:3],v[64:67],v[128:131],a[0:3]
DR v[96:99],v12 offset:32768
v_cmp_gt_u32 vcc,24,v194
MF a[4:7],v[64:67],v[132:135],a[4:7]
v_lshlrev_b32 v204,16,v196
v_and_b32 v205,0xffff0000,v196
MF a[8:11],v[64:67],v[136:139],a[8:11]
DT v[160:161],v14 offset:16384
v_lshlrev_b32 v206,16,v197
MF a[12:15],v[64:67],v[140:143],a[12:15]
v_and_b32 v207,0xffff0000,v197
v_lshlrev_b32 v208,16,v198
MF a[16:19],v[64:67],v[144:147],a[16:19]
DT v[162:163],v14 offset:18432
v_and_b32 v209,0xffff0000,v198
MF a[20:23],v[64:67],v[148:151],a[20:23]
SA m0,s23,98304
s_mov_b32 s22,3145728
BL v26,s[12:15],s22 offen nt lds
MF a[24:27],v[64:67],v[152:155],a[24:27]
DT v[164:165],v15 offset:16384
v_lshlrev_b32 v210,16,v199
MF a[28:31],v[64:67],v[156:159],a[28:31]
v_and_b32 v211,0xffff0000,v199
v_lshlrev_b32 v212,16,v200
MF a[32:35],v[68:71],v[128:131],a[32:35]
DT v[166:167],v15 offset:18432
v_and_b32 v213,0xffff0000,v200
MF a[36:39],v[68:71],v[132:135],a[36:39]
v_lshlrev_b32 v214,16,v201
v_and_b32 v215,0xffff0000,v201
MF a[40:43],v[68:71],v[136:139],a[40:43]
DT v[168:169],v16 offset:16384
v_lshlrev_b32 v216,16,v202
MF a[44:47],v[68:71],v[140:143],a[44:47]
BL v27,s[12:15],s22 offen offset:1024 nt lds
MF a[48:51],v[68:71],v[144:147],a[48:51]
DT v[170:171],v16 offset:18432
v_and_b32 v217,0xffff0000,v202
MF a[52:55],v[68:71],v[148:151],a[52:55]
v_lshlrev_b32 v218,16,v203
v_and_b32 v219,0xffff0000,v203
MF a[56:59],v[68:71],v[152:155],a[56:59]
DT v[172:173],v17 offset:16384
FA v220,v204,v205
MF a[60:63],v[68:71],v[156:159],a[60:63]
FA v220,v220,v206
FA v220,v220,v207
MF a[64:67],v[72:75],v[128:131],a[64:67]
DT v[174:175],v17 offset:18432
FA v220,v220,v208
MF a[68:71],v[72:75],v[132:135],a[68:71]
BL v28,s[12:15],s22 offen offset:2048 nt lds
MF a[72:75],v[72:75],v[136:139],a[72:75]
DT v[176:177],v18 offset:16384
FA v220,v220,v209
MF a[76:79],v[72:75],v[140:143],a[76:79]
FA v220,v220,v210
FA v220,v220,v211
MF a[80:83],v[72:75],v[144:147],a[80:83]
DT v[178:179],v18 offset:18432
FA v220,v220,v212
MF a[84:87],v[72:75],v[148:151],a[84:87]
FA v220,v220,v213
FA v220,v220,v214
MF a[88:91],v[72:75],v[152:155],a[88:91]
DT v[180:181],v19 offset:16384
FA v220,v220,v215
MF a[92:95],v[72:75],v[156:159],a[92:95]
BL v29,s[12:15],s22 offen offset:3072 nt lds
MF a[96:99],v[76:79],v[128:131],a[96:99]
DT v[182:183],v19 offset:18432
FA v220,v220,v216
MF a[100:103],v[76:79],v[132:135],a[100:103]
FA v220,v220,v217
FA v220,v220,v218
MF a[104:107],v[76:79],v[136:139],a[104:107]
DT v[184:185],v20 offset:16384
FA v220,v220,v219
s_nop 1
MF a[108:111],v[76:79],v[140:143],a[108:111]
v_add_f32_dpp v220,v220,v220 row_ror:8 row_mask:0xf bank_mask:0xf
s_nop 1
v_add_f32_dpp v220,v220,v220 row_ror:4 row_mask:0xf bank_mask:0xf
s_nop 1
MF a[112:115],v[76:79],v[144:147],a[112:115]
DT v[186:187],v20 offset:18432
v_add_f32_dpp v220,v220,v220 row_ror:2 row_mask:0xf bank_mask:0xf
s_nop 1
MF a[116:119],v[76:79],v[148:151],a[116:119]
SA m0,s23,16384
s_mov_b32 s21,262912
BL v22,s[8:11],s21 offen lds
MF a[120:123],v[76:79],v[152:155],a[120:123]
DT v[188:189],v21 offset:16384
v_add_f32_dpp v220,v220,v220 row_ror:1 row_mask:0xf bank_mask:0xf
s_nop 1
MF a[124:127],v[76:79],v[156:159],a[124:127]
v_mov_b32 v222,v220
s_nop 1
v_permlane16_swap_b32 v220,v222
s_nop 1
MF a[128:131],v[80:83],v[128:131],a[128:131]
DT v[190:191],v21 offset:18432
FA v220,v220,v222
MF a[132:135],v[80:83],v[132:135],a[132:135]
FM v220,0x3b124925,v220
FS v204,v204,v220
MF a[136:139],v[80:83],v[136:139],a[136:139]
DR v[100:103],v12 offset:34816
FS v205,v205,v220
MF a[140:143],v[80:83],v[140:143],a[140:143]
BL v23,s[8:11],s21 offen offset:1024 lds
MF a[144:147],v[80:83],v[144:147],a[144:147]
DR v[104:107],v12 offset:36864
FS v206,v206,v220
MF a[148:151],v[80:83],v[148:151],a[148:151]
FS v207,v207,v220
FS v208,v208,v220
MF a[152:155],v[80:83],v[152:155],a[152:155]
DR v[108:111],v12 offset:38912
FS v209,v209,v220
MF a[156:159],v[80:83],v[156:159],a[156:159]
FS v210,v210,v220
FS v211,v211,v220
MF a[160:163],v[84:87],v[128:131],a[160:163]
DR v[112:115],v12 offset:40960
FS v212,v212,v220
MF a[164:167],v[84:87],v[132:135],a[164:167]
BL v24,s[8:11],s21 offen offset:2048 lds
MF a[168:171],v[84:87],v[136:139],a[168:171]
DR v[116:119],v12 offset:43008
FS v213,v213,v220
MF a[172:175],v[84:87],v[140:143],a[172:175]
FS v214,v214,v220
FS v215,v215,v220
MF a[176:179],v[84:87],v[144:147],a[176:179]
DR v[120:123],v12 offset:45056
FS v216,v216,v220
MF a[180:183],v[84:87],v[148:151],a[180:183]
FS v217,v217,v220
FS v218,v218,v220
MF a[184:187],v[84:87],v[152:155],a[184:187]
DR v[124:127],v12 offset:47104
FS v219,v219,v220
MF a[188:191],v[84:87],v[156:159],a[188:191]
BL v25,s[8:11],s21 offen offset:3072 lds
MF a[192:195],v[88:91],v[128:131],a[192:195]
CM v212,0,v212,vcc
CM v213,0,v213,vcc
MF a[196:199],v[88:91],v[132:135],a[196:199]
CM v214,0,v214,vcc
CM v215,0,v215,vcc
MF a[200:203],v[88:91],v[136:139],a[200:203]
CM v216,0,v216,vcc
CM v217,0,v217,vcc
MF a[204:207],v[88:91],v[140:143],a[204:207]
CM v218,0,v218,vcc
CM v219,0,v219,vcc
MF a[208:211],v[88:91],v[144:147],a[208:211]
FM v221,v204,v204
v_fmac_f32 v221,v205,v205
MF a[212:215],v[88:91],v[148:151],a[212:215]
v_fmac_f32 v221,v206,v206
v_fmac_f32 v221,v207,v207
MF a[216:219],v[88:91],v[152:155],a[216:219]
v_fmac_f32 v221,v208,v208
v_fmac_f32 v221,v209,v209
MF a[220:223],v[88:91],v[156:159],a[220:223]
v_fmac_f32 v221,v210,v210
v_fmac_f32 v221,v211,v211
MF a[224:227],v[92:95],v[128:131],a[224:227]
v_fmac_f32 v221,v212,v212
v_fmac_f32 v221,v213,v213
MF a[228:231],v[92:95],v[132:135],a[228:231]
v_fmac_f32 v221,v214,v214
v_fmac_f32 v221,v215,v215
MF a[232:235],v[92:95],v[136:139],a[232:235]
v_fmac_f32 v221,v216,v216
v_fmac_f32 v221,v217,v217
MF a[236:239],v[92:95],v[140:143],a[236:239]
v_fmac_f32 v221,v218,v218
v_fmac_f32 v221,v219,v219
s_nop 1
MF a[240:243],v[92:95],v[144:147],a[240:243]
v_add_f32_dpp v221,v221,v221 row_ror:8 row_mask:0xf bank_mask:0xf
s_nop 1
v_add_f32_dpp v221,v221,v221 row_ror:4 row_mask:0xf bank_mask:0xf
s_nop 1
MF a[244:247],v[92:95],v[148:151],a[244:247]
v_add_f32_dpp v221,v221,v221 row_ror:2 row_mask:0xf bank_mask:0xf
s_nop 1
v_add_f32_dpp v221,v221,v221 row_ror:1 row_mask:0xf bank_mask:0xf
s_nop 1
MF a[248:251],v[92:95],v[152:155],a[248:251]
v_mov_b32 v222,v221
s_nop 1
v_permlane16_swap_b32 v221,v222
s_nop 1
MF a[252:255],v[92:95],v[156:159],a[252:255]
FA v221,v221,v222
v_mov_b32 v222,0x3727c5ac
WT vmcnt(16) lgkmcnt(0)
s_barrier
MF a[0:3],v[96:99],v[160:163],a[0:3]
DR v[64:67],v11 offset:0
v_fmac_f32 v222,0x3b124925,v221
MF a[4:7],v[96:99],v[164:167],a[4:7]
v_rsq_f32 v222,v222
s_nop 0
MF a[8:11],v[96:99],v[168:171],a[8:11]
DT v[128:129],v14 offset:32768
FM v204,v204,v222
MF a[12:15],v[96:99],v[172:175],a[12:15]
FM v205,v205,v222
FM v206,v206,v222
MF a[16:19],v[96:99],v[176:179],a[16:19]
DT v[130:131],v14 offset:34816
FM v207,v207,v222
MF a[20:23],v[96:99],v[180:183],a[20:23]
SA m0,s23,114688
s_mov_b32 s22,3407872
BL v26,s[12:15],s22 offen nt lds
MF a[24:27],v[96:99],v[184:187],a[24:27]
DT v[132:133],v15 offset:32768
FM v208,v208,v222
MF a[28:31],v[96:99],v[188:191],a[28:31]
FM v209,v209,v222
FM v210,v210,v222
MF a[32:35],v[100:103],v[160:163],a[32:35]
DT v[134:135],v15 offset:34816
FM v211,v211,v222
MF a[36:39],v[100:103],v[164:167],a[36:39]
FM v212,v212,v222
FM v213,v213,v222
MF a[40:43],v[100:103],v[168:171],a[40:43]
DT v[136:137],v16 offset:32768
FM v214,v214,v222
MF a[44:47],v[100:103],v[172:175],a[44:47]
BL v27,s[12:15],s22 offen offset:1024 nt lds
MF a[48:51],v[100:103],v[176:179],a[48:51]
DT v[138:139],v16 offset:34816
FM v215,v215,v222
MF a[52:55],v[100:103],v[180:183],a[52:55]
FM v216,v216,v222
FM v217,v217,v222
MF a[56:59],v[100:103],v[184:187],a[56:59]
DT v[140:141],v17 offset:32768
FM v218,v218,v222
MF a[60:63],v[100:103],v[188:191],a[60:63]
FM v219,v219,v222
CV v196,v204,v205
MF a[64:67],v[104:107],v[160:163],a[64:67]
DT v[142:143],v17 offset:34816
CV v197,v206,v207
MF a[68:71],v[104:107],v[164:167],a[68:71]
BL v28,s[12:15],s22 offen offset:2048 nt lds
MF a[72:75],v[104:107],v[168:171],a[72:75]
DT v[144:145],v18 offset:32768
CV v198,v208,v209
MF a[76:79],v[104:107],v[172:175],a[76:79]
CV v199,v210,v211
CV v200,v212,v213
MF a[80:83],v[104:107],v[176:179],a[80:83]
DT v[146:147],v18 offset:34816
CV v201,v214,v215
MF a[84:87],v[104:107],v[180:183],a[84:87]
CV v202,v216,v217
CV v203,v218,v219
MF a[88:91],v[104:107],v[184:187],a[88:91]
DT v[148:149],v19 offset:32768
MF a[92:95],v[104:107],v[188:191],a[92:95]
BL v29,s[12:15],s22 offen offset:3072 nt lds
MF a[96:99],v[108:111],v[160:163],a[96:99]
DT v[150:151],v19 offset:34816
MF a[100:103],v[108:111],v[164:167],a[100:103]
BS v[196:199],v192,s[64:67],0 offen sc1
MF a[104:107],v[108:111],v[168:171],a[104:107]
DT v[152:153],v20 offset:32768
MF a[108:111],v[108:111],v[172:175],a[108:111]
BS v[200:203],v193,s[64:67],0 offen sc1
MF a[112:115],v[108:111],v[176:179],a[112:115]
DT v[154:155],v20 offset:34816
MF a[116:119],v[108:111],v[180:183],a[116:119]
SA m0,s23,32768
s_mov_b32 s21,896
BL v22,s[8:11],s21 offen lds
MF a[120:123],v[108:111],v[184:187],a[120:123]
DT v[156:157],v21 offset:32768
MF a[124:127],v[108:111],v[188:191],a[124:127]
MF a[128:131],v[112:115],v[160:163],a[128:131]
DT v[158:159],v21 offset:34816
MF a[132:135],v[112:115],v[164:167],a[132:135]
MF a[136:139],v[112:115],v[168:171],a[136:139]
DR v[68:71],v11 offset:2048
MF a[140:143],v[112:115],v[172:175],a[140:143]
BL v23,s[8:11],s21 offen offset:1024 lds
MF a[144:147],v[112:115],v[176:179],a[144:147]
DR v[72:75],v11 offset:4096
MF a[148:151],v[112:115],v[180:183],a[148:151]
MF a[152:155],v[112:115],v[184:187],a[152:155]
DR v[76:79],v11 offset:6144
MF a[156:159],v[112:115],v[188:191],a[156:159]
MF a[160:163],v[116:119],v[160:163],a[160:163]
DR v[80:83],v11 offset:8192
MF a[164:167],v[116:119],v[164:167],a[164:167]
BL v24,s[8:11],s21 offen offset:2048 lds
MF a[168:171],v[116:119],v[168:171],a[168:171]
DR v[84:87],v11 offset:10240
MF a[172:175],v[116:119],v[172:175],a[172:175]
MF a[176:179],v[116:119],v[176:179],a[176:179]
DR v[88:91],v11 offset:12288
MF a[180:183],v[116:119],v[180:183],a[180:183]
MF a[184:187],v[116:119],v[184:187],a[184:187]
DR v[92:95],v11 offset:14336
MF a[188:191],v[116:119],v[188:191],a[188:191]
BL v25,s[8:11],s21 offen offset:3072 lds
MF a[192:195],v[120:123],v[160:163],a[192:195]
MF a[196:199],v[120:123],v[164:167],a[196:199]
MF a[200:203],v[120:123],v[168:171],a[200:203]
MF a[204:207],v[120:123],v[172:175],a[204:207]
MF a[208:211],v[120:123],v[176:179],a[208:211]
MF a[212:215],v[120:123],v[180:183],a[212:215]
MF a[216:219],v[120:123],v[184:187],a[216:219]
MF a[220:223],v[120:123],v[188:191],a[220:223]
MF a[224:227],v[124:127],v[160:163],a[224:227]
MF a[228:231],v[124:127],v[164:167],a[228:231]
MF a[232:235],v[124:127],v[168:171],a[232:235]
MF a[236:239],v[124:127],v[172:175],a[236:239]
MF a[240:243],v[124:127],v[176:179],a[240:243]
MF a[244:247],v[124:127],v[180:183],a[244:247]
MF a[248:251],v[124:127],v[184:187],a[248:251]
MF a[252:255],v[124:127],v[188:191],a[252:255]
WT vmcnt(22) lgkmcnt(0)
s_barrier
MF a[0:3],v[64:67],v[128:131],a[0:3]
DR v[96:99],v13 offset:0
MF a[4:7],v[64:67],v[132:135],a[4:7]
MF a[8:11],v[64:67],v[136:139],a[8:11]
DT v[160:161],v14 offset:49152
MF a[12:15],v[64:67],v[140:143],a[12:15]
MF a[16:19],v[64:67],v[144:147],a[16:19]
DT v[162:163],v14 offset:51200
MF a[20:23],v[64:67],v[148:151],a[20:23]
SA m0,s23,131072
s_mov_b32 s22,3670016
BL v26,s[12:15],s22 offen nt lds
MF a[24:27],v[64:67],v[152:155],a[24:27]
DT v[164:165],v15 offset:49152
MF a[28:31],v[64:67],v[156:159],a[28:31]
MF a[32:35],v[68:71],v[128:131],a[32:35]
DT v[166:167],v15 offset:51200
MF a[36:39],v[68:71],v[132:135],a[36:39]
MF a[40:43],v[68:71],v[136:139],a[40:43]
DT v[168:169],v16 offset:49152
MF a[44:47],v[68:71],v[140:143],a[44:47]
BL v27,s[12:15],s22 offen offset:1024 nt lds
MF a[48:51],v[68:71],v[144:147],a[48:51]
DT v[170:171],v16 offset:51200
MF a[52:55],v[68:71],v[148:151],a[52:55]
MF a[56:59],v[68:71],v[152:155],a[56:59]
DT v[172:173],v17 offset:49152
MF a[60:63],v[68:71],v[156:159],a[60:63]
MF a[64:67],v[72:75],v[128:131],a[64:67]
DT v[174:175],v17 offset:51200
MF a[68:71],v[72:75],v[132:135],a[68:71]
BL v28,s[12:15],s22 offen offset:2048 nt lds
MF a[72:75],v[72:75],v[136:139],a[72:75]
DT v[176:177],v18 offset:49152
MF a[76:79],v[72:75],v[140:143],a[76:79]
MF a[80:83],v[72:75],v[144:147],a[80:83]
DT v[178:179],v18 offset:51200
MF a[84:87],v[72:75],v[148:151],a[84:87]
MF a[88:91],v[72:75],v[152:155],a[88:91]
DT v[180:181],v19 offset:49152
MF a[92:95],v[72:75],v[156:159],a[92:95]
BL v29,s[12:15],s22 offen offset:3072 nt lds
MF a[96:99],v[76:79],v[128:131],a[96:99]
DT v[182:183],v19 offset:51200
MF a[100:103],v[76:79],v[132:135],a[100:103]
MF a[104:107],v[76:79],v[136:139],a[104:107]
DT v[184:185],v20 offset:49152
MF a[108:111],v[76:79],v[140:143],a[108:111]
MF a[112:115],v[76:79],v[144:147],a[112:115]
DT v[186:187],v20 offset:51200
MF a[116:119],v[76:79],v[148:151],a[116:119]
SA m0,s23,49152
s_mov_b32 s21,263040
BL v22,s[8:11],s21 offen lds
MF a[120:123],v[76:79],v[152:155],a[120:123]
DT v[188:189],v21 offset:49152
MF a[124:127],v[76:79],v[156:159],a[124:127]
MF a[128:131],v[80:83],v[128:131],a[128:131]
DT v[190:191],v21 offset:51200
MF a[132:135],v[80:83],v[132:135],a[132:135]
MF a[136:139],v[80:83],v[136:139],a[136:139]
DR v[100:103],v13 offset:2048
MF a[140:143],v[80:83],v[140:143],a[140:143]
BL v23,s[8:11],s21 offen offset:1024 lds
MF a[144:147],v[80:83],v[144:147],a[144:147]
DR v[104:107],v13 offset:4096
MF a[148:151],v[80:83],v[148:151],a[148:151]
MF a[152:155],v[80:83],v[152:155],a[152:155]
DR v[108:111],v13 offset:6144
MF a[156:159],v[80:83],v[156:159],a[156:159]
MF a[160:163],v[84:87],v[128:131],a[160:163]
DR v[112:115],v13 offset:8192
MF a[164:167],v[84:87],v[132:135],a[164:167]
BL v24,s[8:11],s21 offen offset:2048 lds
MF a[168:171],v[84:87],v[136:139],a[168:171]
DR v[116:119],v13 offset:10240
MF a[172:175],v[84:87],v[140:143],a[172:175]
MF a[176:179],v[84:87],v[144:147],a[176:179]
DR v[120:123],v13 offset:12288
MF a[180:183],v[84:87],v[148:151],a[180:183]
MF a[184:187],v[84:87],v[152:155],a[184:187]
DR v[124:127],v13 offset:14336
MF a[188:191],v[84:87],v[156:159],a[188:191]
BL v25,s[8:11],s21 offen offset:3072 lds
MF a[192:195],v[88:91],v[128:131],a[192:195]
MF a[196:199],v[88:91],v[132:135],a[196:199]
MF a[200:203],v[88:91],v[136:139],a[200:203]
MF a[204:207],v[88:91],v[140:143],a[204:207]
MF a[208:211],v[88:91],v[144:147],a[208:211]
MF a[212:215],v[88:91],v[148:151],a[212:215]
MF a[216:219],v[88:91],v[152:155],a[216:219]
MF a[220:223],v[88:91],v[156:159],a[220:223]
MF a[224:227],v[92:95],v[128:131],a[224:227]
MF a[228:231],v[92:95],v[132:135],a[228:231]
MF a[232:235],v[92:95],v[136:139],a[232:235]
MF a[236:239],v[92:95],v[140:143],a[236:239]
MF a[240:243],v[92:95],v[144:147],a[240:243]
MF a[244:247],v[92:95],v[148:151],a[244:247]
MF a[248:251],v[92:95],v[152:155],a[248:251]
MF a[252:255],v[92:95],v[156:159],a[252:255]
WT vmcnt(18) lgkmcnt(0)
s_barrier
MF a[0:3],v[96:99],v[160:163],a[0:3]
DR v[64:67],v10 offset:0
MF a[4:7],v[96:99],v[164:167],a[4:7]
MF a[8:11],v[96:99],v[168:171],a[8:11]
DT v[128:129],v14 offset:0
MF a[12:15],v[96:99],v[172:175],a[12:15]
MF a[16:19],v[96:99],v[176:179],a[16:19]
DT v[130:131],v14 offset:2048
MF a[20:23],v[96:99],v[180:183],a[20:23]
SA m0,s23,147456
s_mov_b32 s22,3932160
BL v26,s[12:15],s22 offen nt lds
MF a[24:27],v[96:99],v[184:187],a[24:27]
DT v[132:133],v15 offset:0
MF a[28:31],v[96:99],v[188:191],a[28:31]
MF a[32:35],v[100:103],v[160:163],a[32:35]
DT v[134:135],v15 offset:2048
MF a[36:39],v[100:103],v[164:167],a[36:39]
MF a[40:43],v[100:103],v[168:171],a[40:43]
DT v[136:137],v16 offset:0
MF a[44:47],v[100:103],v[172:175],a[44:47]
BL v27,s[12:15],s22 offen offset:1024 nt lds
MF a[48:51],v[100:103],v[176:179],a[48:51]
DT v[138:139],v16 offset:2048
MF a[52:55],v[100:103],v[180:183],a[52:55]
MF a[56:59],v[100:103],v[184:187],a[56:59]
DT v[140:141],v17 offset:0
MF a[60:63],v[100:103],v[188:191],a[60:63]
MF a[64:67],v[104:107],v[160:163],a[64:67]
DT v[142:143],v17 offset:2048
MF a[68:71],v[104:107],v[164:167],a[68:71]
BL v28,s[12:15],s22 offen offset:2048 nt lds
MF a[72:75],v[104:107],v[168:171],a[72:75]
DT v[144:145],v18 offset:0
MF a[76:79],v[104:107],v[172:175],a[76:79]
MF a[80:83],v[104:107],v[176:179],a[80:83]
DT v[146:147],v18 offset:2048
MF a[84:87],v[104:107],v[180:183],a[84:87]
MF a[88:91],v[104:107],v[184:187],a[88:91]
DT v[148:149],v19 offset:0
MF a[92:95],v[104:107],v[188:191],a[92:95]
BL v29,s[12:15],s22 offen offset:3072 nt lds
MF a[96:99],v[108:111],v[160:163],a[96:99]
DT v[150:151],v19 offset:2048
MF a[100:103],v[108:111],v[164:167],a[100:103]
MF a[104:107],v[108:111],v[168:171],a[104:107]
DT v[152:153],v20 offset:0
MF a[108:111],v[108:111],v[172:175],a[108:111]
MF a[112:115],v[108:111],v[176:179],a[112:115]
DT v[154:155],v20 offset:2048
MF a[116:119],v[108:111],v[180:183],a[116:119]
SA m0,s23,65536
s_mov_b32 s21,1024
BL v22,s[8:11],s21 offen lds
MF a[120:123],v[108:111],v[184:187],a[120:123]
DT v[156:157],v21 offset:0
MF a[124:127],v[108:111],v[188:191],a[124:127]
MF a[128:131],v[112:115],v[160:163],a[128:131]
DT v[158:159],v21 offset:2048
MF a[132:135],v[112:115],v[164:167],a[132:135]
MF a[136:139],v[112:115],v[168:171],a[136:139]
DR v[68:71],v10 offset:2048
MF a[140:143],v[112:115],v[172:175],a[140:143]
BL v23,s[8:11],s21 offen offset:1024 lds
MF a[144:147],v[112:115],v[176:179],a[144:147]
DR v[72:75],v10 offset:4096
MF a[148:151],v[112:115],v[180:183],a[148:151]
MF a[152:155],v[112:115],v[184:187],a[152:155]
DR v[76:79],v10 offset:6144
MF a[156:159],v[112:115],v[188:191],a[156:159]
MF a[160:163],v[116:119],v[160:163],a[160:163]
DR v[80:83],v10 offset:8192
MF a[164:167],v[116:119],v[164:167],a[164:167]
BL v24,s[8:11],s21 offen offset:2048 lds
MF a[168:171],v[116:119],v[168:171],a[168:171]
DR v[84:87],v10 offset:10240
MF a[172:175],v[116:119],v[172:175],a[172:175]
MF a[176:179],v[116:119],v[176:179],a[176:179]
DR v[88:91],v10 offset:12288
MF a[180:183],v[116:119],v[180:183],a[180:183]
MF a[184:187],v[116:119],v[184:187],a[184:187]
DR v[92:95],v10 offset:14336
MF a[188:191],v[116:119],v[188:191],a[188:191]
BL v25,s[8:11],s21 offen offset:3072 lds
MF a[192:195],v[120:123],v[160:163],a[192:195]
MF a[196:199],v[120:123],v[164:167],a[196:199]
MF a[200:203],v[120:123],v[168:171],a[200:203]
MF a[204:207],v[120:123],v[172:175],a[204:207]
MF a[208:211],v[120:123],v[176:179],a[208:211]
MF a[212:215],v[120:123],v[180:183],a[212:215]
MF a[216:219],v[120:123],v[184:187],a[216:219]
MF a[220:223],v[120:123],v[188:191],a[220:223]
MF a[224:227],v[124:127],v[160:163],a[224:227]
MF a[228:231],v[124:127],v[164:167],a[228:231]
MF a[232:235],v[124:127],v[168:171],a[232:235]
MF a[236:239],v[124:127],v[172:175],a[236:239]
MF a[240:243],v[124:127],v[176:179],a[240:243]
MF a[244:247],v[124:127],v[180:183],a[244:247]
MF a[248:251],v[124:127],v[184:187],a[248:251]
MF a[252:255],v[124:127],v[188:191],a[252:255]
WT vmcnt(22) lgkmcnt(0)
s_barrier
MF a[0:3],v[64:67],v[128:131],a[0:3]
DR v[96:99],v12 offset:0
MF a[4:7],v[64:67],v[132:135],a[4:7]
MF a[8:11],v[64:67],v[136:139],a[8:11]
DT v[160:161],v14 offset:16384
MF a[12:15],v[64:67],v[140:143],a[12:15]
MF a[16:19],v[64:67],v[144:147],a[16:19]
DT v[162:163],v14 offset:18432
MF a[20:23],v[64:67],v[148:151],a[20:23]
SA m0,s23,98304
s_mov_b32 s22,4194304
BL v26,s[12:15],s22 offen nt lds
MF a[24:27],v[64:67],v[152:155],a[24:27]
DT v[164:165],v15 offset:16384
MF a[28:31],v[64:67],v[156:159],a[28:31]
MF a[32:35],v[68:71],v[128:131],a[32:35]
DT v[166:167],v15 offset:18432
MF a[36:39],v[68:71],v[132:135],a[36:39]
MF a[40:43],v[68:71],v[136:139],a[40:43]
DT v[168:169],v16 offset:16384
MF a[44:47],v[68:71],v[140:143],a[44:47]
BL v27,s[12:15],s22 offen offset:1024 nt lds
MF a[48:51],v[68:71],v[144:147],a[48:51]
DT v[170:171],v16 offset:18432
MF a[52:55],v[68:71],v[148:151],a[52:55]
MF a[56:59],v[68:71],v[152:155],a[56:59]
DT v[172:173],v17 offset:16384
MF a[60:63],v[68:71],v[156:159],a[60:63]
MF a[64:67],v[72:75],v[128:131],a[64:67]
DT v[174:175],v17 offset:18432
MF a[68:71],v[72:75],v[132:135],a[68:71]
BL v28,s[12:15],s22 offen offset:2048 nt lds
MF a[72:75],v[72:75],v[136:139],a[72:75]
DT v[176:177],v18 offset:16384
MF a[76:79],v[72:75],v[140:143],a[76:79]
MF a[80:83],v[72:75],v[144:147],a[80:83]
DT v[178:179],v18 offset:18432
MF a[84:87],v[72:75],v[148:151],a[84:87]
MF a[88:91],v[72:75],v[152:155],a[88:91]
DT v[180:181],v19 offset:16384
MF a[92:95],v[72:75],v[156:159],a[92:95]
BL v29,s[12:15],s22 offen offset:3072 nt lds
MF a[96:99],v[76:79],v[128:131],a[96:99]
DT v[182:183],v19 offset:18432
MF a[100:103],v[76:79],v[132:135],a[100:103]
MF a[104:107],v[76:79],v[136:139],a[104:107]
DT v[184:185],v20 offset:16384
MF a[108:111],v[76:79],v[140:143],a[108:111]
MF a[112:115],v[76:79],v[144:147],a[112:115]
DT v[186:187],v20 offset:18432
MF a[116:119],v[76:79],v[148:151],a[116:119]
SA m0,s23,81920
s_mov_b32 s21,263168
BL v22,s[8:11],s21 offen lds
MF a[120:123],v[76:79],v[152:155],a[120:123]
DT v[188:189],v21 offset:16384
MF a[124:127],v[76:79],v[156:159],a[124:127]
MF a[128:131],v[80:83],v[128:131],a[128:131]
DT v[190:191],v21 offset:18432
MF a[132:135],v[80:83],v[132:135],a[132:135]
MF a[136:139],v[80:83],v[136:139],a[136:139]
DR v[100:103],v12 offset:2048
MF a[140:143],v[80:83],v[140:143],a[140:143]
BL v23,s[8:11],s21 offen offset:1024 lds
MF a[144:147],v[80:83],v[144:147],a[144:147]
DR v[104:107],v12 offset:4096
MF a[148:151],v[80:83],v[148:151],a[148:151]
MF a[152:155],v[80:83],v[152:155],a[152:155]
DR v[108:111],v12 offset:6144
MF a[156:159],v[80:83],v[156:159],a[156:159]
MF a[160:163],v[84:87],v[128:131],a[160:163]
DR v[112:115],v12 offset:8192
MF a[164:167],v[84:87],v[132:135],a[164:167]
BL v24,s[8:11],s21 offen offset:2048 lds
MF a[168:171],v[84:87],v[136:139],a[168:171]
DR v[116:119],v12 offset:10240
MF a[172:175],v[84:87],v[140:143],a[172:175]
MF a[176:179],v[84:87],v[144:147],a[176:179]
DR v[120:123],v12 offset:12288
MF a[180:183],v[84:87],v[148:151],a[180:183]
MF a[184:187],v[84:87],v[152:155],a[184:187]
DR v[124:127],v12 offset:14336
MF a[188:191],v[84:87],v[156:159],a[188:191]
BL v25,s[8:11],s21 offen offset:3072 lds
MF a[192:195],v[88:91],v[128:131],a[192:195]
MF a[196:199],v[88:91],v[132:135],a[196:199]
MF a[200:203],v[88:91],v[136:139],a[200:203]
MF a[204:207],v[88:91],v[140:143],a[204:207]
MF a[208:211],v[88:91],v[144:147],a[208:211]
MF a[212:215],v[88:91],v[148:151],a[212:215]
MF a[216:219],v[88:91],v[152:155],a[216:219]
MF a[220:223],v[88:91],v[156:159],a[220:223]
MF a[224:227],v[92:95],v[128:131],a[224:227]
MF a[228:231],v[92:95],v[132:135],a[228:231]
MF a[232:235],v[92:95],v[136:139],a[232:235]
MF a[236:239],v[92:95],v[140:143],a[236:239]
MF a[240:243],v[92:95],v[144:147],a[240:243]
MF a[244:247],v[92:95],v[148:151],a[244:247]
MF a[248:251],v[92:95],v[152:155],a[248:251]
MF a[252:255],v[92:95],v[156:159],a[252:255]
WT vmcnt(16) lgkmcnt(0)
s_barrier
MF a[0:3],v[96:99],v[160:163],a[0:3]
DR v[64:67],v10 offset:32768
MF a[4:7],v[96:99],v[164:167],a[4:7]
MF a[8:11],v[96:99],v[168:171],a[8:11]
DT v[128:129],v14 offset:32768
MF a[12:15],v[96:99],v[172:175],a[12:15]
MF a[16:19],v[96:99],v[176:179],a[16:19]
DT v[130:131],v14 offset:34816
MF a[20:23],v[96:99],v[180:183],a[20:23]
SA m0,s23,114688
s_mov_b32 s22,4456448
BL v26,s[12:15],s22 offen nt lds
MF a[24:27],v[96:99],v[184:187],a[24:27]
DT v[132:133],v15 offset:32768
MF a[28:31],v[96:99],v[188:191],a[28:31]
MF a[32:35],v[100:103],v[160:163],a[32:35]
DT v[134:135],v15 offset:34816
MF a[36:39],v[100:103],v[164:167],a[36:39]
MF a[40:43],v[100:103],v[168:171],a[40:43]
DT v[136:137],v16 offset:32768
MF a[44:47],v[100:103],v[172:175],a[44:47]
BL v27,s[12:15],s22 offen offset:1024 nt lds
MF a[48:51],v[100:103],v[176:179],a[48:51]
DT v[138:139],v16 offset:34816
MF a[52:55],v[100:103],v[180:183],a[52:55]
MF a[56:59],v[100:103],v[184:187],a[56:59]
DT v[140:141],v17 offset:32768
MF a[60:63],v[100:103],v[188:191],a[60:63]
MF a[64:67],v[104:107],v[160:163],a[64:67]
DT v[142:143],v17 offset:34816
MF a[68:71],v[104:107],v[164:167],a[68:71]
BL v28,s[12:15],s22 offen offset:2048 nt lds
MF a[72:75],v[104:107],v[168:171],a[72:75]
DT v[144:145],v18 offset:32768
MF a[76:79],v[104:107],v[172:175],a[76:79]
MF a[80:83],v[104:107],v[176:179],a[80:83]
DT v[146:147],v18 offset:34816
MF a[84:87],v[104:107],v[180:183],a[84:87]
MF a[88:91],v[104:107],v[184:187],a[88:91]
DT v[148:149],v19 offset:32768
MF a[92:95],v[104:107],v[188:191],a[92:95]
BL v29,s[12:15],s22 offen offset:3072 nt lds
MF a[96:99],v[108:111],v[160:163],a[96:99]
DT v[150:151],v19 offset:34816
MF a[100:103],v[108:111],v[164:167],a[100:103]
MF a[104:107],v[108:111],v[168:171],a[104:107]
DT v[152:153],v20 offset:32768
MF a[108:111],v[108:111],v[172:175],a[108:111]
MF a[112:115],v[108:111],v[176:179],a[112:115]
DT v[154:155],v20 offset:34816
MF a[116:119],v[108:111],v[180:183],a[116:119]
SA m0,s23,0
s_mov_b32 s21,1152
BL v22,s[8:11],s21 offen lds
MF a[120:123],v[108:111],v[184:187],a[120:123]
DT v[156:157],v21 offset:32768
MF a[124:127],v[108:111],v[188:191],a[124:127]
MF a[128:131],v[112:115],v[160:163],a[128:131]
DT v[158:159],v21 offset:34816
MF a[132:135],v[112:115],v[164:167],a[132:135]
MF a[136:139],v[112:115],v[168:171],a[136:139]
DR v[68:71],v10 offset:34816
MF a[140:143],v[112:115],v[172:175],a[140:143]
BL v23,s[8:11],s21 offen offset:1024 lds
MF a[144:147],v[112:115],v[176:179],a[144:147]
DR v[72:75],v10 offset:36864
MF a[148:151],v[112:115],v[180:183],a[148:151]
MF a[152:155],v[112:115],v[184:187],a[152:155]
DR v[76:79],v10 offset:38912
MF a[156:159],v[112:115],v[188:191],a[156:159]
MF a[160:163],v[116:119],v[160:163],a[160:163]
DR v[80:83],v10 offset:40960
MF a[164:167],v[116:119],v[164:167],a[164:167]
BL v24,s[8:11],s21 offen offset:2048 lds
MF a[168:171],v[116:119],v[168:171],a[168:171]
DR v[84:87],v10 offset:43008
MF a[172:175],v[116:119],v[172:175],a[172:175]
MF a[176:179],v[116:119],v[176:179],a[176:179]
DR v[88:91],v10 offset:45056
MF a[180:183],v[116:119],v[180:183],a[180:183]
MF a[184:187],v[116:119],v[184:187],a[184:187]
DR v[92:95],v10 offset:47104
MF a[188:191],v[116:119],v[188:191],a[188:191]
BL v25,s[8:11],s21 offen offset:3072 lds
MF a[192:195],v[120:123],v[160:163],a[192:195]
MF a[196:199],v[120:123],v[164:167],a[196:199]
MF a[200:203],v[120:123],v[168:171],a[200:203]
MF a[204:207],v[120:123],v[172:175],a[204:207]
MF a[208:211],v[120:123],v[176:179],a[208:211]
MF a[212:215],v[120:123],v[180:183],a[212:215]
MF a[216:219],v[120:123],v[184:187],a[216:219]
MF a[220:223],v[120:123],v[188:191],a[220:223]
MF a[224:227],v[124:127],v[160:163],a[224:227]
MF a[228:231],v[124:127],v[164:167],a[228:231]
MF a[232:235],v[124:127],v[168:171],a[232:235]
MF a[236:239],v[124:127],v[172:175],a[236:239]
MF a[240:243],v[124:127],v[176:179],a[240:243]
MF a[244:247],v[124:127],v[180:183],a[244:247]
MF a[248:251],v[124:127],v[184:187],a[248:251]
MF a[252:255],v[124:127],v[188:191],a[252:255]
WT vmcnt(20) lgkmcnt(0)
s_barrier
MF a[0:3],v[64:67],v[128:131],a[0:3]
DR v[96:99],v12 offset:32768
MF a[4:7],v[64:67],v[132:135],a[4:7]
MF a[8:11],v[64:67],v[136:139],a[8:11]
DT v[160:161],v14 offset:49152
MF a[12:15],v[64:67],v[140:143],a[12:15]
MF a[16:19],v[64:67],v[144:147],a[16:19]
DT v[162:163],v14 offset:51200
MF a[20:23],v[64:67],v[148:151],a[20:23]
SA m0,s23,131072
s_mov_b32 s22,4718592
BL v26,s[12:15],s22 offen nt lds
MF a[24:27],v[64:67],v[152:155],a[24:27]
DT v[164:165],v15 offset:49152
MF a[28:31],v[64:67],v[156:159],a[28:31]
MF a[32:35],v[68:71],v[128:131],a[32:35]
DT v[166:167],v15 offset:51200
MF a[36:39],v[68:71],v[132:135],a[36:39]
MF a[40:43],v[68:71],v[136:139],a[40:43]
DT v[168:169],v16 offset:49152
MF a[44:47],v[68:71],v[140:143],a[44:47]
BL v27,s[12:15],s22 offen offset:1024 nt lds
MF a[48:51],v[68:71],v[144:147],a[48:51]
DT v[170:171],v16 offset:51200
MF a[52:55],v[68:71],v[148:151],a[52:55]
MF a[56:59],v[68:71],v[152:155],a[56:59]
DT v[172:173],v17 offset:49152
MF a[60:63],v[68:71],v[156:159],a[60:63]
MF a[64:67],v[72:75],v[128:131],a[64:67]
DT v[174:175],v17 offset:51200
MF a[68:71],v[72:75],v[132:135],a[68:71]
BL v28,s[12:15],s22 offen offset:2048 nt lds
MF a[72:75],v[72:75],v[136:139],a[72:75]
DT v[176:177],v18 offset:49152
MF a[76:79],v[72:75],v[140:143],a[76:79]
MF a[80:83],v[72:75],v[144:147],a[80:83]
DT v[178:179],v18 offset:51200
MF a[84:87],v[72:75],v[148:151],a[84:87]
MF a[88:91],v[72:75],v[152:155],a[88:91]
DT v[180:181],v19 offset:49152
MF a[92:95],v[72:75],v[156:159],a[92:95]
BL v29,s[12:15],s22 offen offset:3072 nt lds
MF a[96:99],v[76:79],v[128:131],a[96:99]
DT v[182:183],v19 offset:51200
MF a[100:103],v[76:79],v[132:135],a[100:103]
MF a[104:107],v[76:79],v[136:139],a[104:107]
DT v[184:185],v20 offset:49152
MF a[108:111],v[76:79],v[140:143],a[108:111]
MF a[112:115],v[76:79],v[144:147],a[112:115]
DT v[186:187],v20 offset:51200
MF a[116:119],v[76:79],v[148:151],a[116:119]
SA m0,s23,16384
s_mov_b32 s21,263296
BL v22,s[8:11],s21 offen lds
MF a[120:123],v[76:79],v[152:155],a[120:123]
DT v[188:189],v21 offset:49152
MF a[124:127],v[76:79],v[156:159],a[124:127]
MF a[128:131],v[80:83],v[128:131],a[128:131]
DT v[190:191],v21 offset:51200
MF a[132:135],v[80:83],v[132:135],a[132:135]
MF a[136:139],v[80:83],v[136:139],a[136:139]
DR v[100:103],v12 offset:34816
MF a[140:143],v[80:83],v[140:143],a[140:143]
BL v23,s[8:11],s21 offen offset:1024 lds
MF a[144:147],v[80:83],v[144:147],a[144:147]
DR v[104:107],v12 offset:36864
MF a[148:151],v[80:83],v[148:151],a[148:151]
MF a[152:155],v[80:83],v[152:155],a[152:155]
DR v[108:111],v12 offset:38912
MF a[156:159],v[80:83],v[156:159],a[156:159]
MF a[160:163],v[84:87],v[128:131],a[160:163]
DR v[112:115],v12 offset:40960
MF a[164:167],v[84:87],v[132:135],a[164:167]
BL v24,s[8:11],s21 offen offset:2048 lds
MF a[168:171],v[84:87],v[136:139],a[168:171]
DR v[116:119],v12 offset:43008
MF a[172:175],v[84:87],v[140:143],a[172:175]
MF a[176:179],v[84:87],v[144:147],a[176:179]
DR v[120:123],v12 offset:45056
MF a[180:183],v[84:87],v[148:151],a[180:183]
MF a[184:187],v[84:87],v[152:155],a[184:187]
DR v[124:127],v12 offset:47104
MF a[188:191],v[84:87],v[156:159],a[188:191]
BL v25,s[8:11],s21 offen offset:3072 lds
MF a[192:195],v[88:91],v[128:131],a[192:195]
MF a[196:199],v[88:91],v[132:135],a[196:199]
MF a[200:203],v[88:91],v[136:139],a[200:203]
MF a[204:207],v[88:91],v[140:143],a[204:207]
MF a[208:211],v[88:91],v[144:147],a[208:211]
MF a[212:215],v[88:91],v[148:151],a[212:215]
MF a[216:219],v[88:91],v[152:155],a[216:219]
MF a[220:223],v[88:91],v[156:159],a[220:223]
MF a[224:227],v[92:95],v[128:131],a[224:227]
MF a[228:231],v[92:95],v[132:135],a[228:231]
MF a[232:235],v[92:95],v[136:139],a[232:235]
MF a[236:239],v[92:95],v[140:143],a[236:239]
MF a[240:243],v[92:95],v[144:147],a[240:243]
MF a[244:247],v[92:95],v[148:151],a[244:247]
MF a[248:251],v[92:95],v[152:155],a[248:251]
MF a[252:255],v[92:95],v[156:159],a[252:255]
WT vmcnt(16) lgkmcnt(0)
s_barrier
MF a[0:3],v[96:99],v[160:163],a[0:3]
DR v[64:67],v11 offset:0
MF a[4:7],v[96:99],v[164:167],a[4:7]
MF a[8:11],v[96:99],v[168:171],a[8:11]
DT v[128:129],v14 offset:0
MF a[12:15],v[96:99],v[172:175],a[12:15]
MF a[16:19],v[96:99],v[176:179],a[16:19]
DT v[130:131],v14 offset:2048
MF a[20:23],v[96:99],v[180:183],a[20:23]
SA m0,s23,147456
s_mov_b32 s22,4980736
BL v26,s[12:15],s22 offen nt lds
MF a[24:27],v[96:99],v[184:187],a[24:27]
DT v[132:133],v15 offset:0
MF a[28:31],v[96:99],v[188:191],a[28:31]
MF a[32:35],v[100:103],v[160:163],a[32:35]
DT v[134:135],v15 offset:2048
MF a[36:39],v[100:103],v[164:167],a[36:39]
MF a[40:43],v[100:103],v[168:171],a[40:43]
DT v[136:137],v16 offset:0
MF a[44:47],v[100:103],v[172:175],a[44:47]
BL v27,s[12:15],s22 offen offset:1024 nt lds
MF a[48:51],v[100:103],v[176:179],a[48:51]
DT v[138:139],v16 offset:2048
MF a[52:55],v[100:103],v[180:183],a[52:55]
MF a[56:59],v[100:103],v[184:187],a[56:59]
DT v[140:141],v17 offset:0
MF a[60:63],v[100:103],v[188:191],a[60:63]
MF a[64:67],v[104:107],v[160:163],a[64:67]
DT v[142:143],v17 offset:2048
MF a[68:71],v[104:107],v[164:167],a[68:71]
BL v28,s[12:15],s22 offen offset:2048 nt lds
MF a[72:75],v[104:107],v[168:171],a[72:75]
DT v[144:145],v18 offset:0
MF a[76:79],v[104:107],v[172:175],a[76:79]
MF a[80:83],v[104:107],v[176:179],a[80:83]
DT v[146:147],v18 offset:2048
MF a[84:87],v[104:107],v[180:183],a[84:87]
MF a[88:91],v[104:107],v[184:187],a[88:91]
DT v[148:149],v19 offset:0
MF a[92:95],v[104:107],v[188:191],a[92:95]
BL v29,s[12:15],s22 offen offset:3072 nt lds
MF a[96:99],v[108:111],v[160:163],a[96:99]
DT v[150:151],v19 offset:2048
MF a[100:103],v[108:111],v[164:167],a[100:103]
MF a[104:107],v[108:111],v[168:171],a[104:107]
DT v[152:153],v20 offset:0
MF a[108:111],v[108:111],v[172:175],a[108:111]
MF a[112:115],v[108:111],v[176:179],a[112:115]
DT v[154:155],v20 offset:2048
MF a[116:119],v[108:111],v[180:183],a[116:119]
SA m0,s23,32768
s_mov_b32 s21,1280
BL v22,s[8:11],s21 offen lds
MF a[120:123],v[108:111],v[184:187],a[120:123]
DT v[156:157],v21 offset:0
MF a[124:127],v[108:111],v[188:191],a[124:127]
MF a[128:131],v[112:115],v[160:163],a[128:131]
DT v[158:159],v21 offset:2048
MF a[132:135],v[112:115],v[164:167],a[132:135]
MF a[136:139],v[112:115],v[168:171],a[136:139]
DR v[68:71],v11 offset:2048
MF a[140:143],v[112:115],v[172:175],a[140:143]
BL v23,s[8:11],s21 offen offset:1024 lds
MF a[144:147],v[112:115],v[176:179],a[144:147]
DR v[72:75],v11 offset:4096
MF a[148:151],v[112:115],v[180:183],a[148:151]
MF a[152:155],v[112:115],v[184:187],a[152:155]
DR v[76:79],v11 offset:6144
MF a[156:159],v[112:115],v[188:191],a[156:159]
MF a[160:163],v[116:119],v[160:163],a[160:163]
DR v[80:83],v11 offset:8192
MF a[164:167],v[116:119],v[164:167],a[164:167]
BL v24,s[8:11],s21 offen offset:2048 lds
MF a[168:171],v[116:119],v[168:171],a[168:171]
DR v[84:87],v11 offset:10240
MF a[172:175],v[116:119],v[172:175],a[172:175]
MF a[176:179],v[116:119],v[176:179],a[176:179]
DR v[88:91],v11 offset:12288
MF a[180:183],v[116:119],v[180:183],a[180:183]
MF a[184:187],v[116:119],v[184:187],a[184:187]
DR v[92:95],v11 offset:14336
MF a[188:191],v[116:119],v[188:191],a[188:191]
BL v25,s[8:11],s21 offen offset:3072 lds
MF a[192:195],v[120:123],v[160:163],a[192:195]
MF a[196:199],v[120:123],v[164:167],a[196:199]
MF a[200:203],v[120:123],v[168:171],a[200:203]
MF a[204:207],v[120:123],v[172:175],a[204:207]
s_cmp_lg_u32 s20,0
s_cbranch_scc1 k1_kernel_v_nosig
s_lshr_b32 s30,s2,4
s_lshl_b32 s30,s30,2
v_mov_b32 v4,1
v_mov_b32 v5,s30
s_mov_b64 exec,1
buffer_atomic_add v4,v5,s[68:71],0 offen sc1
s_mov_b64 exec,-1
k1_kernel_v_nosig:
MF a[208:211],v[120:123],v[176:179],a[208:211]
MF a[212:215],v[120:123],v[180:183],a[212:215]
MF a[216:219],v[120:123],v[184:187],a[216:219]
MF a[220:223],v[120:123],v[188:191],a[220:223]
MF a[224:227],v[124:127],v[160:163],a[224:227]
MF a[228:231],v[124:127],v[164:167],a[228:231]
MF a[232:235],v[124:127],v[168:171],a[232:235]
MF a[236:239],v[124:127],v[172:175],a[236:239]
MF a[240:243],v[124:127],v[176:179],a[240:243]
MF a[244:247],v[124:127],v[180:183],a[244:247]
MF a[248:251],v[124:127],v[184:187],a[248:251]
MF a[252:255],v[124:127],v[188:191],a[252:255]
WT vmcnt(20) lgkmcnt(0)
s_barrier
MF a[0:3],v[64:67],v[128:131],a[0:3]
DR v[96:99],v13 offset:0
MF a[4:7],v[64:67],v[132:135],a[4:7]
MF a[8:11],v[64:67],v[136:139],a[8:11]
DT v[160:161],v14 offset:16384
MF a[12:15],v[64:67],v[140:143],a[12:15]
MF a[16:19],v[64:67],v[144:147],a[16:19]
DT v[162:163],v14 offset:18432
MF a[20:23],v[64:67],v[148:151],a[20:23]
SA m0,s23,98304
s_mov_b32 s22,5242880
BL v26,s[12:15],s22 offen nt lds
MF a[24:27],v[64:67],v[152:155],a[24:27]
DT v[164:165],v15 offset:16384
MF a[28:31],v[64:67],v[156:159],a[28:31]
MF a[32:35],v[68:71],v[128:131],a[32:35]
DT v[166:167],v15 offset:18432
MF a[36:39],v[68:71],v[132:135],a[36:39]
MF a[40:43],v[68:71],v[136:139],a[40:43]
DT v[168:169],v16 offset:16384
MF a[44:47],v[68:71],v[140:143],a[44:47]
BL v27,s[12:15],s22 offen offset:1024 nt lds
MF a[48:51],v[68:71],v[144:147],a[48:51]
DT v[170:171],v16 offset:18432
MF a[52:55],v[68:71],v[148:151],a[52:55]
MF a[56:59],v[68:71],v[152:155],a[56:59]
DT v[172:173],v17 offset:16384
MF a[60:63],v[68:71],v[156:159],a[60:63]
MF a[64:67],v[72:75],v[128:131],a[64:67]
DT v[174:175],v17 offset:18432
MF a[68:71],v[72:75],v[132:135],a[68:71]
BL v28,s[12:15],s22 offen offset:2048 nt lds
MF a[72:75],v[72:75],v[136:139],a[72:75]
DT v[176:177],v18 offset:16384
MF a[76:79],v[72:75],v[140:143],a[76:79]
MF a[80:83],v[72:75],v[144:147],a[80:83]
DT v[178:179],v18 offset:18432
MF a[84:87],v[72:75],v[148:151],a[84:87]
MF a[88:91],v[72:75],v[152:155],a[88:91]
DT v[180:181],v19 offset:16384
MF a[92:95],v[72:75],v[156:159],a[92:95]
BL v29,s[12:15],s22 offen offset:3072 nt lds
MF a[96:99],v[76:79],v[128:131],a[96:99]
DT v[182:183],v19 offset:18432
MF a[100:103],v[76:79],v[132:135],a[100:103]
MF a[104:107],v[76:79],v[136:139],a[104:107]
DT v[184:185],v20 offset:16384
MF a[108:111],v[76:79],v[140:143],a[108:111]
MF a[112:115],v[76:79],v[144:147],a[112:115]
DT v[186:187],v20 offset:18432
MF a[116:119],v[76:79],v[148:151],a[116:119]
SA m0,s23,49152
s_mov_b32 s21,263424
BL v22,s[8:11],s21 offen lds
MF a[120:123],v[76:79],v[152:155],a[120:123]
DT v[188:189],v21 offset:16384
MF a[124:127],v[76:79],v[156:159],a[124:127]
MF a[128:131],v[80:83],v[128:131],a[128:131]
DT v[190:191],v21 offset:18432
MF a[132:135],v[80:83],v[132:135],a[132:135]
MF a[136:139],v[80:83],v[136:139],a[136:139]
DR v[100:103],v13 offset:2048
MF a[140:143],v[80:83],v[140:143],a[140:143]
BL v23,s[8:11],s21 offen offset:1024 lds
MF a[144:147],v[80:83],v[144:147],a[144:147]
DR v[104:107],v13 offset:4096
MF a[148:151],v[80:83],v[148:151],a[148:151]
MF a[152:155],v[80:83],v[152:155],a[152:155]
DR v[108:111],v13 offset:6144
MF a[156:159],v[80:83],v[156:159],a[156:159]
MF a[160:163],v[84:87],v[128:131],a[160:163]
DR v[112:115],v13 offset:8192
MF a[164:167],v[84:87],v[132:135],a[164:167]
BL v24,s[8:11],s21 offen offset:2048 lds
MF a[168:171],v[84:87],v[136:139],a[168:171]
DR v[116:119],v13 offset:10240
MF a[172:175],v[84:87],v[140:143],a[172:175]
MF a[176:179],v[84:87],v[144:147],a[176:179]
DR v[120:123],v13 offset:12288
MF a[180:183],v[84:87],v[148:151],a[180:183]
MF a[184:187],v[84:87],v[152:155],a[184:187]
DR v[124:127],v13 offset:14336
MF a[188:191],v[84:87],v[156:159],a[188:191]
BL v25,s[8:11],s21 offen offset:3072 lds
MF a[192:195],v[88:91],v[128:131],a[192:195]
MF a[196:199],v[88:91],v[132:135],a[196:199]
MF a[200:203],v[88:91],v[136:139],a[200:203]
MF a[204:207],v[88:91],v[140:143],a[204:207]
MF a[208:211],v[88:91],v[144:147],a[208:211]
MF a[212:215],v[88:91],v[148:151],a[212:215]
MF a[216:219],v[88:91],v[152:155],a[216:219]
MF a[220:223],v[88:91],v[156:159],a[220:223]
MF a[224:227],v[92:95],v[128:131],a[224:227]
MF a[228:231],v[92:95],v[132:135],a[228:231]
MF a[232:235],v[92:95],v[136:139],a[232:235]
MF a[236:239],v[92:95],v[140:143],a[236:239]
MF a[240:243],v[92:95],v[144:147],a[240:243]
MF a[244:247],v[92:95],v[148:151],a[244:247]
MF a[248:251],v[92:95],v[152:155],a[248:251]
MF a[252:255],v[92:95],v[156:159],a[252:255]
WT vmcnt(16) lgkmcnt(0)
s_barrier
MF a[0:3],v[96:99],v[160:163],a[0:3]
DR v[64:67],v10 offset:0
MF a[4:7],v[96:99],v[164:167],a[4:7]
MF a[8:11],v[96:99],v[168:171],a[8:11]
DT v[128:129],v14 offset:32768
MF a[12:15],v[96:99],v[172:175],a[12:15]
MF a[16:19],v[96:99],v[176:179],a[16:19]
DT v[130:131],v14 offset:34816
MF a[20:23],v[96:99],v[180:183],a[20:23]
SA m0,s23,114688
s_mov_b32 s22,5505024
BL v26,s[12:15],s22 offen nt lds
MF a[24:27],v[96:99],v[184:187],a[24:27]
DT v[132:133],v15 offset:32768
MF a[28:31],v[96:99],v[188:191],a[28:31]
MF a[32:35],v[100:103],v[160:163],a[32:35]
DT v[134:135],v15 offset:34816
MF a[36:39],v[100:103],v[164:167],a[36:39]
MF a[40:43],v[100:103],v[168:171],a[40:43]
DT v[136:137],v16 offset:32768
MF a[44:47],v[100:103],v[172:175],a[44:47]
BL v27,s[12:15],s22 offen offset:1024 nt lds
MF a[48:51],v[100:103],v[176:179],a[48:51]
DT v[138:139],v16 offset:34816
MF a[52:55],v[100:103],v[180:183],a[52:55]
MF a[56:59],v[100:103],v[184:187],a[56:59]
DT v[140:141],v17 offset:32768
MF a[60:63],v[100:103],v[188:191],a[60:63]
MF a[64:67],v[104:107],v[160:163],a[64:67]
DT v[142:143],v17 offset:34816
MF a[68:71],v[104:107],v[164:167],a[68:71]
BL v28,s[12:15],s22 offen offset:2048 nt lds
MF a[72:75],v[104:107],v[168:171],a[72:75]
DT v[144:145],v18 offset:32768
MF a[76:79],v[104:107],v[172:175],a[76:79]
MF a[80:83],v[104:107],v[176:179],a[80:83]
DT v[146:147],v18 offset:34816
MF a[84:87],v[104:107],v[180:183],a[84:87]
MF a[88:91],v[104:107],v[184:187],a[88:91]
DT v[148:149],v19 offset:32768
MF a[92:95],v[104:107],v[188:191],a[92:95]
BL v29,s[12:15],s22 offen offset:3072 nt lds
MF a[96:99],v[108:111],v[160:163],a[96:99]
DT v[150:151],v19 offset:34816
MF a[100:103],v[108:111],v[164:167],a[100:103]
MF a[104:107],v[108:111],v[168:171],a[104:107]
DT v[152:153],v20 offset:32768
MF a[108:111],v[108:111],v[172:175],a[108:111]
MF a[112:115],v[108:111],v[176:179],a[112:115]
DT v[154:155],v20 offset:34816
MF a[116:119],v[108:111],v[180:183],a[116:119]
SA m0,s23,65536
s_mov_b32 s21,1408
BL v22,s[8:11],s21 offen lds
MF a[120:123],v[108:111],v[184:187],a[120:123]
DT v[156:157],v21 offset:32768
MF a[124:127],v[108:111],v[188:191],a[124:127]
MF a[128:131],v[112:115],v[160:163],a[128:131]
DT v[158:159],v21 offset:34816
MF a[132:135],v[112:115],v[164:167],a[132:135]
MF a[136:139],v[112:115],v[168:171],a[136:139]
DR v[68:71],v10 offset:2048
MF a[140:143],v[112:115],v[172:175],a[140:143]
BL v23,s[8:11],s21 offen offset:1024 lds
MF a[144:147],v[112:115],v[176:179],a[144:147]
DR v[72:75],v10 offset:4096
MF a[148:151],v[112:115],v[180:183],a[148:151]
MF a[152:155],v[112:115],v[184:187],a[152:155]
DR v[76:79],v10 offset:6144
MF a[156:159],v[112:115],v[188:191],a[156:159]
MF a[160:163],v[116:119],v[160:163],a[160:163]
DR v[80:83],v10 offset:8192
MF a[164:167],v[116:119],v[164:167],a[164:167]
BL v24,s[8:11],s21 offen offset:2048 lds
MF a[168:171],v[116:119],v[168:171],a[168:171]
DR v[84:87],v10 offset:10240
MF a[172:175],v[116:119],v[172:175],a[172:175]
MF a[176:179],v[116:119],v[176:179],a[176:179]
DR v[88:91],v10 offset:12288
MF a[180:183],v[116:119],v[180:183],a[180:183]
MF a[184:187],v[116:119],v[184:187],a[184:187]
DR v[92:95],v10 offset:14336
MF a[188:191],v[116:119],v[188:191],a[188:191]
BL v25,s[8:11],s21 offen offset:3072 lds
MF a[192:195],v[120:123],v[160:163],a[192:195]
MF a[196:199],v[120:123],v[164:167],a[196:199]
MF a[200:203],v[120:123],v[168:171],a[200:203]
MF a[204:207],v[120:123],v[172:175],a[204:207]
MF a[208:211],v[120:123],v[176:179],a[208:211]
MF a[212:215],v[120:123],v[180:183],a[212:215]
MF a[216:219],v[120:123],v[184:187],a[216:219]
MF a[220:223],v[120:123],v[188:191],a[220:223]
MF a[224:227],v[124:127],v[160:163],a[224:227]
MF a[228:231],v[124:127],v[164:167],a[228:231]
MF a[232:235],v[124:127],v[168:171],a[232:235]
MF a[236:239],v[124:127],v[172:175],a[236:239]
MF a[240:243],v[124:127],v[176:179],a[240:243]
MF a[244:247],v[124:127],v[180:183],a[244:247]
MF a[248:251],v[124:127],v[184:187],a[248:251]
MF a[252:255],v[124:127],v[188:191],a[252:255]
WT vmcnt(20) lgkmcnt(0)
s_barrier
MF a[0:3],v[64:67],v[128:131],a[0:3]
DR v[96:99],v12 offset:0
MF a[4:7],v[64:67],v[132:135],a[4:7]
MF a[8:11],v[64:67],v[136:139],a[8:11]
DT v[160:161],v14 offset:49152
MF a[12:15],v[64:67],v[140:143],a[12:15]
MF a[16:19],v[64:67],v[144:147],a[16:19]
DT v[162:163],v14 offset:51200
MF a[20:23],v[64:67],v[148:151],a[20:23]
SA m0,s23,131072
s_mov_b32 s22,5767168
BL v26,s[12:15],s22 offen nt lds
MF a[24:27],v[64:67],v[152:155],a[24:27]
DT v[164:165],v15 offset:49152
MF a[28:31],v[64:67],v[156:159],a[28:31]
MF a[32:35],v[68:71],v[128:131],a[32:35]
DT v[166:167],v15 offset:51200
MF a[36:39],v[68:71],v[132:135],a[36:39]
MF a[40:43],v[68:71],v[136:139],a[40:43]
DT v[168:169],v16 offset:49152
MF a[44:47],v[68:71],v[140:143],a[44:47]
BL v27,s[12:15],s22 offen offset:1024 nt lds
MF a[48:51],v[68:71],v[144:147],a[48:51]
DT v[170:171],v16 offset:51200
MF a[52:55],v[68:71],v[148:151],a[52:55]
MF a[56:59],v[68:71],v[152:155],a[56:59]
DT v[172:173],v17 offset:49152
MF a[60:63],v[68:71],v[156:159],a[60:63]
MF a[64:67],v[72:75],v[128:131],a[64:67]
DT v[174:175],v17 offset:51200
MF a[68:71],v[72:75],v[132:135],a[68:71]
BL v28,s[12:15],s22 offen offset:2048 nt lds
MF a[72:75],v[72:75],v[136:139],a[72:75]
DT v[176:177],v18 offset:49152
MF a[76:79],v[72:75],v[140:143],a[76:79]
MF a[80:83],v[72:75],v[144:147],a[80:83]
DT v[178:179],v18 offset:51200
MF a[84:87],v[72:75],v[148:151],a[84:87]
MF a[88:91],v[72:75],v[152:155],a[88:91]
DT v[180:181],v19 offset:49152
MF a[92:95],v[72:75],v[156:159],a[92:95]
BL v29,s[12:15],s22 offen offset:3072 nt lds
MF a[96:99],v[76:79],v[128:131],a[96:99]
DT v[182:183],v19 offset:51200
MF a[100:103],v[76:79],v[132:135],a[100:103]
MF a[104:107],v[76:79],v[136:139],a[104:107]
DT v[184:185],v20 offset:49152
MF a[108:111],v[76:79],v[140:143],a[108:111]
MF a[112:115],v[76:79],v[144:147],a[112:115]
DT v[186:187],v20 offset:51200
MF a[116:119],v[76:79],v[148:151],a[116:119]
SA m0,s23,81920
s_mov_b32 s21,263552
BL v22,s[8:11],s21 offen lds
MF a[120:123],v[76:79],v[152:155],a[120:123]
DT v[188:189],v21 offset:49152
MF a[124:127],v[76:79],v[156:159],a[124:127]
MF a[128:131],v[80:83],v[128:131],a[128:131]
DT v[190:191],v21 offset:51200
MF a[132:135],v[80:83],v[132:135],a[132:135]
MF a[136:139],v[80:83],v[136:139],a[136:139]
DR v[100:103],v12 offset:2048
MF a[140:143],v[80:83],v[140:143],a[140:143]
BL v23,s[8:11],s21 offen offset:1024 lds
MF a[144:147],v[80:83],v[144:147],a[144:147]
DR v[104:107],v12 offset:4096
MF a[148:151],v[80:83],v[148:151],a[148:151]
MF a[152:155],v[80:83],v[152:155],a[152:155]
DR v[108:111],v12 offset:6144
MF a[156:159],v[80:83],v[156:159],a[156:159]
MF a[160:163],v[84:87],v[128:131],a[160:163]
DR v[112:115],v12 offset:8192
MF a[164:167],v[84:87],v[132:135],a[164:167]
BL v24,s[8:11],s21 offen offset:2048 lds
MF a[168:171],v[84:87],v[136:139],a[168:171]
DR v[116:119],v12 offset:10240
MF a[172:175],v[84:87],v[140:143],a[172:175]
MF a[176:179],v[84:87],v[144:147],a[176:179]
DR v[120:123],v12 offset:12288
MF a[180:183],v[84:87],v[148:151],a[180:183]
MF a[184:187],v[84:87],v[152:155],a[184:187]
DR v[124:127],v12 offset:14336
MF a[188:191],v[84:87],v[156:159],a[188:191]
BL v25,s[8:11],s21 offen offset:3072 lds
MF a[192:195],v[88:91],v[128:131],a[192:195]
MF a[196:199],v[88:91],v[132:135],a[196:199]
MF a[200:203],v[88:91],v[136:139],a[200:203]
MF a[204:207],v[88:91],v[140:143],a[204:207]
MF a[208:211],v[88:91],v[144:147],a[208:211]
MF a[212:215],v[88:91],v[148:151],a[212:215]
s_lshl_b32 s30,s51,2
v_mov_b32 v5,s30
buffer_load_dword v6,v5,s[68:71],0 offen sc1
buffer_load_dword v7,v34,s[40:43],0 offen
MF a[216:219],v[88:91],v[152:155],a[216:219]
MF a[220:223],v[88:91],v[156:159],a[220:223]
MF a[224:227],v[92:95],v[128:131],a[224:227]
MF a[228:231],v[92:95],v[132:135],a[228:231]
MF a[232:235],v[92:95],v[136:139],a[232:235]
MF a[236:239],v[92:95],v[140:143],a[236:239]
MF a[240:243],v[92:95],v[144:147],a[240:243]
MF a[244:247],v[92:95],v[148:151],a[244:247]
MF a[248:251],v[92:95],v[152:155],a[248:251]
MF a[252:255],v[92:95],v[156:159],a[252:255]
WT vmcnt(18) lgkmcnt(0)
s_barrier
MF a[0:3],v[96:99],v[160:163],a[0:3]
DR v[64:67],v10 offset:32768
MF a[4:7],v[96:99],v[164:167],a[4:7]
MF a[8:11],v[96:99],v[168:171],a[8:11]
DT v[128:129],v14 offset:0
MF a[12:15],v[96:99],v[172:175],a[12:15]
MF a[16:19],v[96:99],v[176:179],a[16:19]
DT v[130:131],v14 offset:2048
MF a[20:23],v[96:99],v[180:183],a[20:23]
SA m0,s23,147456
s_mov_b32 s22,6029312
BL v26,s[12:15],s22 offen nt lds
MF a[24:27],v[96:99],v[184:187],a[24:27]
DT v[132:133],v15 offset:0
MF a[28:31],v[96:99],v[188:191],a[28:31]
MF a[32:35],v[100:103],v[160:163],a[32:35]
DT v[134:135],v15 offset:2048
MF a[36:39],v[100:103],v[164:167],a[36:39]
MF a[40:43],v[100:103],v[168:171],a[40:43]
DT v[136:137],v16 offset:0
MF a[44:47],v[100:103],v[172:175],a[44:47]
BL v27,s[12:15],s22 offen offset:1024 nt lds
MF a[48:51],v[100:103],v[176:179],a[48:51]
DT v[138:139],v16 offset:2048
MF a[52:55],v[100:103],v[180:183],a[52:55]
MF a[56:59],v[100:103],v[184:187],a[56:59]
DT v[140:141],v17 offset:0
MF a[60:63],v[100:103],v[188:191],a[60:63]
MF a[64:67],v[104:107],v[160:163],a[64:67]
DT v[142:143],v17 offset:2048
MF a[68:71],v[104:107],v[164:167],a[68:71]
BL v28,s[12:15],s22 offen offset:2048 nt lds
MF a[72:75],v[104:107],v[168:171],a[72:75]
DT v[144:145],v18 offset:0
MF a[76:79],v[104:107],v[172:175],a[76:79]
MF a[80:83],v[104:107],v[176:179],a[80:83]
DT v[146:147],v18 offset:2048
MF a[84:87],v[104:107],v[180:183],a[84:87]
MF a[88:91],v[104:107],v[184:187],a[88:91]
DT v[148:149],v19 offset:0
MF a[92:95],v[104:107],v[188:191],a[92:95]
BL v29,s[12:15],s22 offen offset:3072 nt lds
MF a[96:99],v[108:111],v[160:163],a[96:99]
DT v[150:151],v19 offset:2048
MF a[100:103],v[108:111],v[164:167],a[100:103]
MF a[104:107],v[108:111],v[168:171],a[104:107]
DT v[152:153],v20 offset:0
MF a[108:111],v[108:111],v[172:175],a[108:111]
MF a[112:115],v[108:111],v[176:179],a[112:115]
DT v[154:155],v20 offset:2048
MF a[116:119],v[108:111],v[180:183],a[116:119]
SA m0,s23,0
s_mov_b32 s21,1536
BL v22,s[8:11],s21 offen lds
MF a[120:123],v[108:111],v[184:187],a[120:123]
DT v[156:157],v21 offset:0
MF a[124:127],v[108:111],v[188:191],a[124:127]
MF a[128:131],v[112:115],v[160:163],a[128:131]
DT v[158:159],v21 offset:2048
MF a[132:135],v[112:115],v[164:167],a[132:135]
MF a[136:139],v[112:115],v[168:171],a[136:139]
DR v[68:71],v10 offset:34816
MF a[140:143],v[112:115],v[172:175],a[140:143]
BL v23,s[8:11],s21 offen offset:1024 lds
MF a[144:147],v[112:115],v[176:179],a[144:147]
DR v[72:75],v10 offset:36864
MF a[148:151],v[112:115],v[180:183],a[148:151]
MF a[152:155],v[112:115],v[184:187],a[152:155]
DR v[76:79],v10 offset:38912
MF a[156:159],v[112:115],v[188:191],a[156:159]
MF a[160:163],v[116:119],v[160:163],a[160:163]
DR v[80:83],v10 offset:40960
MF a[164:167],v[116:119],v[164:167],a[164:167]
BL v24,s[8:11],s21 offen offset:2048 lds
MF a[168:171],v[116:119],v[168:171],a[168:171]
DR v[84:87],v10 offset:43008
MF a[172:175],v[116:119],v[172:175],a[172:175]
MF a[176:179],v[116:119],v[176:179],a[176:179]
DR v[88:91],v10 offset:45056
MF a[180:183],v[116:119],v[180:183],a[180:183]
MF a[184:187],v[116:119],v[184:187],a[184:187]
DR v[92:95],v10 offset:47104
MF a[188:191],v[116:119],v[188:191],a[188:191]
BL v25,s[8:11],s21 offen offset:3072 lds
MF a[192:195],v[120:123],v[160:163],a[192:195]
MF a[196:199],v[120:123],v[164:167],a[196:199]
MF a[200:203],v[120:123],v[168:171],a[200:203]
MF a[204:207],v[120:123],v[172:175],a[204:207]
MF a[208:211],v[120:123],v[176:179],a[208:211]
MF a[212:215],v[120:123],v[180:183],a[212:215]
MF a[216:219],v[120:123],v[184:187],a[216:219]
MF a[220:223],v[120:123],v[188:191],a[220:223]
MF a[224:227],v[124:127],v[160:163],a[224:227]
MF a[228:231],v[124:127],v[164:167],a[228:231]
MF a[232:235],v[124:127],v[168:171],a[232:235]
MF a[236:239],v[124:127],v[172:175],a[236:239]
MF a[240:243],v[124:127],v[176:179],a[240:243]
MF a[244:247],v[124:127],v[180:183],a[244:247]
MF a[248:251],v[124:127],v[184:187],a[248:251]
MF a[252:255],v[124:127],v[188:191],a[252:255]
WT vmcnt(22) lgkmcnt(0)
s_barrier
MF a[0:3],v[64:67],v[128:131],a[0:3]
DR v[96:99],v12 offset:32768
MF a[4:7],v[64:67],v[132:135],a[4:7]
MF a[8:11],v[64:67],v[136:139],a[8:11]
DT v[160:161],v14 offset:16384
MF a[12:15],v[64:67],v[140:143],a[12:15]
MF a[16:19],v[64:67],v[144:147],a[16:19]
DT v[162:163],v14 offset:18432
MF a[20:23],v[64:67],v[148:151],a[20:23]
SA m0,s23,98304
s_mov_b32 s22,6291456
BL v26,s[12:15],s22 offen nt lds
MF a[24:27],v[64:67],v[152:155],a[24:27]
DT v[164:165],v15 offset:16384
MF a[28:31],v[64:67],v[156:159],a[28:31]
MF a[32:35],v[68:71],v[128:131],a[32:35]
DT v[166:167],v15 offset:18432
MF a[36:39],v[68:71],v[132:135],a[36:39]
MF a[40:43],v[68:71],v[136:139],a[40:43]
DT v[168:169],v16 offset:16384
MF a[44:47],v[68:71],v[140:143],a[44:47]
BL v27,s[12:15],s22 offen offset:1024 nt lds
MF a[48:51],v[68:71],v[144:147],a[48:51]
DT v[170:171],v16 offset:18432
MF a[52:55],v[68:71],v[148:151],a[52:55]
MF a[56:59],v[68:71],v[152:155],a[56:59]
DT v[172:173],v17 offset:16384
MF a[60:63],v[68:71],v[156:159],a[60:63]
MF a[64:67],v[72:75],v[128:131],a[64:67]
DT v[174:175],v17 offset:18432
MF a[68:71],v[72:75],v[132:135],a[68:71]
BL v28,s[12:15],s22 offen offset:2048 nt lds
MF a[72:75],v[72:75],v[136:139],a[72:75]
DT v[176:177],v18 offset:16384
MF a[76:79],v[72:75],v[140:143],a[76:79]
MF a[80:83],v[72:75],v[144:147],a[80:83]
DT v[178:179],v18 offset:18432
MF a[84:87],v[72:75],v[148:151],a[84:87]
MF a[88:91],v[72:75],v[152:155],a[88:91]
DT v[180:181],v19 offset:16384
MF a[92:95],v[72:75],v[156:159],a[92:95]
BL v29,s[12:15],s22 offen offset:3072 nt lds
MF a[96:99],v[76:79],v[128:131],a[96:99]
DT v[182:183],v19 offset:18432
MF a[100:103],v[76:79],v[132:135],a[100:103]
MF a[104:107],v[76:79],v[136:139],a[104:107]
DT v[184:185],v20 offset:16384
MF a[108:111],v[76:79],v[140:143],a[108:111]
MF a[112:115],v[76:79],v[144:147],a[112:115]
DT v[186:187],v20 offset:18432
MF a[116:119],v[76:79],v[148:151],a[116:119]
SA m0,s23,16384
s_mov_b32 s21,263680
BL v22,s[8:11],s21 offen lds
MF a[120:123],v[76:79],v[152:155],a[120:123]
DT v[188:189],v21 offset:16384
MF a[124:127],v[76:79],v[156:159],a[124:127]
MF a[128:131],v[80:83],v[128:131],a[128:131]
DT v[190:191],v21 offset:18432
MF a[132:135],v[80:83],v[132:135],a[132:135]
MF a[136:139],v[80:83],v[136:139],a[136:139]
DR v[100:103],v12 offset:34816
MF a[140:143],v[80:83],v[140:143],a[140:143]
BL v23,s[8:11],s21 offen offset:1024 lds
MF a[144:147],v[80:83],v[144:147],a[144:147]
DR v[104:107],v12 offset:36864
MF a[148:151],v[80:83],v[148:151],a[148:151]
MF a[152:155],v[80:83],v[152:155],a[152:155]
DR v[108:111],v12 offset:38912
MF a[156:159],v[80:83],v[156:159],a[156:159]
MF a[160:163],v[84:87],v[128:131],a[160:163]
DR v[112:115],v12 offset:40960
MF a[164:167],v[84:87],v[132:135],a[164:167]
BL v24,s[8:11],s21 offen offset:2048 lds
MF a[168:171],v[84:87],v[136:139],a[168:171]
DR v[116:119],v12 offset:43008
MF a[172:175],v[84:87],v[140:143],a[172:175]
MF a[176:179],v[84:87],v[144:147],a[176:179]
DR v[120:123],v12 offset:45056
MF a[180:183],v[84:87],v[148:151],a[180:183]
MF a[184:187],v[84:87],v[152:155],a[184:187]
DR v[124:127],v12 offset:47104
MF a[188:191],v[84:87],v[156:159],a[188:191]
BL v25,s[8:11],s21 offen offset:3072 lds
MF a[192:195],v[88:91],v[128:131],a[192:195]
MF a[196:199],v[88:91],v[132:135],a[196:199]
MF a[200:203],v[88:91],v[136:139],a[200:203]
MF a[204:207],v[88:91],v[140:143],a[204:207]
MF a[208:211],v[88:91],v[144:147],a[208:211]
MF a[212:215],v[88:91],v[148:151],a[212:215]
MF a[216:219],v[88:91],v[152:155],a[216:219]
MF a[220:223],v[88:91],v[156:159],a[220:223]
MF a[224:227],v[92:95],v[128:131],a[224:227]
MF a[228:231],v[92:95],v[132:135],a[228:231]
MF a[232:235],v[92:95],v[136:139],a[232:235]
MF a[236:239],v[92:95],v[140:143],a[236:239]
MF a[240:243],v[92:95],v[144:147],a[240:243]
MF a[244:247],v[92:95],v[148:151],a[244:247]
MF a[248:251],v[92:95],v[152:155],a[248:251]
MF a[252:255],v[92:95],v[156:159],a[252:255]
WT vmcnt(18) lgkmcnt(0)
s_barrier
MF a[0:3],v[96:99],v[160:163],a[0:3]
DR v[64:67],v11 offset:0
MF a[4:7],v[96:99],v[164:167],a[4:7]
MF a[8:11],v[96:99],v[168:171],a[8:11]
DT v[128:129],v14 offset:32768
MF a[12:15],v[96:99],v[172:175],a[12:15]
MF a[16:19],v[96:99],v[176:179],a[16:19]
DT v[130:131],v14 offset:34816
MF a[20:23],v[96:99],v[180:183],a[20:23]
SA m0,s23,114688
s_mov_b32 s22,6553600
BL v26,s[12:15],s22 offen nt lds
MF a[24:27],v[96:99],v[184:187],a[24:27]
DT v[132:133],v15 offset:32768
MF a[28:31],v[96:99],v[188:191],a[28:31]
MF a[32:35],v[100:103],v[160:163],a[32:35]
DT v[134:135],v15 offset:34816
MF a[36:39],v[100:103],v[164:167],a[36:39]
MF a[40:43],v[100:103],v[168:171],a[40:43]
DT v[136:137],v16 offset:32768
MF a[44:47],v[100:103],v[172:175],a[44:47]
BL v27,s[12:15],s22 offen offset:1024 nt lds
MF a[48:51],v[100:103],v[176:179],a[48:51]
DT v[138:139],v16 offset:34816
MF a[52:55],v[100:103],v[180:183],a[52:55]
MF a[56:59],v[100:103],v[184:187],a[56:59]
DT v[140:141],v17 offset:32768
MF a[60:63],v[100:103],v[188:191],a[60:63]
MF a[64:67],v[104:107],v[160:163],a[64:67]
DT v[142:143],v17 offset:34816
MF a[68:71],v[104:107],v[164:167],a[68:71]
BL v28,s[12:15],s22 offen offset:2048 nt lds
MF a[72:75],v[104:107],v[168:171],a[72:75]
DT v[144:145],v18 offset:32768
MF a[76:79],v[104:107],v[172:175],a[76:79]
MF a[80:83],v[104:107],v[176:179],a[80:83]
DT v[146:147],v18 offset:34816
MF a[84:87],v[104:107],v[180:183],a[84:87]
MF a[88:91],v[104:107],v[184:187],a[88:91]
DT v[148:149],v19 offset:32768
MF a[92:95],v[104:107],v[188:191],a[92:95]
BL v29,s[12:15],s22 offen offset:3072 nt lds
MF a[96:99],v[108:111],v[160:163],a[96:99]
DT v[150:151],v19 offset:34816
MF a[100:103],v[108:111],v[164:167],a[100:103]
MF a[104:107],v[108:111],v[168:171],a[104:107]
DT v[152:153],v20 offset:32768
MF a[108:111],v[108:111],v[172:175],a[108:111]
MF a[112:115],v[108:111],v[176:179],a[112:115]
DT v[154:155],v20 offset:34816
MF a[116:119],v[108:111],v[180:183],a[116:119]
SA m0,s23,32768
s_mov_b32 s21,1664
BL v22,s[8:11],s21 offen lds
MF a[120:123],v[108:111],v[184:187],a[120:123]
DT v[156:157],v21 offset:32768
MF a[124:127],v[108:111],v[188:191],a[124:127]
MF a[128:131],v[112:115],v[160:163],a[128:131]
DT v[158:159],v21 offset:34816
MF a[132:135],v[112:115],v[164:167],a[132:135]
MF a[136:139],v[112:115],v[168:171],a[136:139]
DR v[68:71],v11 offset:2048
MF a[140:143],v[112:115],v[172:175],a[140:143]
BL v23,s[8:11],s21 offen offset:1024 lds
MF a[144:147],v[112:115],v[176:179],a[144:147]
DR v[72:75],v11 offset:4096
MF a[148:151],v[112:115],v[180:183],a[148:151]
MF a[152:155],v[112:115],v[184:187],a[152:155]
DR v[76:79],v11 offset:6144
MF a[156:159],v[112:115],v[188:191],a[156:159]
MF a[160:163],v[116:119],v[160:163],a[160:163]
DR v[80:83],v11 offset:8192
MF a[164:167],v[116:119],v[164:167],a[164:167]
BL v24,s[8:11],s21 offen offset:2048 lds
MF a[168:171],v[116:119],v[168:171],a[168:171]
DR v[84:87],v11 offset:10240
MF a[172:175],v[116:119],v[172:175],a[172:175]
MF a[176:179],v[116:119],v[176:179],a[176:179]
DR v[88:91],v11 offset:12288
MF a[180:183],v[116:119],v[180:183],a[180:183]
MF a[184:187],v[116:119],v[184:187],a[184:187]
DR v[92:95],v11 offset:14336
MF a[188:191],v[116:119],v[188:191],a[188:191]
BL v25,s[8:11],s21 offen offset:3072 lds
MF a[192:195],v[120:123],v[160:163],a[192:195]
MF a[196:199],v[120:123],v[164:167],a[196:199]
MF a[200:203],v[120:123],v[168:171],a[200:203]
MF a[204:207],v[120:123],v[172:175],a[204:207]
MF a[208:211],v[120:123],v[176:179],a[208:211]
MF a[212:215],v[120:123],v[180:183],a[212:215]
MF a[216:219],v[120:123],v[184:187],a[216:219]
MF a[220:223],v[120:123],v[188:191],a[220:223]
MF a[224:227],v[124:127],v[160:163],a[224:227]
MF a[228:231],v[124:127],v[164:167],a[228:231]
MF a[232:235],v[124:127],v[168:171],a[232:235]
MF a[236:239],v[124:127],v[172:175],a[236:239]
MF a[240:243],v[124:127],v[176:179],a[240:243]
MF a[244:247],v[124:127],v[180:183],a[244:247]
MF a[248:251],v[124:127],v[184:187],a[248:251]
MF a[252:255],v[124:127],v[188:191],a[252:255]
WT vmcnt(20) lgkmcnt(0)
s_barrier
MF a[0:3],v[64:67],v[128:131],a[0:3]
DR v[96:99],v13 offset:0
MF a[4:7],v[64:67],v[132:135],a[4:7]
MF a[8:11],v[64:67],v[136:139],a[8:11]
DT v[160:161],v14 offset:49152
MF a[12:15],v[64:67],v[140:143],a[12:15]
MF a[16:19],v[64:67],v[144:147],a[16:19]
DT v[162:163],v14 offset:51200
MF a[20:23],v[64:67],v[148:151],a[20:23]
SA m0,s23,131072
s_mov_b32 s22,6815744
BL v26,s[12:15],s22 offen nt lds
MF a[24:27],v[64:67],v[152:155],a[24:27]
DT v[164:165],v15 offset:49152
MF a[28:31],v[64:67],v[156:159],a[28:31]
MF a[32:35],v[68:71],v[128:131],a[32:35]
DT v[166:167],v15 offset:51200
MF a[36:39],v[68:71],v[132:135],a[36:39]
MF a[40:43],v[68:71],v[136:139],a[40:43]
DT v[168:169],v16 offset:49152
MF a[44:47],v[68:71],v[140:143],a[44:47]
BL v27,s[12:15],s22 offen offset:1024 nt lds
MF a[48:51],v[68:71],v[144:147],a[48:51]
DT v[170:171],v16 offset:51200
MF a[52:55],v[68:71],v[148:151],a[52:55]
MF a[56:59],v[68:71],v[152:155],a[56:59]
DT v[172:173],v17 offset:49152
MF a[60:63],v[68:71],v[156:159],a[60:63]
MF a[64:67],v[72:75],v[128:131],a[64:67]
DT v[174:175],v17 offset:51200
MF a[68:71],v[72:75],v[132:135],a[68:71]
BL v28,s[12:15],s22 offen offset:2048 nt lds
MF a[72:75],v[72:75],v[136:139],a[72:75]
DT v[176:177],v18 offset:49152
MF a[76:79],v[72:75],v[140:143],a[76:79]
MF a[80:83],v[72:75],v[144:147],a[80:83]
DT v[178:179],v18 offset:51200
MF a[84:87],v[72:75],v[148:151],a[84:87]
MF a[88:91],v[72:75],v[152:155],a[88:91]
DT v[180:181],v19 offset:49152
MF a[92:95],v[72:75],v[156:159],a[92:95]
BL v29,s[12:15],s22 offen offset:3072 nt lds
MF a[96:99],v[76:79],v[128:131],a[96:99]
DT v[182:183],v19 offset:51200
MF a[100:103],v[76:79],v[132:135],a[100:103]
MF a[104:107],v[76:79],v[136:139],a[104:107]
DT v[184:185],v20 offset:49152
MF a[108:111],v[76:79],v[140:143],a[108:111]
MF a[112:115],v[76:79],v[144:147],a[112:115]
DT v[186:187],v20 offset:51200
MF a[116:119],v[76:79],v[148:151],a[116:119]
SA m0,s23,49152
s_mov_b32 s21,263808
BL v22,s[8:11],s21 offen lds
MF a[120:123],v[76:79],v[152:155],a[120:123]
DT v[188:189],v21 offset:49152
MF a[124:127],v[76:79],v[156:159],a[124:127]
MF a[128:131],v[80:83],v[128:131],a[128:131]
DT v[190:191],v21 offset:51200
MF a[132:135],v[80:83],v[132:135],a[132:135]
MF a[136:139],v[80:83],v[136:139],a[136:139]
DR v[100:103],v13 offset:2048
MF a[140:143],v[80:83],v[140:143],a[140:143]
BL v23,s[8:11],s21 offen offset:1024 lds
MF a[144:147],v[80:83],v[144:147],a[144:147]
DR v[104:107],v13 offset:4096
MF a[148:151],v[80:83],v[148:151],a[148:151]
MF a[152:155],v[80:83],v[152:155],a[152:155]
DR v[108:111],v13 offset:6144
MF a[156:159],v[80:83],v[156:159],a[156:159]
MF a[160:163],v[84:87],v[128:131],a[160:163]
DR v[112:115],v13 offset:8192
MF a[164:167],v[84:87],v[132:135],a[164:167]
BL v24,s[8:11],s21 offen offset:2048 lds
MF a[168:171],v[84:87],v[136:139],a[168:171]
DR v[116:119],v13 offset:10240
MF a[172:175],v[84:87],v[140:143],a[172:175]
MF a[176:179],v[84:87],v[144:147],a[176:179]
DR v[120:123],v13 offset:12288
MF a[180:183],v[84:87],v[148:151],a[180:183]
MF a[184:187],v[84:87],v[152:155],a[184:187]
DR v[124:127],v13 offset:14336
MF a[188:191],v[84:87],v[156:159],a[188:191]
BL v25,s[8:11],s21 offen offset:3072 lds
MF a[192:195],v[88:91],v[128:131],a[192:195]
MF a[196:199],v[88:91],v[132:135],a[196:199]
MF a[200:203],v[88:91],v[136:139],a[200:203]
MF a[204:207],v[88:91],v[140:143],a[204:207]
MF a[208:211],v[88:91],v[144:147],a[208:211]
MF a[212:215],v[88:91],v[148:151],a[212:215]
v_readfirstlane_b32 s30,v6
s_cmp_ge_u32 s30,16
s_cbranch_scc1 k1_kernel_v_xnok
s_mov_b32 s31,0
k1_kernel_v_xnpoll:
s_sleep 1
buffer_load_dword v6,v5,s[68:71],0 offen sc1
WT vmcnt(0)
v_readfirstlane_b32 s30,v6
SA s31,s31,1
s_cmp_ge_u32 s31,262144
s_cbranch_scc1 k1_kernel_v_xnto
s_cmp_ge_u32 s30,16
s_cbranch_scc0 k1_kernel_v_xnpoll
s_branch k1_kernel_v_xnok
k1_kernel_v_xnto:
v_mov_b32 v6,0xbad1
v_mov_b32 v7,128
buffer_store_dword v6,v7,s[68:71],0 offen
k1_kernel_v_xnok:
MF a[216:219],v[88:91],v[152:155],a[216:219]
MF a[220:223],v[88:91],v[156:159],a[220:223]
MF a[224:227],v[92:95],v[128:131],a[224:227]
MF a[228:231],v[92:95],v[132:135],a[228:231]
MF a[232:235],v[92:95],v[136:139],a[232:235]
MF a[236:239],v[92:95],v[140:143],a[236:239]
MF a[240:243],v[92:95],v[144:147],a[240:243]
MF a[244:247],v[92:95],v[148:151],a[244:247]
MF a[248:251],v[92:95],v[152:155],a[248:251]
MF a[252:255],v[92:95],v[156:159],a[252:255]
WT vmcnt(16) lgkmcnt(0)
s_barrier
MF a[0:3],v[96:99],v[160:163],a[0:3]
DR v[64:67],v10 offset:0
MF a[4:7],v[96:99],v[164:167],a[4:7]
MF a[8:11],v[96:99],v[168:171],a[8:11]
DT v[128:129],v14 offset:0
MF a[12:15],v[96:99],v[172:175],a[12:15]
MF a[16:19],v[96:99],v[176:179],a[16:19]
DT v[130:131],v14 offset:2048
MF a[20:23],v[96:99],v[180:183],a[20:23]
SA m0,s23,147456
s_mov_b32 s22,7077888
BL v26,s[12:15],s22 offen nt lds
MF a[24:27],v[96:99],v[184:187],a[24:27]
DT v[132:133],v15 offset:0
MF a[28:31],v[96:99],v[188:191],a[28:31]
MF a[32:35],v[100:103],v[160:163],a[32:35]
DT v[134:135],v15 offset:2048
MF a[36:39],v[100:103],v[164:167],a[36:39]
MF a[40:43],v[100:103],v[168:171],a[40:43]
DT v[136:137],v16 offset:0
MF a[44:47],v[100:103],v[172:175],a[44:47]
BL v27,s[12:15],s22 offen offset:1024 nt lds
MF a[48:51],v[100:103],v[176:179],a[48:51]
DT v[138:139],v16 offset:2048
MF a[52:55],v[100:103],v[180:183],a[52:55]
MF a[56:59],v[100:103],v[184:187],a[56:59]
DT v[140:141],v17 offset:0
MF a[60:63],v[100:103],v[188:191],a[60:63]
MF a[64:67],v[104:107],v[160:163],a[64:67]
DT v[142:143],v17 offset:2048
MF a[68:71],v[104:107],v[164:167],a[68:71]
BL v28,s[12:15],s22 offen offset:2048 nt lds
MF a[72:75],v[104:107],v[168:171],a[72:75]
DT v[144:145],v18 offset:0
MF a[76:79],v[104:107],v[172:175],a[76:79]
MF a[80:83],v[104:107],v[176:179],a[80:83]
DT v[146:147],v18 offset:2048
MF a[84:87],v[104:107],v[180:183],a[84:87]
MF a[88:91],v[104:107],v[184:187],a[88:91]
DT v[148:149],v19 offset:0
MF a[92:95],v[104:107],v[188:191],a[92:95]
BL v29,s[12:15],s22 offen offset:3072 nt lds
MF a[96:99],v[108:111],v[160:163],a[96:99]
DT v[150:151],v19 offset:2048
MF a[100:103],v[108:111],v[164:167],a[100:103]
MF a[104:107],v[108:111],v[168:171],a[104:107]
DT v[152:153],v20 offset:0
MF a[108:111],v[108:111],v[172:175],a[108:111]
MF a[112:115],v[108:111],v[176:179],a[112:115]
DT v[154:155],v20 offset:2048
MF a[116:119],v[108:111],v[180:183],a[116:119]
SA m0,s23,65536
s_mov_b32 s21,1792
BL v22,s[8:11],s21 offen lds
MF a[120:123],v[108:111],v[184:187],a[120:123]
DT v[156:157],v21 offset:0
MF a[124:127],v[108:111],v[188:191],a[124:127]
MF a[128:131],v[112:115],v[160:163],a[128:131]
DT v[158:159],v21 offset:2048
MF a[132:135],v[112:115],v[164:167],a[132:135]
MF a[136:139],v[112:115],v[168:171],a[136:139]
DR v[68:71],v10 offset:2048
MF a[140:143],v[112:115],v[172:175],a[140:143]
BL v23,s[8:11],s21 offen offset:1024 lds
MF a[144:147],v[112:115],v[176:179],a[144:147]
DR v[72:75],v10 offset:4096
MF a[148:151],v[112:115],v[180:183],a[148:151]
MF a[152:155],v[112:115],v[184:187],a[152:155]
DR v[76:79],v10 offset:6144
MF a[156:159],v[112:115],v[188:191],a[156:159]
MF a[160:163],v[116:119],v[160:163],a[160:163]
DR v[80:83],v10 offset:8192
MF a[164:167],v[116:119],v[164:167],a[164:167]
BL v24,s[8:11],s21 offen offset:2048 lds
MF a[168:171],v[116:119],v[168:171],a[168:171]
DR v[84:87],v10 offset:10240
MF a[172:175],v[116:119],v[172:175],a[172:175]
MF a[176:179],v[116:119],v[176:179],a[176:179]
DR v[88:91],v10 offset:12288
MF a[180:183],v[116:119],v[180:183],a[180:183]
MF a[184:187],v[116:119],v[184:187],a[184:187]
DR v[92:95],v10 offset:14336
MF a[188:191],v[116:119],v[188:191],a[188:191]
BL v25,s[8:11],s21 offen offset:3072 lds
MF a[192:195],v[120:123],v[160:163],a[192:195]
MF a[196:199],v[120:123],v[164:167],a[196:199]
MF a[200:203],v[120:123],v[168:171],a[200:203]
MF a[204:207],v[120:123],v[172:175],a[204:207]
MF a[208:211],v[120:123],v[176:179],a[208:211]
MF a[212:215],v[120:123],v[180:183],a[212:215]
MF a[216:219],v[120:123],v[184:187],a[216:219]
MF a[220:223],v[120:123],v[188:191],a[220:223]
MF a[224:227],v[124:127],v[160:163],a[224:227]
MF a[228:231],v[124:127],v[164:167],a[228:231]
MF a[232:235],v[124:127],v[168:171],a[232:235]
MF a[236:239],v[124:127],v[172:175],a[236:239]
MF a[240:243],v[124:127],v[176:179],a[240:243]
MF a[244:247],v[124:127],v[180:183],a[244:247]
MF a[248:251],v[124:127],v[184:187],a[248:251]
MF a[252:255],v[124:127],v[188:191],a[252:255]
WT vmcnt(20) lgkmcnt(0)
s_barrier
MF a[0:3],v[64:67],v[128:131],a[0:3]
DR v[96:99],v12 offset:0
MF a[4:7],v[64:67],v[132:135],a[4:7]
MF a[8:11],v[64:67],v[136:139],a[8:11]
DT v[160:161],v14 offset:16384
MF a[12:15],v[64:67],v[140:143],a[12:15]
MF a[16:19],v[64:67],v[144:147],a[16:19]
DT v[162:163],v14 offset:18432
MF a[20:23],v[64:67],v[148:151],a[20:23]
SA m0,s23,98304
s_mov_b32 s22,7340032
BL v26,s[12:15],s22 offen nt lds
MF a[24:27],v[64:67],v[152:155],a[24:27]
DT v[164:165],v15 offset:16384
MF a[28:31],v[64:67],v[156:159],a[28:31]
MF a[32:35],v[68:71],v[128:131],a[32:35]
DT v[166:167],v15 offset:18432
MF a[36:39],v[68:71],v[132:135],a[36:39]
MF a[40:43],v[68:71],v[136:139],a[40:43]
DT v[168:169],v16 offset:16384
MF a[44:47],v[68:71],v[140:143],a[44:47]
BL v27,s[12:15],s22 offen offset:1024 nt lds
MF a[48:51],v[68:71],v[144:147],a[48:51]
DT v[170:171],v16 offset:18432
MF a[52:55],v[68:71],v[148:151],a[52:55]
MF a[56:59],v[68:71],v[152:155],a[56:59]
DT v[172:173],v17 offset:16384
MF a[60:63],v[68:71],v[156:159],a[60:63]
MF a[64:67],v[72:75],v[128:131],a[64:67]
DT v[174:175],v17 offset:18432
MF a[68:71],v[72:75],v[132:135],a[68:71]
BL v28,s[12:15],s22 offen offset:2048 nt lds
MF a[72:75],v[72:75],v[136:139],a[72:75]
DT v[176:177],v18 offset:16384
MF a[76:79],v[72:75],v[140:143],a[76:79]
MF a[80:83],v[72:75],v[144:147],a[80:83]
DT v[178:179],v18 offset:18432
MF a[84:87],v[72:75],v[148:151],a[84:87]
MF a[88:91],v[72:75],v[152:155],a[88:91]
DT v[180:181],v19 offset:16384
MF a[92:95],v[72:75],v[156:159],a[92:95]
BL v29,s[12:15],s22 offen offset:3072 nt lds
MF a[96:99],v[76:79],v[128:131],a[96:99]
DT v[182:183],v19 offset:18432
MF a[100:103],v[76:79],v[132:135],a[100:103]
MF a[104:107],v[76:79],v[136:139],a[104:107]
DT v[184:185],v20 offset:16384
MF a[108:111],v[76:79],v[140:143],a[108:111]
MF a[112:115],v[76:79],v[144:147],a[112:115]
DT v[186:187],v20 offset:18432
MF a[116:119],v[76:79],v[148:151],a[116:119]
SA m0,s23,81920
s_mov_b32 s21,263936
BL v22,s[8:11],s21 offen lds
MF a[120:123],v[76:79],v[152:155],a[120:123]
DT v[188:189],v21 offset:16384
MF a[124:127],v[76:79],v[156:159],a[124:127]
MF a[128:131],v[80:83],v[128:131],a[128:131]
DT v[190:191],v21 offset:18432
MF a[132:135],v[80:83],v[132:135],a[132:135]
MF a[136:139],v[80:83],v[136:139],a[136:139]
DR v[100:103],v12 offset:2048
MF a[140:143],v[80:83],v[140:143],a[140:143]
BL v23,s[8:11],s21 offen offset:1024 lds
MF a[144:147],v[80:83],v[144:147],a[144:147]
DR v[104:107],v12 offset:4096
MF a[148:151],v[80:83],v[148:151],a[148:151]
MF a[152:155],v[80:83],v[152:155],a[152:155]
DR v[108:111],v12 offset:6144
MF a[156:159],v[80:83],v[156:159],a[156:159]
MF a[160:163],v[84:87],v[128:131],a[160:163]
DR v[112:115],v12 offset:8192
MF a[164:167],v[84:87],v[132:135],a[164:167]
BL v24,s[8:11],s21 offen offset:2048 lds
MF a[168:171],v[84:87],v[136:139],a[168:171]
DR v[116:119],v12 offset:10240
MF a[172:175],v[84:87],v[140:143],a[172:175]
MF a[176:179],v[84:87],v[144:147],a[176:179]
DR v[120:123],v12 offset:12288
MF a[180:183],v[84:87],v[148:151],a[180:183]
MF a[184:187],v[84:87],v[152:155],a[184:187]
DR v[124:127],v12 offset:14336
MF a[188:191],v[84:87],v[156:159],a[188:191]
BL v25,s[8:11],s21 offen offset:3072 lds
MF a[192:195],v[88:91],v[128:131],a[192:195]
MF a[196:199],v[88:91],v[132:135],a[196:199]
MF a[200:203],v[88:91],v[136:139],a[200:203]
MF a[204:207],v[88:91],v[140:143],a[204:207]
MF a[208:211],v[88:91],v[144:147],a[208:211]
MF a[212:215],v[88:91],v[148:151],a[212:215]
MF a[216:219],v[88:91],v[152:155],a[216:219]
MF a[220:223],v[88:91],v[156:159],a[220:223]
MF a[224:227],v[92:95],v[128:131],a[224:227]
MF a[228:231],v[92:95],v[132:135],a[228:231]
MF a[232:235],v[92:95],v[136:139],a[232:235]
MF a[236:239],v[92:95],v[140:143],a[236:239]
MF a[240:243],v[92:95],v[144:147],a[240:243]
MF a[244:247],v[92:95],v[148:151],a[244:247]
MF a[248:251],v[92:95],v[152:155],a[248:251]
MF a[252:255],v[92:95],v[156:159],a[252:255]
WT vmcnt(16) lgkmcnt(0)
s_barrier
MF a[0:3],v[96:99],v[160:163],a[0:3]
DR v[64:67],v10 offset:32768
MF a[4:7],v[96:99],v[164:167],a[4:7]
MF a[8:11],v[96:99],v[168:171],a[8:11]
DT v[128:129],v14 offset:32768
MF a[12:15],v[96:99],v[172:175],a[12:15]
MF a[16:19],v[96:99],v[176:179],a[16:19]
DT v[130:131],v14 offset:34816
MF a[20:23],v[96:99],v[180:183],a[20:23]
SA m0,s23,114688
s_mov_b32 s22,7602176
BL v26,s[12:15],s22 offen nt lds
MF a[24:27],v[96:99],v[184:187],a[24:27]
DT v[132:133],v15 offset:32768
MF a[28:31],v[96:99],v[188:191],a[28:31]
MF a[32:35],v[100:103],v[160:163],a[32:35]
DT v[134:135],v15 offset:34816
MF a[36:39],v[100:103],v[164:167],a[36:39]
MF a[40:43],v[100:103],v[168:171],a[40:43]
DT v[136:137],v16 offset:32768
MF a[44:47],v[100:103],v[172:175],a[44:47]
BL v27,s[12:15],s22 offen offset:1024 nt lds
MF a[48:51],v[100:103],v[176:179],a[48:51]
DT v[138:139],v16 offset:34816
MF a[52:55],v[100:103],v[180:183],a[52:55]
MF a[56:59],v[100:103],v[184:187],a[56:59]
DT v[140:141],v17 offset:32768
MF a[60:63],v[100:103],v[188:191],a[60:63]
MF a[64:67],v[104:107],v[160:163],a[64:67]
DT v[142:143],v17 offset:34816
MF a[68:71],v[104:107],v[164:167],a[68:71]
BL v28,s[12:15],s22 offen offset:2048 nt lds
MF a[72:75],v[104:107],v[168:171],a[72:75]
DT v[144:145],v18 offset:32768
MF a[76:79],v[104:107],v[172:175],a[76:79]
MF a[80:83],v[104:107],v[176:179],a[80:83]
DT v[146:147],v18 offset:34816
MF a[84:87],v[104:107],v[180:183],a[84:87]
MF a[88:91],v[104:107],v[184:187],a[88:91]
DT v[148:149],v19 offset:32768
MF a[92:95],v[104:107],v[188:191],a[92:95]
BL v29,s[12:15],s22 offen offset:3072 nt lds
MF a[96:99],v[108:111],v[160:163],a[96:99]
DT v[150:151],v19 offset:34816
MF a[100:103],v[108:111],v[164:167],a[100:103]
MF a[104:107],v[108:111],v[168:171],a[104:107]
DT v[152:153],v20 offset:32768
MF a[108:111],v[108:111],v[172:175],a[108:111]
MF a[112:115],v[108:111],v[176:179],a[112:115]
DT v[154:155],v20 offset:34816
MF a[116:119],v[108:111],v[180:183],a[116:119]
SA m0,s23,0
s_mov_b32 s21,1920
BL v22,s[8:11],s21 offen lds
MF a[120:123],v[108:111],v[184:187],a[120:123]
DT v[156:157],v21 offset:32768
MF a[124:127],v[108:111],v[188:191],a[124:127]
MF a[128:131],v[112:115],v[160:163],a[128:131]
DT v[158:159],v21 offset:34816
MF a[132:135],v[112:115],v[164:167],a[132:135]
MF a[136:139],v[112:115],v[168:171],a[136:139]
DR v[68:71],v10 offset:34816
MF a[140:143],v[112:115],v[172:175],a[140:143]
BL v23,s[8:11],s21 offen offset:1024 lds
MF a[144:147],v[112:115],v[176:179],a[144:147]
DR v[72:75],v10 offset:36864
MF a[148:151],v[112:115],v[180:183],a[148:151]
MF a[152:155],v[112:115],v[184:187],a[152:155]
DR v[76:79],v10 offset:38912
MF a[156:159],v[112:115],v[188:191],a[156:159]
MF a[160:163],v[116:119],v[160:163],a[160:163]
DR v[80:83],v10 offset:40960
MF a[164:167],v[116:119],v[164:167],a[164:167]
BL v24,s[8:11],s21 offen offset:2048 lds
MF a[168:171],v[116:119],v[168:171],a[168:171]
DR v[84:87],v10 offset:43008
MF a[172:175],v[116:119],v[172:175],a[172:175]
MF a[176:179],v[116:119],v[176:179],a[176:179]
DR v[88:91],v10 offset:45056
MF a[180:183],v[116:119],v[180:183],a[180:183]
MF a[184:187],v[116:119],v[184:187],a[184:187]
DR v[92:95],v10 offset:47104
MF a[188:191],v[116:119],v[188:191],a[188:191]
BL v25,s[8:11],s21 offen offset:3072 lds
MF a[192:195],v[120:123],v[160:163],a[192:195]
MF a[196:199],v[120:123],v[164:167],a[196:199]
MF a[200:203],v[120:123],v[168:171],a[200:203]
MF a[204:207],v[120:123],v[172:175],a[204:207]
MF a[208:211],v[120:123],v[176:179],a[208:211]
MF a[212:215],v[120:123],v[180:183],a[212:215]
MF a[216:219],v[120:123],v[184:187],a[216:219]
MF a[220:223],v[120:123],v[188:191],a[220:223]
MF a[224:227],v[124:127],v[160:163],a[224:227]
MF a[228:231],v[124:127],v[164:167],a[228:231]
MF a[232:235],v[124:127],v[168:171],a[232:235]
MF a[236:239],v[124:127],v[172:175],a[236:239]
MF a[240:243],v[124:127],v[176:179],a[240:243]
MF a[244:247],v[124:127],v[180:183],a[244:247]
MF a[248:251],v[124:127],v[184:187],a[248:251]
MF a[252:255],v[124:127],v[188:191],a[252:255]
WT vmcnt(20) lgkmcnt(0)
s_barrier
MF a[0:3],v[64:67],v[128:131],a[0:3]
DR v[96:99],v12 offset:32768
MF a[4:7],v[64:67],v[132:135],a[4:7]
MF a[8:11],v[64:67],v[136:139],a[8:11]
DT v[160:161],v14 offset:49152
MF a[12:15],v[64:67],v[140:143],a[12:15]
MF a[16:19],v[64:67],v[144:147],a[16:19]
DT v[162:163],v14 offset:51200
MF a[20:23],v[64:67],v[148:151],a[20:23]
SA m0,s23,131072
s_mov_b32 s22,7864320
BL v26,s[12:15],s22 offen nt lds
MF a[24:27],v[64:67],v[152:155],a[24:27]
DT v[164:165],v15 offset:49152
MF a[28:31],v[64:67],v[156:159],a[28:31]
MF a[32:35],v[68:71],v[128:131],a[32:35]
DT v[166:167],v15 offset:51200
MF a[36:39],v[68:71],v[132:135],a[36:39]
MF a[40:43],v[68:71],v[136:139],a[40:43]
DT v[168:169],v16 offset:49152
MF a[44:47],v[68:71],v[140:143],a[44:47]
BL v27,s[12:15],s22 offen offset:1024 nt lds
MF a[48:51],v[68:71],v[144:147],a[48:51]
DT v[170:171],v16 offset:51200
MF a[52:55],v[68:71],v[148:151],a[52:55]
MF a[56:59],v[68:71],v[152:155],a[56:59]
DT v[172:173],v17 offset:49152
MF a[60:63],v[68:71],v[156:159],a[60:63]
MF a[64:67],v[72:75],v[128:131],a[64:67]
DT v[174:175],v17 offset:51200
MF a[68:71],v[72:75],v[132:135],a[68:71]
BL v28,s[12:15],s22 offen offset:2048 nt lds
MF a[72:75],v[72:75],v[136:139],a[72:75]
DT v[176:177],v18 offset:49152
MF a[76:79],v[72:75],v[140:143],a[76:79]
MF a[80:83],v[72:75],v[144:147],a[80:83]
DT v[178:179],v18 offset:51200
MF a[84:87],v[72:75],v[148:151],a[84:87]
MF a[88:91],v[72:75],v[152:155],a[88:91]
DT v[180:181],v19 offset:49152
MF a[92:95],v[72:75],v[156:159],a[92:95]
BL v29,s[12:15],s22 offen offset:3072 nt lds
MF a[96:99],v[76:79],v[128:131],a[96:99]
DT v[182:183],v19 offset:51200
MF a[100:103],v[76:79],v[132:135],a[100:103]
MF a[104:107],v[76:79],v[136:139],a[104:107]
DT v[184:185],v20 offset:49152
MF a[108:111],v[76:79],v[140:143],a[108:111]
MF a[112:115],v[76:79],v[144:147],a[112:115]
DT v[186:187],v20 offset:51200
MF a[116:119],v[76:79],v[148:151],a[116:119]
SA m0,s23,16384
s_mov_b32 s21,264064
BL v22,s[8:11],s21 offen lds
MF a[120:123],v[76:79],v[152:155],a[120:123]
DT v[188:189],v21 offset:49152
MF a[124:127],v[76:79],v[156:159],a[124:127]
MF a[128:131],v[80:83],v[128:131],a[128:131]
DT v[190:191],v21 offset:51200
MF a[132:135],v[80:83],v[132:135],a[132:135]
MF a[136:139],v[80:83],v[136:139],a[136:139]
DR v[100:103],v12 offset:34816
MF a[140:143],v[80:83],v[140:143],a[140:143]
BL v23,s[8:11],s21 offen offset:1024 lds
MF a[144:147],v[80:83],v[144:147],a[144:147]
DR v[104:107],v12 offset:36864
MF a[148:151],v[80:83],v[148:151],a[148:151]
MF a[152:155],v[80:83],v[152:155],a[152:155]
DR v[108:111],v12 offset:38912
MF a[156:159],v[80:83],v[156:159],a[156:159]
MF a[160:163],v[84:87],v[128:131],a[160:163]
DR v[112:115],v12 offset:40960
MF a[164:167],v[84:87],v[132:135],a[164:167]
BL v24,s[8:11],s21 offen offset:2048 lds
MF a[168:171],v[84:87],v[136:139],a[168:171]
DR v[116:119],v12 offset:43008
MF a[172:175],v[84:87],v[140:143],a[172:175]
MF a[176:179],v[84:87],v[144:147],a[176:179]
DR v[120:123],v12 offset:45056
MF a[180:183],v[84:87],v[148:151],a[180:183]
MF a[184:187],v[84:87],v[152:155],a[184:187]
DR v[124:127],v12 offset:47104
MF a[188:191],v[84:87],v[156:159],a[188:191]
BL v25,s[8:11],s21 offen offset:3072 lds
MF a[192:195],v[88:91],v[128:131],a[192:195]
MF a[196:199],v[88:91],v[132:135],a[196:199]
MF a[200:203],v[88:91],v[136:139],a[200:203]
MF a[204:207],v[88:91],v[140:143],a[204:207]
MF a[208:211],v[88:91],v[144:147],a[208:211]
MF a[212:215],v[88:91],v[148:151],a[212:215]
MF a[216:219],v[88:91],v[152:155],a[216:219]
MF a[220:223],v[88:91],v[156:159],a[220:223]
MF a[224:227],v[92:95],v[128:131],a[224:227]
MF a[228:231],v[92:95],v[132:135],a[228:231]
MF a[232:235],v[92:95],v[136:139],a[232:235]
MF a[236:239],v[92:95],v[140:143],a[236:239]
MF a[240:243],v[92:95],v[144:147],a[240:243]
MF a[244:247],v[92:95],v[148:151],a[244:247]
MF a[248:251],v[92:95],v[152:155],a[248:251]
MF a[252:255],v[92:95],v[156:159],a[252:255]
WT vmcnt(16) lgkmcnt(0)
s_barrier
MF a[0:3],v[96:99],v[160:163],a[0:3]
DR v[64:67],v11 offset:0
MF a[4:7],v[96:99],v[164:167],a[4:7]
MF a[8:11],v[96:99],v[168:171],a[8:11]
DT v[128:129],v14 offset:0
MF a[12:15],v[96:99],v[172:175],a[12:15]
MF a[16:19],v[96:99],v[176:179],a[16:19]
DT v[130:131],v14 offset:2048
MF a[20:23],v[96:99],v[180:183],a[20:23]
SA m0,s23,147456
s_mov_b32 s22,8126464
BL v26,s[12:15],s22 offen nt lds
MF a[24:27],v[96:99],v[184:187],a[24:27]
DT v[132:133],v15 offset:0
MF a[28:31],v[96:99],v[188:191],a[28:31]
MF a[32:35],v[100:103],v[160:163],a[32:35]
DT v[134:135],v15 offset:2048
MF a[36:39],v[100:103],v[164:167],a[36:39]
MF a[40:43],v[100:103],v[168:171],a[40:43]
DT v[136:137],v16 offset:0
MF a[44:47],v[100:103],v[172:175],a[44:47]
BL v27,s[12:15],s22 offen offset:1024 nt lds
MF a[48:51],v[100:103],v[176:179],a[48:51]
DT v[138:139],v16 offset:2048
MF a[52:55],v[100:103],v[180:183],a[52:55]
MF a[56:59],v[100:103],v[184:187],a[56:59]
DT v[140:141],v17 offset:0
MF a[60:63],v[100:103],v[188:191],a[60:63]
MF a[64:67],v[104:107],v[160:163],a[64:67]
DT v[142:143],v17 offset:2048
MF a[68:71],v[104:107],v[164:167],a[68:71]
BL v28,s[12:15],s22 offen offset:2048 nt lds
MF a[72:75],v[104:107],v[168:171],a[72:75]
DT v[144:145],v18 offset:0
MF a[76:79],v[104:107],v[172:175],a[76:79]
MF a[80:83],v[104:107],v[176:179],a[80:83]
DT v[146:147],v18 offset:2048
MF a[84:87],v[104:107],v[180:183],a[84:87]
MF a[88:91],v[104:107],v[184:187],a[88:91]
DT v[148:149],v19 offset:0
MF a[92:95],v[104:107],v[188:191],a[92:95]
BL v29,s[12:15],s22 offen offset:3072 nt lds
MF a[96:99],v[108:111],v[160:163],a[96:99]
DT v[150:151],v19 offset:2048
MF a[100:103],v[108:111],v[164:167],a[100:103]
MF a[104:107],v[108:111],v[168:171],a[104:107]
DT v[152:153],v20 offset:0
MF a[108:111],v[108:111],v[172:175],a[108:111]
MF a[112:115],v[108:111],v[176:179],a[112:115]
DT v[154:155],v20 offset:2048
MF a[116:119],v[108:111],v[180:183],a[116:119]
SA m0,s23,32768
s_mov_b32 s21,0
BL v30,s[36:39],s21 offen lds
MF a[120:123],v[108:111],v[184:187],a[120:123]
DT v[156:157],v21 offset:0
MF a[124:127],v[108:111],v[188:191],a[124:127]
MF a[128:131],v[112:115],v[160:163],a[128:131]
DT v[158:159],v21 offset:2048
MF a[132:135],v[112:115],v[164:167],a[132:135]
MF a[136:139],v[112:115],v[168:171],a[136:139]
DR v[68:71],v11 offset:2048
MF a[140:143],v[112:115],v[172:175],a[140:143]
BL v31,s[36:39],s21 offen offset:1024 lds
MF a[144:147],v[112:115],v[176:179],a[144:147]
DR v[72:75],v11 offset:4096
MF a[148:151],v[112:115],v[180:183],a[148:151]
MF a[152:155],v[112:115],v[184:187],a[152:155]
DR v[76:79],v11 offset:6144
MF a[156:159],v[112:115],v[188:191],a[156:159]
MF a[160:163],v[116:119],v[160:163],a[160:163]
DR v[80:83],v11 offset:8192
MF a[164:167],v[116:119],v[164:167],a[164:167]
BL v32,s[36:39],s21 offen offset:2048 lds
MF a[168:171],v[116:119],v[168:171],a[168:171]
DR v[84:87],v11 offset:10240
MF a[172:175],v[116:119],v[172:175],a[172:175]
MF a[176:179],v[116:119],v[176:179],a[176:179]
DR v[88:91],v11 offset:12288
MF a[180:183],v[116:119],v[180:183],a[180:183]
MF a[184:187],v[116:119],v[184:187],a[184:187]
DR v[92:95],v11 offset:14336
MF a[188:191],v[116:119],v[188:191],a[188:191]
BL v33,s[36:39],s21 offen offset:3072 lds
MF a[192:195],v[120:123],v[160:163],a[192:195]
MF a[196:199],v[120:123],v[164:167],a[196:199]
MF a[200:203],v[120:123],v[168:171],a[200:203]
MF a[204:207],v[120:123],v[172:175],a[204:207]
MF a[208:211],v[120:123],v[176:179],a[208:211]
MF a[212:215],v[120:123],v[180:183],a[212:215]
MF a[216:219],v[120:123],v[184:187],a[216:219]
MF a[220:223],v[120:123],v[188:191],a[220:223]
MF a[224:227],v[124:127],v[160:163],a[224:227]
MF a[228:231],v[124:127],v[164:167],a[228:231]
MF a[232:235],v[124:127],v[168:171],a[232:235]
MF a[236:239],v[124:127],v[172:175],a[236:239]
MF a[240:243],v[124:127],v[176:179],a[240:243]
MF a[244:247],v[124:127],v[180:183],a[244:247]
MF a[248:251],v[124:127],v[184:187],a[248:251]
MF a[252:255],v[124:127],v[188:191],a[252:255]
WT vmcnt(20) lgkmcnt(0)
s_barrier
MF a[0:3],v[64:67],v[128:131],a[0:3]
DR v[96:99],v13 offset:0
MF a[4:7],v[64:67],v[132:135],a[4:7]
MF a[8:11],v[64:67],v[136:139],a[8:11]
DT v[160:161],v14 offset:16384
MF a[12:15],v[64:67],v[140:143],a[12:15]
MF a[16:19],v[64:67],v[144:147],a[16:19]
DT v[162:163],v14 offset:18432
MF a[20:23],v[64:67],v[148:151],a[20:23]
SA m0,s23,98304
s_mov_b32 s22,0
BL v26,s[40:43],s22 offen nt lds
MF a[24:27],v[64:67],v[152:155],a[24:27]
DT v[164:165],v15 offset:16384
MF a[28:31],v[64:67],v[156:159],a[28:31]
MF a[32:35],v[68:71],v[128:131],a[32:35]
DT v[166:167],v15 offset:18432
MF a[36:39],v[68:71],v[132:135],a[36:39]
MF a[40:43],v[68:71],v[136:139],a[40:43]
DT v[168:169],v16 offset:16384
MF a[44:47],v[68:71],v[140:143],a[44:47]
BL v27,s[40:43],s22 offen offset:1024 nt lds
MF a[48:51],v[68:71],v[144:147],a[48:51]
DT v[170:171],v16 offset:18432
MF a[52:55],v[68:71],v[148:151],a[52:55]
MF a[56:59],v[68:71],v[152:155],a[56:59]
DT v[172:173],v17 offset:16384
MF a[60:63],v[68:71],v[156:159],a[60:63]
MF a[64:67],v[72:75],v[128:131],a[64:67]
DT v[174:175],v17 offset:18432
MF a[68:71],v[72:75],v[132:135],a[68:71]
BL v28,s[40:43],s22 offen offset:2048 nt lds
MF a[72:75],v[72:75],v[136:139],a[72:75]
DT v[176:177],v18 offset:16384
MF a[76:79],v[72:75],v[140:143],a[76:79]
MF a[80:83],v[72:75],v[144:147],a[80:83]
DT v[178:179],v18 offset:18432
MF a[84:87],v[72:75],v[148:151],a[84:87]
MF a[88:91],v[72:75],v[152:155],a[88:91]
DT v[180:181],v19 offset:16384
MF a[92:95],v[72:75],v[156:159],a[92:95]
BL v29,s[40:43],s22 offen offset:3072 nt lds
MF a[96:99],v[76:79],v[128:131],a[96:99]
DT v[182:183],v19 offset:18432
MF a[100:103],v[76:79],v[132:135],a[100:103]
MF a[104:107],v[76:79],v[136:139],a[104:107]
DT v[184:185],v20 offset:16384
MF a[108:111],v[76:79],v[140:143],a[108:111]
MF a[112:115],v[76:79],v[144:147],a[112:115]
DT v[186:187],v20 offset:18432
MF a[116:119],v[76:79],v[148:151],a[116:119]
SA m0,s23,49152
s_mov_b32 s22,1048576
BL v26,s[40:43],s22 offen nt lds
MF a[120:123],v[76:79],v[152:155],a[120:123]
DT v[188:189],v21 offset:16384
MF a[124:127],v[76:79],v[156:159],a[124:127]
MF a[128:131],v[80:83],v[128:131],a[128:131]
DT v[190:191],v21 offset:18432
MF a[132:135],v[80:83],v[132:135],a[132:135]
MF a[136:139],v[80:83],v[136:139],a[136:139]
DR v[100:103],v13 offset:2048
MF a[140:143],v[80:83],v[140:143],a[140:143]
BL v27,s[40:43],s22 offen offset:1024 nt lds
MF a[144:147],v[80:83],v[144:147],a[144:147]
DR v[104:107],v13 offset:4096
MF a[148:151],v[80:83],v[148:151],a[148:151]
MF a[152:155],v[80:83],v[152:155],a[152:155]
DR v[108:111],v13 offset:6144
MF a[156:159],v[80:83],v[156:159],a[156:159]
MF a[160:163],v[84:87],v[128:131],a[160:163]
DR v[112:115],v13 offset:8192
MF a[164:167],v[84:87],v[132:135],a[164:167]
BL v28,s[40:43],s22 offen offset:2048 nt lds
MF a[168:171],v[84:87],v[136:139],a[168:171]
DR v[116:119],v13 offset:10240
MF a[172:175],v[84:87],v[140:143],a[172:175]
MF a[176:179],v[84:87],v[144:147],a[176:179]
DR v[120:123],v13 offset:12288
MF a[180:183],v[84:87],v[148:151],a[180:183]
MF a[184:187],v[84:87],v[152:155],a[184:187]
DR v[124:127],v13 offset:14336
MF a[188:191],v[84:87],v[156:159],a[188:191]
BL v29,s[40:43],s22 offen offset:3072 nt lds
MF a[192:195],v[88:91],v[128:131],a[192:195]
MF a[196:199],v[88:91],v[132:135],a[196:199]
MF a[200:203],v[88:91],v[136:139],a[200:203]
MF a[204:207],v[88:91],v[140:143],a[204:207]
MF a[208:211],v[88:91],v[144:147],a[208:211]
MF a[212:215],v[88:91],v[148:151],a[212:215]
MF a[216:219],v[88:91],v[152:155],a[216:219]
MF a[220:223],v[88:91],v[156:159],a[220:223]
MF a[224:227],v[92:95],v[128:131],a[224:227]
MF a[228:231],v[92:95],v[132:135],a[228:231]
MF a[232:235],v[92:95],v[136:139],a[232:235]
MF a[236:239],v[92:95],v[140:143],a[236:239]
MF a[240:243],v[92:95],v[144:147],a[240:243]
MF a[244:247],v[92:95],v[148:151],a[244:247]
MF a[248:251],v[92:95],v[152:155],a[248:251]
MF a[252:255],v[92:95],v[156:159],a[252:255]
WT vmcnt(16) lgkmcnt(0)
s_barrier
MF a[0:3],v[96:99],v[160:163],a[0:3]
DR v[64:67],v10 offset:0
MF a[4:7],v[96:99],v[164:167],a[4:7]
MF a[8:11],v[96:99],v[168:171],a[8:11]
DT v[128:129],v14 offset:32768
MF a[12:15],v[96:99],v[172:175],a[12:15]
MF a[16:19],v[96:99],v[176:179],a[16:19]
DT v[130:131],v14 offset:34816
MF a[20:23],v[96:99],v[180:183],a[20:23]
SA m0,s23,114688
s_mov_b32 s22,262144
BL v26,s[40:43],s22 offen nt lds
MF a[24:27],v[96:99],v[184:187],a[24:27]
DT v[132:133],v15 offset:32768
MF a[28:31],v[96:99],v[188:191],a[28:31]
MF a[32:35],v[100:103],v[160:163],a[32:35]
DT v[134:135],v15 offset:34816
MF a[36:39],v[100:103],v[164:167],a[36:39]
MF a[40:43],v[100:103],v[168:171],a[40:43]
DT v[136:137],v16 offset:32768
MF a[44:47],v[100:103],v[172:175],a[44:47]
BL v27,s[40:43],s22 offen offset:1024 nt lds
MF a[48:51],v[100:103],v[176:179],a[48:51]
DT v[138:139],v16 offset:34816
MF a[52:55],v[100:103],v[180:183],a[52:55]
MF a[56:59],v[100:103],v[184:187],a[56:59]
DT v[140:141],v17 offset:32768
MF a[60:63],v[100:103],v[188:191],a[60:63]
MF a[64:67],v[104:107],v[160:163],a[64:67]
DT v[142:143],v17 offset:34816
MF a[68:71],v[104:107],v[164:167],a[68:71]
BL v28,s[40:43],s22 offen offset:2048 nt lds
MF a[72:75],v[104:107],v[168:171],a[72:75]
DT v[144:145],v18 offset:32768
MF a[76:79],v[104:107],v[172:175],a[76:79]
MF a[80:83],v[104:107],v[176:179],a[80:83]
DT v[146:147],v18 offset:34816
MF a[84:87],v[104:107],v[180:183],a[84:87]
MF a[88:91],v[104:107],v[184:187],a[88:91]
DT v[148:149],v19 offset:32768
MF a[92:95],v[104:107],v[188:191],a[92:95]
BL v29,s[40:43],s22 offen offset:3072 nt lds
MF a[96:99],v[108:111],v[160:163],a[96:99]
DT v[150:151],v19 offset:34816
MF a[100:103],v[108:111],v[164:167],a[100:103]
MF a[104:107],v[108:111],v[168:171],a[104:107]
DT v[152:153],v20 offset:32768
MF a[108:111],v[108:111],v[172:175],a[108:111]
MF a[112:115],v[108:111],v[176:179],a[112:115]
DT v[154:155],v20 offset:34816
MF a[116:119],v[108:111],v[180:183],a[116:119]
SA m0,s23,65536
s_mov_b32 s21,128
BL v30,s[36:39],s21 offen lds
MF a[120:123],v[108:111],v[184:187],a[120:123]
DT v[156:157],v21 offset:32768
MF a[124:127],v[108:111],v[188:191],a[124:127]
MF a[128:131],v[112:115],v[160:163],a[128:131]
DT v[158:159],v21 offset:34816
MF a[132:135],v[112:115],v[164:167],a[132:135]
MF a[136:139],v[112:115],v[168:171],a[136:139]
DR v[68:71],v10 offset:2048
MF a[140:143],v[112:115],v[172:175],a[140:143]
BL v31,s[36:39],s21 offen offset:1024 lds
MF a[144:147],v[112:115],v[176:179],a[144:147]
DR v[72:75],v10 offset:4096
MF a[148:151],v[112:115],v[180:183],a[148:151]
MF a[152:155],v[112:115],v[184:187],a[152:155]
DR v[76:79],v10 offset:6144
MF a[156:159],v[112:115],v[188:191],a[156:159]
MF a[160:163],v[116:119],v[160:163],a[160:163]
DR v[80:83],v10 offset:8192
MF a[164:167],v[116:119],v[164:167],a[164:167]
BL v32,s[36:39],s21 offen offset:2048 lds
MF a[168:171],v[116:119],v[168:171],a[168:171]
DR v[84:87],v10 offset:10240
MF a[172:175],v[116:119],v[172:175],a[172:175]
MF a[176:179],v[116:119],v[176:179],a[176:179]
DR v[88:91],v10 offset:12288
MF a[180:183],v[116:119],v[180:183],a[180:183]
MF a[184:187],v[116:119],v[184:187],a[184:187]
DR v[92:95],v10 offset:14336
MF a[188:191],v[116:119],v[188:191],a[188:191]
BL v33,s[36:39],s21 offen offset:3072 lds
MF a[192:195],v[120:123],v[160:163],a[192:195]
MF a[196:199],v[120:123],v[164:167],a[196:199]
MF a[200:203],v[120:123],v[168:171],a[200:203]
MF a[204:207],v[120:123],v[172:175],a[204:207]
MF a[208:211],v[120:123],v[176:179],a[208:211]
MF a[212:215],v[120:123],v[180:183],a[212:215]
MF a[216:219],v[120:123],v[184:187],a[216:219]
MF a[220:223],v[120:123],v[188:191],a[220:223]
MF a[224:227],v[124:127],v[160:163],a[224:227]
MF a[228:231],v[124:127],v[164:167],a[228:231]
MF a[232:235],v[124:127],v[168:171],a[232:235]
MF a[236:239],v[124:127],v[172:175],a[236:239]
MF a[240:243],v[124:127],v[176:179],a[240:243]
MF a[244:247],v[124:127],v[180:183],a[244:247]
MF a[248:251],v[124:127],v[184:187],a[248:251]
MF a[252:255],v[124:127],v[188:191],a[252:255]
WT vmcnt(20) lgkmcnt(0)
s_barrier
MF a[0:3],v[64:67],v[128:131],a[0:3]
DR v[96:99],v12 offset:0
MF a[4:7],v[64:67],v[132:135],a[4:7]
MF a[8:11],v[64:67],v[136:139],a[8:11]
DT v[160:161],v14 offset:49152
MF a[12:15],v[64:67],v[140:143],a[12:15]
MF a[16:19],v[64:67],v[144:147],a[16:19]
DT v[162:163],v14 offset:51200
MF a[20:23],v[64:67],v[148:151],a[20:23]
SA m0,s23,131072
s_mov_b32 s22,524288
BL v26,s[40:43],s22 offen nt lds
MF a[24:27],v[64:67],v[152:155],a[24:27]
DT v[164:165],v15 offset:49152
MF a[28:31],v[64:67],v[156:159],a[28:31]
MF a[32:35],v[68:71],v[128:131],a[32:35]
DT v[166:167],v15 offset:51200
MF a[36:39],v[68:71],v[132:135],a[36:39]
MF a[40:43],v[68:71],v[136:139],a[40:43]
DT v[168:169],v16 offset:49152
MF a[44:47],v[68:71],v[140:143],a[44:47]
BL v27,s[40:43],s22 offen offset:1024 nt lds
MF a[48:51],v[68:71],v[144:147],a[48:51]
DT v[170:171],v16 offset:51200
MF a[52:55],v[68:71],v[148:151],a[52:55]
MF a[56:59],v[68:71],v[152:155],a[56:59]
DT v[172:173],v17 offset:49152
MF a[60:63],v[68:71],v[156:159],a[60:63]
MF a[64:67],v[72:75],v[128:131],a[64:67]
DT v[174:175],v17 offset:51200
MF a[68:71],v[72:75],v[132:135],a[68:71]
BL v28,s[40:43],s22 offen offset:2048 nt lds
MF a[72:75],v[72:75],v[136:139],a[72:75]
DT v[176:177],v18 offset:49152
MF a[76:79],v[72:75],v[140:143],a[76:79]
MF a[80:83],v[72:75],v[144:147],a[80:83]
DT v[178:179],v18 offset:51200
MF a[84:87],v[72:75],v[148:151],a[84:87]
MF a[88:91],v[72:75],v[152:155],a[88:91]
DT v[180:181],v19 offset:49152
MF a[92:95],v[72:75],v[156:159],a[92:95]
BL v29,s[40:43],s22 offen offset:3072 nt lds
MF a[96:99],v[76:79],v[128:131],a[96:99]
DT v[182:183],v19 offset:51200
MF a[100:103],v[76:79],v[132:135],a[100:103]
MF a[104:107],v[76:79],v[136:139],a[104:107]
DT v[184:185],v20 offset:49152
MF a[108:111],v[76:79],v[140:143],a[108:111]
MF a[112:115],v[76:79],v[144:147],a[112:115]
DT v[186:187],v20 offset:51200
MF a[116:119],v[76:79],v[148:151],a[116:119]
SA m0,s23,81920
s_mov_b32 s22,1310720
BL v26,s[40:43],s22 offen nt lds
MF a[120:123],v[76:79],v[152:155],a[120:123]
DT v[188:189],v21 offset:49152
MF a[124:127],v[76:79],v[156:159],a[124:127]
MF a[128:131],v[80:83],v[128:131],a[128:131]
DT v[190:191],v21 offset:51200
MF a[132:135],v[80:83],v[132:135],a[132:135]
MF a[136:139],v[80:83],v[136:139],a[136:139]
DR v[100:103],v12 offset:2048
MF a[140:143],v[80:83],v[140:143],a[140:143]
BL v27,s[40:43],s22 offen offset:1024 nt lds
MF a[144:147],v[80:83],v[144:147],a[144:147]
DR v[104:107],v12 offset:4096
MF a[148:151],v[80:83],v[148:151],a[148:151]
MF a[152:155],v[80:83],v[152:155],a[152:155]
DR v[108:111],v12 offset:6144
MF a[156:159],v[80:83],v[156:159],a[156:159]
MF a[160:163],v[84:87],v[128:131],a[160:163]
DR v[112:115],v12 offset:8192
MF a[164:167],v[84:87],v[132:135],a[164:167]
BL v28,s[40:43],s22 offen offset:2048 nt lds
MF a[168:171],v[84:87],v[136:139],a[168:171]
DR v[116:119],v12 offset:10240
MF a[172:175],v[84:87],v[140:143],a[172:175]
MF a[176:179],v[84:87],v[144:147],a[176:179]
DR v[120:123],v12 offset:12288
MF a[180:183],v[84:87],v[148:151],a[180:183]
MF a[184:187],v[84:87],v[152:155],a[184:187]
DR v[124:127],v12 offset:14336
MF a[188:191],v[84:87],v[156:159],a[188:191]
BL v29,s[40:43],s22 offen offset:3072 nt lds
MF a[192:195],v[88:91],v[128:131],a[192:195]
MF a[196:199],v[88:91],v[132:135],a[196:199]
MF a[200:203],v[88:91],v[136:139],a[200:203]
MF a[204:207],v[88:91],v[140:143],a[204:207]
MF a[208:211],v[88:91],v[144:147],a[208:211]
MF a[212:215],v[88:91],v[148:151],a[212:215]
MF a[216:219],v[88:91],v[152:155],a[216:219]
MF a[220:223],v[88:91],v[156:159],a[220:223]
MF a[224:227],v[92:95],v[128:131],a[224:227]
MF a[228:231],v[92:95],v[132:135],a[228:231]
MF a[232:235],v[92:95],v[136:139],a[232:235]
MF a[236:239],v[92:95],v[140:143],a[236:239]
MF a[240:243],v[92:95],v[144:147],a[240:243]
MF a[244:247],v[92:95],v[148:151],a[244:247]
MF a[248:251],v[92:95],v[152:155],a[248:251]
MF a[252:255],v[92:95],v[156:159],a[252:255]
WT vmcnt(20) lgkmcnt(0)
s_barrier
MF a[0:3],v[96:99],v[160:163],a[0:3]
MF a[4:7],v[96:99],v[164:167],a[4:7]
MF a[8:11],v[96:99],v[168:171],a[8:11]
MF a[12:15],v[96:99],v[172:175],a[12:15]
MF a[16:19],v[96:99],v[176:179],a[16:19]
MF a[20:23],v[96:99],v[180:183],a[20:23]
SA m0,s23,147456
s_mov_b32 s22,786432
BL v26,s[40:43],s22 offen nt lds
MF a[24:27],v[96:99],v[184:187],a[24:27]
MF a[28:31],v[96:99],v[188:191],a[28:31]
MF a[32:35],v[100:103],v[160:163],a[32:35]
MF a[36:39],v[100:103],v[164:167],a[36:39]
MF a[40:43],v[100:103],v[168:171],a[40:43]
MF a[44:47],v[100:103],v[172:175],a[44:47]
BL v27,s[40:43],s22 offen offset:1024 nt lds
MF a[48:51],v[100:103],v[176:179],a[48:51]
MF a[52:55],v[100:103],v[180:183],a[52:55]
MF a[56:59],v[100:103],v[184:187],a[56:59]
MF a[60:63],v[100:103],v[188:191],a[60:63]
MF a[64:67],v[104:107],v[160:163],a[64:67]
MF a[68:71],v[104:107],v[164:167],a[68:71]
BL v28,s[40:43],s22 offen offset:2048 nt lds
MF a[72:75],v[104:107],v[168:171],a[72:75]
MF a[76:79],v[104:107],v[172:175],a[76:79]
MF a[80:83],v[104:107],v[176:179],a[80:83]
MF a[84:87],v[104:107],v[180:183],a[84:87]
MF a[88:91],v[104:107],v[184:187],a[88:91]
MF a[92:95],v[104:107],v[188:191],a[92:95]
BL v29,s[40:43],s22 offen offset:3072 nt lds
MF a[96:99],v[108:111],v[160:163],a[96:99]
MF a[100:103],v[108:111],v[164:167],a[100:103]
MF a[104:107],v[108:111],v[168:171],a[104:107]
MF a[108:111],v[108:111],v[172:175],a[108:111]
MF a[112:115],v[108:111],v[176:179],a[112:115]
MF a[116:119],v[108:111],v[180:183],a[116:119]
SA m0,s23,0
s_mov_b32 s21,256
BL v30,s[36:39],s21 offen lds
MF a[120:123],v[108:111],v[184:187],a[120:123]
MF a[124:127],v[108:111],v[188:191],a[124:127]
MF a[128:131],v[112:115],v[160:163],a[128:131]
MF a[132:135],v[112:115],v[164:167],a[132:135]
MF a[136:139],v[112:115],v[168:171],a[136:139]
MF a[140:143],v[112:115],v[172:175],a[140:143]
BL v31,s[36:39],s21 offen offset:1024 lds
MF a[144:147],v[112:115],v[176:179],a[144:147]
MF a[148:151],v[112:115],v[180:183],a[148:151]
MF a[152:155],v[112:115],v[184:187],a[152:155]
MF a[156:159],v[112:115],v[188:191],a[156:159]
MF a[160:163],v[116:119],v[160:163],a[160:163]
MF a[164:167],v[116:119],v[164:167],a[164:167]
BL v32,s[36:39],s21 offen offset:2048 lds
MF a[168:171],v[116:119],v[168:171],a[168:171]
MF a[172:175],v[116:119],v[172:175],a[172:175]
MF a[176:179],v[116:119],v[176:179],a[176:179]
MF a[180:183],v[116:119],v[180:183],a[180:183]
MF a[184:187],v[116:119],v[184:187],a[184:187]
MF a[188:191],v[116:119],v[188:191],a[188:191]
BL v33,s[36:39],s21 offen offset:3072 lds
MF a[192:195],v[120:123],v[160:163],a[192:195]
MF a[196:199],v[120:123],v[164:167],a[196:199]
MF a[200:203],v[120:123],v[168:171],a[200:203]
MF a[204:207],v[120:123],v[172:175],a[204:207]
MF a[208:211],v[120:123],v[176:179],a[208:211]
MF a[212:215],v[120:123],v[180:183],a[212:215]
MF a[216:219],v[120:123],v[184:187],a[216:219]
MF a[220:223],v[120:123],v[188:191],a[220:223]
MF a[224:227],v[124:127],v[160:163],a[224:227]
MF a[228:231],v[124:127],v[164:167],a[228:231]
MF a[232:235],v[124:127],v[168:171],a[232:235]
MF a[236:239],v[124:127],v[172:175],a[236:239]
MF a[240:243],v[124:127],v[176:179],a[240:243]
MF a[244:247],v[124:127],v[180:183],a[244:247]
MF a[248:251],v[124:127],v[184:187],a[248:251]
MF a[252:255],v[124:127],v[188:191],a[252:255]
v_lshrrev_b32 v4,7,v0
v_lshlrev_b32 v4,13,v4
v_sub_u32 v10,v10,v4
v_sub_u32 v11,v11,v4
v_sub_u32 v12,v12,v4
v_sub_u32 v13,v13,v4
DR v[64:67],v10 offset:32768
DT v[128:129],v14 offset:0
DT v[130:131],v14 offset:2048
DT v[132:133],v15 offset:0
DT v[134:135],v15 offset:2048
DT v[136:137],v16 offset:0
DT v[138:139],v16 offset:2048
DT v[140:141],v17 offset:0
DT v[142:143],v17 offset:2048
DT v[144:145],v18 offset:0
DT v[146:147],v18 offset:2048
DT v[148:149],v19 offset:0
DT v[150:151],v19 offset:2048
DT v[152:153],v20 offset:0
DT v[154:155],v20 offset:2048
DT v[156:157],v21 offset:0
DT v[158:159],v21 offset:2048
DR v[68:71],v10 offset:34816
DR v[72:75],v10 offset:36864
DR v[76:79],v10 offset:38912
s_nop 4
v_lshlrev_b32 v3,4,v1
v_lshrrev_b32 v4,7,v0
v_lshlrev_b32 v4,16,v4
v_add_u32 v3,v3,v4
v_bfe_u32 v4,v0,6,1
v_lshlrev_b32 v4,13,v4
v_add_u32 v3,v3,v4
s_lshl_b32 s29,s28,17
AR v192,a0
AR v193,a1
AR v194,a2
AR v195,a3
AR v196,a32
AR v197,a33
AR v198,a34
AR v199,a35
CV v200,v192,v193
CV v201,v194,v195
CV v202,v196,v197
CV v203,v198,v199
SA s30,s29,0
BS v[200:203],v3,s[16:19],s30 offen sc1
AR v204,a4
AR v205,a5
AR v206,a6
AR v207,a7
AR v208,a36
AR v209,a37
AR v210,a38
AR v211,a39
CV v212,v204,v205
CV v213,v206,v207
CV v214,v208,v209
CV v215,v210,v211
SA s30,s29,1024
BS v[212:215],v3,s[16:19],s30 offen sc1
AR v216,a8
AR v217,a9
AR v218,a10
AR v219,a11
AR v220,a40
AR v221,a41
AR v222,a42
AR v223,a43
CV v224,v216,v217
CV v225,v218,v219
CV v226,v220,v221
CV v227,v222,v223
SA s30,s29,2048
BS v[224:227],v3,s[16:19],s30 offen sc1
AR v228,a12
AR v229,a13
AR v230,a14
AR v231,a15
AR v232,a44
AR v233,a45
AR v234,a46
AR v235,a47
CV v236,v228,v229
CV v237,v230,v231
CV v238,v232,v233
CV v239,v234,v235
SA s30,s29,3072
BS v[236:239],v3,s[16:19],s30 offen sc1
AR v192,a16
AR v193,a17
AR v194,a18
AR v195,a19
AR v196,a48
AR v197,a49
AR v198,a50
AR v199,a51
CV v200,v192,v193
CV v201,v194,v195
CV v202,v196,v197
CV v203,v198,v199
SA s30,s29,4096
BS v[200:203],v3,s[16:19],s30 offen sc1
AR v204,a20
AR v205,a21
AR v206,a22
AR v207,a23
AR v208,a52
AR v209,a53
AR v210,a54
AR v211,a55
CV v212,v204,v205
CV v213,v206,v207
CV v214,v208,v209
CV v215,v210,v211
SA s30,s29,5120
BS v[212:215],v3,s[16:19],s30 offen sc1
AR v216,a24
AR v217,a25
AR v218,a26
AR v219,a27
AR v220,a56
AR v221,a57
AR v222,a58
AR v223,a59
CV v224,v216,v217
CV v225,v218,v219
CV v226,v220,v221
CV v227,v222,v223
SA s30,s29,6144
BS v[224:227],v3,s[16:19],s30 offen sc1
AR v228,a28
AR v229,a29
AR v230,a30
AR v231,a31
AR v232,a60
AR v233,a61
AR v234,a62
AR v235,a63
CV v236,v228,v229
CV v237,v230,v231
CV v238,v232,v233
CV v239,v234,v235
SA s30,s29,7168
BS v[236:239],v3,s[16:19],s30 offen sc1
AR v192,a64
AR v193,a65
AR v194,a66
AR v195,a67
AR v196,a96
AR v197,a97
AR v198,a98
AR v199,a99
CV v200,v192,v193
CV v201,v194,v195
CV v202,v196,v197
CV v203,v198,v199
SA s30,s29,16384
BS v[200:203],v3,s[16:19],s30 offen sc1
AR v204,a68
AR v205,a69
AR v206,a70
AR v207,a71
AR v208,a100
AR v209,a101
AR v210,a102
AR v211,a103
CV v212,v204,v205
CV v213,v206,v207
CV v214,v208,v209
CV v215,v210,v211
SA s30,s29,17408
BS v[212:215],v3,s[16:19],s30 offen sc1
AR v216,a72
AR v217,a73
AR v218,a74
AR v219,a75
AR v220,a104
AR v221,a105
AR v222,a106
AR v223,a107
CV v224,v216,v217
CV v225,v218,v219
CV v226,v220,v221
CV v227,v222,v223
SA s30,s29,18432
BS v[224:227],v3,s[16:19],s30 offen sc1
AR v228,a76
AR v229,a77
AR v230,a78
AR v231,a79
AR v232,a108
AR v233,a109
AR v234,a110
AR v235,a111
CV v236,v228,v229
CV v237,v230,v231
CV v238,v232,v233
CV v239,v234,v235
SA s30,s29,19456
BS v[236:239],v3,s[16:19],s30 offen sc1
AR v192,a80
AR v193,a81
AR v194,a82
AR v195,a83
AR v196,a112
AR v197,a113
AR v198,a114
AR v199,a115
CV v200,v192,v193
CV v201,v194,v195
CV v202,v196,v197
CV v203,v198,v199
SA s30,s29,20480
BS v[200:203],v3,s[16:19],s30 offen sc1
AR v204,a84
AR v205,a85
AR v206,a86
AR v207,a87
AR v208,a116
AR v209,a117
AR v210,a118
AR v211,a119
CV v212,v204,v205
CV v213,v206,v207
CV v214,v208,v209
CV v215,v210,v211
SA s30,s29,21504
BS v[212:215],v3,s[16:19],s30 offen sc1
AR v216,a88
AR v217,a89
AR v218,a90
AR v219,a91
AR v220,a120
AR v221,a121
AR v222,a122
AR v223,a123
CV v224,v216,v217
CV v225,v218,v219
CV v226,v220,v221
CV v227,v222,v223
SA s30,s29,22528
BS v[224:227],v3,s[16:19],s30 offen sc1
AR v228,a92
AR v229,a93
AR v230,a94
AR v231,a95
AR v232,a124
AR v233,a125
AR v234,a126
AR v235,a127
CV v236,v228,v229
CV v237,v230,v231
CV v238,v232,v233
CV v239,v234,v235
SA s30,s29,23552
BS v[236:239],v3,s[16:19],s30 offen sc1
WT vmcnt(36) lgkmcnt(0)
s_barrier
MF a[0:3],v[128:131],v[64:67],0
DR v[96:99],v12 offset:32768
AR v192,a128
MF a[4:7],v[132:135],v[64:67],0
DT v[160:161],v14 offset:16384
AR v193,a129
MF a[8:11],v[136:139],v[64:67],0
DT v[162:163],v14 offset:18432
AR v194,a130
MF a[12:15],v[140:143],v[64:67],0
DT v[164:165],v15 offset:16384
AR v195,a131
MF a[16:19],v[144:147],v[64:67],0
DT v[166:167],v15 offset:18432
AR v196,a160
MF a[20:23],v[148:151],v[64:67],0
DT v[168:169],v16 offset:16384
AR v197,a161
MF a[24:27],v[152:155],v[64:67],0
DT v[170:171],v16 offset:18432
AR v198,a162
MF a[28:31],v[156:159],v[64:67],0
DT v[172:173],v17 offset:16384
AR v199,a163
MF a[32:35],v[128:131],v[68:71],0
DT v[174:175],v17 offset:18432
CV v200,v192,v193
MF a[36:39],v[132:135],v[68:71],0
DT v[176:177],v18 offset:16384
CV v201,v194,v195
MF a[40:43],v[136:139],v[68:71],0
DT v[178:179],v18 offset:18432
CV v202,v196,v197
MF a[44:47],v[140:143],v[68:71],0
DT v[180:181],v19 offset:16384
CV v203,v198,v199
MF a[48:51],v[144:147],v[68:71],0
DT v[182:183],v19 offset:18432
MF a[52:55],v[148:151],v[68:71],0
DT v[184:185],v20 offset:16384
MF a[56:59],v[152:155],v[68:71],0
DT v[186:187],v20 offset:18432
MF a[60:63],v[156:159],v[68:71],0
DT v[188:189],v21 offset:16384
MF a[64:67],v[128:131],v[72:75],0
DT v[190:191],v21 offset:18432
MF a[68:71],v[132:135],v[72:75],0
DR v[100:103],v12 offset:34816
MF a[72:75],v[136:139],v[72:75],0
DR v[104:107],v12 offset:36864
MF a[76:79],v[140:143],v[72:75],0
DR v[108:111],v12 offset:38912
MF a[80:83],v[144:147],v[72:75],0
SA s30,s29,32768
BS v[200:203],v3,s[16:19],s30 offen sc1
MF a[84:87],v[148:151],v[72:75],0
SA m0,s23,98304
s_mov_b32 s22,1572864
BL v26,s[40:43],s22 offen nt lds
MF a[88:91],v[152:155],v[72:75],0
AR v204,a132
AR v205,a133
MF a[92:95],v[156:159],v[72:75],0
AR v206,a134
AR v207,a135
MF a[96:99],v[128:131],v[76:79],0
BL v27,s[40:43],s22 offen offset:1024 nt lds
MF a[100:103],v[132:135],v[76:79],0
AR v208,a164
AR v209,a165
MF a[104:107],v[136:139],v[76:79],0
AR v210,a166
AR v211,a167
MF a[108:111],v[140:143],v[76:79],0
BL v28,s[40:43],s22 offen offset:2048 nt lds
MF a[112:115],v[144:147],v[76:79],0
CV v212,v204,v205
CV v213,v206,v207
MF a[116:119],v[148:151],v[76:79],0
CV v214,v208,v209
CV v215,v210,v211
MF a[120:123],v[152:155],v[76:79],0
BL v29,s[40:43],s22 offen offset:3072 nt lds
MF a[124:127],v[156:159],v[76:79],0
SA s30,s29,33792
BS v[212:215],v3,s[16:19],s30 offen sc1
WT vmcnt(34) lgkmcnt(0)
s_barrier
MF a[0:3],v[160:163],v[96:99],a[0:3]
DR v[64:67],v11 offset:0
AR v216,a136
MF a[4:7],v[164:167],v[96:99],a[4:7]
DT v[128:129],v14 offset:32768
AR v217,a137
MF a[8:11],v[168:171],v[96:99],a[8:11]
DT v[130:131],v14 offset:34816
AR v218,a138
MF a[12:15],v[172:175],v[96:99],a[12:15]
DT v[132:133],v15 offset:32768
AR v219,a139
MF a[16:19],v[176:179],v[96:99],a[16:19]
DT v[134:135],v15 offset:34816
AR v220,a168
MF a[20:23],v[180:183],v[96:99],a[20:23]
DT v[136:137],v16 offset:32768
AR v221,a169
MF a[24:27],v[184:187],v[96:99],a[24:27]
DT v[138:139],v16 offset:34816
AR v222,a170
MF a[28:31],v[188:191],v[96:99],a[28:31]
DT v[140:141],v17 offset:32768
AR v223,a171
MF a[32:35],v[160:163],v[100:103],a[32:35]
DT v[142:143],v17 offset:34816
CV v224,v216,v217
MF a[36:39],v[164:167],v[100:103],a[36:39]
DT v[144:145],v18 offset:32768
CV v225,v218,v219
MF a[40:43],v[168:171],v[100:103],a[40:43]
DT v[146:147],v18 offset:34816
CV v226,v220,v221
MF a[44:47],v[172:175],v[100:103],a[44:47]
DT v[148:149],v19 offset:32768
CV v227,v222,v223
MF a[48:51],v[176:179],v[100:103],a[48:51]
DT v[150:151],v19 offset:34816
MF a[52:55],v[180:183],v[100:103],a[52:55]
DT v[152:153],v20 offset:32768
MF a[56:59],v[184:187],v[100:103],a[56:59]
DT v[154:155],v20 offset:34816
MF a[60:63],v[188:191],v[100:103],a[60:63]
DT v[156:157],v21 offset:32768
MF a[64:67],v[160:163],v[104:107],a[64:67]
DT v[158:159],v21 offset:34816
MF a[68:71],v[164:167],v[104:107],a[68:71]
DR v[68:71],v11 offset:2048
MF a[72:75],v[168:171],v[104:107],a[72:75]
DR v[72:75],v11 offset:4096
MF a[76:79],v[172:175],v[104:107],a[76:79]
DR v[76:79],v11 offset:6144
MF a[80:83],v[176:179],v[104:107],a[80:83]
SA m0,s23,32768
s_mov_b32 s21,384
BL v30,s[36:39],s21 offen lds
MF a[84:87],v[180:183],v[104:107],a[84:87]
BL v31,s[36:39],s21 offen offset:1024 lds
MF a[88:91],v[184:187],v[104:107],a[88:91]
BL v32,s[36:39],s21 offen offset:2048 lds
MF a[92:95],v[188:191],v[104:107],a[92:95]
SA s30,s29,34816
BS v[224:227],v3,s[16:19],s30 offen sc1
MF a[96:99],v[160:163],v[108:111],a[96:99]
BL v33,s[36:39],s21 offen offset:3072 lds
MF a[100:103],v[164:167],v[108:111],a[100:103]
SA m0,s23,114688
s_mov_b32 s22,1835008
BL v26,s[40:43],s22 offen nt lds
MF a[104:107],v[168:171],v[108:111],a[104:107]
AR v228,a140
AR v229,a141
MF a[108:111],v[172:175],v[108:111],a[108:111]
BL v27,s[40:43],s22 offen offset:1024 nt lds
MF a[112:115],v[176:179],v[108:111],a[112:115]
AR v230,a142
AR v231,a143
MF a[116:119],v[180:183],v[108:111],a[116:119]
BL v28,s[40:43],s22 offen offset:2048 nt lds
MF a[120:123],v[184:187],v[108:111],a[120:123]
AR v232,a172
AR v233,a173
MF a[124:127],v[188:191],v[108:111],a[124:127]
BL v29,s[40:43],s22 offen offset:3072 nt lds
WT vmcnt(35) lgkmcnt(0)
s_barrier
MF a[0:3],v[128:131],v[64:67],a[0:3]
DR v[96:99],v13 offset:0
AR v234,a174
MF a[4:7],v[132:135],v[64:67],a[4:7]
DT v[160:161],v14 offset:49152
AR v235,a175
MF a[8:11],v[136:139],v[64:67],a[8:11]
DT v[162:163],v14 offset:51200
CV v236,v228,v229
MF a[12:15],v[140:143],v[64:67],a[12:15]
DT v[164:165],v15 offset:49152
CV v237,v230,v231
MF a[16:19],v[144:147],v[64:67],a[16:19]
DT v[166:167],v15 offset:51200
CV v238,v232,v233
MF a[20:23],v[148:151],v[64:67],a[20:23]
DT v[168:169],v16 offset:49152
CV v239,v234,v235
MF a[24:27],v[152:155],v[64:67],a[24:27]
DT v[170:171],v16 offset:51200
MF a[28:31],v[156:159],v[64:67],a[28:31]
DT v[172:173],v17 offset:49152
MF a[32:35],v[128:131],v[68:71],a[32:35]
DT v[174:175],v17 offset:51200
MF a[36:39],v[132:135],v[68:71],a[36:39]
DT v[176:177],v18 offset:49152
MF a[40:43],v[136:139],v[68:71],a[40:43]
DT v[178:179],v18 offset:51200
MF a[44:47],v[140:143],v[68:71],a[44:47]
DT v[180:181],v19 offset:49152
MF a[48:51],v[144:147],v[68:71],a[48:51]
DT v[182:183],v19 offset:51200
MF a[52:55],v[148:151],v[68:71],a[52:55]
DT v[184:185],v20 offset:49152
MF a[56:59],v[152:155],v[68:71],a[56:59]
DT v[186:187],v20 offset:51200
MF a[60:63],v[156:159],v[68:71],a[60:63]
DT v[188:189],v21 offset:49152
MF a[64:67],v[128:131],v[72:75],a[64:67]
DT v[190:191],v21 offset:51200
MF a[68:71],v[132:135],v[72:75],a[68:71]
DR v[100:103],v13 offset:2048
MF a[72:75],v[136:139],v[72:75],a[72:75]
DR v[104:107],v13 offset:4096
MF a[76:79],v[140:143],v[72:75],a[76:79]
DR v[108:111],v13 offset:6144
MF a[80:83],v[144:147],v[72:75],a[80:83]
SA s30,s29,35840
BS v[236:239],v3,s[16:19],s30 offen sc1
MF a[84:87],v[148:151],v[72:75],a[84:87]
SA m0,s23,131072
s_mov_b32 s22,2097152
BL v26,s[40:43],s22 offen nt lds
MF a[88:91],v[152:155],v[72:75],a[88:91]
AR v192,a144
AR v193,a145
MF a[92:95],v[156:159],v[72:75],a[92:95]
AR v194,a146
AR v195,a147
MF a[96:99],v[128:131],v[76:79],a[96:99]
BL v27,s[40:43],s22 offen offset:1024 nt lds
MF a[100:103],v[132:135],v[76:79],a[100:103]
AR v196,a176
AR v197,a177
MF a[104:107],v[136:139],v[76:79],a[104:107]
AR v198,a178
AR v199,a179
MF a[108:111],v[140:143],v[76:79],a[108:111]
BL v28,s[40:43],s22 offen offset:2048 nt lds
MF a[112:115],v[144:147],v[76:79],a[112:115]
CV v200,v192,v193
CV v201,v194,v195
MF a[116:119],v[148:151],v[76:79],a[116:119]
CV v202,v196,v197
CV v203,v198,v199
MF a[120:123],v[152:155],v[76:79],a[120:123]
BL v29,s[40:43],s22 offen offset:3072 nt lds
MF a[124:127],v[156:159],v[76:79],a[124:127]
SA s30,s29,36864
BS v[200:203],v3,s[16:19],s30 offen sc1
WT vmcnt(37) lgkmcnt(0)
s_barrier
MF a[0:3],v[160:163],v[96:99],a[0:3]
DR v[64:67],v10 offset:0
AR v204,a148
MF a[4:7],v[164:167],v[96:99],a[4:7]
DT v[128:129],v40 offset:16384
AR v205,a149
MF a[8:11],v[168:171],v[96:99],a[8:11]
DT v[130:131],v40 offset:18432
AR v206,a150
MF a[12:15],v[172:175],v[96:99],a[12:15]
DT v[132:133],v41 offset:16384
AR v207,a151
MF a[16:19],v[176:179],v[96:99],a[16:19]
DT v[134:135],v41 offset:18432
AR v208,a180
MF a[20:23],v[180:183],v[96:99],a[20:23]
DT v[136:137],v42 offset:16384
AR v209,a181
MF a[24:27],v[184:187],v[96:99],a[24:27]
DT v[138:139],v42 offset:18432
AR v210,a182
MF a[28:31],v[188:191],v[96:99],a[28:31]
DT v[140:141],v43 offset:16384
AR v211,a183
MF a[32:35],v[160:163],v[100:103],a[32:35]
DT v[142:143],v43 offset:18432
CV v212,v204,v205
MF a[36:39],v[164:167],v[100:103],a[36:39]
DT v[144:145],v44 offset:16384
CV v213,v206,v207
MF a[40:43],v[168:171],v[100:103],a[40:43]
DT v[146:147],v44 offset:18432
CV v214,v208,v209
MF a[44:47],v[172:175],v[100:103],a[44:47]
DT v[148:149],v45 offset:16384
CV v215,v210,v211
MF a[48:51],v[176:179],v[100:103],a[48:51]
DT v[150:151],v45 offset:18432
MF a[52:55],v[180:183],v[100:103],a[52:55]
DT v[152:153],v46 offset:16384
MF a[56:59],v[184:187],v[100:103],a[56:59]
DT v[154:155],v46 offset:18432
MF a[60:63],v[188:191],v[100:103],a[60:63]
DT v[156:157],v47 offset:16384
MF a[64:67],v[160:163],v[104:107],a[64:67]
DT v[158:159],v47 offset:18432
MF a[68:71],v[164:167],v[104:107],a[68:71]
DR v[68:71],v10 offset:2048
MF a[72:75],v[168:171],v[104:107],a[72:75]
DR v[72:75],v10 offset:4096
MF a[76:79],v[172:175],v[104:107],a[76:79]
DR v[76:79],v10 offset:6144
MF a[80:83],v[176:179],v[104:107],a[80:83]
SA m0,s23,65536
s_mov_b32 s21,512
BL v30,s[36:39],s21 offen lds
MF a[84:87],v[180:183],v[104:107],a[84:87]
BL v31,s[36:39],s21 offen offset:1024 lds
MF a[88:91],v[184:187],v[104:107],a[88:91]
BL v32,s[36:39],s21 offen offset:2048 lds
MF a[92:95],v[188:191],v[104:107],a[92:95]
SA s30,s29,37888
BS v[212:215],v3,s[16:19],s30 offen sc1
MF a[96:99],v[160:163],v[108:111],a[96:99]
BL v33,s[36:39],s21 offen offset:3072 lds
MF a[100:103],v[164:167],v[108:111],a[100:103]
SA m0,s23,147456
s_mov_b32 s22,2359296
BL v26,s[40:43],s22 offen nt lds
MF a[104:107],v[168:171],v[108:111],a[104:107]
AR v216,a152
AR v217,a153
MF a[108:111],v[172:175],v[108:111],a[108:111]
BL v27,s[40:43],s22 offen offset:1024 nt lds
MF a[112:115],v[176:179],v[108:111],a[112:115]
AR v218,a154
AR v219,a155
MF a[116:119],v[180:183],v[108:111],a[116:119]
BL v28,s[40:43],s22 offen offset:2048 nt lds
MF a[120:123],v[184:187],v[108:111],a[120:123]
AR v220,a184
AR v221,a185
MF a[124:127],v[188:191],v[108:111],a[124:127]
BL v29,s[40:43],s22 offen offset:3072 nt lds
WT vmcnt(46) lgkmcnt(0)
s_barrier
MF a[0:3],v[128:131],v[64:67],a[0:3]
DR v[96:99],v12 offset:0
AR v222,a186
MF a[4:7],v[132:135],v[64:67],a[4:7]
DT v[160:161],v40 offset:49152
AR v223,a187
MF a[8:11],v[136:139],v[64:67],a[8:11]
DT v[162:163],v40 offset:51200
CV v224,v216,v217
MF a[12:15],v[140:143],v[64:67],a[12:15]
DT v[164:165],v41 offset:49152
CV v225,v218,v219
MF a[16:19],v[144:147],v[64:67],a[16:19]
DT v[166:167],v41 offset:51200
CV v226,v220,v221
MF a[20:23],v[148:151],v[64:67],a[20:23]
DT v[168:169],v42 offset:49152
CV v227,v222,v223
MF a[24:27],v[152:155],v[64:67],a[24:27]
DT v[170:171],v42 offset:51200
MF a[28:31],v[156:159],v[64:67],a[28:31]
DT v[172:173],v43 offset:49152
MF a[32:35],v[128:131],v[68:71],a[32:35]
DT v[174:175],v43 offset:51200
MF a[36:39],v[132:135],v[68:71],a[36:39]
DT v[176:177],v44 offset:49152
MF a[40:43],v[136:139],v[68:71],a[40:43]
DT v[178:179],v44 offset:51200
MF a[44:47],v[140:143],v[68:71],a[44:47]
DT v[180:181],v45 offset:49152
MF a[48:51],v[144:147],v[68:71],a[48:51]
DT v[182:183],v45 offset:51200
MF a[52:55],v[148:151],v[68:71],a[52:55]
DT v[184:185],v46 offset:49152
MF a[56:59],v[152:155],v[68:71],a[56:59]
DT v[186:187],v46 offset:51200
MF a[60:63],v[156:159],v[68:71],a[60:63]
DT v[188:189],v47 offset:49152
MF a[64:67],v[128:131],v[72:75],a[64:67]
DT v[190:191],v47 offset:51200
MF a[68:71],v[132:135],v[72:75],a[68:71]
DR v[100:103],v12 offset:2048
MF a[72:75],v[136:139],v[72:75],a[72:75]
DR v[104:107],v12 offset:4096
MF a[76:79],v[140:143],v[72:75],a[76:79]
DR v[108:111],v12 offset:6144
MF a[80:83],v[144:147],v[72:75],a[80:83]
SA s30,s29,38912
BS v[224:227],v3,s[16:19],s30 offen sc1
MF a[84:87],v[148:151],v[72:75],a[84:87]
SA m0,s23,49152
s_mov_b32 s22,2621440
BL v26,s[40:43],s22 offen nt lds
MF a[88:91],v[152:155],v[72:75],a[88:91]
AR v228,a156
AR v229,a157
MF a[92:95],v[156:159],v[72:75],a[92:95]
AR v230,a158
AR v231,a159
MF a[96:99],v[128:131],v[76:79],a[96:99]
BL v27,s[40:43],s22 offen offset:1024 nt lds
MF a[100:103],v[132:135],v[76:79],a[100:103]
AR v232,a188
AR v233,a189
MF a[104:107],v[136:139],v[76:79],a[104:107]
AR v234,a190
AR v235,a191
MF a[108:111],v[140:143],v[76:79],a[108:111]
BL v28,s[40:43],s22 offen offset:2048 nt lds
MF a[112:115],v[144:147],v[76:79],a[112:115]
CV v236,v228,v229
CV v237,v230,v231
MF a[116:119],v[148:151],v[76:79],a[116:119]
CV v238,v232,v233
CV v239,v234,v235
MF a[120:123],v[152:155],v[76:79],a[120:123]
BL v29,s[40:43],s22 offen offset:3072 nt lds
MF a[124:127],v[156:159],v[76:79],a[124:127]
SA s30,s29,39936
BS v[236:239],v3,s[16:19],s30 offen sc1
WT vmcnt(25) lgkmcnt(0)
s_barrier
MF a[0:3],v[160:163],v[96:99],a[0:3]
DR v[64:67],v10 offset:32768
AR v192,a192
MF a[4:7],v[164:167],v[96:99],a[4:7]
DT v[128:129],v14 offset:0
AR v193,a193
MF a[8:11],v[168:171],v[96:99],a[8:11]
DT v[130:131],v14 offset:2048
AR v194,a194
MF a[12:15],v[172:175],v[96:99],a[12:15]
DT v[132:133],v15 offset:0
AR v195,a195
MF a[16:19],v[176:179],v[96:99],a[16:19]
DT v[134:135],v15 offset:2048
AR v196,a224
MF a[20:23],v[180:183],v[96:99],a[20:23]
DT v[136:137],v16 offset:0
AR v197,a225
MF a[24:27],v[184:187],v[96:99],a[24:27]
DT v[138:139],v16 offset:2048
AR v198,a226
MF a[28:31],v[188:191],v[96:99],a[28:31]
DT v[140:141],v17 offset:0
AR v199,a227
MF a[32:35],v[160:163],v[100:103],a[32:35]
DT v[142:143],v17 offset:2048
CV v200,v192,v193
MF a[36:39],v[164:167],v[100:103],a[36:39]
DT v[144:145],v18 offset:0
CV v201,v194,v195
MF a[40:43],v[168:171],v[100:103],a[40:43]
DT v[146:147],v18 offset:2048
CV v202,v196,v197
MF a[44:47],v[172:175],v[100:103],a[44:47]
DT v[148:149],v19 offset:0
CV v203,v198,v199
MF a[48:51],v[176:179],v[100:103],a[48:51]
DT v[150:151],v19 offset:2048
MF a[52:55],v[180:183],v[100:103],a[52:55]
DT v[152:153],v20 offset:0
MF a[56:59],v[184:187],v[100:103],a[56:59]
DT v[154:155],v20 offset:2048
MF a[60:63],v[188:191],v[100:103],a[60:63]
DT v[156:157],v21 offset:0
MF a[64:67],v[160:163],v[104:107],a[64:67]
DT v[158:159],v21 offset:2048
MF a[68:71],v[164:167],v[104:107],a[68:71]
DR v[68:71],v10 offset:34816
MF a[72:75],v[168:171],v[104:107],a[72:75]
DR v[72:75],v10 offset:36864
MF a[76:79],v[172:175],v[104:107],a[76:79]
DR v[76:79],v10 offset:38912
MF a[80:83],v[176:179],v[104:107],a[80:83]
SA m0,s23,0
s_mov_b32 s21,640
BL v30,s[36:39],s21 offen lds
MF a[84:87],v[180:183],v[104:107],a[84:87]
BL v31,s[36:39],s21 offen offset:1024 lds
MF a[88:91],v[184:187],v[104:107],a[88:91]
BL v32,s[36:39],s21 offen offset:2048 lds
MF a[92:95],v[188:191],v[104:107],a[92:95]
SA s30,s29,49152
BS v[200:203],v3,s[16:19],s30 offen sc1
MF a[96:99],v[160:163],v[108:111],a[96:99]
BL v33,s[36:39],s21 offen offset:3072 lds
MF a[100:103],v[164:167],v[108:111],a[100:103]
SA m0,s23,81920
s_mov_b32 s22,2883584
BL v26,s[40:43],s22 offen nt lds
MF a[104:107],v[168:171],v[108:111],a[104:107]
AR v204,a196
AR v205,a197
MF a[108:111],v[172:175],v[108:111],a[108:111]
BL v27,s[40:43],s22 offen offset:1024 nt lds
MF a[112:115],v[176:179],v[108:111],a[112:115]
AR v206,a198
AR v207,a199
MF a[116:119],v[180:183],v[108:111],a[116:119]
BL v28,s[40:43],s22 offen offset:2048 nt lds
MF a[120:123],v[184:187],v[108:111],a[120:123]
AR v208,a228
AR v209,a229
MF a[124:127],v[188:191],v[108:111],a[124:127]
BL v29,s[40:43],s22 offen offset:3072 nt lds
WT vmcnt(30) lgkmcnt(0)
s_barrier
MF a[0:3],v[128:131],v[64:67],a[0:3]
DR v[96:99],v12 offset:32768
AR v210,a230
MF a[4:7],v[132:135],v[64:67],a[4:7]
DT v[160:161],v14 offset:16384
AR v211,a231
MF a[8:11],v[136:139],v[64:67],a[8:11]
DT v[162:163],v14 offset:18432
CV v212,v204,v205
MF a[12:15],v[140:143],v[64:67],a[12:15]
DT v[164:165],v15 offset:16384
CV v213,v206,v207
MF a[16:19],v[144:147],v[64:67],a[16:19]
DT v[166:167],v15 offset:18432
CV v214,v208,v209
MF a[20:23],v[148:151],v[64:67],a[20:23]
DT v[168:169],v16 offset:16384
CV v215,v210,v211
MF a[24:27],v[152:155],v[64:67],a[24:27]
DT v[170:171],v16 offset:18432
MF a[28:31],v[156:159],v[64:67],a[28:31]
DT v[172:173],v17 offset:16384
MF a[32:35],v[128:131],v[68:71],a[32:35]
DT v[174:175],v17 offset:18432
MF a[36:39],v[132:135],v[68:71],a[36:39]
DT v[176:177],v18 offset:16384
MF a[40:43],v[136:139],v[68:71],a[40:43]
DT v[178:179],v18 offset:18432
MF a[44:47],v[140:143],v[68:71],a[44:47]
DT v[180:181],v19 offset:16384
MF a[48:51],v[144:147],v[68:71],a[48:51]
DT v[182:183],v19 offset:18432
MF a[52:55],v[148:151],v[68:71],a[52:55]
DT v[184:185],v20 offset:16384
MF a[56:59],v[152:155],v[68:71],a[56:59]
DT v[186:187],v20 offset:18432
MF a[60:63],v[156:159],v[68:71],a[60:63]
DT v[188:189],v21 offset:16384
MF a[64:67],v[128:131],v[72:75],a[64:67]
DT v[190:191],v21 offset:18432
MF a[68:71],v[132:135],v[72:75],a[68:71]
DR v[100:103],v12 offset:34816
MF a[72:75],v[136:139],v[72:75],a[72:75]
DR v[104:107],v12 offset:36864
MF a[76:79],v[140:143],v[72:75],a[76:79]
DR v[108:111],v12 offset:38912
MF a[80:83],v[144:147],v[72:75],a[80:83]
SA s30,s29,50176
BS v[212:215],v3,s[16:19],s30 offen sc1
MF a[84:87],v[148:151],v[72:75],a[84:87]
SA m0,s23,98304
s_mov_b32 s22,3145728
BL v26,s[40:43],s22 offen nt lds
MF a[88:91],v[152:155],v[72:75],a[88:91]
AR v216,a200
AR v217,a201
MF a[92:95],v[156:159],v[72:75],a[92:95]
AR v218,a202
AR v219,a203
MF a[96:99],v[128:131],v[76:79],a[96:99]
BL v27,s[40:43],s22 offen offset:1024 nt lds
MF a[100:103],v[132:135],v[76:79],a[100:103]
AR v220,a232
AR v221,a233
MF a[104:107],v[136:139],v[76:79],a[104:107]
AR v222,a234
AR v223,a235
MF a[108:111],v[140:143],v[76:79],a[108:111]
BL v28,s[40:43],s22 offen offset:2048 nt lds
MF a[112:115],v[144:147],v[76:79],a[112:115]
CV v224,v216,v217
CV v225,v218,v219
MF a[116:119],v[148:151],v[76:79],a[116:119]
CV v226,v220,v221
CV v227,v222,v223
MF a[120:123],v[152:155],v[76:79],a[120:123]
BL v29,s[40:43],s22 offen offset:3072 nt lds
MF a[124:127],v[156:159],v[76:79],a[124:127]
SA s30,s29,51200
BS v[224:227],v3,s[16:19],s30 offen sc1
WT vmcnt(25) lgkmcnt(0)
s_barrier
MF a[0:3],v[160:163],v[96:99],a[0:3]
DR v[64:67],v11 offset:0
AR v228,a204
MF a[4:7],v[164:167],v[96:99],a[4:7]
DT v[128:129],v14 offset:32768
AR v229,a205
MF a[8:11],v[168:171],v[96:99],a[8:11]
DT v[130:131],v14 offset:34816
AR v230,a206
MF a[12:15],v[172:175],v[96:99],a[12:15]
DT v[132:133],v15 offset:32768
AR v231,a207
MF a[16:19],v[176:179],v[96:99],a[16:19]
DT v[134:135],v15 offset:34816
AR v232,a236
MF a[20:23],v[180:183],v[96:99],a[20:23]
DT v[136:137],v16 offset:32768
AR v233,a237
MF a[24:27],v[184:187],v[96:99],a[24:27]
DT v[138:139],v16 offset:34816
AR v234,a238
MF a[28:31],v[188:191],v[96:99],a[28:31]
DT v[140:141],v17 offset:32768
AR v235,a239
MF a[32:35],v[160:163],v[100:103],a[32:35]
DT v[142:143],v17 offset:34816
CV v236,v228,v229
MF a[36:39],v[164:167],v[100:103],a[36:39]
DT v[144:145],v18 offset:32768
CV v237,v230,v231
MF a[40:43],v[168:171],v[100:103],a[40:43]
DT v[146:147],v18 offset:34816
CV v238,v232,v233
MF a[44:47],v[172:175],v[100:103],a[44:47]
DT v[148:149],v19 offset:32768
CV v239,v234,v235
MF a[48:51],v[176:179],v[100:103],a[48:51]
DT v[150:151],v19 offset:34816
MF a[52:55],v[180:183],v[100:103],a[52:55]
DT v[152:153],v20 offset:32768
MF a[56:59],v[184:187],v[100:103],a[56:59]
DT v[154:155],v20 offset:34816
MF a[60:63],v[188:191],v[100:103],a[60:63]
DT v[156:157],v21 offset:32768
MF a[64:67],v[160:163],v[104:107],a[64:67]
DT v[158:159],v21 offset:34816
MF a[68:71],v[164:167],v[104:107],a[68:71]
DR v[68:71],v11 offset:2048
MF a[72:75],v[168:171],v[104:107],a[72:75]
DR v[72:75],v11 offset:4096
MF a[76:79],v[172:175],v[104:107],a[76:79]
DR v[76:79],v11 offset:6144
MF a[80:83],v[176:179],v[104:107],a[80:83]
SA m0,s23,32768
s_mov_b32 s21,768
BL v30,s[36:39],s21 offen lds
MF a[84:87],v[180:183],v[104:107],a[84:87]
BL v31,s[36:39],s21 offen offset:1024 lds
MF a[88:91],v[184:187],v[104:107],a[88:91]
BL v32,s[36:39],s21 offen offset:2048 lds
MF a[92:95],v[188:191],v[104:107],a[92:95]
SA s30,s29,52224
BS v[236:239],v3,s[16:19],s30 offen sc1
MF a[96:99],v[160:163],v[108:111],a[96:99]
BL v33,s[36:39],s21 offen offset:3072 lds
MF a[100:103],v[164:167],v[108:111],a[100:103]
SA m0,s23,114688
s_mov_b32 s22,3407872
BL v26,s[40:43],s22 offen nt lds
MF a[104:107],v[168:171],v[108:111],a[104:107]
AR v192,a208
AR v193,a209
MF a[108:111],v[172:175],v[108:111],a[108:111]
BL v27,s[40:43],s22 offen offset:1024 nt lds
MF a[112:115],v[176:179],v[108:111],a[112:115]
AR v194,a210
AR v195,a211
MF a[116:119],v[180:183],v[108:111],a[116:119]
BL v28,s[40:43],s22 offen offset:2048 nt lds
MF a[120:123],v[184:187],v[108:111],a[120:123]
AR v196,a240
AR v197,a241
MF a[124:127],v[188:191],v[108:111],a[124:127]
BL v29,s[40:43],s22 offen offset:3072 nt lds
WT vmcnt(30) lgkmcnt(0)
s_barrier
MF a[0:3],v[128:131],v[64:67],a[0:3]
DR v[96:99],v13 offset:0
AR v198,a242
MF a[4:7],v[132:135],v[64:67],a[4:7]
DT v[160:161],v14 offset:49152
AR v199,a243
MF a[8:11],v[136:139],v[64:67],a[8:11]
DT v[162:163],v14 offset:51200
CV v200,v192,v193
MF a[12:15],v[140:143],v[64:67],a[12:15]
DT v[164:165],v15 offset:49152
CV v201,v194,v195
MF a[16:19],v[144:147],v[64:67],a[16:19]
DT v[166:167],v15 offset:51200
CV v202,v196,v197
MF a[20:23],v[148:151],v[64:67],a[20:23]
DT v[168:169],v16 offset:49152
CV v203,v198,v199
MF a[24:27],v[152:155],v[64:67],a[24:27]
DT v[170:171],v16 offset:51200
MF a[28:31],v[156:159],v[64:67],a[28:31]
DT v[172:173],v17 offset:49152
MF a[32:35],v[128:131],v[68:71],a[32:35]
DT v[174:175],v17 offset:51200
MF a[36:39],v[132:135],v[68:71],a[36:39]
DT v[176:177],v18 offset:49152
MF a[40:43],v[136:139],v[68:71],a[40:43]
DT v[178:179],v18 offset:51200
MF a[44:47],v[140:143],v[68:71],a[44:47]
DT v[180:181],v19 offset:49152
MF a[48:51],v[144:147],v[68:71],a[48:51]
DT v[182:183],v19 offset:51200
MF a[52:55],v[148:151],v[68:71],a[52:55]
DT v[184:185],v20 offset:49152
MF a[56:59],v[152:155],v[68:71],a[56:59]
DT v[186:187],v20 offset:51200
MF a[60:63],v[156:159],v[68:71],a[60:63]
DT v[188:189],v21 offset:49152
MF a[64:67],v[128:131],v[72:75],a[64:67]
DT v[190:191],v21 offset:51200
MF a[68:71],v[132:135],v[72:75],a[68:71]
DR v[100:103],v13 offset:2048
MF a[72:75],v[136:139],v[72:75],a[72:75]
DR v[104:107],v13 offset:4096
MF a[76:79],v[140:143],v[72:75],a[76:79]
DR v[108:111],v13 offset:6144
MF a[80:83],v[144:147],v[72:75],a[80:83]
SA s30,s29,53248
BS v[200:203],v3,s[16:19],s30 offen sc1
MF a[84:87],v[148:151],v[72:75],a[84:87]
AR v204,a212
AR v205,a213
MF a[88:91],v[152:155],v[72:75],a[88:91]
AR v206,a214
AR v207,a215
MF a[92:95],v[156:159],v[72:75],a[92:95]
AR v208,a244
AR v209,a245
MF a[96:99],v[128:131],v[76:79],a[96:99]
AR v210,a246
AR v211,a247
MF a[100:103],v[132:135],v[76:79],a[100:103]
CV v212,v204,v205
CV v213,v206,v207
MF a[104:107],v[136:139],v[76:79],a[104:107]
CV v214,v208,v209
CV v215,v210,v211
MF a[108:111],v[140:143],v[76:79],a[108:111]
SA s30,s29,54272
BS v[212:215],v3,s[16:19],s30 offen sc1
MF a[112:115],v[144:147],v[76:79],a[112:115]
AR v216,a216
AR v217,a217
MF a[116:119],v[148:151],v[76:79],a[116:119]
AR v218,a218
AR v219,a219
MF a[120:123],v[152:155],v[76:79],a[120:123]
AR v220,a248
AR v221,a249
MF a[124:127],v[156:159],v[76:79],a[124:127]
AR v222,a250
AR v223,a251
WT vmcnt(21) lgkmcnt(0)
s_barrier
MF a[0:3],v[160:163],v[96:99],a[0:3]
DR v[64:67],v10 offset:0
CV v224,v216,v217
MF a[4:7],v[164:167],v[96:99],a[4:7]
DT v[128:129],v40 offset:16384
CV v225,v218,v219
MF a[8:11],v[168:171],v[96:99],a[8:11]
DT v[130:131],v40 offset:18432
CV v226,v220,v221
MF a[12:15],v[172:175],v[96:99],a[12:15]
DT v[132:133],v41 offset:16384
CV v227,v222,v223
MF a[16:19],v[176:179],v[96:99],a[16:19]
DT v[134:135],v41 offset:18432
MF a[20:23],v[180:183],v[96:99],a[20:23]
DT v[136:137],v42 offset:16384
MF a[24:27],v[184:187],v[96:99],a[24:27]
DT v[138:139],v42 offset:18432
MF a[28:31],v[188:191],v[96:99],a[28:31]
DT v[140:141],v43 offset:16384
MF a[32:35],v[160:163],v[100:103],a[32:35]
DT v[142:143],v43 offset:18432
MF a[36:39],v[164:167],v[100:103],a[36:39]
DT v[144:145],v44 offset:16384
MF a[40:43],v[168:171],v[100:103],a[40:43]
DT v[146:147],v44 offset:18432
MF a[44:47],v[172:175],v[100:103],a[44:47]
DT v[148:149],v45 offset:16384
MF a[48:51],v[176:179],v[100:103],a[48:51]
DT v[150:151],v45 offset:18432
MF a[52:55],v[180:183],v[100:103],a[52:55]
DT v[152:153],v46 offset:16384
MF a[56:59],v[184:187],v[100:103],a[56:59]
DT v[154:155],v46 offset:18432
MF a[60:63],v[188:191],v[100:103],a[60:63]
DT v[156:157],v47 offset:16384
MF a[64:67],v[160:163],v[104:107],a[64:67]
DT v[158:159],v47 offset:18432
MF a[68:71],v[164:167],v[104:107],a[68:71]
DR v[68:71],v10 offset:2048
MF a[72:75],v[168:171],v[104:107],a[72:75]
DR v[72:75],v10 offset:4096
MF a[76:79],v[172:175],v[104:107],a[76:79]
DR v[76:79],v10 offset:6144
MF a[80:83],v[176:179],v[104:107],a[80:83]
SA s30,s29,55296
BS v[224:227],v3,s[16:19],s30 offen sc1
MF a[84:87],v[180:183],v[104:107],a[84:87]
AR v228,a220
AR v229,a221
MF a[88:91],v[184:187],v[104:107],a[88:91]
AR v230,a222
AR v231,a223
MF a[92:95],v[188:191],v[104:107],a[92:95]
AR v232,a252
AR v233,a253
MF a[96:99],v[160:163],v[108:111],a[96:99]
AR v234,a254
AR v235,a255
MF a[100:103],v[164:167],v[108:111],a[100:103]
CV v236,v228,v229
CV v237,v230,v231
MF a[104:107],v[168:171],v[108:111],a[104:107]
CV v238,v232,v233
CV v239,v234,v235
MF a[108:111],v[172:175],v[108:111],a[108:111]
SA s30,s29,56320
BS v[236:239],v3,s[16:19],s30 offen sc1
MF a[112:115],v[176:179],v[108:111],a[112:115]
MF a[116:119],v[180:183],v[108:111],a[116:119]
MF a[120:123],v[184:187],v[108:111],a[120:123]
MF a[124:127],v[188:191],v[108:111],a[124:127]
WT vmcnt(19) lgkmcnt(0)
s_barrier
MF a[0:3],v[128:131],v[64:67],a[0:3]
DR v[96:99],v12 offset:0
MF a[4:7],v[132:135],v[64:67],a[4:7]
DT v[160:161],v40 offset:49152
MF a[8:11],v[136:139],v[64:67],a[8:11]
DT v[162:163],v40 offset:51200
MF a[12:15],v[140:143],v[64:67],a[12:15]
DT v[164:165],v41 offset:49152
MF a[16:19],v[144:147],v[64:67],a[16:19]
DT v[166:167],v41 offset:51200
MF a[20:23],v[148:151],v[64:67],a[20:23]
DT v[168:169],v42 offset:49152
MF a[24:27],v[152:155],v[64:67],a[24:27]
DT v[170:171],v42 offset:51200
MF a[28:31],v[156:159],v[64:67],a[28:31]
DT v[172:173],v43 offset:49152
MF a[32:35],v[128:131],v[68:71],a[32:35]
DT v[174:175],v43 offset:51200
MF a[36:39],v[132:135],v[68:71],a[36:39]
DT v[176:177],v44 offset:49152
MF a[40:43],v[136:139],v[68:71],a[40:43]
DT v[178:179],v44 offset:51200
MF a[44:47],v[140:143],v[68:71],a[44:47]
DT v[180:181],v45 offset:49152
MF a[48:51],v[144:147],v[68:71],a[48:51]
DT v[182:183],v45 offset:51200
MF a[52:55],v[148:151],v[68:71],a[52:55]
DT v[184:185],v46 offset:49152
MF a[56:59],v[152:155],v[68:71],a[56:59]
DT v[186:187],v46 offset:51200
MF a[60:63],v[156:159],v[68:71],a[60:63]
DT v[188:189],v47 offset:49152
MF a[64:67],v[128:131],v[72:75],a[64:67]
DT v[190:191],v47 offset:51200
MF a[68:71],v[132:135],v[72:75],a[68:71]
DR v[100:103],v12 offset:2048
MF a[72:75],v[136:139],v[72:75],a[72:75]
DR v[104:107],v12 offset:4096
MF a[76:79],v[140:143],v[72:75],a[76:79]
DR v[108:111],v12 offset:6144
MF a[80:83],v[144:147],v[72:75],a[80:83]
MF a[84:87],v[148:151],v[72:75],a[84:87]
MF a[88:91],v[152:155],v[72:75],a[88:91]
MF a[92:95],v[156:159],v[72:75],a[92:95]
MF a[96:99],v[128:131],v[76:79],a[96:99]
MF a[100:103],v[132:135],v[76:79],a[100:103]
MF a[104:107],v[136:139],v[76:79],a[104:107]
MF a[108:111],v[140:143],v[76:79],a[108:111]
MF a[112:115],v[144:147],v[76:79],a[112:115]
MF a[116:119],v[148:151],v[76:79],a[116:119]
MF a[120:123],v[152:155],v[76:79],a[120:123]
MF a[124:127],v[156:159],v[76:79],a[124:127]
WT vmcnt(8) lgkmcnt(0)
s_barrier
MF a[0:3],v[160:163],v[96:99],a[0:3]
DR v[64:67],v10 offset:32768
MF a[4:7],v[164:167],v[96:99],a[4:7]
DT v[128:129],v14 offset:0
MF a[8:11],v[168:171],v[96:99],a[8:11]
DT v[130:131],v14 offset:2048
MF a[12:15],v[172:175],v[96:99],a[12:15]
DT v[132:133],v15 offset:0
MF a[16:19],v[176:179],v[96:99],a[16:19]
DT v[134:135],v15 offset:2048
MF a[20:23],v[180:183],v[96:99],a[20:23]
DT v[136:137],v16 offset:0
MF a[24:27],v[184:187],v[96:99],a[24:27]
DT v[138:139],v16 offset:2048
MF a[28:31],v[188:191],v[96:99],a[28:31]
DT v[140:141],v17 offset:0
MF a[32:35],v[160:163],v[100:103],a[32:35]
DT v[142:143],v17 offset:2048
MF a[36:39],v[164:167],v[100:103],a[36:39]
DT v[144:145],v18 offset:0
MF a[40:43],v[168:171],v[100:103],a[40:43]
DT v[146:147],v18 offset:2048
MF a[44:47],v[172:175],v[100:103],a[44:47]
DT v[148:149],v19 offset:0
MF a[48:51],v[176:179],v[100:103],a[48:51]
DT v[150:151],v19 offset:2048
MF a[52:55],v[180:183],v[100:103],a[52:55]
DT v[152:153],v20 offset:0
MF a[56:59],v[184:187],v[100:103],a[56:59]
DT v[154:155],v20 offset:2048
MF a[60:63],v[188:191],v[100:103],a[60:63]
DT v[156:157],v21 offset:0
MF a[64:67],v[160:163],v[104:107],a[64:67]
DT v[158:159],v21 offset:2048
MF a[68:71],v[164:167],v[104:107],a[68:71]
DR v[68:71],v10 offset:34816
MF a[72:75],v[168:171],v[104:107],a[72:75]
DR v[72:75],v10 offset:36864
MF a[76:79],v[172:175],v[104:107],a[76:79]
DR v[76:79],v10 offset:38912
MF a[80:83],v[176:179],v[104:107],a[80:83]
MF a[84:87],v[180:183],v[104:107],a[84:87]
MF a[88:91],v[184:187],v[104:107],a[88:91]
MF a[92:95],v[188:191],v[104:107],a[92:95]
MF a[96:99],v[160:163],v[108:111],a[96:99]
MF a[100:103],v[164:167],v[108:111],a[100:103]
MF a[104:107],v[168:171],v[108:111],a[104:107]
MF a[108:111],v[172:175],v[108:111],a[108:111]
MF a[112:115],v[176:179],v[108:111],a[112:115]
MF a[116:119],v[180:183],v[108:111],a[116:119]
MF a[120:123],v[184:187],v[108:111],a[120:123]
MF a[124:127],v[188:191],v[108:111],a[124:127]
WT vmcnt(4) lgkmcnt(0)
s_barrier
MF a[0:3],v[128:131],v[64:67],a[0:3]
DR v[96:99],v12 offset:32768
MF a[4:7],v[132:135],v[64:67],a[4:7]
DT v[160:161],v14 offset:16384
MF a[8:11],v[136:139],v[64:67],a[8:11]
DT v[162:163],v14 offset:18432
MF a[12:15],v[140:143],v[64:67],a[12:15]
DT v[164:165],v15 offset:16384
MF a[16:19],v[144:147],v[64:67],a[16:19]
DT v[166:167],v15 offset:18432
MF a[20:23],v[148:151],v[64:67],a[20:23]
DT v[168:169],v16 offset:16384
MF a[24:27],v[152:155],v[64:67],a[24:27]
DT v[170:171],v16 offset:18432
MF a[28:31],v[156:159],v[64:67],a[28:31]
DT v[172:173],v17 offset:16384
MF a[32:35],v[128:131],v[68:71],a[32:35]
DT v[174:175],v17 offset:18432
MF a[36:39],v[132:135],v[68:71],a[36:39]
DT v[176:177],v18 offset:16384
MF a[40:43],v[136:139],v[68:71],a[40:43]
DT v[178:179],v18 offset:18432
MF a[44:47],v[140:143],v[68:71],a[44:47]
DT v[180:181],v19 offset:16384
MF a[48:51],v[144:147],v[68:71],a[48:51]
DT v[182:183],v19 offset:18432
MF a[52:55],v[148:151],v[68:71],a[52:55]
DT v[184:185],v20 offset:16384
MF a[56:59],v[152:155],v[68:71],a[56:59]
DT v[186:187],v20 offset:18432
MF a[60:63],v[156:159],v[68:71],a[60:63]
DT v[188:189],v21 offset:16384
MF a[64:67],v[128:131],v[72:75],a[64:67]
DT v[190:191],v21 offset:18432
MF a[68:71],v[132:135],v[72:75],a[68:71]
DR v[100:103],v12 offset:34816
MF a[72:75],v[136:139],v[72:75],a[72:75]
DR v[104:107],v12 offset:36864
MF a[76:79],v[140:143],v[72:75],a[76:79]
DR v[108:111],v12 offset:38912
MF a[80:83],v[144:147],v[72:75],a[80:83]
MF a[84:87],v[148:151],v[72:75],a[84:87]
MF a[88:91],v[152:155],v[72:75],a[88:91]
MF a[92:95],v[156:159],v[72:75],a[92:95]
MF a[96:99],v[128:131],v[76:79],a[96:99]
MF a[100:103],v[132:135],v[76:79],a[100:103]
MF a[104:107],v[136:139],v[76:79],a[104:107]
MF a[108:111],v[140:143],v[76:79],a[108:111]
MF a[112:115],v[144:147],v[76:79],a[112:115]
MF a[116:119],v[148:151],v[76:79],a[116:119]
MF a[120:123],v[152:155],v[76:79],a[120:123]
MF a[124:127],v[156:159],v[76:79],a[124:127]
WT lgkmcnt(0)
MF a[0:3],v[160:163],v[96:99],a[0:3]
MF a[4:7],v[164:167],v[96:99],a[4:7]
MF a[8:11],v[168:171],v[96:99],a[8:11]
MF a[12:15],v[172:175],v[96:99],a[12:15]
MF a[16:19],v[176:179],v[96:99],a[16:19]
MF a[20:23],v[180:183],v[96:99],a[20:23]
MF a[24:27],v[184:187],v[96:99],a[24:27]
MF a[28:31],v[188:191],v[96:99],a[28:31]
MF a[32:35],v[160:163],v[100:103],a[32:35]
MF a[36:39],v[164:167],v[100:103],a[36:39]
MF a[40:43],v[168:171],v[100:103],a[40:43]
MF a[44:47],v[172:175],v[100:103],a[44:47]
MF a[48:51],v[176:179],v[100:103],a[48:51]
MF a[52:55],v[180:183],v[100:103],a[52:55]
MF a[56:59],v[184:187],v[100:103],a[56:59]
MF a[60:63],v[188:191],v[100:103],a[60:63]
MF a[64:67],v[160:163],v[104:107],a[64:67]
MF a[68:71],v[164:167],v[104:107],a[68:71]
MF a[72:75],v[168:171],v[104:107],a[72:75]
MF a[76:79],v[172:175],v[104:107],a[76:79]
MF a[80:83],v[176:179],v[104:107],a[80:83]
MF a[84:87],v[180:183],v[104:107],a[84:87]
MF a[88:91],v[184:187],v[104:107],a[88:91]
MF a[92:95],v[188:191],v[104:107],a[92:95]
MF a[96:99],v[160:163],v[108:111],a[96:99]
MF a[100:103],v[164:167],v[108:111],a[100:103]
MF a[104:107],v[168:171],v[108:111],a[104:107]
MF a[108:111],v[172:175],v[108:111],a[108:111]
MF a[112:115],v[176:179],v[108:111],a[112:115]
MF a[116:119],v[180:183],v[108:111],a[116:119]
MF a[120:123],v[184:187],v[108:111],a[120:123]
MF a[124:127],v[188:191],v[108:111],a[124:127]
s_cmp_lg_u32 s20,0
s_cbranch_scc1 cps_k1_kernel_v_n_skip
s_getpc_b64 s[72:73]
cpf_k1_kernel_v_n:
s_mov_b32 s74,k2_kernel-cpf_k1_kernel_v_n
s_ashr_i32 s75,s74,31
SA s72,s72,s74
s_addc_u32 s73,s73,s75
s_lshr_b32 s74,s2,3
s_lshl_b32 s74,s74,12
v_and_b32 v8,63,v0
v_lshlrev_b32 v8,6,v8
v_add_u32 v8,s74,v8
v_min_u32 v8,54780,v8
global_load_dword v9,v8,s[72:73]
cps_k1_kernel_v_n_skip:
s_nop 7
v_lshlrev_b32 v3,4,v1
v_lshrrev_b32 v4,7,v0
v_lshlrev_b32 v4,15,v4
v_add_u32 v3,v3,v4
v_bfe_u32 v4,v0,6,1
v_lshlrev_b32 v4,12,v4
v_add_u32 v3,v3,v4
s_lshl_b32 s29,s51,16
s_mov_b32 s31,0x3db8aa3b
AR v192,a0
AR v193,a1
AR v194,a2
AR v195,a3
AR v196,a4
AR v197,a5
AR v198,a6
AR v199,a7
FM v192,s31,v192
FM v193,s31,v193
FM v194,s31,v194
FM v195,s31,v195
FM v196,s31,v196
FM v197,s31,v197
FM v198,s31,v198
FM v199,s31,v199
CV v200,v192,v193
CV v201,v194,v195
CV v202,v196,v197
CV v203,v198,v199
SA s30,s29,0
BS v[200:203],v3,s[44:47],s30 offen sc1
AR v204,a8
AR v205,a9
AR v206,a10
AR v207,a11
AR v208,a12
AR v209,a13
AR v210,a14
AR v211,a15
FM v204,s31,v204
FM v205,s31,v205
FM v206,s31,v206
FM v207,s31,v207
FM v208,s31,v208
FM v209,s31,v209
FM v210,s31,v210
FM v211,s31,v211
CV v212,v204,v205
CV v213,v206,v207
CV v214,v208,v209
CV v215,v210,v211
SA s30,s29,1024
BS v[212:215],v3,s[44:47],s30 offen sc1
AR v216,a16
AR v217,a17
AR v218,a18
AR v219,a19
AR v220,a20
AR v221,a21
AR v222,a22
AR v223,a23
FM v216,s31,v216
FM v217,s31,v217
FM v218,s31,v218
FM v219,s31,v219
FM v220,s31,v220
FM v221,s31,v221
FM v222,s31,v222
FM v223,s31,v223
CV v224,v216,v217
CV v225,v218,v219
CV v226,v220,v221
CV v227,v222,v223
SA s30,s29,2048
BS v[224:227],v3,s[44:47],s30 offen sc1
AR v228,a24
AR v229,a25
AR v230,a26
AR v231,a27
AR v232,a28
AR v233,a29
AR v234,a30
AR v235,a31
FM v228,s31,v228
FM v229,s31,v229
FM v230,s31,v230
FM v231,s31,v231
FM v232,s31,v232
FM v233,s31,v233
FM v234,s31,v234
FM v235,s31,v235
CV v236,v228,v229
CV v237,v230,v231
CV v238,v232,v233
CV v239,v234,v235
SA s30,s29,3072
BS v[236:239],v3,s[44:47],s30 offen sc1
AR v192,a32
AR v193,a33
AR v194,a34
AR v195,a35
AR v196,a36
AR v197,a37
AR v198,a38
AR v199,a39
FM v192,s31,v192
FM v193,s31,v193
FM v194,s31,v194
FM v195,s31,v195
FM v196,s31,v196
FM v197,s31,v197
FM v198,s31,v198
FM v199,s31,v199
CV v200,v192,v193
CV v201,v194,v195
CV v202,v196,v197
CV v203,v198,v199
SA s30,s29,8192
BS v[200:203],v3,s[44:47],s30 offen sc1
AR v204,a40
AR v205,a41
AR v206,a42
AR v207,a43
AR v208,a44
AR v209,a45
AR v210,a46
AR v211,a47
FM v204,s31,v204
FM v205,s31,v205
FM v206,s31,v206
FM v207,s31,v207
FM v208,s31,v208
FM v209,s31,v209
FM v210,s31,v210
FM v211,s31,v211
CV v212,v204,v205
CV v213,v206,v207
CV v214,v208,v209
CV v215,v210,v211
SA s30,s29,9216
BS v[212:215],v3,s[44:47],s30 offen sc1
AR v216,a48
AR v217,a49
AR v218,a50
AR v219,a51
AR v220,a52
AR v221,a53
AR v222,a54
AR v223,a55
FM v216,s31,v216
FM v217,s31,v217
FM v218,s31,v218
FM v219,s31,v219
FM v220,s31,v220
FM v221,s31,v221
FM v222,s31,v222
FM v223,s31,v223
CV v224,v216,v217
CV v225,v218,v219
CV v226,v220,v221
CV v227,v222,v223
SA s30,s29,10240
BS v[224:227],v3,s[44:47],s30 offen sc1
AR v228,a56
AR v229,a57
AR v230,a58
AR v231,a59
AR v232,a60
AR v233,a61
AR v234,a62
AR v235,a63
FM v228,s31,v228
FM v229,s31,v229
FM v230,s31,v230
FM v231,s31,v231
FM v232,s31,v232
FM v233,s31,v233
FM v234,s31,v234
FM v235,s31,v235
CV v236,v228,v229
CV v237,v230,v231
CV v238,v232,v233
CV v239,v234,v235
SA s30,s29,11264
BS v[236:239],v3,s[44:47],s30 offen sc1
AR v192,a64
AR v193,a65
AR v194,a66
AR v195,a67
AR v196,a68
AR v197,a69
AR v198,a70
AR v199,a71
FM v192,s31,v192
FM v193,s31,v193
FM v194,s31,v194
FM v195,s31,v195
FM v196,s31,v196
FM v197,s31,v197
FM v198,s31,v198
FM v199,s31,v199
CV v200,v192,v193
CV v201,v194,v195
CV v202,v196,v197
CV v203,v198,v199
SA s30,s29,16384
BS v[200:203],v3,s[44:47],s30 offen sc1
AR v204,a72
AR v205,a73
AR v206,a74
AR v207,a75
AR v208,a76
AR v209,a77
AR v210,a78
AR v211,a79
FM v204,s31,v204
FM v205,s31,v205
FM v206,s31,v206
FM v207,s31,v207
FM v208,s31,v208
FM v209,s31,v209
FM v210,s31,v210
FM v211,s31,v211
CV v212,v204,v205
CV v213,v206,v207
CV v214,v208,v209
CV v215,v210,v211
SA s30,s29,17408
BS v[212:215],v3,s[44:47],s30 offen sc1
AR v216,a80
AR v217,a81
AR v218,a82
AR v219,a83
AR v220,a84
AR v221,a85
AR v222,a86
AR v223,a87
FM v216,s31,v216
FM v217,s31,v217
FM v218,s31,v218
FM v219,s31,v219
FM v220,s31,v220
FM v221,s31,v221
FM v222,s31,v222
FM v223,s31,v223
CV v224,v216,v217
CV v225,v218,v219
CV v226,v220,v221
CV v227,v222,v223
SA s30,s29,18432
BS v[224:227],v3,s[44:47],s30 offen sc1
AR v228,a88
AR v229,a89
AR v230,a90
AR v231,a91
AR v232,a92
AR v233,a93
AR v234,a94
AR v235,a95
FM v228,s31,v228
FM v229,s31,v229
FM v230,s31,v230
FM v231,s31,v231
FM v232,s31,v232
FM v233,s31,v233
FM v234,s31,v234
FM v235,s31,v235
CV v236,v228,v229
CV v237,v230,v231
CV v238,v232,v233
CV v239,v234,v235
SA s30,s29,19456
BS v[236:239],v3,s[44:47],s30 offen sc1
AR v192,a96
AR v193,a97
AR v194,a98
AR v195,a99
AR v196,a100
AR v197,a101
AR v198,a102
AR v199,a103
FM v192,s31,v192
FM v193,s31,v193
FM v194,s31,v194
FM v195,s31,v195
FM v196,s31,v196
FM v197,s31,v197
FM v198,s31,v198
FM v199,s31,v199
CV v200,v192,v193
CV v201,v194,v195
CV v202,v196,v197
CV v203,v198,v199
SA s30,s29,24576
BS v[200:203],v3,s[44:47],s30 offen sc1
AR v204,a104
AR v205,a105
AR v206,a106
AR v207,a107
AR v208,a108
AR v209,a109
AR v210,a110
AR v211,a111
FM v204,s31,v204
FM v205,s31,v205
FM v206,s31,v206
FM v207,s31,v207
FM v208,s31,v208
FM v209,s31,v209
FM v210,s31,v210
FM v211,s31,v211
CV v212,v204,v205
CV v213,v206,v207
CV v214,v208,v209
CV v215,v210,v211
SA s30,s29,25600
BS v[212:215],v3,s[44:47],s30 offen sc1
AR v216,a112
AR v217,a113
AR v218,a114
AR v219,a115
AR v220,a116
AR v221,a117
AR v222,a118
AR v223,a119
FM v216,s31,v216
FM v217,s31,v217
FM v218,s31,v218
FM v219,s31,v219
FM v220,s31,v220
FM v221,s31,v221
FM v222,s31,v222
FM v223,s31,v223
CV v224,v216,v217
CV v225,v218,v219
CV v226,v220,v221
CV v227,v222,v223
SA s30,s29,26624
BS v[224:227],v3,s[44:47],s30 offen sc1
AR v228,a120
AR v229,a121
AR v230,a122
AR v231,a123
AR v232,a124
AR v233,a125
AR v234,a126
AR v235,a127
FM v228,s31,v228
FM v229,s31,v229
FM v230,s31,v230
FM v231,s31,v231
FM v232,s31,v232
FM v233,s31,v233
FM v234,s31,v234
FM v235,s31,v235
CV v236,v228,v229
CV v237,v230,v231
CV v238,v232,v233
CV v239,v234,v235
SA s30,s29,27648
BS v[236:239],v3,s[44:47],s30 offen sc1
s_endpgm
k1_kernel_end:
s_endpgm
.section .rodata,"a"
.p2align 6
.amdhsa_kernel k1_kernel
  .amdhsa_next_free_vgpr 512
  .amdhsa_next_free_sgpr 102
  .amdhsa_accum_offset 256
  .amdhsa_group_segment_fixed_size 0
  .amdhsa_kernarg_size 104
  .amdhsa_user_sgpr_count 2
  .amdhsa_user_sgpr_kernarg_segment_ptr 1
  .amdhsa_system_sgpr_workgroup_id_x 1
  .amdhsa_float_denorm_mode_32 3
.end_amdhsa_kernel
.text
.globl k2_kernel
.p2align 8
.type k2_kernel,@function
k2_kernel:
s_cmp_ge_u32 s2,256
s_cbranch_scc1 k2_kernel_end
s_load_dwordx2 s[4:5],s[0:1],96
s_load_dwordx2 s[6:7],s[0:1],40
s_load_dwordx4 s[64:67],s[0:1],56
s_load_dwordx2 s[68:69],s[0:1],72
s_load_dwordx2 s[78:79],s[0:1],0
s_load_dwordx2 s[80:81],s[0:1],80
s_and_b32 s45,s2,7
s_lshr_b32 s46,s2,3
s_and_b32 s47,s46,1
s_lshl_b32 s45,s45,1
SA s33,s45,s47
s_lshr_b32 s46,s46,1
s_and_b32 s35,s46,1
s_lshr_b32 s34,s46,1
v_lshrrev_b32 v200,6,v0
v_and_b32 v1,63,v0
v_readfirstlane_b32 s32,v200
v_lshlrev_b32 v194,4,v1
s_lshl_b32 s45,s34,1
s_sub_u32 s46,14,s45
SA s47,s45,2
s_cmp_eq_u32 s35,0
s_cselect_b32 s70,18,s46
s_cselect_b32 s71,0,18
s_cselect_b32 s72,0,s47
s_lshl_b32 s55,s70,1
s_lshl_b32 s52,s72,1
SA s52,s52,s55
v_cmp_gt_u32 vcc,s55,v1
v_subrev_u32 v203,s55,v1
s_nop 0
CM v200,v203,v1,vcc
v_mov_b32 v204,s72
v_mov_b32 v205,s70
CM v201,v204,v205,vcc
v_mov_b32 v204,0
v_mov_b32 v205,s71
CM v202,v204,v205,vcc
v_min_u32 v204,2,v201
v_cmp_lt_u32 s[56:57],v200,v204
v_lshlrev_b32 v205,1,v201
v_subrev_u32 v205,2,v205
v_cmp_lt_i32 s[58:59],v200,v205
v_and_b32 v206,1,v200
v_cmp_eq_u32 s[60:61],0,v206
v_sub_u32 v207,v200,v201
v_lshrrev_b32 v208,1,v200
v_add_u32 v209,1,v208
v_subrev_u32 v208,1,v208
CM v208,v208,v209,s[60:61]
CM v207,v207,v208,s[58:59]
CM v207,v207,v200,s[56:57]
s_and_b64 s[58:59],s[58:59],s[60:61]
s_or_b64 s[58:59],s[58:59],s[56:57]
v_mov_b32 v208,16777216
v_mov_b32 v209,0
CM v208,v208,v209,s[58:59]
v_add_u32 v207,v207,v202
v_lshlrev_b32 v207,15,v207
v_add_u32 v207,v207,v208
s_lshl_b32 s45,s33,20
v_add_u32 v207,s45,v207
v_subrev_u32 v208,s52,v1
v_and_b32 v209,3,v208
v_mul_u32_u24 v209,57344,v209
v_lshrrev_b32 v210,2,v208
v_mul_u32_u24 v210,448,v210
v_add_u32 v209,v209,v210
v_cmp_gt_u32 vcc,8,v208
v_mov_b32 v210,0x7ff00000
s_nop 0
CM v209,v210,v209,vcc
v_cmp_gt_u32 vcc,s52,v1
s_nop 1
CM v196,v209,v207,vcc
s_lshl_b32 s48,s32,13
v_add_u32 v224,s48,v194
v_mov_b32 v225,v224
v_mov_b32 v226,v224
v_mov_b32 v227,v224
v_add_u32 v228,4096,v224
v_add_u32 v229,4096,v224
v_add_u32 v230,4096,v224
v_add_u32 v231,4096,v224
WT lgkmcnt(0)
s_mov_b32 s8,s4
s_mov_b32 s9,s5
s_mov_b32 s10,33554432
s_mov_b32 s11,0x20000
s_lshl_b32 s45,s33,20
SA s45,s45,33554432
SA s12,s4,s45
s_addc_u32 s13,s5,0
s_mov_b32 s14,1048576
s_mov_b32 s15,0x20000
s_mov_b32 s40,s70
s_mov_b32 s42,s71
s_sub_u32 s43,15,s34
s_xor_b32 s44,s35,1
s_cmp_lg_u32 s70,0
s_cbranch_scc1 k2_kernel_n1ok1
s_mov_b32 s40,s72
s_mov_b32 s42,0
s_mov_b32 s43,s34
s_mov_b32 s44,1
k2_kernel_n1ok1:
s_cmp_lt_u32 s34,7
s_cselect_b32 s54,1,0
s_cmp_eq_u32 s35,0
s_cselect_b32 s54,s54,0
s_mov_b32 s53,0
s_mov_b32 s82,1
s_lshl_b32 s45,s43,3
s_lshl_b32 s46,s32,1
SA s45,s45,s46
s_lshl_b32 s45,s45,13
SA s46,s45,0
BL a[128:131],v194,s[12:15],s46 offen offset:0 nt
BL a[132:135],v194,s[12:15],s46 offen offset:1024 nt
BL a[136:139],v194,s[12:15],s46 offen offset:2048 nt
BL a[140:143],v194,s[12:15],s46 offen offset:3072 nt
SA s46,s45,4096
BL a[144:147],v194,s[12:15],s46 offen offset:0 nt
BL a[148:151],v194,s[12:15],s46 offen offset:1024 nt
BL a[152:155],v194,s[12:15],s46 offen offset:2048 nt
BL a[156:159],v194,s[12:15],s46 offen offset:3072 nt
SA s46,s45,8192
BL a[160:163],v194,s[12:15],s46 offen offset:0 nt
BL a[164:167],v194,s[12:15],s46 offen offset:1024 nt
BL a[168:171],v194,s[12:15],s46 offen offset:2048 nt
BL a[172:175],v194,s[12:15],s46 offen offset:3072 nt
SA s46,s45,12288
BL a[176:179],v194,s[12:15],s46 offen offset:0 nt
BL a[180:183],v194,s[12:15],s46 offen offset:1024 nt
BL a[184:187],v194,s[12:15],s46 offen offset:2048 nt
BL a[188:191],v194,s[12:15],s46 offen offset:3072 nt
v_readlane_b32 s39,v196,0
SA m0,s48,0
s_nop 3
BL v224,s[8:11],s39 offen offset:0 lds
BL v225,s[8:11],s39 offen offset:1024 lds
BL v226,s[8:11],s39 offen offset:2048 lds
BL v227,s[8:11],s39 offen offset:3072 lds
SA m0,m0,4096
s_nop 0
BL v228,s[8:11],s39 offen offset:0 lds
BL v229,s[8:11],s39 offen offset:1024 lds
BL v230,s[8:11],s39 offen offset:2048 lds
BL v231,s[8:11],s39 offen offset:3072 lds
v_readlane_b32 s39,v196,1
SA m0,s48,32768
s_nop 3
BL v224,s[8:11],s39 offen offset:0 lds
BL v225,s[8:11],s39 offen offset:1024 lds
BL v226,s[8:11],s39 offen offset:2048 lds
BL v227,s[8:11],s39 offen offset:3072 lds
SA m0,m0,4096
s_nop 0
BL v228,s[8:11],s39 offen offset:0 lds
BL v229,s[8:11],s39 offen offset:1024 lds
BL v230,s[8:11],s39 offen offset:2048 lds
BL v231,s[8:11],s39 offen offset:3072 lds
v_readlane_b32 s39,v196,2
SA m0,s48,65536
s_nop 3
BL v224,s[8:11],s39 offen offset:0 lds
BL v225,s[8:11],s39 offen offset:1024 lds
BL v226,s[8:11],s39 offen offset:2048 lds
BL v227,s[8:11],s39 offen offset:3072 lds
SA m0,m0,4096
s_nop 0
BL v228,s[8:11],s39 offen offset:0 lds
BL v229,s[8:11],s39 offen offset:1024 lds
BL v230,s[8:11],s39 offen offset:2048 lds
BL v231,s[8:11],s39 offen offset:3072 lds
v_readlane_b32 s39,v196,3
SA m0,s48,98304
s_nop 3
BL v224,s[8:11],s39 offen offset:0 lds
BL v225,s[8:11],s39 offen offset:1024 lds
BL v226,s[8:11],s39 offen offset:2048 lds
BL v227,s[8:11],s39 offen offset:3072 lds
SA m0,m0,4096
s_nop 0
BL v228,s[8:11],s39 offen offset:0 lds
BL v229,s[8:11],s39 offen offset:1024 lds
BL v230,s[8:11],s39 offen offset:2048 lds
BL v231,s[8:11],s39 offen offset:3072 lds
s_lshl_b32 s45,s2,2
SA s45,s45,s32
s_mul_i32 s45,s45,1568
v_min_u32 v2,24,v1
v_lshlrev_b32 v2,6,v2
s_mov_b32 s56,s64
s_mov_b32 s57,s65
s_mov_b32 s58,1605632
s_mov_b32 s59,0x20000
buffer_load_dword v3,v2,s[56:59],s45 offen
s_mov_b32 s56,s66
s_mov_b32 s57,s67
s_mov_b32 s58,1605632
s_mov_b32 s59,0x20000
buffer_load_dword v4,v2,s[56:59],s45 offen
s_mov_b32 s56,s68
s_mov_b32 s57,s69
s_mov_b32 s58,1605632
s_mov_b32 s59,0x20000
buffer_load_dword v5,v2,s[56:59],s45 offen
s_mov_b32 s56,s6
s_mov_b32 s57,s7
s_mov_b32 s58,3670016
s_mov_b32 s59,0x20000
s_lshl_b32 s45,s2,2
SA s45,s45,s32
s_mul_i32 s45,s45,3584
v_lshlrev_b32 v2,6,v1
buffer_load_dword v3,v2,s[56:59],s45 offen
s_lshl_b32 s45,s33,3
SA s62,s45,s34
s_lshl_b32 s45,s62,17
SA s45,s45,83886080
SA s16,s4,s45
s_addc_u32 s17,s5,0
s_mov_b32 s18,131072
s_mov_b32 s19,0x20000
s_mul_i32 s45,s33,1835008
SA s45,s45,52428800
SA s20,s4,s45
s_addc_u32 s21,s5,0
s_mov_b32 s22,1835008
s_mov_b32 s23,0x20000
s_mul_i32 s45,s33,229376
SA s24,s6,s45
s_addc_u32 s25,s7,0
s_mov_b32 s26,229376
s_mov_b32 s27,0x20000
SA s28,s4,125829120
s_addc_u32 s29,s5,0
s_mov_b32 s30,32768
s_mov_b32 s31,0x20000
s_lshl_b32 s45,s62,7
v_mov_b32 v251,s45
s_mov_b32 s36,4
s_mov_b32 s37,131072
s_mov_b32 s38,0
v_mov_b32 v192,v194
s_lshl_b32 s45,s32,9
SA s45,s45,0
v_add_u32 v200,s45,v1
v_mul_u32_u24 v201,9363,v200
v_lshrrev_b32 v201,18,v201
v_mul_u32_u24 v202,28,v201
v_sub_u32 v203,v200,v202
v_bfe_u32 v202,v201,2,1
v_lshlrev_b32 v202,1,v202
v_xor_b32 v203,v203,v202
v_lshlrev_b32 v203,4,v203
v_mul_u32_u24 v201,896,v201
v_add_u32 v203,v203,v201
v_cmp_gt_u32 vcc,1792,v200
v_subrev_u32 v203,0,v203
v_mov_b32 v202,0x7ff00000
v_add_u32 v203,4096,v203
CM v232,v202,v203,vcc
s_lshl_b32 s45,s32,9
SA s45,s45,64
v_add_u32 v200,s45,v1
v_mul_u32_u24 v201,9363,v200
v_lshrrev_b32 v201,18,v201
v_mul_u32_u24 v202,28,v201
v_sub_u32 v203,v200,v202
v_bfe_u32 v202,v201,2,1
v_lshlrev_b32 v202,1,v202
v_xor_b32 v203,v203,v202
v_lshlrev_b32 v203,4,v203
v_mul_u32_u24 v201,896,v201
v_add_u32 v203,v203,v201
v_cmp_gt_u32 vcc,1792,v200
v_subrev_u32 v203,1024,v203
v_mov_b32 v202,0x7ff00000
v_add_u32 v203,4096,v203
CM v233,v202,v203,vcc
s_lshl_b32 s45,s32,9
SA s45,s45,128
v_add_u32 v200,s45,v1
v_mul_u32_u24 v201,9363,v200
v_lshrrev_b32 v201,18,v201
v_mul_u32_u24 v202,28,v201
v_sub_u32 v203,v200,v202
v_bfe_u32 v202,v201,2,1
v_lshlrev_b32 v202,1,v202
v_xor_b32 v203,v203,v202
v_lshlrev_b32 v203,4,v203
v_mul_u32_u24 v201,896,v201
v_add_u32 v203,v203,v201
v_cmp_gt_u32 vcc,1792,v200
v_subrev_u32 v203,2048,v203
v_mov_b32 v202,0x7ff00000
v_add_u32 v203,4096,v203
CM v234,v202,v203,vcc
s_lshl_b32 s45,s32,9
SA s45,s45,192
v_add_u32 v200,s45,v1
v_mul_u32_u24 v201,9363,v200
v_lshrrev_b32 v201,18,v201
v_mul_u32_u24 v202,28,v201
v_sub_u32 v203,v200,v202
v_bfe_u32 v202,v201,2,1
v_lshlrev_b32 v202,1,v202
v_xor_b32 v203,v203,v202
v_lshlrev_b32 v203,4,v203
v_mul_u32_u24 v201,896,v201
v_add_u32 v203,v203,v201
v_cmp_gt_u32 vcc,1792,v200
v_subrev_u32 v203,3072,v203
v_mov_b32 v202,0x7ff00000
v_add_u32 v203,4096,v203
CM v235,v202,v203,vcc
s_lshl_b32 s45,s32,9
SA s45,s45,256
v_add_u32 v200,s45,v1
v_mul_u32_u24 v201,9363,v200
v_lshrrev_b32 v201,18,v201
v_mul_u32_u24 v202,28,v201
v_sub_u32 v203,v200,v202
v_bfe_u32 v202,v201,2,1
v_lshlrev_b32 v202,1,v202
v_xor_b32 v203,v203,v202
v_lshlrev_b32 v203,4,v203
v_mul_u32_u24 v201,896,v201
v_add_u32 v203,v203,v201
v_cmp_gt_u32 vcc,1792,v200
v_subrev_u32 v203,0,v203
v_mov_b32 v202,0x7ff00000
v_add_u32 v203,4096,v203
CM v236,v202,v203,vcc
s_lshl_b32 s45,s32,9
SA s45,s45,320
v_add_u32 v200,s45,v1
v_mul_u32_u24 v201,9363,v200
v_lshrrev_b32 v201,18,v201
v_mul_u32_u24 v202,28,v201
v_sub_u32 v203,v200,v202
v_bfe_u32 v202,v201,2,1
v_lshlrev_b32 v202,1,v202
v_xor_b32 v203,v203,v202
v_lshlrev_b32 v203,4,v203
v_mul_u32_u24 v201,896,v201
v_add_u32 v203,v203,v201
v_cmp_gt_u32 vcc,1792,v200
v_subrev_u32 v203,1024,v203
v_mov_b32 v202,0x7ff00000
v_add_u32 v203,4096,v203
CM v237,v202,v203,vcc
s_lshl_b32 s45,s32,9
SA s45,s45,384
v_add_u32 v200,s45,v1
v_mul_u32_u24 v201,9363,v200
v_lshrrev_b32 v201,18,v201
v_mul_u32_u24 v202,28,v201
v_sub_u32 v203,v200,v202
v_bfe_u32 v202,v201,2,1
v_lshlrev_b32 v202,1,v202
v_xor_b32 v203,v203,v202
v_lshlrev_b32 v203,4,v203
v_mul_u32_u24 v201,896,v201
v_add_u32 v203,v203,v201
v_cmp_gt_u32 vcc,1792,v200
v_subrev_u32 v203,2048,v203
v_mov_b32 v202,0x7ff00000
v_add_u32 v203,4096,v203
CM v238,v202,v203,vcc
s_lshl_b32 s45,s32,9
SA s45,s45,448
v_add_u32 v200,s45,v1
v_mul_u32_u24 v201,9363,v200
v_lshrrev_b32 v201,18,v201
v_mul_u32_u24 v202,28,v201
v_sub_u32 v203,v200,v202
v_bfe_u32 v202,v201,2,1
v_lshlrev_b32 v202,1,v202
v_xor_b32 v203,v203,v202
v_lshlrev_b32 v203,4,v203
v_mul_u32_u24 v201,896,v201
v_add_u32 v203,v203,v201
v_cmp_gt_u32 vcc,1792,v200
v_subrev_u32 v203,3072,v203
v_mov_b32 v202,0x7ff00000
v_add_u32 v203,4096,v203
CM v239,v202,v203,vcc
v_bfe_u32 v200,v1,4,2
v_lshlrev_b32 v201,2,v200
v_bfe_u32 v202,v1,2,2
v_add_u32 v201,v201,v202
v_mul_u32_u24 v201,448,v201
v_and_b32 v202,3,v1
v_lshlrev_b32 v202,3,v202
v_add_u32 v201,v201,v202
v_and_b32 v200,1,v200
v_lshlrev_b32 v200,5,v200
v_add_u32 v240,v201,v200
v_sub_u32 v241,v201,v200
v_add_u32 v241,32,v241
WT vmcnt(28)
s_barrier
DR a[192:195],v192 offset:0
DR a[196:199],v192 offset:1024
DR a[200:203],v192 offset:2048
DR a[204:207],v192 offset:3072
DR a[208:211],v192 offset:4096
DR a[212:215],v192 offset:5120
DR a[216:219],v192 offset:6144
DR a[220:223],v192 offset:7168
k2_kernel_item:
s_lshl_b32 s45,s43,7
s_lshl_b32 s46,s32,5
SA s45,s45,s46
v_and_b32 v200,15,v0
v_bfe_u32 v201,v0,4,2
v_lshlrev_b32 v201,2,v201
v_sub_u32 v200,v200,v201
v_add_u32 v190,s45,v200
v_add_u32 v191,16,v190
WT lgkmcnt(4)
MF v[64:67],a[192:195],a[128:131],0
DR a[224:227],v192 offset:8192
MF v[68:71],a[192:195],a[160:163],0
WT vmcnt(16)
s_barrier
MF v[64:67],a[196:199],a[132:135],v[64:67]
DR a[228:231],v192 offset:9216
s_cmp_lg_u32 s36,s52
s_cbranch_scc1 k2_kernel_swb3
v_mov_b32 v224,v232
v_mov_b32 v225,v233
v_mov_b32 v226,v234
v_mov_b32 v227,v235
v_mov_b32 v228,v236
v_mov_b32 v229,v237
v_mov_b32 v230,v238
v_mov_b32 v231,v239
s_sub_u32 s8,s24,4096
s_subb_u32 s9,s25,0
SA s10,s26,4096
s_mov_b32 s11,0x20000
k2_kernel_swb3:
AW a0,0
MF v[68:71],a[196:199],a[164:167],v[68:71]
v_readlane_b32 s39,v196,s36
AW a1,0
MF v[64:67],a[200:203],a[136:139],v[64:67]
DR a[232:235],v192 offset:10240
SA s38,s38,32768
s_cmp_eq_u32 s38,163840
s_cselect_b32 s38,0,s38
AW a2,0
MF v[68:71],a[200:203],a[168:171],v[68:71]
AW a3,0
AW a4,0
MF v[64:67],a[204:207],a[140:143],v[64:67]
DR a[236:239],v192 offset:11264
SA s36,s36,1
SA m0,s37,s48
v_add_u32 v193,s38,v194
MF v[68:71],a[204:207],a[172:175],v[68:71]
AW a5,0
AW a6,0
WT lgkmcnt(4)
MF v[64:67],a[208:211],a[144:147],v[64:67]
DR a[240:243],v192 offset:12288
AW a7,0
MF v[68:71],a[208:211],a[176:179],v[68:71]
BL v224,s[8:11],s39 offen offset:0 lds
MF v[64:67],a[212:215],a[148:151],v[64:67]
DR a[244:247],v192 offset:13312
AW a8,0
MF v[68:71],a[212:215],a[180:183],v[68:71]
AW a9,0
AW a10,0
MF v[64:67],a[216:219],a[152:155],v[64:67]
DR a[248:251],v192 offset:14336
AW a11,0
MF v[68:71],a[216:219],a[184:187],v[68:71]
AW a12,0
AW a13,0
MF v[64:67],a[220:223],a[156:159],v[64:67]
DR a[252:255],v192 offset:15360
AW a14,0
MF v[68:71],a[220:223],a[188:191],v[68:71]
BL v225,s[8:11],s39 offen offset:1024 lds
WT lgkmcnt(4)
MF v[72:75],a[224:227],a[128:131],0
DR a[192:195],v192 offset:16384
AW a15,0
MF v[76:79],a[224:227],a[160:163],0
AW a16,0
AW a17,0
MF v[72:75],a[228:231],a[132:135],v[72:75]
DR a[196:199],v192 offset:17408
AW a18,0
MF v[76:79],a[228:231],a[164:167],v[76:79]
AW a19,0
AW a20,0
MF v[72:75],a[232:235],a[136:139],v[72:75]
DR a[200:203],v192 offset:18432
AW a21,0
MF v[76:79],a[232:235],a[168:171],v[76:79]
BL v226,s[8:11],s39 offen offset:2048 lds
MF v[72:75],a[236:239],a[140:143],v[72:75]
DR a[204:207],v192 offset:19456
AW a22,0
MF v[76:79],a[236:239],a[172:175],v[76:79]
AW a23,0
AW a24,0
WT lgkmcnt(4)
MF v[72:75],a[240:243],a[144:147],v[72:75]
DR a[208:211],v192 offset:20480
AW a25,0
MF v[76:79],a[240:243],a[176:179],v[76:79]
AW a26,0
AW a27,0
MF v[72:75],a[244:247],a[148:151],v[72:75]
DR a[212:215],v192 offset:21504
AW a28,0
MF v[76:79],a[244:247],a[180:183],v[76:79]
BL v227,s[8:11],s39 offen offset:3072 lds
MF v[72:75],a[248:251],a[152:155],v[72:75]
DR a[216:219],v192 offset:22528
SA m0,m0,4096
AW a29,0
MF v[76:79],a[248:251],a[184:187],v[76:79]
AW a30,0
AW a31,0
MF v[72:75],a[252:255],a[156:159],v[72:75]
DR a[220:223],v192 offset:23552
AW a32,0
MF v[76:79],a[252:255],a[188:191],v[76:79]
AW a33,0
AW a34,0
WT lgkmcnt(4)
MF v[80:83],a[192:195],a[128:131],0
DR a[224:227],v192 offset:24576
AW a35,0
MF v[84:87],a[192:195],a[160:163],0
BL v228,s[8:11],s39 offen offset:0 lds
MF v[80:83],a[196:199],a[132:135],v[80:83]
DR a[228:231],v192 offset:25600
AW a36,0
MF v[84:87],a[196:199],a[164:167],v[84:87]
AW a37,0
AW a38,0
MF v[80:83],a[200:203],a[136:139],v[80:83]
DR a[232:235],v192 offset:26624
AW a39,0
MF v[84:87],a[200:203],a[168:171],v[84:87]
AW a40,0
AW a41,0
MF v[80:83],a[204:207],a[140:143],v[80:83]
DR a[236:239],v192 offset:27648
AW a42,0
MF v[84:87],a[204:207],a[172:175],v[84:87]
BL v229,s[8:11],s39 offen offset:1024 lds
WT lgkmcnt(4)
MF v[80:83],a[208:211],a[144:147],v[80:83]
DR a[240:243],v192 offset:28672
AW a43,0
MF v[84:87],a[208:211],a[176:179],v[84:87]
AW a44,0
AW a45,0
MF v[80:83],a[212:215],a[148:151],v[80:83]
DR a[244:247],v192 offset:29696
AW a46,0
MF v[84:87],a[212:215],a[180:183],v[84:87]
AW a47,0
AW a48,0
MF v[80:83],a[216:219],a[152:155],v[80:83]
DR a[248:251],v192 offset:30720
AW a49,0
MF v[84:87],a[216:219],a[184:187],v[84:87]
BL v230,s[8:11],s39 offen offset:2048 lds
MF v[80:83],a[220:223],a[156:159],v[80:83]
DR a[252:255],v192 offset:31744
AW a50,0
MF v[84:87],a[220:223],a[188:191],v[84:87]
AW a51,0
AW a52,0
WT lgkmcnt(4)
MF v[88:91],a[224:227],a[128:131],0
DR a[192:195],v193 offset:0
AW a53,0
MF v[92:95],a[224:227],a[160:163],0
AW a54,0
AW a55,0
MF v[88:91],a[228:231],a[132:135],v[88:91]
DR a[196:199],v193 offset:1024
AW a56,0
MF v[92:95],a[228:231],a[164:167],v[92:95]
BL v231,s[8:11],s39 offen offset:3072 lds
MF v[88:91],a[232:235],a[136:139],v[88:91]
DR a[200:203],v193 offset:2048
SA s37,s37,32768
s_cmp_eq_u32 s37,163840
s_cselect_b32 s37,0,s37
AW a57,0
MF v[92:95],a[232:235],a[168:171],v[92:95]
AW a58,0
AW a59,0
MF v[88:91],a[236:239],a[140:143],v[88:91]
DR a[204:207],v193 offset:3072
AW a60,0
MF v[92:95],a[236:239],a[172:175],v[92:95]
AW a61,0
AW a62,0
WT lgkmcnt(4)
MF v[88:91],a[240:243],a[144:147],v[88:91]
DR a[208:211],v193 offset:4096
AW a63,0
MF v[92:95],a[240:243],a[176:179],v[92:95]
AW a64,0
AW a65,0
MF v[88:91],a[244:247],a[148:151],v[88:91]
DR a[212:215],v193 offset:5120
AW a66,0
MF v[92:95],a[244:247],a[180:183],v[92:95]
AW a67,0
AW a68,0
MF v[88:91],a[248:251],a[152:155],v[88:91]
DR a[216:219],v193 offset:6144
AW a69,0
MF v[92:95],a[248:251],a[184:187],v[92:95]
AW a70,0
AW a71,0
MF v[88:91],a[252:255],a[156:159],v[88:91]
DR a[220:223],v193 offset:7168
AW a72,0
MF v[92:95],a[252:255],a[188:191],v[92:95]
AW a73,0
AW a74,0
AW a75,0
AW a76,0
AW a77,0
AW a78,0
AW a79,0
AW a80,0
AW a81,0
AW a82,0
AW a83,0
AW a84,0
AW a85,0
AW a86,0
AW a87,0
AW a88,0
AW a89,0
AW a90,0
AW a91,0
AW a92,0
AW a93,0
AW a94,0
AW a95,0
AW a96,0
AW a97,0
AW a98,0
AW a99,0
AW a100,0
AW a101,0
AW a102,0
AW a103,0
AW a104,0
AW a105,0
AW a106,0
AW a107,0
AW a108,0
AW a109,0
AW a110,0
AW a111,0
AW a112,0
AW a113,0
AW a114,0
AW a115,0
AW a116,0
AW a117,0
AW a118,0
AW a119,0
AW a120,0
AW a121,0
AW a122,0
AW a123,0
AW a124,0
AW a125,0
AW a126,0
AW a127,0
k2_kernel_qk0done:
s_nop 7
s_lshl_b32 s45,s43,1
s_cmp_lt_u32 s42,s45
s_cbranch_scc1 k2_kernel_nomask4
s_lshl_b32 s45,s42,6
v_subrev_u32 v200,s45,v190
v_subrev_u32 v201,s45,v191
v_mov_b32 v202,0xff800000
v_cmp_le_i32 s[56:57],0,v200
v_cmp_le_i32 s[58:59],1,v200
v_cmp_le_i32 s[60:61],2,v200
CM v64,v202,v64,s[56:57]
v_cmp_le_i32 s[56:57],3,v200
CM v65,v202,v65,s[58:59]
v_cmp_le_i32 s[58:59],16,v200
CM v66,v202,v66,s[60:61]
v_cmp_le_i32 s[60:61],17,v200
CM v67,v202,v67,s[56:57]
v_cmp_le_i32 s[56:57],18,v200
CM v72,v202,v72,s[58:59]
v_cmp_le_i32 s[58:59],19,v200
CM v73,v202,v73,s[60:61]
v_cmp_le_i32 s[60:61],32,v200
CM v74,v202,v74,s[56:57]
v_cmp_le_i32 s[56:57],33,v200
CM v75,v202,v75,s[58:59]
v_cmp_le_i32 s[58:59],34,v200
CM v80,v202,v80,s[60:61]
v_cmp_le_i32 s[60:61],35,v200
CM v81,v202,v81,s[56:57]
v_cmp_le_i32 s[56:57],48,v200
CM v82,v202,v82,s[58:59]
v_cmp_le_i32 s[58:59],49,v200
CM v83,v202,v83,s[60:61]
v_cmp_le_i32 s[60:61],50,v200
CM v88,v202,v88,s[56:57]
v_cmp_le_i32 s[56:57],51,v200
CM v89,v202,v89,s[58:59]
v_cmp_le_i32 s[58:59],0,v201
CM v90,v202,v90,s[60:61]
v_cmp_le_i32 s[60:61],1,v201
CM v91,v202,v91,s[56:57]
v_cmp_le_i32 s[56:57],2,v201
CM v68,v202,v68,s[58:59]
v_cmp_le_i32 s[58:59],3,v201
CM v69,v202,v69,s[60:61]
v_cmp_le_i32 s[60:61],16,v201
CM v70,v202,v70,s[56:57]
v_cmp_le_i32 s[56:57],17,v201
CM v71,v202,v71,s[58:59]
v_cmp_le_i32 s[58:59],18,v201
CM v76,v202,v76,s[60:61]
v_cmp_le_i32 s[60:61],19,v201
CM v77,v202,v77,s[56:57]
v_cmp_le_i32 s[56:57],32,v201
CM v78,v202,v78,s[58:59]
v_cmp_le_i32 s[58:59],33,v201
CM v79,v202,v79,s[60:61]
v_cmp_le_i32 s[60:61],34,v201
CM v84,v202,v84,s[56:57]
v_cmp_le_i32 s[56:57],35,v201
CM v85,v202,v85,s[58:59]
v_cmp_le_i32 s[58:59],48,v201
CM v86,v202,v86,s[60:61]
v_cmp_le_i32 s[60:61],49,v201
CM v87,v202,v87,s[56:57]
v_cmp_le_i32 s[56:57],50,v201
CM v92,v202,v92,s[58:59]
v_cmp_le_i32 s[58:59],51,v201
CM v93,v202,v93,s[60:61]
CM v94,v202,v94,s[56:57]
s_nop 0
CM v95,v202,v95,s[58:59]
s_nop 0
k2_kernel_nomask4:
v_max3_f32 v188,v64,v65,v66
v_max3_f32 v188,v188,v67,v72
v_max3_f32 v188,v188,v73,v74
v_max3_f32 v188,v188,v75,v80
v_max3_f32 v188,v188,v81,v82
v_max3_f32 v188,v188,v83,v88
v_max3_f32 v188,v188,v89,v90
v_max_f32 v188,v188,v91
v_max3_f32 v189,v68,v69,v70
v_max3_f32 v189,v189,v71,v76
v_max3_f32 v189,v189,v77,v78
v_max3_f32 v189,v189,v79,v84
v_max3_f32 v189,v189,v85,v86
v_max3_f32 v189,v189,v87,v92
v_max3_f32 v189,v189,v93,v94
v_max_f32 v189,v189,v95
v_mov_b32 v200,v188
v_mov_b32 v201,v189
s_nop 0
v_permlane16_swap_b32 v188,v200
v_permlane16_swap_b32 v189,v201
s_nop 0
v_max_f32 v188,v188,v200
v_max_f32 v189,v189,v201
v_mov_b32 v200,v188
v_mov_b32 v201,v189
s_nop 0
v_permlane32_swap_b32 v188,v200
v_permlane32_swap_b32 v189,v201
s_nop 0
v_max_f32 v188,v188,v200
v_max_f32 v189,v189,v201
v_max_f32 v188,0xf149f2ca,v188
FS v160,0,v188
FS v161,0,v188
FS v162,0,v188
FS v163,0,v188
v_mov_b32 v184,0
v_max_f32 v189,0xf149f2ca,v189
FS v164,0,v189
FS v165,0,v189
FS v166,0,v189
FS v167,0,v189
v_mov_b32 v185,0
FS v64,v64,v188
FS v65,v65,v188
FS v66,v66,v188
FS v67,v67,v188
FS v72,v72,v188
FS v73,v73,v188
FS v74,v74,v188
FS v75,v75,v188
FS v80,v80,v188
FS v81,v81,v188
FS v82,v82,v188
FS v83,v83,v188
FS v88,v88,v188
FS v89,v89,v188
FS v90,v90,v188
FS v91,v91,v188
FS v68,v68,v189
FS v69,v69,v189
FS v70,v70,v189
FS v71,v71,v189
FS v76,v76,v189
FS v77,v77,v189
FS v78,v78,v189
FS v79,v79,v189
FS v84,v84,v189
FS v85,v85,v189
FS v86,v86,v189
FS v87,v87,v189
FS v92,v92,v189
FS v93,v93,v189
FS v94,v94,v189
FS v95,v95,v189
WT lgkmcnt(4)
MF v[96:99],a[192:195],a[128:131],v[160:163]
DR a[224:227],v193 offset:8192
MF v[100:103],a[192:195],a[160:163],v[164:167]
WT vmcnt(16)
s_barrier
MF v[96:99],a[196:199],a[132:135],v[96:99]
DR a[228:231],v193 offset:9216
MF v[100:103],a[196:199],a[164:167],v[100:103]
v_readlane_b32 s39,v196,s36
MF v[96:99],a[200:203],a[136:139],v[96:99]
DR a[232:235],v193 offset:10240
SA s38,s38,32768
s_cmp_eq_u32 s38,163840
s_cselect_b32 s38,0,s38
MF v[100:103],a[200:203],a[168:171],v[100:103]
EX v168,v64
MF v[96:99],a[204:207],a[140:143],v[96:99]
DR a[236:239],v193 offset:11264
SA s36,s36,1
SA m0,s37,s48
v_add_u32 v192,s38,v194
MF v[100:103],a[204:207],a[172:175],v[100:103]
EX v169,v65
WT lgkmcnt(4)
MF v[96:99],a[208:211],a[144:147],v[96:99]
DR a[240:243],v193 offset:12288
MF v[100:103],a[208:211],a[176:179],v[100:103]
BL v224,s[8:11],s39 offen offset:0 lds
MF v[96:99],a[212:215],a[148:151],v[96:99]
DR a[244:247],v193 offset:13312
MF v[100:103],a[212:215],a[180:183],v[100:103]
EX v170,v66
MF v[96:99],a[216:219],a[152:155],v[96:99]
DR a[248:251],v193 offset:14336
MF v[100:103],a[216:219],a[184:187],v[100:103]
EX v171,v67
MF v[96:99],a[220:223],a[156:159],v[96:99]
DR a[252:255],v193 offset:15360
FA v186,v168,v169
MF v[100:103],a[220:223],a[188:191],v[100:103]
BL v225,s[8:11],s39 offen offset:1024 lds
WT lgkmcnt(4)
MF v[104:107],a[224:227],a[128:131],v[160:163]
DR a[192:195],v193 offset:16384
CV v128,v168,v169
MF v[108:111],a[224:227],a[160:163],v[164:167]
EX v172,v68
MF v[104:107],a[228:231],a[132:135],v[104:107]
DR a[196:199],v193 offset:17408
FA v186,v186,v170
MF v[108:111],a[228:231],a[164:167],v[108:111]
EX v173,v69
MF v[104:107],a[232:235],a[136:139],v[104:107]
DR a[200:203],v193 offset:18432
CV v129,v170,v171
MF v[108:111],a[232:235],a[168:171],v[108:111]
BL v226,s[8:11],s39 offen offset:2048 lds
MF v[104:107],a[236:239],a[140:143],v[104:107]
DR a[204:207],v193 offset:19456
FA v186,v186,v171
MF v[108:111],a[236:239],a[172:175],v[108:111]
EX v174,v70
WT lgkmcnt(4)
MF v[104:107],a[240:243],a[144:147],v[104:107]
DR a[208:211],v193 offset:20480
MF v[108:111],a[240:243],a[176:179],v[108:111]
EX v175,v71
MF v[104:107],a[244:247],a[148:151],v[104:107]
DR a[212:215],v193 offset:21504
FA v187,v172,v173
MF v[108:111],a[244:247],a[180:183],v[108:111]
BL v227,s[8:11],s39 offen offset:3072 lds
MF v[104:107],a[248:251],a[152:155],v[104:107]
DR a[216:219],v193 offset:22528
SA m0,m0,4096
CV v132,v172,v173
MF v[108:111],a[248:251],a[184:187],v[108:111]
EX v176,v72
MF v[104:107],a[252:255],a[156:159],v[104:107]
DR a[220:223],v193 offset:23552
FA v187,v187,v174
MF v[108:111],a[252:255],a[188:191],v[108:111]
EX v177,v73
WT lgkmcnt(4)
MF v[112:115],a[192:195],a[128:131],v[160:163]
DR a[224:227],v193 offset:24576
CV v133,v174,v175
MF v[116:119],a[192:195],a[160:163],v[164:167]
BL v228,s[8:11],s39 offen offset:0 lds
MF v[112:115],a[196:199],a[132:135],v[112:115]
DR a[228:231],v193 offset:25600
FA v187,v187,v175
MF v[116:119],a[196:199],a[164:167],v[116:119]
EX v178,v74
MF v[112:115],a[200:203],a[136:139],v[112:115]
DR a[232:235],v193 offset:26624
MF v[116:119],a[200:203],a[168:171],v[116:119]
EX v179,v75
MF v[112:115],a[204:207],a[140:143],v[112:115]
DR a[236:239],v193 offset:27648
FA v186,v186,v176
MF v[116:119],a[204:207],a[172:175],v[116:119]
BL v229,s[8:11],s39 offen offset:1024 lds
WT lgkmcnt(4)
MF v[112:115],a[208:211],a[144:147],v[112:115]
DR a[240:243],v193 offset:28672
FA v186,v186,v177
MF v[116:119],a[208:211],a[176:179],v[116:119]
EX v180,v76
MF v[112:115],a[212:215],a[148:151],v[112:115]
DR a[244:247],v193 offset:29696
CV v130,v176,v177
MF v[116:119],a[212:215],a[180:183],v[116:119]
EX v181,v77
MF v[112:115],a[216:219],a[152:155],v[112:115]
DR a[248:251],v193 offset:30720
FA v186,v186,v178
MF v[116:119],a[216:219],a[184:187],v[116:119]
BL v230,s[8:11],s39 offen offset:2048 lds
MF v[112:115],a[220:223],a[156:159],v[112:115]
DR a[252:255],v193 offset:31744
CV v131,v178,v179
MF v[116:119],a[220:223],a[188:191],v[116:119]
EX v182,v78
WT lgkmcnt(4)
MF v[120:123],a[224:227],a[128:131],v[160:163]
DR a[192:195],v192 offset:0
FA v186,v186,v179
MF v[124:127],a[224:227],a[160:163],v[164:167]
EX v183,v79
MF v[120:123],a[228:231],a[132:135],v[120:123]
DR a[196:199],v192 offset:1024
FA v187,v187,v180
MF v[124:127],a[228:231],a[164:167],v[124:127]
BL v231,s[8:11],s39 offen offset:3072 lds
MF v[120:123],a[232:235],a[136:139],v[120:123]
DR a[200:203],v192 offset:2048
SA s37,s37,32768
s_cmp_eq_u32 s37,163840
s_cselect_b32 s37,0,s37
FA v187,v187,v181
MF v[124:127],a[232:235],a[168:171],v[124:127]
CV v134,v180,v181
FA v187,v187,v182
MF v[120:123],a[236:239],a[140:143],v[120:123]
DR a[204:207],v192 offset:3072
CV v135,v182,v183
MF v[124:127],a[236:239],a[172:175],v[124:127]
FA v187,v187,v183
WT lgkmcnt(4)
MF v[120:123],a[240:243],a[144:147],v[120:123]
DR a[208:211],v192 offset:4096
MF v[124:127],a[240:243],a[176:179],v[124:127]
MF v[120:123],a[244:247],a[148:151],v[120:123]
DR a[212:215],v192 offset:5120
MF v[124:127],a[244:247],a[180:183],v[124:127]
MF v[120:123],a[248:251],a[152:155],v[120:123]
DR a[216:219],v192 offset:6144
MF v[124:127],a[248:251],a[184:187],v[124:127]
MF v[120:123],a[252:255],a[156:159],v[120:123]
DR a[220:223],v192 offset:7168
MF v[124:127],a[252:255],a[188:191],v[124:127]
EX v168,v80
EX v169,v81
EX v170,v82
EX v171,v83
FA v186,v186,v168
FA v186,v186,v169
CV v136,v168,v169
FA v186,v186,v170
CV v137,v170,v171
FA v186,v186,v171
EX v172,v84
EX v173,v85
EX v174,v86
EX v175,v87
FA v187,v187,v172
FA v187,v187,v173
CV v140,v172,v173
FA v187,v187,v174
CV v141,v174,v175
FA v187,v187,v175
EX v176,v88
EX v177,v89
EX v178,v90
EX v179,v91
FA v186,v186,v176
FA v186,v186,v177
CV v138,v176,v177
FA v186,v186,v178
CV v139,v178,v179
FA v186,v186,v179
EX v180,v92
EX v181,v93
EX v182,v94
EX v183,v95
FA v187,v187,v180
FA v187,v187,v181
CV v142,v180,v181
FA v187,v187,v182
CV v143,v182,v183
FA v187,v187,v183
v_max_f32 v200,v186,v187
v_cmp_lt_f32 vcc,1149239296,v200
s_cbranch_vccnz k2_kernel_slow5
k2_kernel_back6:
FA v184,v184,v186
FA v185,v185,v187
SA s42,s42,1
s_lshr_b32 s41,s40,1
s_sub_u32 s41,s41,1
s_cmp_eq_u32 s41,0
s_cbranch_scc1 k2_kernel_last
k2_kernel_loop:
WT lgkmcnt(4)
MF v[64:67],a[192:195],a[128:131],v[160:163]
DR a[224:227],v192 offset:8192
MF v[68:71],a[192:195],a[160:163],v[164:167]
WT vmcnt(16)
s_barrier
MF v[64:67],a[196:199],a[132:135],v[64:67]
DR a[228:231],v192 offset:9216
MF v[68:71],a[196:199],a[164:167],v[68:71]
v_readlane_b32 s39,v196,s36
MF v[64:67],a[200:203],a[136:139],v[64:67]
DR a[232:235],v192 offset:10240
SA s38,s38,32768
s_cmp_eq_u32 s38,163840
s_cselect_b32 s38,0,s38
MF v[68:71],a[200:203],a[168:171],v[68:71]
EX v168,v96
MF v[64:67],a[204:207],a[140:143],v[64:67]
DR a[236:239],v192 offset:11264
SA s36,s36,1
SA m0,s37,s48
v_add_u32 v193,s38,v194
MF v[68:71],a[204:207],a[172:175],v[68:71]
EX v169,v97
WT lgkmcnt(4)
MF v[64:67],a[208:211],a[144:147],v[64:67]
DR a[240:243],v192 offset:12288
MF v[68:71],a[208:211],a[176:179],v[68:71]
BL v224,s[8:11],s39 offen offset:0 lds
MF v[64:67],a[212:215],a[148:151],v[64:67]
DR a[244:247],v192 offset:13312
MF v[68:71],a[212:215],a[180:183],v[68:71]
EX v170,v98
MF v[64:67],a[216:219],a[152:155],v[64:67]
DR a[248:251],v192 offset:14336
MF v[68:71],a[216:219],a[184:187],v[68:71]
s_cmp_lg_u32 s53,1
s_cbranch_scc1 k2_kernel_sgb8
s_mov_b32 s53,0
s_cmp_lg_u32 s32,0
s_cbranch_scc1 k2_kernel_sgb8
v_mov_b32 v254,1
s_mov_b64 exec,1
buffer_store_dword v254,v251,s[28:31],0 offen sc1
s_mov_b64 exec,-1
k2_kernel_sgb8:
EX v171,v99
MF v[64:67],a[220:223],a[156:159],v[64:67]
DR a[252:255],v192 offset:15360
FA v186,v168,v169
MF v[68:71],a[220:223],a[188:191],v[68:71]
BL v225,s[8:11],s39 offen offset:1024 lds
WT lgkmcnt(4)
MF v[72:75],a[224:227],a[128:131],v[160:163]
DR a[192:195],v192 offset:16384
CV v144,v168,v169
MF v[76:79],a[224:227],a[160:163],v[164:167]
EX v172,v100
MF v[72:75],a[228:231],a[132:135],v[72:75]
DR a[196:199],v192 offset:17408
FA v186,v186,v170
MF v[76:79],a[228:231],a[164:167],v[76:79]
EX v173,v101
MF v[72:75],a[232:235],a[136:139],v[72:75]
DR a[200:203],v192 offset:18432
CV v145,v170,v171
MF v[76:79],a[232:235],a[168:171],v[76:79]
BL v226,s[8:11],s39 offen offset:2048 lds
MF v[72:75],a[236:239],a[140:143],v[72:75]
DR a[204:207],v192 offset:19456
FA v186,v186,v171
MF v[76:79],a[236:239],a[172:175],v[76:79]
EX v174,v102
WT lgkmcnt(4)
MF v[72:75],a[240:243],a[144:147],v[72:75]
DR a[208:211],v192 offset:20480
MF v[76:79],a[240:243],a[176:179],v[76:79]
EX v175,v103
MF v[72:75],a[244:247],a[148:151],v[72:75]
DR a[212:215],v192 offset:21504
FA v187,v172,v173
MF v[76:79],a[244:247],a[180:183],v[76:79]
BL v227,s[8:11],s39 offen offset:3072 lds
MF v[72:75],a[248:251],a[152:155],v[72:75]
DR a[216:219],v192 offset:22528
SA m0,m0,4096
CV v148,v172,v173
MF v[76:79],a[248:251],a[184:187],v[76:79]
EX v176,v104
MF v[72:75],a[252:255],a[156:159],v[72:75]
DR a[220:223],v192 offset:23552
FA v187,v187,v174
MF v[76:79],a[252:255],a[188:191],v[76:79]
EX v177,v105
WT lgkmcnt(4)
MF v[80:83],a[192:195],a[128:131],v[160:163]
DR a[224:227],v192 offset:24576
CV v149,v174,v175
MF v[84:87],a[192:195],a[160:163],v[164:167]
BL v228,s[8:11],s39 offen offset:0 lds
MF v[80:83],a[196:199],a[132:135],v[80:83]
DR a[228:231],v192 offset:25600
FA v187,v187,v175
MF v[84:87],a[196:199],a[164:167],v[84:87]
EX v178,v106
MF v[80:83],a[200:203],a[136:139],v[80:83]
DR a[232:235],v192 offset:26624
MF v[84:87],a[200:203],a[168:171],v[84:87]
EX v179,v107
MF v[80:83],a[204:207],a[140:143],v[80:83]
DR a[236:239],v192 offset:27648
FA v186,v186,v176
MF v[84:87],a[204:207],a[172:175],v[84:87]
BL v229,s[8:11],s39 offen offset:1024 lds
WT lgkmcnt(4)
MF v[80:83],a[208:211],a[144:147],v[80:83]
DR a[240:243],v192 offset:28672
FA v186,v186,v177
MF v[84:87],a[208:211],a[176:179],v[84:87]
EX v180,v108
MF v[80:83],a[212:215],a[148:151],v[80:83]
DR a[244:247],v192 offset:29696
CV v146,v176,v177
MF v[84:87],a[212:215],a[180:183],v[84:87]
EX v181,v109
MF v[80:83],a[216:219],a[152:155],v[80:83]
DR a[248:251],v192 offset:30720
FA v186,v186,v178
MF v[84:87],a[216:219],a[184:187],v[84:87]
BL v230,s[8:11],s39 offen offset:2048 lds
MF v[80:83],a[220:223],a[156:159],v[80:83]
DR a[252:255],v192 offset:31744
CV v147,v178,v179
MF v[84:87],a[220:223],a[188:191],v[84:87]
EX v182,v110
WT lgkmcnt(4)
MF v[88:91],a[224:227],a[128:131],v[160:163]
DR a[192:195],v193 offset:0
FA v186,v186,v179
MF v[92:95],a[224:227],a[160:163],v[164:167]
EX v183,v111
MF v[88:91],a[228:231],a[132:135],v[88:91]
DR a[196:199],v193 offset:1024
FA v187,v187,v180
MF v[92:95],a[228:231],a[164:167],v[92:95]
BL v231,s[8:11],s39 offen offset:3072 lds
MF v[88:91],a[232:235],a[136:139],v[88:91]
DR a[200:203],v193 offset:2048
SA s37,s37,32768
s_cmp_eq_u32 s37,163840
s_cselect_b32 s37,0,s37
FA v187,v187,v181
MF v[92:95],a[232:235],a[168:171],v[92:95]
CV v150,v180,v181
FA v187,v187,v182
MF v[88:91],a[236:239],a[140:143],v[88:91]
DR a[204:207],v193 offset:3072
CV v151,v182,v183
MF v[92:95],a[236:239],a[172:175],v[92:95]
FA v187,v187,v183
WT lgkmcnt(4)
MF v[88:91],a[240:243],a[144:147],v[88:91]
DR a[208:211],v193 offset:4096
MF v[92:95],a[240:243],a[176:179],v[92:95]
MF v[88:91],a[244:247],a[148:151],v[88:91]
DR a[212:215],v193 offset:5120
MF v[92:95],a[244:247],a[180:183],v[92:95]
MF v[88:91],a[248:251],a[152:155],v[88:91]
DR a[216:219],v193 offset:6144
MF v[92:95],a[248:251],a[184:187],v[92:95]
MF v[88:91],a[252:255],a[156:159],v[88:91]
DR a[220:223],v193 offset:7168
MF v[92:95],a[252:255],a[188:191],v[92:95]
WT lgkmcnt(4)
MF a[0:3],a[192:195],v[128:131],a[0:3]
DR a[224:227],v193 offset:8192
MF a[4:7],a[192:195],v[132:135],a[4:7]
WT vmcnt(16)
s_barrier
MF a[8:11],a[196:199],v[128:131],a[8:11]
DR a[228:231],v193 offset:9216
MF a[12:15],a[196:199],v[132:135],a[12:15]
v_readlane_b32 s39,v196,s36
MF a[16:19],a[200:203],v[128:131],a[16:19]
DR a[232:235],v193 offset:10240
SA s38,s38,32768
s_cmp_eq_u32 s38,163840
s_cselect_b32 s38,0,s38
MF a[20:23],a[200:203],v[132:135],a[20:23]
EX v168,v112
MF a[24:27],a[204:207],v[128:131],a[24:27]
DR a[236:239],v193 offset:11264
SA s36,s36,1
SA m0,s37,s48
v_add_u32 v192,s38,v194
MF a[28:31],a[204:207],v[132:135],a[28:31]
EX v169,v113
WT lgkmcnt(4)
MF a[32:35],a[208:211],v[128:131],a[32:35]
DR a[240:243],v193 offset:12288
SA s42,s42,1
MF a[36:39],a[208:211],v[132:135],a[36:39]
BL v224,s[8:11],s39 offen offset:0 lds
MF a[40:43],a[212:215],v[128:131],a[40:43]
DR a[244:247],v193 offset:13312
MF a[44:47],a[212:215],v[132:135],a[44:47]
EX v170,v114
MF a[48:51],a[216:219],v[128:131],a[48:51]
DR a[248:251],v193 offset:14336
MF a[52:55],a[216:219],v[132:135],a[52:55]
EX v171,v115
MF a[56:59],a[220:223],v[128:131],a[56:59]
DR a[252:255],v193 offset:15360
FA v186,v186,v168
MF a[60:63],a[220:223],v[132:135],a[60:63]
BL v225,s[8:11],s39 offen offset:1024 lds
WT lgkmcnt(4)
MF a[64:67],a[224:227],v[128:131],a[64:67]
DR a[192:195],v193 offset:16384
FA v186,v186,v169
MF a[68:71],a[224:227],v[132:135],a[68:71]
EX v172,v116
MF a[72:75],a[228:231],v[128:131],a[72:75]
DR a[196:199],v193 offset:17408
CV v152,v168,v169
MF a[76:79],a[228:231],v[132:135],a[76:79]
EX v173,v117
MF a[80:83],a[232:235],v[128:131],a[80:83]
DR a[200:203],v193 offset:18432
FA v186,v186,v170
MF a[84:87],a[232:235],v[132:135],a[84:87]
BL v226,s[8:11],s39 offen offset:2048 lds
MF a[88:91],a[236:239],v[128:131],a[88:91]
DR a[204:207],v193 offset:19456
CV v153,v170,v171
MF a[92:95],a[236:239],v[132:135],a[92:95]
EX v174,v118
WT lgkmcnt(4)
MF a[96:99],a[240:243],v[128:131],a[96:99]
DR a[208:211],v193 offset:20480
FA v186,v186,v171
MF a[100:103],a[240:243],v[132:135],a[100:103]
EX v175,v119
MF a[104:107],a[244:247],v[128:131],a[104:107]
DR a[212:215],v193 offset:21504
FA v187,v187,v172
MF a[108:111],a[244:247],v[132:135],a[108:111]
BL v227,s[8:11],s39 offen offset:3072 lds
MF a[112:115],a[248:251],v[128:131],a[112:115]
DR a[216:219],v193 offset:22528
SA m0,m0,4096
FA v187,v187,v173
MF a[116:119],a[248:251],v[132:135],a[116:119]
EX v176,v120
MF a[120:123],a[252:255],v[128:131],a[120:123]
DR a[220:223],v193 offset:23552
CV v156,v172,v173
MF a[124:127],a[252:255],v[132:135],a[124:127]
EX v177,v121
WT lgkmcnt(4)
MF a[0:3],a[192:195],v[136:139],a[0:3]
DR a[224:227],v193 offset:24576
FA v187,v187,v174
MF a[4:7],a[192:195],v[140:143],a[4:7]
BL v228,s[8:11],s39 offen offset:0 lds
MF a[8:11],a[196:199],v[136:139],a[8:11]
DR a[228:231],v193 offset:25600
CV v157,v174,v175
MF a[12:15],a[196:199],v[140:143],a[12:15]
EX v178,v122
MF a[16:19],a[200:203],v[136:139],a[16:19]
DR a[232:235],v193 offset:26624
FA v187,v187,v175
MF a[20:23],a[200:203],v[140:143],a[20:23]
EX v179,v123
MF a[24:27],a[204:207],v[136:139],a[24:27]
DR a[236:239],v193 offset:27648
FA v186,v186,v176
MF a[28:31],a[204:207],v[140:143],a[28:31]
BL v229,s[8:11],s39 offen offset:1024 lds
WT lgkmcnt(4)
MF a[32:35],a[208:211],v[136:139],a[32:35]
DR a[240:243],v193 offset:28672
FA v186,v186,v177
MF a[36:39],a[208:211],v[140:143],a[36:39]
EX v180,v124
MF a[40:43],a[212:215],v[136:139],a[40:43]
DR a[244:247],v193 offset:29696
CV v154,v176,v177
MF a[44:47],a[212:215],v[140:143],a[44:47]
EX v181,v125
MF a[48:51],a[216:219],v[136:139],a[48:51]
DR a[248:251],v193 offset:30720
FA v186,v186,v178
MF a[52:55],a[216:219],v[140:143],a[52:55]
BL v230,s[8:11],s39 offen offset:2048 lds
MF a[56:59],a[220:223],v[136:139],a[56:59]
DR a[252:255],v193 offset:31744
CV v155,v178,v179
MF a[60:63],a[220:223],v[140:143],a[60:63]
EX v182,v126
WT lgkmcnt(4)
MF a[64:67],a[224:227],v[136:139],a[64:67]
DR a[192:195],v192 offset:0
FA v186,v186,v179
MF a[68:71],a[224:227],v[140:143],a[68:71]
EX v183,v127
MF a[72:75],a[228:231],v[136:139],a[72:75]
DR a[196:199],v192 offset:1024
FA v187,v187,v180
MF a[76:79],a[228:231],v[140:143],a[76:79]
BL v231,s[8:11],s39 offen offset:3072 lds
MF a[80:83],a[232:235],v[136:139],a[80:83]
DR a[200:203],v192 offset:2048
SA s37,s37,32768
s_cmp_eq_u32 s37,163840
s_cselect_b32 s37,0,s37
FA v187,v187,v181
MF a[84:87],a[232:235],v[140:143],a[84:87]
CV v158,v180,v181
FA v187,v187,v182
MF a[88:91],a[236:239],v[136:139],a[88:91]
DR a[204:207],v192 offset:3072
CV v159,v182,v183
MF a[92:95],a[236:239],v[140:143],a[92:95]
FA v187,v187,v183
WT lgkmcnt(4)
MF a[96:99],a[240:243],v[136:139],a[96:99]
DR a[208:211],v192 offset:4096
MF a[100:103],a[240:243],v[140:143],a[100:103]
MF a[104:107],a[244:247],v[136:139],a[104:107]
DR a[212:215],v192 offset:5120
v_max_f32 v200,v186,v187
MF a[108:111],a[244:247],v[140:143],a[108:111]
v_cmp_lt_f32 vcc,1149239296,v200
MF a[112:115],a[248:251],v[136:139],a[112:115]
DR a[216:219],v192 offset:6144
MF a[116:119],a[248:251],v[140:143],a[116:119]
MF a[120:123],a[252:255],v[136:139],a[120:123]
DR a[220:223],v192 offset:7168
MF a[124:127],a[252:255],v[140:143],a[124:127]
s_cbranch_vccnz k2_kernel_slow9
k2_kernel_back10:
FA v184,v184,v186
FA v185,v185,v187
s_lshl_b32 s45,s43,1
s_cmp_lt_u32 s42,s45
s_cbranch_scc1 k2_kernel_nomask11
s_lshl_b32 s45,s42,6
v_subrev_u32 v200,s45,v190
v_subrev_u32 v201,s45,v191
v_mov_b32 v202,0xff800000
v_cmp_le_i32 s[56:57],0,v200
v_cmp_le_i32 s[58:59],1,v200
v_cmp_le_i32 s[60:61],2,v200
CM v64,v202,v64,s[56:57]
v_cmp_le_i32 s[56:57],3,v200
CM v65,v202,v65,s[58:59]
v_cmp_le_i32 s[58:59],16,v200
CM v66,v202,v66,s[60:61]
v_cmp_le_i32 s[60:61],17,v200
CM v67,v202,v67,s[56:57]
v_cmp_le_i32 s[56:57],18,v200
CM v72,v202,v72,s[58:59]
v_cmp_le_i32 s[58:59],19,v200
CM v73,v202,v73,s[60:61]
v_cmp_le_i32 s[60:61],32,v200
CM v74,v202,v74,s[56:57]
v_cmp_le_i32 s[56:57],33,v200
CM v75,v202,v75,s[58:59]
v_cmp_le_i32 s[58:59],34,v200
CM v80,v202,v80,s[60:61]
v_cmp_le_i32 s[60:61],35,v200
CM v81,v202,v81,s[56:57]
v_cmp_le_i32 s[56:57],48,v200
CM v82,v202,v82,s[58:59]
v_cmp_le_i32 s[58:59],49,v200
CM v83,v202,v83,s[60:61]
v_cmp_le_i32 s[60:61],50,v200
CM v88,v202,v88,s[56:57]
v_cmp_le_i32 s[56:57],51,v200
CM v89,v202,v89,s[58:59]
v_cmp_le_i32 s[58:59],0,v201
CM v90,v202,v90,s[60:61]
v_cmp_le_i32 s[60:61],1,v201
CM v91,v202,v91,s[56:57]
v_cmp_le_i32 s[56:57],2,v201
CM v68,v202,v68,s[58:59]
v_cmp_le_i32 s[58:59],3,v201
CM v69,v202,v69,s[60:61]
v_cmp_le_i32 s[60:61],16,v201
CM v70,v202,v70,s[56:57]
v_cmp_le_i32 s[56:57],17,v201
CM v71,v202,v71,s[58:59]
v_cmp_le_i32 s[58:59],18,v201
CM v76,v202,v76,s[60:61]
v_cmp_le_i32 s[60:61],19,v201
CM v77,v202,v77,s[56:57]
v_cmp_le_i32 s[56:57],32,v201
CM v78,v202,v78,s[58:59]
v_cmp_le_i32 s[58:59],33,v201
CM v79,v202,v79,s[60:61]
v_cmp_le_i32 s[60:61],34,v201
CM v84,v202,v84,s[56:57]
v_cmp_le_i32 s[56:57],35,v201
CM v85,v202,v85,s[58:59]
v_cmp_le_i32 s[58:59],48,v201
CM v86,v202,v86,s[60:61]
v_cmp_le_i32 s[60:61],49,v201
CM v87,v202,v87,s[56:57]
v_cmp_le_i32 s[56:57],50,v201
CM v92,v202,v92,s[58:59]
v_cmp_le_i32 s[58:59],51,v201
CM v93,v202,v93,s[60:61]
CM v94,v202,v94,s[56:57]
s_nop 0
CM v95,v202,v95,s[58:59]
s_nop 0
k2_kernel_nomask11:
WT lgkmcnt(4)
MF v[96:99],a[192:195],a[128:131],v[160:163]
DR a[224:227],v192 offset:8192
MF v[100:103],a[192:195],a[160:163],v[164:167]
WT vmcnt(16)
s_barrier
MF v[96:99],a[196:199],a[132:135],v[96:99]
DR a[228:231],v192 offset:9216
s_cmp_lg_u32 s36,s52
s_cbranch_scc1 k2_kernel_swb13
v_mov_b32 v224,v232
v_mov_b32 v225,v233
v_mov_b32 v226,v234
v_mov_b32 v227,v235
v_mov_b32 v228,v236
v_mov_b32 v229,v237
v_mov_b32 v230,v238
v_mov_b32 v231,v239
s_sub_u32 s8,s24,4096
s_subb_u32 s9,s25,0
SA s10,s26,4096
s_mov_b32 s11,0x20000
k2_kernel_swb13:
MF v[100:103],a[196:199],a[164:167],v[100:103]
v_readlane_b32 s39,v196,s36
MF v[96:99],a[200:203],a[136:139],v[96:99]
DR a[232:235],v192 offset:10240
SA s38,s38,32768
s_cmp_eq_u32 s38,163840
s_cselect_b32 s38,0,s38
MF v[100:103],a[200:203],a[168:171],v[100:103]
EX v168,v64
MF v[96:99],a[204:207],a[140:143],v[96:99]
DR a[236:239],v192 offset:11264
SA s36,s36,1
SA m0,s37,s48
v_add_u32 v193,s38,v194
MF v[100:103],a[204:207],a[172:175],v[100:103]
EX v169,v65
WT lgkmcnt(4)
MF v[96:99],a[208:211],a[144:147],v[96:99]
DR a[240:243],v192 offset:12288
MF v[100:103],a[208:211],a[176:179],v[100:103]
BL v224,s[8:11],s39 offen offset:0 lds
MF v[96:99],a[212:215],a[148:151],v[96:99]
DR a[244:247],v192 offset:13312
MF v[100:103],a[212:215],a[180:183],v[100:103]
EX v170,v66
MF v[96:99],a[216:219],a[152:155],v[96:99]
DR a[248:251],v192 offset:14336
MF v[100:103],a[216:219],a[184:187],v[100:103]
EX v171,v67
MF v[96:99],a[220:223],a[156:159],v[96:99]
DR a[252:255],v192 offset:15360
FA v186,v168,v169
MF v[100:103],a[220:223],a[188:191],v[100:103]
BL v225,s[8:11],s39 offen offset:1024 lds
WT lgkmcnt(4)
MF v[104:107],a[224:227],a[128:131],v[160:163]
DR a[192:195],v192 offset:16384
CV v128,v168,v169
MF v[108:111],a[224:227],a[160:163],v[164:167]
EX v172,v68
MF v[104:107],a[228:231],a[132:135],v[104:107]
DR a[196:199],v192 offset:17408
FA v186,v186,v170
MF v[108:111],a[228:231],a[164:167],v[108:111]
EX v173,v69
MF v[104:107],a[232:235],a[136:139],v[104:107]
DR a[200:203],v192 offset:18432
CV v129,v170,v171
MF v[108:111],a[232:235],a[168:171],v[108:111]
BL v226,s[8:11],s39 offen offset:2048 lds
MF v[104:107],a[236:239],a[140:143],v[104:107]
DR a[204:207],v192 offset:19456
FA v186,v186,v171
MF v[108:111],a[236:239],a[172:175],v[108:111]
EX v174,v70
WT lgkmcnt(4)
MF v[104:107],a[240:243],a[144:147],v[104:107]
DR a[208:211],v192 offset:20480
MF v[108:111],a[240:243],a[176:179],v[108:111]
EX v175,v71
MF v[104:107],a[244:247],a[148:151],v[104:107]
DR a[212:215],v192 offset:21504
FA v187,v172,v173
MF v[108:111],a[244:247],a[180:183],v[108:111]
BL v227,s[8:11],s39 offen offset:3072 lds
MF v[104:107],a[248:251],a[152:155],v[104:107]
DR a[216:219],v192 offset:22528
SA m0,m0,4096
CV v132,v172,v173
MF v[108:111],a[248:251],a[184:187],v[108:111]
EX v176,v72
MF v[104:107],a[252:255],a[156:159],v[104:107]
DR a[220:223],v192 offset:23552
FA v187,v187,v174
MF v[108:111],a[252:255],a[188:191],v[108:111]
EX v177,v73
WT lgkmcnt(4)
MF v[112:115],a[192:195],a[128:131],v[160:163]
DR a[224:227],v192 offset:24576
CV v133,v174,v175
MF v[116:119],a[192:195],a[160:163],v[164:167]
BL v228,s[8:11],s39 offen offset:0 lds
MF v[112:115],a[196:199],a[132:135],v[112:115]
DR a[228:231],v192 offset:25600
FA v187,v187,v175
MF v[116:119],a[196:199],a[164:167],v[116:119]
EX v178,v74
MF v[112:115],a[200:203],a[136:139],v[112:115]
DR a[232:235],v192 offset:26624
MF v[116:119],a[200:203],a[168:171],v[116:119]
EX v179,v75
MF v[112:115],a[204:207],a[140:143],v[112:115]
DR a[236:239],v192 offset:27648
FA v186,v186,v176
MF v[116:119],a[204:207],a[172:175],v[116:119]
BL v229,s[8:11],s39 offen offset:1024 lds
WT lgkmcnt(4)
MF v[112:115],a[208:211],a[144:147],v[112:115]
DR a[240:243],v192 offset:28672
FA v186,v186,v177
MF v[116:119],a[208:211],a[176:179],v[116:119]
EX v180,v76
MF v[112:115],a[212:215],a[148:151],v[112:115]
DR a[244:247],v192 offset:29696
CV v130,v176,v177
MF v[116:119],a[212:215],a[180:183],v[116:119]
EX v181,v77
MF v[112:115],a[216:219],a[152:155],v[112:115]
DR a[248:251],v192 offset:30720
FA v186,v186,v178
MF v[116:119],a[216:219],a[184:187],v[116:119]
BL v230,s[8:11],s39 offen offset:2048 lds
MF v[112:115],a[220:223],a[156:159],v[112:115]
DR a[252:255],v192 offset:31744
CV v131,v178,v179
MF v[116:119],a[220:223],a[188:191],v[116:119]
EX v182,v78
WT lgkmcnt(4)
MF v[120:123],a[224:227],a[128:131],v[160:163]
DR a[192:195],v193 offset:0
FA v186,v186,v179
MF v[124:127],a[224:227],a[160:163],v[164:167]
EX v183,v79
MF v[120:123],a[228:231],a[132:135],v[120:123]
DR a[196:199],v193 offset:1024
FA v187,v187,v180
MF v[124:127],a[228:231],a[164:167],v[124:127]
BL v231,s[8:11],s39 offen offset:3072 lds
MF v[120:123],a[232:235],a[136:139],v[120:123]
DR a[200:203],v193 offset:2048
SA s37,s37,32768
s_cmp_eq_u32 s37,163840
s_cselect_b32 s37,0,s37
FA v187,v187,v181
MF v[124:127],a[232:235],a[168:171],v[124:127]
CV v134,v180,v181
FA v187,v187,v182
MF v[120:123],a[236:239],a[140:143],v[120:123]
DR a[204:207],v193 offset:3072
CV v135,v182,v183
MF v[124:127],a[236:239],a[172:175],v[124:127]
FA v187,v187,v183
WT lgkmcnt(4)
MF v[120:123],a[240:243],a[144:147],v[120:123]
DR a[208:211],v193 offset:4096
MF v[124:127],a[240:243],a[176:179],v[124:127]
MF v[120:123],a[244:247],a[148:151],v[120:123]
DR a[212:215],v193 offset:5120
MF v[124:127],a[244:247],a[180:183],v[124:127]
MF v[120:123],a[248:251],a[152:155],v[120:123]
DR a[216:219],v193 offset:6144
MF v[124:127],a[248:251],a[184:187],v[124:127]
MF v[120:123],a[252:255],a[156:159],v[120:123]
DR a[220:223],v193 offset:7168
MF v[124:127],a[252:255],a[188:191],v[124:127]
WT lgkmcnt(4)
MF a[0:3],a[192:195],v[144:147],a[0:3]
DR a[224:227],v193 offset:8192
MF a[4:7],a[192:195],v[148:151],a[4:7]
WT vmcnt(16)
s_barrier
MF a[8:11],a[196:199],v[144:147],a[8:11]
DR a[228:231],v193 offset:9216
MF a[12:15],a[196:199],v[148:151],a[12:15]
v_readlane_b32 s39,v196,s36
MF a[16:19],a[200:203],v[144:147],a[16:19]
DR a[232:235],v193 offset:10240
SA s38,s38,32768
s_cmp_eq_u32 s38,163840
s_cselect_b32 s38,0,s38
MF a[20:23],a[200:203],v[148:151],a[20:23]
EX v168,v80
MF a[24:27],a[204:207],v[144:147],a[24:27]
DR a[236:239],v193 offset:11264
SA s36,s36,1
SA m0,s37,s48
v_add_u32 v192,s38,v194
MF a[28:31],a[204:207],v[148:151],a[28:31]
EX v169,v81
WT lgkmcnt(4)
MF a[32:35],a[208:211],v[144:147],a[32:35]
DR a[240:243],v193 offset:12288
SA s42,s42,1
MF a[36:39],a[208:211],v[148:151],a[36:39]
BL v224,s[8:11],s39 offen offset:0 lds
MF a[40:43],a[212:215],v[144:147],a[40:43]
DR a[244:247],v193 offset:13312
MF a[44:47],a[212:215],v[148:151],a[44:47]
EX v170,v82
MF a[48:51],a[216:219],v[144:147],a[48:51]
DR a[248:251],v193 offset:14336
s_sub_u32 s41,s41,1
MF a[52:55],a[216:219],v[148:151],a[52:55]
EX v171,v83
MF a[56:59],a[220:223],v[144:147],a[56:59]
DR a[252:255],v193 offset:15360
FA v186,v186,v168
MF a[60:63],a[220:223],v[148:151],a[60:63]
BL v225,s[8:11],s39 offen offset:1024 lds
WT lgkmcnt(4)
MF a[64:67],a[224:227],v[144:147],a[64:67]
DR a[192:195],v193 offset:16384
FA v186,v186,v169
MF a[68:71],a[224:227],v[148:151],a[68:71]
EX v172,v84
MF a[72:75],a[228:231],v[144:147],a[72:75]
DR a[196:199],v193 offset:17408
CV v136,v168,v169
MF a[76:79],a[228:231],v[148:151],a[76:79]
EX v173,v85
MF a[80:83],a[232:235],v[144:147],a[80:83]
DR a[200:203],v193 offset:18432
FA v186,v186,v170
MF a[84:87],a[232:235],v[148:151],a[84:87]
BL v226,s[8:11],s39 offen offset:2048 lds
MF a[88:91],a[236:239],v[144:147],a[88:91]
DR a[204:207],v193 offset:19456
CV v137,v170,v171
MF a[92:95],a[236:239],v[148:151],a[92:95]
EX v174,v86
WT lgkmcnt(4)
MF a[96:99],a[240:243],v[144:147],a[96:99]
DR a[208:211],v193 offset:20480
FA v186,v186,v171
MF a[100:103],a[240:243],v[148:151],a[100:103]
EX v175,v87
MF a[104:107],a[244:247],v[144:147],a[104:107]
DR a[212:215],v193 offset:21504
FA v187,v187,v172
MF a[108:111],a[244:247],v[148:151],a[108:111]
BL v227,s[8:11],s39 offen offset:3072 lds
MF a[112:115],a[248:251],v[144:147],a[112:115]
DR a[216:219],v193 offset:22528
SA m0,m0,4096
FA v187,v187,v173
MF a[116:119],a[248:251],v[148:151],a[116:119]
EX v176,v88
MF a[120:123],a[252:255],v[144:147],a[120:123]
DR a[220:223],v193 offset:23552
CV v140,v172,v173
MF a[124:127],a[252:255],v[148:151],a[124:127]
EX v177,v89
WT lgkmcnt(4)
MF a[0:3],a[192:195],v[152:155],a[0:3]
DR a[224:227],v193 offset:24576
FA v187,v187,v174
MF a[4:7],a[192:195],v[156:159],a[4:7]
BL v228,s[8:11],s39 offen offset:0 lds
MF a[8:11],a[196:199],v[152:155],a[8:11]
DR a[228:231],v193 offset:25600
CV v141,v174,v175
MF a[12:15],a[196:199],v[156:159],a[12:15]
EX v178,v90
MF a[16:19],a[200:203],v[152:155],a[16:19]
DR a[232:235],v193 offset:26624
FA v187,v187,v175
MF a[20:23],a[200:203],v[156:159],a[20:23]
EX v179,v91
MF a[24:27],a[204:207],v[152:155],a[24:27]
DR a[236:239],v193 offset:27648
FA v186,v186,v176
MF a[28:31],a[204:207],v[156:159],a[28:31]
BL v229,s[8:11],s39 offen offset:1024 lds
WT lgkmcnt(4)
MF a[32:35],a[208:211],v[152:155],a[32:35]
DR a[240:243],v193 offset:28672
FA v186,v186,v177
MF a[36:39],a[208:211],v[156:159],a[36:39]
EX v180,v92
MF a[40:43],a[212:215],v[152:155],a[40:43]
DR a[244:247],v193 offset:29696
CV v138,v176,v177
MF a[44:47],a[212:215],v[156:159],a[44:47]
EX v181,v93
MF a[48:51],a[216:219],v[152:155],a[48:51]
DR a[248:251],v193 offset:30720
FA v186,v186,v178
MF a[52:55],a[216:219],v[156:159],a[52:55]
BL v230,s[8:11],s39 offen offset:2048 lds
MF a[56:59],a[220:223],v[152:155],a[56:59]
DR a[252:255],v193 offset:31744
CV v139,v178,v179
MF a[60:63],a[220:223],v[156:159],a[60:63]
EX v182,v94
WT lgkmcnt(4)
MF a[64:67],a[224:227],v[152:155],a[64:67]
DR a[192:195],v192 offset:0
FA v186,v186,v179
MF a[68:71],a[224:227],v[156:159],a[68:71]
EX v183,v95
MF a[72:75],a[228:231],v[152:155],a[72:75]
DR a[196:199],v192 offset:1024
FA v187,v187,v180
MF a[76:79],a[228:231],v[156:159],a[76:79]
BL v231,s[8:11],s39 offen offset:3072 lds
MF a[80:83],a[232:235],v[152:155],a[80:83]
DR a[200:203],v192 offset:2048
SA s37,s37,32768
s_cmp_eq_u32 s37,163840
s_cselect_b32 s37,0,s37
FA v187,v187,v181
MF a[84:87],a[232:235],v[156:159],a[84:87]
CV v142,v180,v181
FA v187,v187,v182
MF a[88:91],a[236:239],v[152:155],a[88:91]
DR a[204:207],v192 offset:3072
CV v143,v182,v183
MF a[92:95],a[236:239],v[156:159],a[92:95]
FA v187,v187,v183
WT lgkmcnt(4)
MF a[96:99],a[240:243],v[152:155],a[96:99]
DR a[208:211],v192 offset:4096
MF a[100:103],a[240:243],v[156:159],a[100:103]
MF a[104:107],a[244:247],v[152:155],a[104:107]
DR a[212:215],v192 offset:5120
v_max_f32 v200,v186,v187
MF a[108:111],a[244:247],v[156:159],a[108:111]
v_cmp_lt_f32 vcc,1149239296,v200
MF a[112:115],a[248:251],v[152:155],a[112:115]
DR a[216:219],v192 offset:6144
MF a[116:119],a[248:251],v[156:159],a[116:119]
MF a[120:123],a[252:255],v[152:155],a[120:123]
DR a[220:223],v192 offset:7168
MF a[124:127],a[252:255],v[156:159],a[124:127]
s_cbranch_vccnz k2_kernel_slow14
k2_kernel_back15:
FA v184,v184,v186
FA v185,v185,v187
s_cmp_lg_u32 s41,0
s_cbranch_scc1 k2_kernel_loop
k2_kernel_last:
s_lshl_b32 s45,s43,1
s_cmp_lt_u32 s42,s45
s_cbranch_scc1 k2_kernel_nomask16
s_lshl_b32 s45,s42,6
v_subrev_u32 v200,s45,v190
v_subrev_u32 v201,s45,v191
v_mov_b32 v202,0xff800000
v_cmp_le_i32 s[56:57],0,v200
v_cmp_le_i32 s[58:59],1,v200
v_cmp_le_i32 s[60:61],2,v200
CM v96,v202,v96,s[56:57]
v_cmp_le_i32 s[56:57],3,v200
CM v97,v202,v97,s[58:59]
v_cmp_le_i32 s[58:59],16,v200
CM v98,v202,v98,s[60:61]
v_cmp_le_i32 s[60:61],17,v200
CM v99,v202,v99,s[56:57]
v_cmp_le_i32 s[56:57],18,v200
CM v104,v202,v104,s[58:59]
v_cmp_le_i32 s[58:59],19,v200
CM v105,v202,v105,s[60:61]
v_cmp_le_i32 s[60:61],32,v200
CM v106,v202,v106,s[56:57]
v_cmp_le_i32 s[56:57],33,v200
CM v107,v202,v107,s[58:59]
v_cmp_le_i32 s[58:59],34,v200
CM v112,v202,v112,s[60:61]
v_cmp_le_i32 s[60:61],35,v200
CM v113,v202,v113,s[56:57]
v_cmp_le_i32 s[56:57],48,v200
CM v114,v202,v114,s[58:59]
v_cmp_le_i32 s[58:59],49,v200
CM v115,v202,v115,s[60:61]
v_cmp_le_i32 s[60:61],50,v200
CM v120,v202,v120,s[56:57]
v_cmp_le_i32 s[56:57],51,v200
CM v121,v202,v121,s[58:59]
v_cmp_le_i32 s[58:59],0,v201
CM v122,v202,v122,s[60:61]
v_cmp_le_i32 s[60:61],1,v201
CM v123,v202,v123,s[56:57]
v_cmp_le_i32 s[56:57],2,v201
CM v100,v202,v100,s[58:59]
v_cmp_le_i32 s[58:59],3,v201
CM v101,v202,v101,s[60:61]
v_cmp_le_i32 s[60:61],16,v201
CM v102,v202,v102,s[56:57]
v_cmp_le_i32 s[56:57],17,v201
CM v103,v202,v103,s[58:59]
v_cmp_le_i32 s[58:59],18,v201
CM v108,v202,v108,s[60:61]
v_cmp_le_i32 s[60:61],19,v201
CM v109,v202,v109,s[56:57]
v_cmp_le_i32 s[56:57],32,v201
CM v110,v202,v110,s[58:59]
v_cmp_le_i32 s[58:59],33,v201
CM v111,v202,v111,s[60:61]
v_cmp_le_i32 s[60:61],34,v201
CM v116,v202,v116,s[56:57]
v_cmp_le_i32 s[56:57],35,v201
CM v117,v202,v117,s[58:59]
v_cmp_le_i32 s[58:59],48,v201
CM v118,v202,v118,s[60:61]
v_cmp_le_i32 s[60:61],49,v201
CM v119,v202,v119,s[56:57]
v_cmp_le_i32 s[56:57],50,v201
CM v124,v202,v124,s[58:59]
v_cmp_le_i32 s[58:59],51,v201
CM v125,v202,v125,s[60:61]
CM v126,v202,v126,s[56:57]
s_nop 0
CM v127,v202,v127,s[58:59]
s_nop 0
k2_kernel_nomask16:
EX v168,v96
EX v169,v97
EX v170,v98
EX v171,v99
FA v186,v168,v169
CV v144,v168,v169
FA v186,v186,v170
CV v145,v170,v171
FA v186,v186,v171
EX v172,v100
EX v173,v101
EX v174,v102
EX v175,v103
FA v187,v172,v173
CV v148,v172,v173
FA v187,v187,v174
CV v149,v174,v175
FA v187,v187,v175
EX v176,v104
EX v177,v105
EX v178,v106
EX v179,v107
FA v186,v186,v176
FA v186,v186,v177
CV v146,v176,v177
FA v186,v186,v178
CV v147,v178,v179
FA v186,v186,v179
EX v180,v108
EX v181,v109
EX v182,v110
EX v183,v111
FA v187,v187,v180
FA v187,v187,v181
CV v150,v180,v181
FA v187,v187,v182
CV v151,v182,v183
FA v187,v187,v183
WT lgkmcnt(4)
MF a[0:3],a[192:195],v[128:131],a[0:3]
DR a[224:227],v192 offset:8192
MF a[4:7],a[192:195],v[132:135],a[4:7]
WT vmcnt(16)
s_barrier
MF a[8:11],a[196:199],v[128:131],a[8:11]
DR a[228:231],v192 offset:9216
MF a[12:15],a[196:199],v[132:135],a[12:15]
v_readlane_b32 s39,v196,s36
MF a[16:19],a[200:203],v[128:131],a[16:19]
DR a[232:235],v192 offset:10240
SA s38,s38,32768
s_cmp_eq_u32 s38,163840
s_cselect_b32 s38,0,s38
MF a[20:23],a[200:203],v[132:135],a[20:23]
EX v168,v112
MF a[24:27],a[204:207],v[128:131],a[24:27]
DR a[236:239],v192 offset:11264
SA s36,s36,1
SA m0,s37,s48
v_add_u32 v193,s38,v194
MF a[28:31],a[204:207],v[132:135],a[28:31]
buffer_load_dword v250,v251,s[28:31],0 offen sc1
WT lgkmcnt(4)
MF a[32:35],a[208:211],v[128:131],a[32:35]
DR a[240:243],v192 offset:12288
MF a[36:39],a[208:211],v[132:135],a[36:39]
BL v224,s[8:11],s39 offen offset:0 lds
MF a[40:43],a[212:215],v[128:131],a[40:43]
DR a[244:247],v192 offset:13312
MF a[44:47],a[212:215],v[132:135],a[44:47]
EX v169,v113
MF a[48:51],a[216:219],v[128:131],a[48:51]
DR a[248:251],v192 offset:14336
MF a[52:55],a[216:219],v[132:135],a[52:55]
s_cmp_lg_u32 s53,1
s_cbranch_scc1 k2_kernel_sgb18
s_mov_b32 s53,0
s_cmp_lg_u32 s32,0
s_cbranch_scc1 k2_kernel_sgb18
v_mov_b32 v254,1
s_mov_b64 exec,1
buffer_store_dword v254,v251,s[28:31],0 offen sc1
s_mov_b64 exec,-1
k2_kernel_sgb18:
EX v170,v114
MF a[56:59],a[220:223],v[128:131],a[56:59]
DR a[252:255],v192 offset:15360
MF a[60:63],a[220:223],v[132:135],a[60:63]
BL v225,s[8:11],s39 offen offset:1024 lds
WT lgkmcnt(4)
MF a[64:67],a[224:227],v[128:131],a[64:67]
DR a[192:195],v192 offset:16384
MF a[68:71],a[224:227],v[132:135],a[68:71]
EX v171,v115
MF a[72:75],a[228:231],v[128:131],a[72:75]
DR a[196:199],v192 offset:17408
FA v186,v186,v168
MF a[76:79],a[228:231],v[132:135],a[76:79]
EX v172,v116
MF a[80:83],a[232:235],v[128:131],a[80:83]
DR a[200:203],v192 offset:18432
FA v186,v186,v169
MF a[84:87],a[232:235],v[132:135],a[84:87]
BL v226,s[8:11],s39 offen offset:2048 lds
MF a[88:91],a[236:239],v[128:131],a[88:91]
DR a[204:207],v192 offset:19456
CV v152,v168,v169
MF a[92:95],a[236:239],v[132:135],a[92:95]
EX v173,v117
WT lgkmcnt(4)
MF a[96:99],a[240:243],v[128:131],a[96:99]
DR a[208:211],v192 offset:20480
FA v186,v186,v170
MF a[100:103],a[240:243],v[132:135],a[100:103]
EX v174,v118
MF a[104:107],a[244:247],v[128:131],a[104:107]
DR a[212:215],v192 offset:21504
CV v153,v170,v171
MF a[108:111],a[244:247],v[132:135],a[108:111]
BL v227,s[8:11],s39 offen offset:3072 lds
MF a[112:115],a[248:251],v[128:131],a[112:115]
DR a[216:219],v192 offset:22528
SA m0,m0,4096
FA v186,v186,v171
MF a[116:119],a[248:251],v[132:135],a[116:119]
EX v175,v119
MF a[120:123],a[252:255],v[128:131],a[120:123]
DR a[220:223],v192 offset:23552
FA v187,v187,v172
MF a[124:127],a[252:255],v[132:135],a[124:127]
EX v176,v120
WT lgkmcnt(4)
MF a[0:3],a[192:195],v[136:139],a[0:3]
DR a[224:227],v192 offset:24576
FA v187,v187,v173
MF a[4:7],a[192:195],v[140:143],a[4:7]
BL v228,s[8:11],s39 offen offset:0 lds
MF a[8:11],a[196:199],v[136:139],a[8:11]
DR a[228:231],v192 offset:25600
CV v156,v172,v173
MF a[12:15],a[196:199],v[140:143],a[12:15]
EX v177,v121
MF a[16:19],a[200:203],v[136:139],a[16:19]
DR a[232:235],v192 offset:26624
FA v187,v187,v174
MF a[20:23],a[200:203],v[140:143],a[20:23]
EX v178,v122
MF a[24:27],a[204:207],v[136:139],a[24:27]
DR a[236:239],v192 offset:27648
CV v157,v174,v175
MF a[28:31],a[204:207],v[140:143],a[28:31]
BL v229,s[8:11],s39 offen offset:1024 lds
WT lgkmcnt(4)
MF a[32:35],a[208:211],v[136:139],a[32:35]
DR a[240:243],v192 offset:28672
FA v187,v187,v175
MF a[36:39],a[208:211],v[140:143],a[36:39]
EX v179,v123
MF a[40:43],a[212:215],v[136:139],a[40:43]
DR a[244:247],v192 offset:29696
FA v186,v186,v176
MF a[44:47],a[212:215],v[140:143],a[44:47]
EX v180,v124
MF a[48:51],a[216:219],v[136:139],a[48:51]
DR a[248:251],v192 offset:30720
FA v186,v186,v177
MF a[52:55],a[216:219],v[140:143],a[52:55]
BL v230,s[8:11],s39 offen offset:2048 lds
MF a[56:59],a[220:223],v[136:139],a[56:59]
DR a[252:255],v192 offset:31744
CV v154,v176,v177
MF a[60:63],a[220:223],v[140:143],a[60:63]
EX v181,v125
WT lgkmcnt(4)
MF a[64:67],a[224:227],v[136:139],a[64:67]
DR a[192:195],v193 offset:0
FA v186,v186,v178
MF a[68:71],a[224:227],v[140:143],a[68:71]
EX v182,v126
MF a[72:75],a[228:231],v[136:139],a[72:75]
DR a[196:199],v193 offset:1024
CV v155,v178,v179
MF a[76:79],a[228:231],v[140:143],a[76:79]
BL v231,s[8:11],s39 offen offset:3072 lds
MF a[80:83],a[232:235],v[136:139],a[80:83]
DR a[200:203],v193 offset:2048
SA s37,s37,32768
s_cmp_eq_u32 s37,163840
s_cselect_b32 s37,0,s37
FA v186,v186,v179
MF a[84:87],a[232:235],v[140:143],a[84:87]
EX v183,v127
MF a[88:91],a[236:239],v[136:139],a[88:91]
DR a[204:207],v193 offset:3072
FA v187,v187,v180
MF a[92:95],a[236:239],v[140:143],a[92:95]
FA v187,v187,v181
CV v158,v180,v181
WT lgkmcnt(4)
MF a[96:99],a[240:243],v[136:139],a[96:99]
DR a[208:211],v193 offset:4096
FA v187,v187,v182
MF a[100:103],a[240:243],v[140:143],a[100:103]
CV v159,v182,v183
FA v187,v187,v183
MF a[104:107],a[244:247],v[136:139],a[104:107]
DR a[212:215],v193 offset:5120
v_max_f32 v200,v186,v187
MF a[108:111],a[244:247],v[140:143],a[108:111]
v_cmp_lt_f32 vcc,1149239296,v200
MF a[112:115],a[248:251],v[136:139],a[112:115]
DR a[216:219],v193 offset:6144
MF a[116:119],a[248:251],v[140:143],a[116:119]
MF a[120:123],a[252:255],v[136:139],a[120:123]
DR a[220:223],v193 offset:7168
MF a[124:127],a[252:255],v[140:143],a[124:127]
s_cbranch_vccnz k2_kernel_slow19
k2_kernel_back20:
FA v184,v184,v186
FA v185,v185,v187
s_cmp_eq_u32 s44,1
s_cbranch_scc0 k2_kernel_qnext24
s_cmp_eq_u32 s54,0
s_cbranch_scc1 k2_kernel_nopre21
WT vmcnt(7)
s_mov_b32 s73,0
k2_kernel_poll26:
v_readfirstlane_b32 s47,v250
s_cmp_lg_u32 s47,0
s_cbranch_scc1 k2_kernel_got25
s_sleep 2
buffer_load_dword v250,v251,s[28:31],0 offen sc1
WT vmcnt(0)
SA s73,s73,1
s_cmp_lt_u32 s73,262144
s_cbranch_scc1 k2_kernel_poll26
v_mov_b32 v200,0xbad2
v_mov_b32 v201,32000
buffer_store_dword v200,v201,s[28:31],0 offen
k2_kernel_got25:
s_lshl_b32 s45,s32,15
SA s46,s45,0
BL v[64:67],v194,s[16:19],s46 offen sc1
SA s46,s45,1024
BL v[68:71],v194,s[16:19],s46 offen sc1
SA s46,s45,2048
BL v[72:75],v194,s[16:19],s46 offen sc1
SA s46,s45,3072
BL v[76:79],v194,s[16:19],s46 offen sc1
SA s46,s45,4096
BL v[80:83],v194,s[16:19],s46 offen sc1
SA s46,s45,5120
BL v[84:87],v194,s[16:19],s46 offen sc1
SA s46,s45,6144
BL v[88:91],v194,s[16:19],s46 offen sc1
SA s46,s45,7168
BL v[92:95],v194,s[16:19],s46 offen sc1
SA s46,s45,8192
BL v[96:99],v194,s[16:19],s46 offen sc1
SA s46,s45,9216
BL v[100:103],v194,s[16:19],s46 offen sc1
SA s46,s45,10240
BL v[104:107],v194,s[16:19],s46 offen sc1
SA s46,s45,11264
BL v[108:111],v194,s[16:19],s46 offen sc1
SA s46,s45,12288
BL v[112:115],v194,s[16:19],s46 offen sc1
SA s46,s45,13312
BL v[116:119],v194,s[16:19],s46 offen sc1
SA s46,s45,14336
BL v[120:123],v194,s[16:19],s46 offen sc1
SA s46,s45,15360
BL v[124:127],v194,s[16:19],s46 offen sc1
SA s46,s45,16384
BL v[246:249],v194,s[16:19],s46 offen sc1
s_mov_b32 s47,1
s_branch k2_kernel_fina22
k2_kernel_qnext24:
s_lshl_b32 s45,s34,3
s_lshl_b32 s46,s32,1
SA s45,s45,s46
s_lshl_b32 s45,s45,13
SA s46,s45,0
BL a[128:131],v194,s[12:15],s46 offen offset:0 nt
BL a[132:135],v194,s[12:15],s46 offen offset:1024 nt
BL a[136:139],v194,s[12:15],s46 offen offset:2048 nt
BL a[140:143],v194,s[12:15],s46 offen offset:3072 nt
SA s46,s45,4096
BL a[144:147],v194,s[12:15],s46 offen offset:0 nt
BL a[148:151],v194,s[12:15],s46 offen offset:1024 nt
BL a[152:155],v194,s[12:15],s46 offen offset:2048 nt
BL a[156:159],v194,s[12:15],s46 offen offset:3072 nt
SA s46,s45,8192
BL a[160:163],v194,s[12:15],s46 offen offset:0 nt
BL a[164:167],v194,s[12:15],s46 offen offset:1024 nt
BL a[168:171],v194,s[12:15],s46 offen offset:2048 nt
BL a[172:175],v194,s[12:15],s46 offen offset:3072 nt
SA s46,s45,12288
BL a[176:179],v194,s[12:15],s46 offen offset:0 nt
BL a[180:183],v194,s[12:15],s46 offen offset:1024 nt
BL a[184:187],v194,s[12:15],s46 offen offset:2048 nt
BL a[188:191],v194,s[12:15],s46 offen offset:3072 nt
s_mov_b32 s47,1
s_branch k2_kernel_fina22
k2_kernel_nopre21:
s_mov_b32 s47,0
k2_kernel_fina22:
WT lgkmcnt(4)
MF a[0:3],a[192:195],v[144:147],a[0:3]
DR a[224:227],v193 offset:8192
MF a[4:7],a[192:195],v[148:151],a[4:7]
s_cmp_eq_u32 s47,0
s_cbranch_scc1 k2_kernel_w28
WT vmcnt(32)
s_branch k2_kernel_w29
k2_kernel_w28:
WT vmcnt(16)
k2_kernel_w29:
s_barrier
MF a[8:11],a[196:199],v[144:147],a[8:11]
DR a[228:231],v193 offset:9216
MF a[12:15],a[196:199],v[148:151],a[12:15]
v_readlane_b32 s39,v196,s36
MF a[16:19],a[200:203],v[144:147],a[16:19]
DR a[232:235],v193 offset:10240
SA s38,s38,32768
s_cmp_eq_u32 s38,163840
s_cselect_b32 s38,0,s38
MF a[20:23],a[200:203],v[148:151],a[20:23]
MF a[24:27],a[204:207],v[144:147],a[24:27]
DR a[236:239],v193 offset:11264
SA s36,s36,1
SA m0,s37,s48
v_add_u32 v192,s38,v194
MF a[28:31],a[204:207],v[148:151],a[28:31]
WT lgkmcnt(4)
MF a[32:35],a[208:211],v[144:147],a[32:35]
DR a[240:243],v193 offset:12288
MF a[36:39],a[208:211],v[148:151],a[36:39]
BL v224,s[8:11],s39 offen offset:0 lds
MF a[40:43],a[212:215],v[144:147],a[40:43]
DR a[244:247],v193 offset:13312
MF a[44:47],a[212:215],v[148:151],a[44:47]
MF a[48:51],a[216:219],v[144:147],a[48:51]
DR a[248:251],v193 offset:14336
MF a[52:55],a[216:219],v[148:151],a[52:55]
MF a[56:59],a[220:223],v[144:147],a[56:59]
DR a[252:255],v193 offset:15360
MF a[60:63],a[220:223],v[148:151],a[60:63]
BL v225,s[8:11],s39 offen offset:1024 lds
WT lgkmcnt(4)
MF a[64:67],a[224:227],v[144:147],a[64:67]
DR a[192:195],v193 offset:16384
MF a[68:71],a[224:227],v[148:151],a[68:71]
MF a[72:75],a[228:231],v[144:147],a[72:75]
DR a[196:199],v193 offset:17408
MF a[76:79],a[228:231],v[148:151],a[76:79]
MF a[80:83],a[232:235],v[144:147],a[80:83]
DR a[200:203],v193 offset:18432
MF a[84:87],a[232:235],v[148:151],a[84:87]
BL v226,s[8:11],s39 offen offset:2048 lds
MF a[88:91],a[236:239],v[144:147],a[88:91]
DR a[204:207],v193 offset:19456
MF a[92:95],a[236:239],v[148:151],a[92:95]
WT lgkmcnt(4)
MF a[96:99],a[240:243],v[144:147],a[96:99]
DR a[208:211],v193 offset:20480
MF a[100:103],a[240:243],v[148:151],a[100:103]
MF a[104:107],a[244:247],v[144:147],a[104:107]
DR a[212:215],v193 offset:21504
MF a[108:111],a[244:247],v[148:151],a[108:111]
BL v227,s[8:11],s39 offen offset:3072 lds
MF a[112:115],a[248:251],v[144:147],a[112:115]
DR a[216:219],v193 offset:22528
SA m0,m0,4096
MF a[116:119],a[248:251],v[148:151],a[116:119]
MF a[120:123],a[252:255],v[144:147],a[120:123]
DR a[220:223],v193 offset:23552
MF a[124:127],a[252:255],v[148:151],a[124:127]
WT lgkmcnt(4)
MF a[0:3],a[192:195],v[152:155],a[0:3]
DR a[224:227],v193 offset:24576
MF a[4:7],a[192:195],v[156:159],a[4:7]
BL v228,s[8:11],s39 offen offset:0 lds
MF a[8:11],a[196:199],v[152:155],a[8:11]
DR a[228:231],v193 offset:25600
MF a[12:15],a[196:199],v[156:159],a[12:15]
MF a[16:19],a[200:203],v[152:155],a[16:19]
DR a[232:235],v193 offset:26624
MF a[20:23],a[200:203],v[156:159],a[20:23]
MF a[24:27],a[204:207],v[152:155],a[24:27]
DR a[236:239],v193 offset:27648
MF a[28:31],a[204:207],v[156:159],a[28:31]
BL v229,s[8:11],s39 offen offset:1024 lds
WT lgkmcnt(4)
MF a[32:35],a[208:211],v[152:155],a[32:35]
DR a[240:243],v193 offset:28672
MF a[36:39],a[208:211],v[156:159],a[36:39]
MF a[40:43],a[212:215],v[152:155],a[40:43]
DR a[244:247],v193 offset:29696
MF a[44:47],a[212:215],v[156:159],a[44:47]
MF a[48:51],a[216:219],v[152:155],a[48:51]
DR a[248:251],v193 offset:30720
MF a[52:55],a[216:219],v[156:159],a[52:55]
BL v230,s[8:11],s39 offen offset:2048 lds
MF a[56:59],a[220:223],v[152:155],a[56:59]
DR a[252:255],v193 offset:31744
MF a[60:63],a[220:223],v[156:159],a[60:63]
WT lgkmcnt(4)
MF a[64:67],a[224:227],v[152:155],a[64:67]
DR a[192:195],v192 offset:0
MF a[68:71],a[224:227],v[156:159],a[68:71]
MF a[72:75],a[228:231],v[152:155],a[72:75]
DR a[196:199],v192 offset:1024
MF a[76:79],a[228:231],v[156:159],a[76:79]
BL v231,s[8:11],s39 offen offset:3072 lds
MF a[80:83],a[232:235],v[152:155],a[80:83]
DR a[200:203],v192 offset:2048
SA s37,s37,32768
s_cmp_eq_u32 s37,163840
s_cselect_b32 s37,0,s37
MF a[84:87],a[232:235],v[156:159],a[84:87]
MF a[88:91],a[236:239],v[152:155],a[88:91]
DR a[204:207],v192 offset:3072
MF a[92:95],a[236:239],v[156:159],a[92:95]
WT lgkmcnt(4)
MF a[96:99],a[240:243],v[152:155],a[96:99]
DR a[208:211],v192 offset:4096
MF a[100:103],a[240:243],v[156:159],a[100:103]
MF a[104:107],a[244:247],v[152:155],a[104:107]
DR a[212:215],v192 offset:5120
MF a[108:111],a[244:247],v[156:159],a[108:111]
MF a[112:115],a[248:251],v[152:155],a[112:115]
DR a[216:219],v192 offset:6144
MF a[116:119],a[248:251],v[156:159],a[116:119]
MF a[120:123],a[252:255],v[152:155],a[120:123]
DR a[220:223],v192 offset:7168
MF a[124:127],a[252:255],v[156:159],a[124:127]
k2_kernel_itemdone:
s_nop 7
v_mov_b32 v200,v184
v_mov_b32 v201,v185
s_nop 0
v_permlane16_swap_b32 v184,v200
v_permlane16_swap_b32 v185,v201
s_nop 0
FA v184,v184,v200
FA v185,v185,v201
v_mov_b32 v200,v184
v_mov_b32 v201,v185
s_nop 0
v_permlane32_swap_b32 v184,v200
v_permlane32_swap_b32 v185,v201
s_nop 0
FA v184,v184,v200
FA v185,v185,v201
s_cmp_eq_u32 s44,1
s_cbranch_scc1 k2_kernel_final
s_lshl_b32 s45,s32,15
AR v200,a0
AR v201,a1
AR v202,a2
AR v203,a3
AR v204,a8
AR v205,a9
AR v206,a10
AR v207,a11
CV v208,v200,v201
CV v209,v202,v203
CV v210,v204,v205
CV v211,v206,v207
SA s46,s45,0
BS v[208:211],v194,s[16:19],s46 offen sc1
AR v212,a16
AR v213,a17
AR v214,a18
AR v215,a19
AR v216,a24
AR v217,a25
AR v218,a26
AR v219,a27
CV v220,v212,v213
CV v221,v214,v215
CV v222,v216,v217
CV v223,v218,v219
SA s46,s45,1024
BS v[220:223],v194,s[16:19],s46 offen sc1
AR v200,a32
AR v201,a33
AR v202,a34
AR v203,a35
AR v204,a40
AR v205,a41
AR v206,a42
AR v207,a43
CV v208,v200,v201
CV v209,v202,v203
CV v210,v204,v205
CV v211,v206,v207
SA s46,s45,2048
BS v[208:211],v194,s[16:19],s46 offen sc1
AR v212,a48
AR v213,a49
AR v214,a50
AR v215,a51
AR v216,a56
AR v217,a57
AR v218,a58
AR v219,a59
CV v220,v212,v213
CV v221,v214,v215
CV v222,v216,v217
CV v223,v218,v219
SA s46,s45,3072
BS v[220:223],v194,s[16:19],s46 offen sc1
AR v200,a64
AR v201,a65
AR v202,a66
AR v203,a67
AR v204,a72
AR v205,a73
AR v206,a74
AR v207,a75
CV v208,v200,v201
CV v209,v202,v203
CV v210,v204,v205
CV v211,v206,v207
SA s46,s45,4096
BS v[208:211],v194,s[16:19],s46 offen sc1
AR v212,a80
AR v213,a81
AR v214,a82
AR v215,a83
AR v216,a88
AR v217,a89
AR v218,a90
AR v219,a91
CV v220,v212,v213
CV v221,v214,v215
CV v222,v216,v217
CV v223,v218,v219
SA s46,s45,5120
BS v[220:223],v194,s[16:19],s46 offen sc1
AR v200,a96
AR v201,a97
AR v202,a98
AR v203,a99
AR v204,a104
AR v205,a105
AR v206,a106
AR v207,a107
CV v208,v200,v201
CV v209,v202,v203
CV v210,v204,v205
CV v211,v206,v207
SA s46,s45,6144
BS v[208:211],v194,s[16:19],s46 offen sc1
AR v212,a112
AR v213,a113
AR v214,a114
AR v215,a115
AR v216,a120
AR v217,a121
AR v218,a122
AR v219,a123
CV v220,v212,v213
CV v221,v214,v215
CV v222,v216,v217
CV v223,v218,v219
SA s46,s45,7168
BS v[220:223],v194,s[16:19],s46 offen sc1
AR v200,a4
AR v201,a5
AR v202,a6
AR v203,a7
AR v204,a12
AR v205,a13
AR v206,a14
AR v207,a15
CV v208,v200,v201
CV v209,v202,v203
CV v210,v204,v205
CV v211,v206,v207
SA s46,s45,8192
BS v[208:211],v194,s[16:19],s46 offen sc1
AR v212,a20
AR v213,a21
AR v214,a22
AR v215,a23
AR v216,a28
AR v217,a29
AR v218,a30
AR v219,a31
CV v220,v212,v213
CV v221,v214,v215
CV v222,v216,v217
CV v223,v218,v219
SA s46,s45,9216
BS v[220:223],v194,s[16:19],s46 offen sc1
AR v200,a36
AR v201,a37
AR v202,a38
AR v203,a39
AR v204,a44
AR v205,a45
AR v206,a46
AR v207,a47
CV v208,v200,v201
CV v209,v202,v203
CV v210,v204,v205
CV v211,v206,v207
SA s46,s45,10240
BS v[208:211],v194,s[16:19],s46 offen sc1
AR v212,a52
AR v213,a53
AR v214,a54
AR v215,a55
AR v216,a60
AR v217,a61
AR v218,a62
AR v219,a63
CV v220,v212,v213
CV v221,v214,v215
CV v222,v216,v217
CV v223,v218,v219
SA s46,s45,11264
BS v[220:223],v194,s[16:19],s46 offen sc1
AR v200,a68
AR v201,a69
AR v202,a70
AR v203,a71
AR v204,a76
AR v205,a77
AR v206,a78
AR v207,a79
CV v208,v200,v201
CV v209,v202,v203
CV v210,v204,v205
CV v211,v206,v207
SA s46,s45,12288
BS v[208:211],v194,s[16:19],s46 offen sc1
AR v212,a84
AR v213,a85
AR v214,a86
AR v215,a87
AR v216,a92
AR v217,a93
AR v218,a94
AR v219,a95
CV v220,v212,v213
CV v221,v214,v215
CV v222,v216,v217
CV v223,v218,v219
SA s46,s45,13312
BS v[220:223],v194,s[16:19],s46 offen sc1
AR v200,a100
AR v201,a101
AR v202,a102
AR v203,a103
AR v204,a108
AR v205,a109
AR v206,a110
AR v207,a111
CV v208,v200,v201
CV v209,v202,v203
CV v210,v204,v205
CV v211,v206,v207
SA s46,s45,14336
BS v[208:211],v194,s[16:19],s46 offen sc1
AR v212,a116
AR v213,a117
AR v214,a118
AR v215,a119
AR v216,a124
AR v217,a125
AR v218,a126
AR v219,a127
CV v220,v212,v213
CV v221,v214,v215
CV v222,v216,v217
CV v223,v218,v219
SA s46,s45,15360
BS v[220:223],v194,s[16:19],s46 offen sc1
v_mov_b32 v246,v188
v_mov_b32 v247,v189
v_mov_b32 v248,v184
v_mov_b32 v249,v185
SA s46,s45,16384
BS v[246:249],v194,s[16:19],s46 offen sc1
s_lshl_b32 s45,s34,1
SA s40,s45,2
s_mov_b32 s42,0
s_mov_b32 s43,s34
s_mov_b32 s44,1
s_mov_b32 s53,1
WT vmcnt(25)
s_branch k2_kernel_item
k2_kernel_final:
s_cmp_eq_u32 s54,0
s_cbranch_scc1 k2_kernel_plain
WT vmcnt(8)
v_max_f32 v212,v188,v246
FS v213,v188,v212
FS v214,v246,v212
EX v213,v213
EX v214,v214
s_nop 0
FM v212,v184,v213
v_fmac_f32 v212,v248,v214
v_rcp_f32 v212,v212
s_nop 0
FM v208,v213,v212
FM v210,v214,v212
v_max_f32 v212,v189,v247
FS v213,v189,v212
FS v214,v247,v212
EX v213,v213
EX v214,v214
s_nop 0
FM v212,v185,v213
v_fmac_f32 v212,v249,v214
v_rcp_f32 v212,v212
s_nop 0
FM v209,v213,v212
FM v211,v214,v212
s_cmp_lg_u32 s32,0
s_cbranch_scc1 cps_k2_kernel_tA_skip
s_getpc_b64 s[72:73]
cpf_k2_kernel_tA:
s_mov_b32 s74,tl_start-cpf_k2_kernel_tA
s_ashr_i32 s75,s74,31
SA s72,s72,s74
s_addc_u32 s73,s73,s75
s_lshr_b32 s74,s2,3
s_lshl_b32 s74,s74,12
v_and_b32 v8,63,v0
v_lshlrev_b32 v8,6,v8
v_add_u32 v8,s74,v8
v_min_u32 v8,20476,v8
global_load_dword v9,v8,s[72:73]
cps_k2_kernel_tA_skip:
v_add_u32 v242,s38,v240
v_add_u32 v243,s38,v241
DT v[128:129],v242 offset:0
DT v[130:131],v242 offset:7168
DT v[132:133],v243 offset:0
DT v[134:135],v243 offset:7168
DT v[136:137],v242 offset:64
DT v[138:139],v242 offset:7232
DT v[140:141],v243 offset:64
DT v[142:143],v243 offset:7232
DT v[144:145],v242 offset:128
DT v[146:147],v242 offset:7296
DT v[148:149],v243 offset:128
DT v[150:151],v243 offset:7296
AR v10,a0
AR v11,a1
AR v12,a2
AR v13,a3
AR v14,a8
AR v15,a9
AR v16,a10
AR v17,a11
FM v10,v10,v208
FM v11,v11,v208
FM v12,v12,v208
FM v13,v13,v208
FM v14,v14,v208
FM v15,v15,v208
FM v16,v16,v208
FM v17,v17,v208
v_lshlrev_b32 v18,16,v64
v_and_b32 v19,0xffff0000,v64
v_fmac_f32 v10,v18,v210
v_fmac_f32 v11,v19,v210
CV v64,v10,v11
v_lshlrev_b32 v18,16,v65
v_and_b32 v19,0xffff0000,v65
v_fmac_f32 v12,v18,v210
v_fmac_f32 v13,v19,v210
CV v65,v12,v13
v_lshlrev_b32 v18,16,v66
v_and_b32 v19,0xffff0000,v66
v_fmac_f32 v14,v18,v210
v_fmac_f32 v15,v19,v210
CV v66,v14,v15
v_lshlrev_b32 v18,16,v67
v_and_b32 v19,0xffff0000,v67
v_fmac_f32 v16,v18,v210
v_fmac_f32 v17,v19,v210
CV v67,v16,v17
AR v22,a4
AR v23,a5
AR v24,a6
AR v25,a7
AR v26,a12
AR v27,a13
AR v28,a14
AR v29,a15
FM v22,v22,v209
FM v23,v23,v209
FM v24,v24,v209
FM v25,v25,v209
FM v26,v26,v209
FM v27,v27,v209
FM v28,v28,v209
FM v29,v29,v209
v_lshlrev_b32 v30,16,v96
v_and_b32 v31,0xffff0000,v96
v_fmac_f32 v22,v30,v211
v_fmac_f32 v23,v31,v211
CV v96,v22,v23
v_lshlrev_b32 v30,16,v97
v_and_b32 v31,0xffff0000,v97
v_fmac_f32 v24,v30,v211
v_fmac_f32 v25,v31,v211
CV v97,v24,v25
v_lshlrev_b32 v30,16,v98
v_and_b32 v31,0xffff0000,v98
v_fmac_f32 v26,v30,v211
v_fmac_f32 v27,v31,v211
CV v98,v26,v27
v_lshlrev_b32 v30,16,v99
v_and_b32 v31,0xffff0000,v99
v_fmac_f32 v28,v30,v211
v_fmac_f32 v29,v31,v211
CV v99,v28,v29
AR v10,a16
AR v11,a17
AR v12,a18
AR v13,a19
AR v14,a24
AR v15,a25
AR v16,a26
AR v17,a27
FM v10,v10,v208
FM v11,v11,v208
FM v12,v12,v208
FM v13,v13,v208
FM v14,v14,v208
FM v15,v15,v208
FM v16,v16,v208
FM v17,v17,v208
v_lshlrev_b32 v18,16,v68
v_and_b32 v19,0xffff0000,v68
v_fmac_f32 v10,v18,v210
v_fmac_f32 v11,v19,v210
CV v68,v10,v11
v_lshlrev_b32 v18,16,v69
v_and_b32 v19,0xffff0000,v69
v_fmac_f32 v12,v18,v210
v_fmac_f32 v13,v19,v210
CV v69,v12,v13
v_lshlrev_b32 v18,16,v70
v_and_b32 v19,0xffff0000,v70
v_fmac_f32 v14,v18,v210
v_fmac_f32 v15,v19,v210
CV v70,v14,v15
v_lshlrev_b32 v18,16,v71
v_and_b32 v19,0xffff0000,v71
v_fmac_f32 v16,v18,v210
v_fmac_f32 v17,v19,v210
CV v71,v16,v17
AR v22,a20
AR v23,a21
AR v24,a22
AR v25,a23
AR v26,a28
AR v27,a29
AR v28,a30
AR v29,a31
FM v22,v22,v209
FM v23,v23,v209
FM v24,v24,v209
FM v25,v25,v209
FM v26,v26,v209
FM v27,v27,v209
FM v28,v28,v209
FM v29,v29,v209
v_lshlrev_b32 v30,16,v100
v_and_b32 v31,0xffff0000,v100
v_fmac_f32 v22,v30,v211
v_fmac_f32 v23,v31,v211
CV v100,v22,v23
v_lshlrev_b32 v30,16,v101
v_and_b32 v31,0xffff0000,v101
v_fmac_f32 v24,v30,v211
v_fmac_f32 v25,v31,v211
CV v101,v24,v25
v_lshlrev_b32 v30,16,v102
v_and_b32 v31,0xffff0000,v102
v_fmac_f32 v26,v30,v211
v_fmac_f32 v27,v31,v211
CV v102,v26,v27
v_lshlrev_b32 v30,16,v103
v_and_b32 v31,0xffff0000,v103
v_fmac_f32 v28,v30,v211
v_fmac_f32 v29,v31,v211
CV v103,v28,v29
s_nop 1
s_lshl_b32 s45,s43,3
s_lshl_b32 s46,s32,1
SA s45,s45,s46
s_mul_i32 s70,s45,14336
WT lgkmcnt(8)
MF a[128:131],v[128:131],v[64:67],0
DT v[152:153],v242 offset:192
MF a[132:135],v[128:131],v[96:99],0
DT v[154:155],v242 offset:7360
WT vmcnt(16)
s_barrier
MF a[136:139],v[132:135],v[64:67],0
DT v[156:157],v243 offset:192
MF a[140:143],v[132:135],v[96:99],0
DT v[158:159],v243 offset:7360
v_readlane_b32 s39,v196,s36
WT lgkmcnt(8)
MF a[144:147],v[136:139],v[64:67],0
DT v[160:161],v242 offset:256
SA s38,s38,32768
s_cmp_eq_u32 s38,163840
s_cselect_b32 s38,0,s38
MF a[148:151],v[136:139],v[96:99],0
DT v[162:163],v242 offset:7424
MF a[152:155],v[140:143],v[64:67],0
DT v[164:165],v243 offset:256
SA s36,s36,1
SA m0,s37,s48
v_add_u32 v244,s38,v240
MF a[156:159],v[140:143],v[96:99],0
DT v[166:167],v243 offset:7424
v_add_u32 v245,s38,v241
WT lgkmcnt(8)
MF a[160:163],v[144:147],v[64:67],0
DT v[168:169],v242 offset:320
AR v10,a32
MF a[164:167],v[144:147],v[96:99],0
DT v[170:171],v242 offset:7488
BL v224,s[8:11],s39 offen offset:0 lds
MF a[168:171],v[148:151],v[64:67],0
DT v[172:173],v243 offset:320
AR v11,a33
MF a[172:175],v[148:151],v[96:99],0
DT v[174:175],v243 offset:7488
AR v12,a34
WT lgkmcnt(8)
MF a[176:179],v[152:155],v[64:67],0
DT v[176:177],v242 offset:384
AR v13,a35
MF a[180:183],v[152:155],v[96:99],0
DT v[178:179],v242 offset:7552
AR v14,a40
MF a[184:187],v[156:159],v[64:67],0
DT v[180:181],v243 offset:384
BL v225,s[8:11],s39 offen offset:1024 lds
MF a[188:191],v[156:159],v[96:99],0
DT v[182:183],v243 offset:7552
AR v15,a41
WT lgkmcnt(8)
MF a[192:195],v[160:163],v[64:67],0
DT v[184:185],v242 offset:14336
AR v16,a42
MF a[196:199],v[160:163],v[96:99],0
DT v[186:187],v242 offset:21504
AR v17,a43
MF a[200:203],v[164:167],v[64:67],0
DT v[188:189],v243 offset:14336
FM v10,v10,v208
MF a[204:207],v[164:167],v[96:99],0
DT v[190:191],v243 offset:21504
BL v226,s[8:11],s39 offen offset:2048 lds
WT lgkmcnt(8)
MF a[208:211],v[168:171],v[64:67],0
DT v[128:129],v242 offset:14400
FM v11,v11,v208
MF a[212:215],v[168:171],v[96:99],0
DT v[130:131],v242 offset:21568
FM v12,v12,v208
MF a[216:219],v[172:175],v[64:67],0
DT v[132:133],v243 offset:14400
FM v13,v13,v208
MF a[220:223],v[172:175],v[96:99],0
DT v[134:135],v243 offset:21568
FM v14,v14,v208
WT lgkmcnt(8)
MF a[224:227],v[176:179],v[64:67],0
DT v[136:137],v242 offset:14464
BL v227,s[8:11],s39 offen offset:3072 lds
MF a[228:231],v[176:179],v[96:99],0
DT v[138:139],v242 offset:21632
SA m0,m0,4096
FM v15,v15,v208
MF a[232:235],v[180:183],v[64:67],0
DT v[140:141],v243 offset:14464
FM v16,v16,v208
MF a[236:239],v[180:183],v[96:99],0
DT v[142:143],v243 offset:21632
FM v17,v17,v208
WT lgkmcnt(8)
MF a[128:131],v[184:187],v[68:71],a[128:131]
DT v[144:145],v242 offset:14528
v_lshlrev_b32 v18,16,v72
MF a[132:135],v[184:187],v[100:103],a[132:135]
DT v[146:147],v242 offset:21696
BL v228,s[8:11],s39 offen offset:0 lds
MF a[136:139],v[188:191],v[68:71],a[136:139]
DT v[148:149],v243 offset:14528
v_and_b32 v19,0xffff0000,v72
MF a[140:143],v[188:191],v[100:103],a[140:143]
DT v[150:151],v243 offset:21696
v_fmac_f32 v10,v18,v210
WT lgkmcnt(8)
MF a[144:147],v[128:131],v[68:71],a[144:147]
DT v[152:153],v242 offset:14592
v_fmac_f32 v11,v19,v210
MF a[148:151],v[128:131],v[100:103],a[148:151]
DT v[154:155],v242 offset:21760
CV v72,v10,v11
MF a[152:155],v[132:135],v[68:71],a[152:155]
DT v[156:157],v243 offset:14592
BL v229,s[8:11],s39 offen offset:1024 lds
MF a[156:159],v[132:135],v[100:103],a[156:159]
DT v[158:159],v243 offset:21760
v_lshlrev_b32 v18,16,v73
WT lgkmcnt(8)
MF a[160:163],v[136:139],v[68:71],a[160:163]
DT v[160:161],v242 offset:14656
v_and_b32 v19,0xffff0000,v73
MF a[164:167],v[136:139],v[100:103],a[164:167]
DT v[162:163],v242 offset:21824
v_fmac_f32 v12,v18,v210
MF a[168:171],v[140:143],v[68:71],a[168:171]
DT v[164:165],v243 offset:14656
v_fmac_f32 v13,v19,v210
MF a[172:175],v[140:143],v[100:103],a[172:175]
DT v[166:167],v243 offset:21824
BL v230,s[8:11],s39 offen offset:2048 lds
WT lgkmcnt(8)
MF a[176:179],v[144:147],v[68:71],a[176:179]
DT v[168:169],v242 offset:14720
CV v73,v12,v13
MF a[180:183],v[144:147],v[100:103],a[180:183]
DT v[170:171],v242 offset:21888
v_lshlrev_b32 v18,16,v74
MF a[184:187],v[148:151],v[68:71],a[184:187]
DT v[172:173],v243 offset:14720
v_and_b32 v19,0xffff0000,v74
MF a[188:191],v[148:151],v[100:103],a[188:191]
DT v[174:175],v243 offset:21888
BL v231,s[8:11],s39 offen offset:3072 lds
WT lgkmcnt(8)
MF a[192:195],v[152:155],v[68:71],a[192:195]
DT v[176:177],v244 offset:0
SA s37,s37,32768
s_cmp_eq_u32 s37,163840
s_cselect_b32 s37,0,s37
v_fmac_f32 v14,v18,v210
MF a[196:199],v[152:155],v[100:103],a[196:199]
DT v[178:179],v244 offset:7168
v_fmac_f32 v15,v19,v210
MF a[200:203],v[156:159],v[68:71],a[200:203]
DT v[180:181],v245 offset:0
CV v74,v14,v15
MF a[204:207],v[156:159],v[100:103],a[204:207]
DT v[182:183],v245 offset:7168
v_lshlrev_b32 v18,16,v75
WT lgkmcnt(8)
MF a[208:211],v[160:163],v[68:71],a[208:211]
DT v[184:185],v244 offset:64
v_and_b32 v19,0xffff0000,v75
MF a[212:215],v[160:163],v[100:103],a[212:215]
DT v[186:187],v244 offset:7232
v_fmac_f32 v16,v18,v210
MF a[216:219],v[164:167],v[68:71],a[216:219]
DT v[188:189],v245 offset:64
v_fmac_f32 v17,v19,v210
MF a[220:223],v[164:167],v[100:103],a[220:223]
DT v[190:191],v245 offset:7232
CV v75,v16,v17
WT lgkmcnt(8)
MF a[224:227],v[168:171],v[68:71],a[224:227]
DT v[128:129],v244 offset:128
AR v22,a36
MF a[228:231],v[168:171],v[100:103],a[228:231]
DT v[130:131],v244 offset:7296
AR v23,a37
MF a[232:235],v[172:175],v[68:71],a[232:235]
DT v[132:133],v245 offset:128
MF a[236:239],v[172:175],v[100:103],a[236:239]
DT v[134:135],v245 offset:7296
AR v24,a38
AR v25,a39
AR v26,a44
AR v27,a45
AR v28,a46
AR v29,a47
FM v22,v22,v209
FM v23,v23,v209
FM v24,v24,v209
FM v25,v25,v209
FM v26,v26,v209
FM v27,v27,v209
FM v28,v28,v209
FM v29,v29,v209
v_lshlrev_b32 v30,16,v104
v_and_b32 v31,0xffff0000,v104
v_fmac_f32 v22,v30,v211
v_fmac_f32 v23,v31,v211
CV v104,v22,v23
v_lshlrev_b32 v30,16,v105
v_and_b32 v31,0xffff0000,v105
v_fmac_f32 v24,v30,v211
v_fmac_f32 v25,v31,v211
CV v105,v24,v25
v_lshlrev_b32 v30,16,v106
v_and_b32 v31,0xffff0000,v106
v_fmac_f32 v26,v30,v211
v_fmac_f32 v27,v31,v211
CV v106,v26,v27
v_lshlrev_b32 v30,16,v107
v_and_b32 v31,0xffff0000,v107
v_fmac_f32 v28,v30,v211
v_fmac_f32 v29,v31,v211
CV v107,v28,v29
AR v10,a48
AR v11,a49
AR v12,a50
AR v13,a51
AR v14,a56
AR v15,a57
AR v16,a58
AR v17,a59
FM v10,v10,v208
FM v11,v11,v208
FM v12,v12,v208
FM v13,v13,v208
FM v14,v14,v208
FM v15,v15,v208
FM v16,v16,v208
FM v17,v17,v208
v_lshlrev_b32 v18,16,v76
v_and_b32 v19,0xffff0000,v76
v_fmac_f32 v10,v18,v210
v_fmac_f32 v11,v19,v210
CV v76,v10,v11
v_lshlrev_b32 v18,16,v77
v_and_b32 v19,0xffff0000,v77
v_fmac_f32 v12,v18,v210
v_fmac_f32 v13,v19,v210
CV v77,v12,v13
v_lshlrev_b32 v18,16,v78
v_and_b32 v19,0xffff0000,v78
v_fmac_f32 v14,v18,v210
v_fmac_f32 v15,v19,v210
CV v78,v14,v15
v_lshlrev_b32 v18,16,v79
v_and_b32 v19,0xffff0000,v79
v_fmac_f32 v16,v18,v210
v_fmac_f32 v17,v19,v210
CV v79,v16,v17
AR v22,a52
AR v23,a53
AR v24,a54
AR v25,a55
AR v26,a60
AR v27,a61
AR v28,a62
AR v29,a63
FM v22,v22,v209
FM v23,v23,v209
FM v24,v24,v209
FM v25,v25,v209
FM v26,v26,v209
FM v27,v27,v209
FM v28,v28,v209
FM v29,v29,v209
v_lshlrev_b32 v30,16,v108
v_and_b32 v31,0xffff0000,v108
v_fmac_f32 v22,v30,v211
v_fmac_f32 v23,v31,v211
CV v108,v22,v23
v_lshlrev_b32 v30,16,v109
v_and_b32 v31,0xffff0000,v109
v_fmac_f32 v24,v30,v211
v_fmac_f32 v25,v31,v211
CV v109,v24,v25
v_lshlrev_b32 v30,16,v110
v_and_b32 v31,0xffff0000,v110
v_fmac_f32 v26,v30,v211
v_fmac_f32 v27,v31,v211
CV v110,v26,v27
v_lshlrev_b32 v30,16,v111
v_and_b32 v31,0xffff0000,v111
v_fmac_f32 v28,v30,v211
v_fmac_f32 v29,v31,v211
CV v111,v28,v29
s_nop 1
WT lgkmcnt(8)
MF a[128:131],v[176:179],v[72:75],a[128:131]
DT v[136:137],v244 offset:192
MF a[132:135],v[176:179],v[104:107],a[132:135]
DT v[138:139],v244 offset:7360
WT vmcnt(16)
s_barrier
MF a[136:139],v[180:183],v[72:75],a[136:139]
DT v[140:141],v245 offset:192
MF a[140:143],v[180:183],v[104:107],a[140:143]
DT v[142:143],v245 offset:7360
v_readlane_b32 s39,v196,s36
WT lgkmcnt(8)
MF a[144:147],v[184:187],v[72:75],a[144:147]
DT v[144:145],v244 offset:256
SA s38,s38,32768
s_cmp_eq_u32 s38,163840
s_cselect_b32 s38,0,s38
MF a[148:151],v[184:187],v[104:107],a[148:151]
DT v[146:147],v244 offset:7424
MF a[152:155],v[188:191],v[72:75],a[152:155]
DT v[148:149],v245 offset:256
SA s36,s36,1
SA m0,s37,s48
v_add_u32 v242,s38,v240
MF a[156:159],v[188:191],v[104:107],a[156:159]
DT v[150:151],v245 offset:7424
v_add_u32 v243,s38,v241
WT lgkmcnt(8)
MF a[160:163],v[128:131],v[72:75],a[160:163]
DT v[152:153],v244 offset:320
AR v10,a64
MF a[164:167],v[128:131],v[104:107],a[164:167]
DT v[154:155],v244 offset:7488
BL v224,s[8:11],s39 offen offset:0 lds
MF a[168:171],v[132:135],v[72:75],a[168:171]
DT v[156:157],v245 offset:320
AR v11,a65
MF a[172:175],v[132:135],v[104:107],a[172:175]
DT v[158:159],v245 offset:7488
AR v12,a66
WT lgkmcnt(8)
MF a[176:179],v[136:139],v[72:75],a[176:179]
DT v[160:161],v244 offset:384
AR v13,a67
MF a[180:183],v[136:139],v[104:107],a[180:183]
DT v[162:163],v244 offset:7552
AR v14,a72
MF a[184:187],v[140:143],v[72:75],a[184:187]
DT v[164:165],v245 offset:384
BL v225,s[8:11],s39 offen offset:1024 lds
MF a[188:191],v[140:143],v[104:107],a[188:191]
DT v[166:167],v245 offset:7552
AR v15,a73
WT lgkmcnt(8)
MF a[192:195],v[144:147],v[72:75],a[192:195]
DT v[168:169],v244 offset:14336
AR v16,a74
MF a[196:199],v[144:147],v[104:107],a[196:199]
DT v[170:171],v244 offset:21504
AR v17,a75
MF a[200:203],v[148:151],v[72:75],a[200:203]
DT v[172:173],v245 offset:14336
FM v10,v10,v208
MF a[204:207],v[148:151],v[104:107],a[204:207]
DT v[174:175],v245 offset:21504
BL v226,s[8:11],s39 offen offset:2048 lds
WT lgkmcnt(8)
MF a[208:211],v[152:155],v[72:75],a[208:211]
DT v[176:177],v244 offset:14400
FM v11,v11,v208
MF a[212:215],v[152:155],v[104:107],a[212:215]
DT v[178:179],v244 offset:21568
FM v12,v12,v208
MF a[216:219],v[156:159],v[72:75],a[216:219]
DT v[180:181],v245 offset:14400
FM v13,v13,v208
MF a[220:223],v[156:159],v[104:107],a[220:223]
DT v[182:183],v245 offset:21568
FM v14,v14,v208
WT lgkmcnt(8)
MF a[224:227],v[160:163],v[72:75],a[224:227]
DT v[184:185],v244 offset:14464
BL v227,s[8:11],s39 offen offset:3072 lds
MF a[228:231],v[160:163],v[104:107],a[228:231]
DT v[186:187],v244 offset:21632
SA m0,m0,4096
FM v15,v15,v208
MF a[232:235],v[164:167],v[72:75],a[232:235]
DT v[188:189],v245 offset:14464
FM v16,v16,v208
MF a[236:239],v[164:167],v[104:107],a[236:239]
DT v[190:191],v245 offset:21632
FM v17,v17,v208
WT lgkmcnt(8)
MF a[128:131],v[168:171],v[76:79],a[128:131]
DT v[128:129],v244 offset:14528
v_lshlrev_b32 v18,16,v80
MF a[132:135],v[168:171],v[108:111],a[132:135]
DT v[130:131],v244 offset:21696
BL v228,s[8:11],s39 offen offset:0 lds
MF a[136:139],v[172:175],v[76:79],a[136:139]
DT v[132:133],v245 offset:14528
v_and_b32 v19,0xffff0000,v80
MF a[140:143],v[172:175],v[108:111],a[140:143]
DT v[134:135],v245 offset:21696
v_fmac_f32 v10,v18,v210
WT lgkmcnt(8)
MF a[144:147],v[176:179],v[76:79],a[144:147]
DT v[136:137],v244 offset:14592
v_fmac_f32 v11,v19,v210
MF a[148:151],v[176:179],v[108:111],a[148:151]
DT v[138:139],v244 offset:21760
CV v80,v10,v11
MF a[152:155],v[180:183],v[76:79],a[152:155]
DT v[140:141],v245 offset:14592
BL v229,s[8:11],s39 offen offset:1024 lds
MF a[156:159],v[180:183],v[108:111],a[156:159]
DT v[142:143],v245 offset:21760
v_lshlrev_b32 v18,16,v81
WT lgkmcnt(8)
MF a[160:163],v[184:187],v[76:79],a[160:163]
DT v[144:145],v244 offset:14656
v_and_b32 v19,0xffff0000,v81
MF a[164:167],v[184:187],v[108:111],a[164:167]
DT v[146:147],v244 offset:21824
v_fmac_f32 v12,v18,v210
MF a[168:171],v[188:191],v[76:79],a[168:171]
DT v[148:149],v245 offset:14656
v_fmac_f32 v13,v19,v210
MF a[172:175],v[188:191],v[108:111],a[172:175]
DT v[150:151],v245 offset:21824
BL v230,s[8:11],s39 offen offset:2048 lds
WT lgkmcnt(8)
MF a[176:179],v[128:131],v[76:79],a[176:179]
DT v[152:153],v244 offset:14720
CV v81,v12,v13
MF a[180:183],v[128:131],v[108:111],a[180:183]
DT v[154:155],v244 offset:21888
v_lshlrev_b32 v18,16,v82
MF a[184:187],v[132:135],v[76:79],a[184:187]
DT v[156:157],v245 offset:14720
v_and_b32 v19,0xffff0000,v82
MF a[188:191],v[132:135],v[108:111],a[188:191]
DT v[158:159],v245 offset:21888
BL v231,s[8:11],s39 offen offset:3072 lds
WT lgkmcnt(8)
MF a[192:195],v[136:139],v[76:79],a[192:195]
DT v[160:161],v242 offset:0
SA s37,s37,32768
s_cmp_eq_u32 s37,163840
s_cselect_b32 s37,0,s37
v_fmac_f32 v14,v18,v210
MF a[196:199],v[136:139],v[108:111],a[196:199]
DT v[162:163],v242 offset:7168
v_fmac_f32 v15,v19,v210
MF a[200:203],v[140:143],v[76:79],a[200:203]
DT v[164:165],v243 offset:0
CV v82,v14,v15
MF a[204:207],v[140:143],v[108:111],a[204:207]
DT v[166:167],v243 offset:7168
v_lshlrev_b32 v18,16,v83
WT lgkmcnt(8)
MF a[208:211],v[144:147],v[76:79],a[208:211]
DT v[168:169],v242 offset:64
v_and_b32 v19,0xffff0000,v83
MF a[212:215],v[144:147],v[108:111],a[212:215]
DT v[170:171],v242 offset:7232
v_fmac_f32 v16,v18,v210
MF a[216:219],v[148:151],v[76:79],a[216:219]
DT v[172:173],v243 offset:64
v_fmac_f32 v17,v19,v210
MF a[220:223],v[148:151],v[108:111],a[220:223]
DT v[174:175],v243 offset:7232
CV v83,v16,v17
WT lgkmcnt(8)
MF a[224:227],v[152:155],v[76:79],a[224:227]
DT v[176:177],v242 offset:128
AR v22,a68
MF a[228:231],v[152:155],v[108:111],a[228:231]
DT v[178:179],v242 offset:7296
AR v23,a69
MF a[232:235],v[156:159],v[76:79],a[232:235]
DT v[180:181],v243 offset:128
MF a[236:239],v[156:159],v[108:111],a[236:239]
DT v[182:183],v243 offset:7296
AR v24,a70
AR v25,a71
AR v26,a76
AR v27,a77
AR v28,a78
AR v29,a79
FM v22,v22,v209
FM v23,v23,v209
FM v24,v24,v209
FM v25,v25,v209
FM v26,v26,v209
FM v27,v27,v209
FM v28,v28,v209
FM v29,v29,v209
v_lshlrev_b32 v30,16,v112
v_and_b32 v31,0xffff0000,v112
v_fmac_f32 v22,v30,v211
v_fmac_f32 v23,v31,v211
CV v112,v22,v23
v_lshlrev_b32 v30,16,v113
v_and_b32 v31,0xffff0000,v113
v_fmac_f32 v24,v30,v211
v_fmac_f32 v25,v31,v211
CV v113,v24,v25
v_lshlrev_b32 v30,16,v114
v_and_b32 v31,0xffff0000,v114
v_fmac_f32 v26,v30,v211
v_fmac_f32 v27,v31,v211
CV v114,v26,v27
v_lshlrev_b32 v30,16,v115
v_and_b32 v31,0xffff0000,v115
v_fmac_f32 v28,v30,v211
v_fmac_f32 v29,v31,v211
CV v115,v28,v29
AR v10,a80
AR v11,a81
AR v12,a82
AR v13,a83
AR v14,a88
AR v15,a89
AR v16,a90
AR v17,a91
FM v10,v10,v208
FM v11,v11,v208
FM v12,v12,v208
FM v13,v13,v208
FM v14,v14,v208
FM v15,v15,v208
FM v16,v16,v208
FM v17,v17,v208
v_lshlrev_b32 v18,16,v84
v_and_b32 v19,0xffff0000,v84
v_fmac_f32 v10,v18,v210
v_fmac_f32 v11,v19,v210
CV v84,v10,v11
v_lshlrev_b32 v18,16,v85
v_and_b32 v19,0xffff0000,v85
v_fmac_f32 v12,v18,v210
v_fmac_f32 v13,v19,v210
CV v85,v12,v13
v_lshlrev_b32 v18,16,v86
v_and_b32 v19,0xffff0000,v86
v_fmac_f32 v14,v18,v210
v_fmac_f32 v15,v19,v210
CV v86,v14,v15
v_lshlrev_b32 v18,16,v87
v_and_b32 v19,0xffff0000,v87
v_fmac_f32 v16,v18,v210
v_fmac_f32 v17,v19,v210
CV v87,v16,v17
AR v22,a84
AR v23,a85
AR v24,a86
AR v25,a87
AR v26,a92
AR v27,a93
AR v28,a94
AR v29,a95
FM v22,v22,v209
FM v23,v23,v209
FM v24,v24,v209
FM v25,v25,v209
FM v26,v26,v209
FM v27,v27,v209
FM v28,v28,v209
FM v29,v29,v209
v_lshlrev_b32 v30,16,v116
v_and_b32 v31,0xffff0000,v116
v_fmac_f32 v22,v30,v211
v_fmac_f32 v23,v31,v211
CV v116,v22,v23
v_lshlrev_b32 v30,16,v117
v_and_b32 v31,0xffff0000,v117
v_fmac_f32 v24,v30,v211
v_fmac_f32 v25,v31,v211
CV v117,v24,v25
v_lshlrev_b32 v30,16,v118
v_and_b32 v31,0xffff0000,v118
v_fmac_f32 v26,v30,v211
v_fmac_f32 v27,v31,v211
CV v118,v26,v27
v_lshlrev_b32 v30,16,v119
v_and_b32 v31,0xffff0000,v119
v_fmac_f32 v28,v30,v211
v_fmac_f32 v29,v31,v211
CV v119,v28,v29
s_nop 1
WT lgkmcnt(8)
MF a[128:131],v[160:163],v[80:83],a[128:131]
DT v[184:185],v242 offset:192
MF a[132:135],v[160:163],v[112:115],a[132:135]
DT v[186:187],v242 offset:7360
WT vmcnt(16)
s_barrier
MF a[136:139],v[164:167],v[80:83],a[136:139]
DT v[188:189],v243 offset:192
MF a[140:143],v[164:167],v[112:115],a[140:143]
DT v[190:191],v243 offset:7360
v_readlane_b32 s39,v196,s36
WT lgkmcnt(8)
MF a[144:147],v[168:171],v[80:83],a[144:147]
DT v[128:129],v242 offset:256
SA s38,s38,32768
s_cmp_eq_u32 s38,163840
s_cselect_b32 s38,0,s38
MF a[148:151],v[168:171],v[112:115],a[148:151]
DT v[130:131],v242 offset:7424
MF a[152:155],v[172:175],v[80:83],a[152:155]
DT v[132:133],v243 offset:256
SA s36,s36,1
SA m0,s37,s48
v_add_u32 v244,s38,v240
MF a[156:159],v[172:175],v[112:115],a[156:159]
DT v[134:135],v243 offset:7424
v_add_u32 v245,s38,v241
WT lgkmcnt(8)
MF a[160:163],v[176:179],v[80:83],a[160:163]
DT v[136:137],v242 offset:320
AR v10,a96
MF a[164:167],v[176:179],v[112:115],a[164:167]
DT v[138:139],v242 offset:7488
BL v224,s[8:11],s39 offen offset:0 lds
MF a[168:171],v[180:183],v[80:83],a[168:171]
DT v[140:141],v243 offset:320
AR v11,a97
MF a[172:175],v[180:183],v[112:115],a[172:175]
DT v[142:143],v243 offset:7488
AR v12,a98
WT lgkmcnt(8)
MF a[176:179],v[184:187],v[80:83],a[176:179]
DT v[144:145],v242 offset:384
AR v13,a99
MF a[180:183],v[184:187],v[112:115],a[180:183]
DT v[146:147],v242 offset:7552
AR v14,a104
MF a[184:187],v[188:191],v[80:83],a[184:187]
DT v[148:149],v243 offset:384
BL v225,s[8:11],s39 offen offset:1024 lds
MF a[188:191],v[188:191],v[112:115],a[188:191]
DT v[150:151],v243 offset:7552
AR v15,a105
WT lgkmcnt(8)
MF a[192:195],v[128:131],v[80:83],a[192:195]
DT v[152:153],v242 offset:14336
AR v16,a106
MF a[196:199],v[128:131],v[112:115],a[196:199]
DT v[154:155],v242 offset:21504
AR v17,a107
MF a[200:203],v[132:135],v[80:83],a[200:203]
DT v[156:157],v243 offset:14336
FM v10,v10,v208
MF a[204:207],v[132:135],v[112:115],a[204:207]
DT v[158:159],v243 offset:21504
BL v226,s[8:11],s39 offen offset:2048 lds
WT lgkmcnt(8)
MF a[208:211],v[136:139],v[80:83],a[208:211]
DT v[160:161],v242 offset:14400
FM v11,v11,v208
MF a[212:215],v[136:139],v[112:115],a[212:215]
DT v[162:163],v242 offset:21568
FM v12,v12,v208
MF a[216:219],v[140:143],v[80:83],a[216:219]
DT v[164:165],v243 offset:14400
FM v13,v13,v208
MF a[220:223],v[140:143],v[112:115],a[220:223]
DT v[166:167],v243 offset:21568
FM v14,v14,v208
WT lgkmcnt(8)
MF a[224:227],v[144:147],v[80:83],a[224:227]
DT v[168:169],v242 offset:14464
BL v227,s[8:11],s39 offen offset:3072 lds
MF a[228:231],v[144:147],v[112:115],a[228:231]
DT v[170:171],v242 offset:21632
SA m0,m0,4096
FM v15,v15,v208
MF a[232:235],v[148:151],v[80:83],a[232:235]
DT v[172:173],v243 offset:14464
FM v16,v16,v208
MF a[236:239],v[148:151],v[112:115],a[236:239]
DT v[174:175],v243 offset:21632
FM v17,v17,v208
WT lgkmcnt(8)
MF a[128:131],v[152:155],v[84:87],a[128:131]
DT v[176:177],v242 offset:14528
v_lshlrev_b32 v18,16,v88
MF a[132:135],v[152:155],v[116:119],a[132:135]
DT v[178:179],v242 offset:21696
BL v228,s[8:11],s39 offen offset:0 lds
MF a[136:139],v[156:159],v[84:87],a[136:139]
DT v[180:181],v243 offset:14528
v_and_b32 v19,0xffff0000,v88
MF a[140:143],v[156:159],v[116:119],a[140:143]
DT v[182:183],v243 offset:21696
v_fmac_f32 v10,v18,v210
WT lgkmcnt(8)
MF a[144:147],v[160:163],v[84:87],a[144:147]
DT v[184:185],v242 offset:14592
v_fmac_f32 v11,v19,v210
MF a[148:151],v[160:163],v[116:119],a[148:151]
DT v[186:187],v242 offset:21760
CV v88,v10,v11
MF a[152:155],v[164:167],v[84:87],a[152:155]
DT v[188:189],v243 offset:14592
BL v229,s[8:11],s39 offen offset:1024 lds
MF a[156:159],v[164:167],v[116:119],a[156:159]
DT v[190:191],v243 offset:21760
v_lshlrev_b32 v18,16,v89
WT lgkmcnt(8)
MF a[160:163],v[168:171],v[84:87],a[160:163]
DT v[128:129],v242 offset:14656
v_and_b32 v19,0xffff0000,v89
MF a[164:167],v[168:171],v[116:119],a[164:167]
DT v[130:131],v242 offset:21824
v_fmac_f32 v12,v18,v210
MF a[168:171],v[172:175],v[84:87],a[168:171]
DT v[132:133],v243 offset:14656
v_fmac_f32 v13,v19,v210
MF a[172:175],v[172:175],v[116:119],a[172:175]
DT v[134:135],v243 offset:21824
BL v230,s[8:11],s39 offen offset:2048 lds
WT lgkmcnt(8)
MF a[176:179],v[176:179],v[84:87],a[176:179]
DT v[136:137],v242 offset:14720
CV v89,v12,v13
MF a[180:183],v[176:179],v[116:119],a[180:183]
DT v[138:139],v242 offset:21888
v_lshlrev_b32 v18,16,v90
MF a[184:187],v[180:183],v[84:87],a[184:187]
DT v[140:141],v243 offset:14720
v_and_b32 v19,0xffff0000,v90
MF a[188:191],v[180:183],v[116:119],a[188:191]
DT v[142:143],v243 offset:21888
BL v231,s[8:11],s39 offen offset:3072 lds
WT lgkmcnt(8)
MF a[192:195],v[184:187],v[84:87],a[192:195]
DT v[144:145],v244 offset:0
SA s37,s37,32768
s_cmp_eq_u32 s37,163840
s_cselect_b32 s37,0,s37
v_fmac_f32 v14,v18,v210
MF a[196:199],v[184:187],v[116:119],a[196:199]
DT v[146:147],v244 offset:7168
v_fmac_f32 v15,v19,v210
MF a[200:203],v[188:191],v[84:87],a[200:203]
DT v[148:149],v245 offset:0
CV v90,v14,v15
MF a[204:207],v[188:191],v[116:119],a[204:207]
DT v[150:151],v245 offset:7168
v_lshlrev_b32 v18,16,v91
WT lgkmcnt(8)
MF a[208:211],v[128:131],v[84:87],a[208:211]
DT v[152:153],v244 offset:64
v_and_b32 v19,0xffff0000,v91
MF a[212:215],v[128:131],v[116:119],a[212:215]
DT v[154:155],v244 offset:7232
v_fmac_f32 v16,v18,v210
MF a[216:219],v[132:135],v[84:87],a[216:219]
DT v[156:157],v245 offset:64
v_fmac_f32 v17,v19,v210
MF a[220:223],v[132:135],v[116:119],a[220:223]
DT v[158:159],v245 offset:7232
CV v91,v16,v17
WT lgkmcnt(8)
MF a[224:227],v[136:139],v[84:87],a[224:227]
DT v[160:161],v244 offset:128
AR v22,a100
MF a[228:231],v[136:139],v[116:119],a[228:231]
DT v[162:163],v244 offset:7296
AR v23,a101
MF a[232:235],v[140:143],v[84:87],a[232:235]
DT v[164:165],v245 offset:128
MF a[236:239],v[140:143],v[116:119],a[236:239]
DT v[166:167],v245 offset:7296
AR v24,a102
AR v25,a103
AR v26,a108
AR v27,a109
AR v28,a110
AR v29,a111
FM v22,v22,v209
FM v23,v23,v209
FM v24,v24,v209
FM v25,v25,v209
FM v26,v26,v209
FM v27,v27,v209
FM v28,v28,v209
FM v29,v29,v209
v_lshlrev_b32 v30,16,v120
v_and_b32 v31,0xffff0000,v120
v_fmac_f32 v22,v30,v211
v_fmac_f32 v23,v31,v211
CV v120,v22,v23
v_lshlrev_b32 v30,16,v121
v_and_b32 v31,0xffff0000,v121
v_fmac_f32 v24,v30,v211
v_fmac_f32 v25,v31,v211
CV v121,v24,v25
v_lshlrev_b32 v30,16,v122
v_and_b32 v31,0xffff0000,v122
v_fmac_f32 v26,v30,v211
v_fmac_f32 v27,v31,v211
CV v122,v26,v27
v_lshlrev_b32 v30,16,v123
v_and_b32 v31,0xffff0000,v123
v_fmac_f32 v28,v30,v211
v_fmac_f32 v29,v31,v211
CV v123,v28,v29
AR v10,a112
AR v11,a113
AR v12,a114
AR v13,a115
AR v14,a120
AR v15,a121
AR v16,a122
AR v17,a123
FM v10,v10,v208
FM v11,v11,v208
FM v12,v12,v208
FM v13,v13,v208
FM v14,v14,v208
FM v15,v15,v208
FM v16,v16,v208
FM v17,v17,v208
v_lshlrev_b32 v18,16,v92
v_and_b32 v19,0xffff0000,v92
v_fmac_f32 v10,v18,v210
v_fmac_f32 v11,v19,v210
CV v92,v10,v11
v_lshlrev_b32 v18,16,v93
v_and_b32 v19,0xffff0000,v93
v_fmac_f32 v12,v18,v210
v_fmac_f32 v13,v19,v210
CV v93,v12,v13
v_lshlrev_b32 v18,16,v94
v_and_b32 v19,0xffff0000,v94
v_fmac_f32 v14,v18,v210
v_fmac_f32 v15,v19,v210
CV v94,v14,v15
v_lshlrev_b32 v18,16,v95
v_and_b32 v19,0xffff0000,v95
v_fmac_f32 v16,v18,v210
v_fmac_f32 v17,v19,v210
CV v95,v16,v17
AR v22,a116
AR v23,a117
AR v24,a118
AR v25,a119
AR v26,a124
AR v27,a125
AR v28,a126
AR v29,a127
FM v22,v22,v209
FM v23,v23,v209
FM v24,v24,v209
FM v25,v25,v209
FM v26,v26,v209
FM v27,v27,v209
FM v28,v28,v209
FM v29,v29,v209
v_lshlrev_b32 v30,16,v124
v_and_b32 v31,0xffff0000,v124
v_fmac_f32 v22,v30,v211
v_fmac_f32 v23,v31,v211
CV v124,v22,v23
v_lshlrev_b32 v30,16,v125
v_and_b32 v31,0xffff0000,v125
v_fmac_f32 v24,v30,v211
v_fmac_f32 v25,v31,v211
CV v125,v24,v25
v_lshlrev_b32 v30,16,v126
v_and_b32 v31,0xffff0000,v126
v_fmac_f32 v26,v30,v211
v_fmac_f32 v27,v31,v211
CV v126,v26,v27
v_lshlrev_b32 v30,16,v127
v_and_b32 v31,0xffff0000,v127
v_fmac_f32 v28,v30,v211
v_fmac_f32 v29,v31,v211
CV v127,v28,v29
s_nop 1
s_branch k2_kernel_oproj3
k2_kernel_plain:
v_rcp_f32 v208,v184
v_rcp_f32 v209,v185
s_nop 0
s_cmp_lg_u32 s32,0
s_cbranch_scc1 cps_k2_kernel_tP_skip
s_getpc_b64 s[72:73]
cpf_k2_kernel_tP:
s_mov_b32 s74,tl_start-cpf_k2_kernel_tP
s_ashr_i32 s75,s74,31
SA s72,s72,s74
s_addc_u32 s73,s73,s75
s_lshr_b32 s74,s2,3
s_lshl_b32 s74,s74,12
v_and_b32 v8,63,v0
v_lshlrev_b32 v8,6,v8
v_add_u32 v8,s74,v8
v_min_u32 v8,20476,v8
global_load_dword v9,v8,s[72:73]
cps_k2_kernel_tP_skip:
v_add_u32 v242,s38,v240
v_add_u32 v243,s38,v241
DT v[128:129],v242 offset:0
DT v[130:131],v242 offset:7168
DT v[132:133],v243 offset:0
DT v[134:135],v243 offset:7168
DT v[136:137],v242 offset:64
DT v[138:139],v242 offset:7232
DT v[140:141],v243 offset:64
DT v[142:143],v243 offset:7232
DT v[144:145],v242 offset:128
DT v[146:147],v242 offset:7296
DT v[148:149],v243 offset:128
DT v[150:151],v243 offset:7296
AR v10,a0
AR v11,a1
AR v12,a2
AR v13,a3
AR v14,a8
AR v15,a9
AR v16,a10
AR v17,a11
FM v10,v10,v208
FM v11,v11,v208
FM v12,v12,v208
FM v13,v13,v208
FM v14,v14,v208
FM v15,v15,v208
FM v16,v16,v208
FM v17,v17,v208
CV v64,v10,v11
CV v65,v12,v13
CV v66,v14,v15
CV v67,v16,v17
AR v22,a4
AR v23,a5
AR v24,a6
AR v25,a7
AR v26,a12
AR v27,a13
AR v28,a14
AR v29,a15
FM v22,v22,v209
FM v23,v23,v209
FM v24,v24,v209
FM v25,v25,v209
FM v26,v26,v209
FM v27,v27,v209
FM v28,v28,v209
FM v29,v29,v209
CV v96,v22,v23
CV v97,v24,v25
CV v98,v26,v27
CV v99,v28,v29
AR v10,a16
AR v11,a17
AR v12,a18
AR v13,a19
AR v14,a24
AR v15,a25
AR v16,a26
AR v17,a27
FM v10,v10,v208
FM v11,v11,v208
FM v12,v12,v208
FM v13,v13,v208
FM v14,v14,v208
FM v15,v15,v208
FM v16,v16,v208
FM v17,v17,v208
CV v68,v10,v11
CV v69,v12,v13
CV v70,v14,v15
CV v71,v16,v17
AR v22,a20
AR v23,a21
AR v24,a22
AR v25,a23
AR v26,a28
AR v27,a29
AR v28,a30
AR v29,a31
FM v22,v22,v209
FM v23,v23,v209
FM v24,v24,v209
FM v25,v25,v209
FM v26,v26,v209
FM v27,v27,v209
FM v28,v28,v209
FM v29,v29,v209
CV v100,v22,v23
CV v101,v24,v25
CV v102,v26,v27
CV v103,v28,v29
s_nop 1
s_lshl_b32 s45,s43,3
s_lshl_b32 s46,s32,1
SA s45,s45,s46
s_mul_i32 s70,s45,14336
WT lgkmcnt(8)
MF a[128:131],v[128:131],v[64:67],0
DT v[152:153],v242 offset:192
MF a[132:135],v[128:131],v[96:99],0
DT v[154:155],v242 offset:7360
WT vmcnt(16)
s_barrier
MF a[136:139],v[132:135],v[64:67],0
DT v[156:157],v243 offset:192
MF a[140:143],v[132:135],v[96:99],0
DT v[158:159],v243 offset:7360
v_readlane_b32 s39,v196,s36
WT lgkmcnt(8)
MF a[144:147],v[136:139],v[64:67],0
DT v[160:161],v242 offset:256
SA s38,s38,32768
s_cmp_eq_u32 s38,163840
s_cselect_b32 s38,0,s38
MF a[148:151],v[136:139],v[96:99],0
DT v[162:163],v242 offset:7424
MF a[152:155],v[140:143],v[64:67],0
DT v[164:165],v243 offset:256
SA s36,s36,1
SA m0,s37,s48
v_add_u32 v244,s38,v240
MF a[156:159],v[140:143],v[96:99],0
DT v[166:167],v243 offset:7424
v_add_u32 v245,s38,v241
WT lgkmcnt(8)
MF a[160:163],v[144:147],v[64:67],0
DT v[168:169],v242 offset:320
AR v10,a32
MF a[164:167],v[144:147],v[96:99],0
DT v[170:171],v242 offset:7488
BL v224,s[8:11],s39 offen offset:0 lds
MF a[168:171],v[148:151],v[64:67],0
DT v[172:173],v243 offset:320
AR v11,a33
MF a[172:175],v[148:151],v[96:99],0
DT v[174:175],v243 offset:7488
AR v12,a34
WT lgkmcnt(8)
MF a[176:179],v[152:155],v[64:67],0
DT v[176:177],v242 offset:384
AR v13,a35
MF a[180:183],v[152:155],v[96:99],0
DT v[178:179],v242 offset:7552
AR v14,a40
MF a[184:187],v[156:159],v[64:67],0
DT v[180:181],v243 offset:384
BL v225,s[8:11],s39 offen offset:1024 lds
MF a[188:191],v[156:159],v[96:99],0
DT v[182:183],v243 offset:7552
AR v15,a41
WT lgkmcnt(8)
MF a[192:195],v[160:163],v[64:67],0
DT v[184:185],v242 offset:14336
AR v16,a42
MF a[196:199],v[160:163],v[96:99],0
DT v[186:187],v242 offset:21504
AR v17,a43
MF a[200:203],v[164:167],v[64:67],0
DT v[188:189],v243 offset:14336
FM v10,v10,v208
MF a[204:207],v[164:167],v[96:99],0
DT v[190:191],v243 offset:21504
BL v226,s[8:11],s39 offen offset:2048 lds
WT lgkmcnt(8)
MF a[208:211],v[168:171],v[64:67],0
DT v[128:129],v242 offset:14400
FM v11,v11,v208
MF a[212:215],v[168:171],v[96:99],0
DT v[130:131],v242 offset:21568
FM v12,v12,v208
MF a[216:219],v[172:175],v[64:67],0
DT v[132:133],v243 offset:14400
FM v13,v13,v208
MF a[220:223],v[172:175],v[96:99],0
DT v[134:135],v243 offset:21568
FM v14,v14,v208
WT lgkmcnt(8)
MF a[224:227],v[176:179],v[64:67],0
DT v[136:137],v242 offset:14464
BL v227,s[8:11],s39 offen offset:3072 lds
MF a[228:231],v[176:179],v[96:99],0
DT v[138:139],v242 offset:21632
SA m0,m0,4096
FM v15,v15,v208
MF a[232:235],v[180:183],v[64:67],0
DT v[140:141],v243 offset:14464
FM v16,v16,v208
MF a[236:239],v[180:183],v[96:99],0
DT v[142:143],v243 offset:21632
FM v17,v17,v208
WT lgkmcnt(8)
MF a[128:131],v[184:187],v[68:71],a[128:131]
DT v[144:145],v242 offset:14528
CV v72,v10,v11
MF a[132:135],v[184:187],v[100:103],a[132:135]
DT v[146:147],v242 offset:21696
BL v228,s[8:11],s39 offen offset:0 lds
MF a[136:139],v[188:191],v[68:71],a[136:139]
DT v[148:149],v243 offset:14528
CV v73,v12,v13
MF a[140:143],v[188:191],v[100:103],a[140:143]
DT v[150:151],v243 offset:21696
CV v74,v14,v15
WT lgkmcnt(8)
MF a[144:147],v[128:131],v[68:71],a[144:147]
DT v[152:153],v242 offset:14592
CV v75,v16,v17
MF a[148:151],v[128:131],v[100:103],a[148:151]
DT v[154:155],v242 offset:21760
AR v22,a36
MF a[152:155],v[132:135],v[68:71],a[152:155]
DT v[156:157],v243 offset:14592
BL v229,s[8:11],s39 offen offset:1024 lds
MF a[156:159],v[132:135],v[100:103],a[156:159]
DT v[158:159],v243 offset:21760
AR v23,a37
WT lgkmcnt(8)
MF a[160:163],v[136:139],v[68:71],a[160:163]
DT v[160:161],v242 offset:14656
AR v24,a38
MF a[164:167],v[136:139],v[100:103],a[164:167]
DT v[162:163],v242 offset:21824
AR v25,a39
MF a[168:171],v[140:143],v[68:71],a[168:171]
DT v[164:165],v243 offset:14656
AR v26,a44
MF a[172:175],v[140:143],v[100:103],a[172:175]
DT v[166:167],v243 offset:21824
BL v230,s[8:11],s39 offen offset:2048 lds
WT lgkmcnt(8)
MF a[176:179],v[144:147],v[68:71],a[176:179]
DT v[168:169],v242 offset:14720
AR v27,a45
MF a[180:183],v[144:147],v[100:103],a[180:183]
DT v[170:171],v242 offset:21888
AR v28,a46
MF a[184:187],v[148:151],v[68:71],a[184:187]
DT v[172:173],v243 offset:14720
AR v29,a47
MF a[188:191],v[148:151],v[100:103],a[188:191]
DT v[174:175],v243 offset:21888
BL v231,s[8:11],s39 offen offset:3072 lds
WT lgkmcnt(8)
MF a[192:195],v[152:155],v[68:71],a[192:195]
DT v[176:177],v244 offset:0
SA s37,s37,32768
s_cmp_eq_u32 s37,163840
s_cselect_b32 s37,0,s37
FM v22,v22,v209
MF a[196:199],v[152:155],v[100:103],a[196:199]
DT v[178:179],v244 offset:7168
FM v23,v23,v209
MF a[200:203],v[156:159],v[68:71],a[200:203]
DT v[180:181],v245 offset:0
FM v24,v24,v209
MF a[204:207],v[156:159],v[100:103],a[204:207]
DT v[182:183],v245 offset:7168
FM v25,v25,v209
WT lgkmcnt(8)
MF a[208:211],v[160:163],v[68:71],a[208:211]
DT v[184:185],v244 offset:64
FM v26,v26,v209
MF a[212:215],v[160:163],v[100:103],a[212:215]
DT v[186:187],v244 offset:7232
FM v27,v27,v209
MF a[216:219],v[164:167],v[68:71],a[216:219]
DT v[188:189],v245 offset:64
FM v28,v28,v209
MF a[220:223],v[164:167],v[100:103],a[220:223]
DT v[190:191],v245 offset:7232
FM v29,v29,v209
WT lgkmcnt(8)
MF a[224:227],v[168:171],v[68:71],a[224:227]
DT v[128:129],v244 offset:128
CV v104,v22,v23
MF a[228:231],v[168:171],v[100:103],a[228:231]
DT v[130:131],v244 offset:7296
CV v105,v24,v25
MF a[232:235],v[172:175],v[68:71],a[232:235]
DT v[132:133],v245 offset:128
MF a[236:239],v[172:175],v[100:103],a[236:239]
DT v[134:135],v245 offset:7296
CV v106,v26,v27
CV v107,v28,v29
AR v10,a48
AR v11,a49
AR v12,a50
AR v13,a51
AR v14,a56
AR v15,a57
AR v16,a58
AR v17,a59
FM v10,v10,v208
FM v11,v11,v208
FM v12,v12,v208
FM v13,v13,v208
FM v14,v14,v208
FM v15,v15,v208
FM v16,v16,v208
FM v17,v17,v208
CV v76,v10,v11
CV v77,v12,v13
CV v78,v14,v15
CV v79,v16,v17
AR v22,a52
AR v23,a53
AR v24,a54
AR v25,a55
AR v26,a60
AR v27,a61
AR v28,a62
AR v29,a63
FM v22,v22,v209
FM v23,v23,v209
FM v24,v24,v209
FM v25,v25,v209
FM v26,v26,v209
FM v27,v27,v209
FM v28,v28,v209
FM v29,v29,v209
CV v108,v22,v23
CV v109,v24,v25
CV v110,v26,v27
CV v111,v28,v29
s_nop 1
WT lgkmcnt(8)
MF a[128:131],v[176:179],v[72:75],a[128:131]
DT v[136:137],v244 offset:192
MF a[132:135],v[176:179],v[104:107],a[132:135]
DT v[138:139],v244 offset:7360
WT vmcnt(16)
s_barrier
MF a[136:139],v[180:183],v[72:75],a[136:139]
DT v[140:141],v245 offset:192
MF a[140:143],v[180:183],v[104:107],a[140:143]
DT v[142:143],v245 offset:7360
v_readlane_b32 s39,v196,s36
WT lgkmcnt(8)
MF a[144:147],v[184:187],v[72:75],a[144:147]
DT v[144:145],v244 offset:256
SA s38,s38,32768
s_cmp_eq_u32 s38,163840
s_cselect_b32 s38,0,s38
MF a[148:151],v[184:187],v[104:107],a[148:151]
DT v[146:147],v244 offset:7424
MF a[152:155],v[188:191],v[72:75],a[152:155]
DT v[148:149],v245 offset:256
SA s36,s36,1
SA m0,s37,s48
v_add_u32 v242,s38,v240
MF a[156:159],v[188:191],v[104:107],a[156:159]
DT v[150:151],v245 offset:7424
v_add_u32 v243,s38,v241
WT lgkmcnt(8)
MF a[160:163],v[128:131],v[72:75],a[160:163]
DT v[152:153],v244 offset:320
AR v10,a64
MF a[164:167],v[128:131],v[104:107],a[164:167]
DT v[154:155],v244 offset:7488
BL v224,s[8:11],s39 offen offset:0 lds
MF a[168:171],v[132:135],v[72:75],a[168:171]
DT v[156:157],v245 offset:320
AR v11,a65
MF a[172:175],v[132:135],v[104:107],a[172:175]
DT v[158:159],v245 offset:7488
AR v12,a66
WT lgkmcnt(8)
MF a[176:179],v[136:139],v[72:75],a[176:179]
DT v[160:161],v244 offset:384
AR v13,a67
MF a[180:183],v[136:139],v[104:107],a[180:183]
DT v[162:163],v244 offset:7552
AR v14,a72
MF a[184:187],v[140:143],v[72:75],a[184:187]
DT v[164:165],v245 offset:384
BL v225,s[8:11],s39 offen offset:1024 lds
MF a[188:191],v[140:143],v[104:107],a[188:191]
DT v[166:167],v245 offset:7552
AR v15,a73
WT lgkmcnt(8)
MF a[192:195],v[144:147],v[72:75],a[192:195]
DT v[168:169],v244 offset:14336
AR v16,a74
MF a[196:199],v[144:147],v[104:107],a[196:199]
DT v[170:171],v244 offset:21504
AR v17,a75
MF a[200:203],v[148:151],v[72:75],a[200:203]
DT v[172:173],v245 offset:14336
FM v10,v10,v208
MF a[204:207],v[148:151],v[104:107],a[204:207]
DT v[174:175],v245 offset:21504
BL v226,s[8:11],s39 offen offset:2048 lds
WT lgkmcnt(8)
MF a[208:211],v[152:155],v[72:75],a[208:211]
DT v[176:177],v244 offset:14400
FM v11,v11,v208
MF a[212:215],v[152:155],v[104:107],a[212:215]
DT v[178:179],v244 offset:21568
FM v12,v12,v208
MF a[216:219],v[156:159],v[72:75],a[216:219]
DT v[180:181],v245 offset:14400
FM v13,v13,v208
MF a[220:223],v[156:159],v[104:107],a[220:223]
DT v[182:183],v245 offset:21568
FM v14,v14,v208
WT lgkmcnt(8)
MF a[224:227],v[160:163],v[72:75],a[224:227]
DT v[184:185],v244 offset:14464
BL v227,s[8:11],s39 offen offset:3072 lds
MF a[228:231],v[160:163],v[104:107],a[228:231]
DT v[186:187],v244 offset:21632
SA m0,m0,4096
FM v15,v15,v208
MF a[232:235],v[164:167],v[72:75],a[232:235]
DT v[188:189],v245 offset:14464
FM v16,v16,v208
MF a[236:239],v[164:167],v[104:107],a[236:239]
DT v[190:191],v245 offset:21632
FM v17,v17,v208
WT lgkmcnt(8)
MF a[128:131],v[168:171],v[76:79],a[128:131]
DT v[128:129],v244 offset:14528
CV v80,v10,v11
MF a[132:135],v[168:171],v[108:111],a[132:135]
DT v[130:131],v244 offset:21696
BL v228,s[8:11],s39 offen offset:0 lds
MF a[136:139],v[172:175],v[76:79],a[136:139]
DT v[132:133],v245 offset:14528
CV v81,v12,v13
MF a[140:143],v[172:175],v[108:111],a[140:143]
DT v[134:135],v245 offset:21696
CV v82,v14,v15
WT lgkmcnt(8)
MF a[144:147],v[176:179],v[76:79],a[144:147]
DT v[136:137],v244 offset:14592
CV v83,v16,v17
MF a[148:151],v[176:179],v[108:111],a[148:151]
DT v[138:139],v244 offset:21760
AR v22,a68
MF a[152:155],v[180:183],v[76:79],a[152:155]
DT v[140:141],v245 offset:14592
BL v229,s[8:11],s39 offen offset:1024 lds
MF a[156:159],v[180:183],v[108:111],a[156:159]
DT v[142:143],v245 offset:21760
AR v23,a69
WT lgkmcnt(8)
MF a[160:163],v[184:187],v[76:79],a[160:163]
DT v[144:145],v244 offset:14656
AR v24,a70
MF a[164:167],v[184:187],v[108:111],a[164:167]
DT v[146:147],v244 offset:21824
AR v25,a71
MF a[168:171],v[188:191],v[76:79],a[168:171]
DT v[148:149],v245 offset:14656
AR v26,a76
MF a[172:175],v[188:191],v[108:111],a[172:175]
DT v[150:151],v245 offset:21824
BL v230,s[8:11],s39 offen offset:2048 lds
WT lgkmcnt(8)
MF a[176:179],v[128:131],v[76:79],a[176:179]
DT v[152:153],v244 offset:14720
AR v27,a77
MF a[180:183],v[128:131],v[108:111],a[180:183]
DT v[154:155],v244 offset:21888
AR v28,a78
MF a[184:187],v[132:135],v[76:79],a[184:187]
DT v[156:157],v245 offset:14720
AR v29,a79
MF a[188:191],v[132:135],v[108:111],a[188:191]
DT v[158:159],v245 offset:21888
BL v231,s[8:11],s39 offen offset:3072 lds
WT lgkmcnt(8)
MF a[192:195],v[136:139],v[76:79],a[192:195]
DT v[160:161],v242 offset:0
SA s37,s37,32768
s_cmp_eq_u32 s37,163840
s_cselect_b32 s37,0,s37
FM v22,v22,v209
MF a[196:199],v[136:139],v[108:111],a[196:199]
DT v[162:163],v242 offset:7168
FM v23,v23,v209
MF a[200:203],v[140:143],v[76:79],a[200:203]
DT v[164:165],v243 offset:0
FM v24,v24,v209
MF a[204:207],v[140:143],v[108:111],a[204:207]
DT v[166:167],v243 offset:7168
FM v25,v25,v209
WT lgkmcnt(8)
MF a[208:211],v[144:147],v[76:79],a[208:211]
DT v[168:169],v242 offset:64
FM v26,v26,v209
MF a[212:215],v[144:147],v[108:111],a[212:215]
DT v[170:171],v242 offset:7232
FM v27,v27,v209
MF a[216:219],v[148:151],v[76:79],a[216:219]
DT v[172:173],v243 offset:64
FM v28,v28,v209
MF a[220:223],v[148:151],v[108:111],a[220:223]
DT v[174:175],v243 offset:7232
FM v29,v29,v209
WT lgkmcnt(8)
MF a[224:227],v[152:155],v[76:79],a[224:227]
DT v[176:177],v242 offset:128
CV v112,v22,v23
MF a[228:231],v[152:155],v[108:111],a[228:231]
DT v[178:179],v242 offset:7296
CV v113,v24,v25
MF a[232:235],v[156:159],v[76:79],a[232:235]
DT v[180:181],v243 offset:128
MF a[236:239],v[156:159],v[108:111],a[236:239]
DT v[182:183],v243 offset:7296
CV v114,v26,v27
CV v115,v28,v29
AR v10,a80
AR v11,a81
AR v12,a82
AR v13,a83
AR v14,a88
AR v15,a89
AR v16,a90
AR v17,a91
FM v10,v10,v208
FM v11,v11,v208
FM v12,v12,v208
FM v13,v13,v208
FM v14,v14,v208
FM v15,v15,v208
FM v16,v16,v208
FM v17,v17,v208
CV v84,v10,v11
CV v85,v12,v13
CV v86,v14,v15
CV v87,v16,v17
AR v22,a84
AR v23,a85
AR v24,a86
AR v25,a87
AR v26,a92
AR v27,a93
AR v28,a94
AR v29,a95
FM v22,v22,v209
FM v23,v23,v209
FM v24,v24,v209
FM v25,v25,v209
FM v26,v26,v209
FM v27,v27,v209
FM v28,v28,v209
FM v29,v29,v209
CV v116,v22,v23
CV v117,v24,v25
CV v118,v26,v27
CV v119,v28,v29
s_nop 1
WT lgkmcnt(8)
MF a[128:131],v[160:163],v[80:83],a[128:131]
DT v[184:185],v242 offset:192
MF a[132:135],v[160:163],v[112:115],a[132:135]
DT v[186:187],v242 offset:7360
WT vmcnt(16)
s_barrier
MF a[136:139],v[164:167],v[80:83],a[136:139]
DT v[188:189],v243 offset:192
MF a[140:143],v[164:167],v[112:115],a[140:143]
DT v[190:191],v243 offset:7360
v_readlane_b32 s39,v196,s36
WT lgkmcnt(8)
MF a[144:147],v[168:171],v[80:83],a[144:147]
DT v[128:129],v242 offset:256
SA s38,s38,32768
s_cmp_eq_u32 s38,163840
s_cselect_b32 s38,0,s38
MF a[148:151],v[168:171],v[112:115],a[148:151]
DT v[130:131],v242 offset:7424
MF a[152:155],v[172:175],v[80:83],a[152:155]
DT v[132:133],v243 offset:256
SA s36,s36,1
SA m0,s37,s48
v_add_u32 v244,s38,v240
MF a[156:159],v[172:175],v[112:115],a[156:159]
DT v[134:135],v243 offset:7424
v_add_u32 v245,s38,v241
WT lgkmcnt(8)
MF a[160:163],v[176:179],v[80:83],a[160:163]
DT v[136:137],v242 offset:320
AR v10,a96
MF a[164:167],v[176:179],v[112:115],a[164:167]
DT v[138:139],v242 offset:7488
BL v224,s[8:11],s39 offen offset:0 lds
MF a[168:171],v[180:183],v[80:83],a[168:171]
DT v[140:141],v243 offset:320
AR v11,a97
MF a[172:175],v[180:183],v[112:115],a[172:175]
DT v[142:143],v243 offset:7488
AR v12,a98
WT lgkmcnt(8)
MF a[176:179],v[184:187],v[80:83],a[176:179]
DT v[144:145],v242 offset:384
AR v13,a99
MF a[180:183],v[184:187],v[112:115],a[180:183]
DT v[146:147],v242 offset:7552
AR v14,a104
MF a[184:187],v[188:191],v[80:83],a[184:187]
DT v[148:149],v243 offset:384
BL v225,s[8:11],s39 offen offset:1024 lds
MF a[188:191],v[188:191],v[112:115],a[188:191]
DT v[150:151],v243 offset:7552
AR v15,a105
WT lgkmcnt(8)
MF a[192:195],v[128:131],v[80:83],a[192:195]
DT v[152:153],v242 offset:14336
AR v16,a106
MF a[196:199],v[128:131],v[112:115],a[196:199]
DT v[154:155],v242 offset:21504
AR v17,a107
MF a[200:203],v[132:135],v[80:83],a[200:203]
DT v[156:157],v243 offset:14336
FM v10,v10,v208
MF a[204:207],v[132:135],v[112:115],a[204:207]
DT v[158:159],v243 offset:21504
BL v226,s[8:11],s39 offen offset:2048 lds
WT lgkmcnt(8)
MF a[208:211],v[136:139],v[80:83],a[208:211]
DT v[160:161],v242 offset:14400
FM v11,v11,v208
MF a[212:215],v[136:139],v[112:115],a[212:215]
DT v[162:163],v242 offset:21568
FM v12,v12,v208
MF a[216:219],v[140:143],v[80:83],a[216:219]
DT v[164:165],v243 offset:14400
FM v13,v13,v208
MF a[220:223],v[140:143],v[112:115],a[220:223]
DT v[166:167],v243 offset:21568
FM v14,v14,v208
WT lgkmcnt(8)
MF a[224:227],v[144:147],v[80:83],a[224:227]
DT v[168:169],v242 offset:14464
BL v227,s[8:11],s39 offen offset:3072 lds
MF a[228:231],v[144:147],v[112:115],a[228:231]
DT v[170:171],v242 offset:21632
SA m0,m0,4096
FM v15,v15,v208
MF a[232:235],v[148:151],v[80:83],a[232:235]
DT v[172:173],v243 offset:14464
FM v16,v16,v208
MF a[236:239],v[148:151],v[112:115],a[236:239]
DT v[174:175],v243 offset:21632
FM v17,v17,v208
WT lgkmcnt(8)
MF a[128:131],v[152:155],v[84:87],a[128:131]
DT v[176:177],v242 offset:14528
CV v88,v10,v11
MF a[132:135],v[152:155],v[116:119],a[132:135]
DT v[178:179],v242 offset:21696
BL v228,s[8:11],s39 offen offset:0 lds
MF a[136:139],v[156:159],v[84:87],a[136:139]
DT v[180:181],v243 offset:14528
CV v89,v12,v13
MF a[140:143],v[156:159],v[116:119],a[140:143]
DT v[182:183],v243 offset:21696
CV v90,v14,v15
WT lgkmcnt(8)
MF a[144:147],v[160:163],v[84:87],a[144:147]
DT v[184:185],v242 offset:14592
CV v91,v16,v17
MF a[148:151],v[160:163],v[116:119],a[148:151]
DT v[186:187],v242 offset:21760
AR v22,a100
MF a[152:155],v[164:167],v[84:87],a[152:155]
DT v[188:189],v243 offset:14592
BL v229,s[8:11],s39 offen offset:1024 lds
MF a[156:159],v[164:167],v[116:119],a[156:159]
DT v[190:191],v243 offset:21760
AR v23,a101
WT lgkmcnt(8)
MF a[160:163],v[168:171],v[84:87],a[160:163]
DT v[128:129],v242 offset:14656
AR v24,a102
MF a[164:167],v[168:171],v[116:119],a[164:167]
DT v[130:131],v242 offset:21824
AR v25,a103
MF a[168:171],v[172:175],v[84:87],a[168:171]
DT v[132:133],v243 offset:14656
AR v26,a108
MF a[172:175],v[172:175],v[116:119],a[172:175]
DT v[134:135],v243 offset:21824
BL v230,s[8:11],s39 offen offset:2048 lds
WT lgkmcnt(8)
MF a[176:179],v[176:179],v[84:87],a[176:179]
DT v[136:137],v242 offset:14720
AR v27,a109
MF a[180:183],v[176:179],v[116:119],a[180:183]
DT v[138:139],v242 offset:21888
AR v28,a110
MF a[184:187],v[180:183],v[84:87],a[184:187]
DT v[140:141],v243 offset:14720
AR v29,a111
MF a[188:191],v[180:183],v[116:119],a[188:191]
DT v[142:143],v243 offset:21888
BL v231,s[8:11],s39 offen offset:3072 lds
WT lgkmcnt(8)
MF a[192:195],v[184:187],v[84:87],a[192:195]
DT v[144:145],v244 offset:0
SA s37,s37,32768
s_cmp_eq_u32 s37,163840
s_cselect_b32 s37,0,s37
FM v22,v22,v209
MF a[196:199],v[184:187],v[116:119],a[196:199]
DT v[146:147],v244 offset:7168
FM v23,v23,v209
MF a[200:203],v[188:191],v[84:87],a[200:203]
DT v[148:149],v245 offset:0
FM v24,v24,v209
MF a[204:207],v[188:191],v[116:119],a[204:207]
DT v[150:151],v245 offset:7168
FM v25,v25,v209
WT lgkmcnt(8)
MF a[208:211],v[128:131],v[84:87],a[208:211]
DT v[152:153],v244 offset:64
FM v26,v26,v209
MF a[212:215],v[128:131],v[116:119],a[212:215]
DT v[154:155],v244 offset:7232
FM v27,v27,v209
MF a[216:219],v[132:135],v[84:87],a[216:219]
DT v[156:157],v245 offset:64
FM v28,v28,v209
MF a[220:223],v[132:135],v[116:119],a[220:223]
DT v[158:159],v245 offset:7232
FM v29,v29,v209
WT lgkmcnt(8)
MF a[224:227],v[136:139],v[84:87],a[224:227]
DT v[160:161],v244 offset:128
CV v120,v22,v23
MF a[228:231],v[136:139],v[116:119],a[228:231]
DT v[162:163],v244 offset:7296
CV v121,v24,v25
MF a[232:235],v[140:143],v[84:87],a[232:235]
DT v[164:165],v245 offset:128
MF a[236:239],v[140:143],v[116:119],a[236:239]
DT v[166:167],v245 offset:7296
CV v122,v26,v27
CV v123,v28,v29
AR v10,a112
AR v11,a113
AR v12,a114
AR v13,a115
AR v14,a120
AR v15,a121
AR v16,a122
AR v17,a123
FM v10,v10,v208
FM v11,v11,v208
FM v12,v12,v208
FM v13,v13,v208
FM v14,v14,v208
FM v15,v15,v208
FM v16,v16,v208
FM v17,v17,v208
CV v92,v10,v11
CV v93,v12,v13
CV v94,v14,v15
CV v95,v16,v17
AR v22,a116
AR v23,a117
AR v24,a118
AR v25,a119
AR v26,a124
AR v27,a125
AR v28,a126
AR v29,a127
FM v22,v22,v209
FM v23,v23,v209
FM v24,v24,v209
FM v25,v25,v209
FM v26,v26,v209
FM v27,v27,v209
FM v28,v28,v209
FM v29,v29,v209
CV v124,v22,v23
CV v125,v24,v25
CV v126,v26,v27
CV v127,v28,v29
s_nop 1
k2_kernel_oproj3:
WT lgkmcnt(8)
MF a[128:131],v[144:147],v[88:91],a[128:131]
DT v[168:169],v244 offset:192
MF a[132:135],v[144:147],v[120:123],a[132:135]
DT v[170:171],v244 offset:7360
WT vmcnt(16)
s_barrier
MF a[136:139],v[148:151],v[88:91],a[136:139]
DT v[172:173],v245 offset:192
MF a[140:143],v[148:151],v[120:123],a[140:143]
DT v[174:175],v245 offset:7360
v_readlane_b32 s39,v196,s36
WT lgkmcnt(8)
MF a[144:147],v[152:155],v[88:91],a[144:147]
DT v[176:177],v244 offset:256
SA s38,s38,32768
s_cmp_eq_u32 s38,163840
s_cselect_b32 s38,0,s38
MF a[148:151],v[152:155],v[120:123],a[148:151]
DT v[178:179],v244 offset:7424
MF a[152:155],v[156:159],v[88:91],a[152:155]
DT v[180:181],v245 offset:256
SA s36,s36,1
SA m0,s37,s48
v_add_u32 v242,s38,v240
MF a[156:159],v[156:159],v[120:123],a[156:159]
DT v[182:183],v245 offset:7424
v_add_u32 v243,s38,v241
WT lgkmcnt(8)
MF a[160:163],v[160:163],v[88:91],a[160:163]
DT v[184:185],v244 offset:320
MF a[164:167],v[160:163],v[120:123],a[164:167]
DT v[186:187],v244 offset:7488
BL v224,s[8:11],s39 offen offset:0 lds
MF a[168:171],v[164:167],v[88:91],a[168:171]
DT v[188:189],v245 offset:320
MF a[172:175],v[164:167],v[120:123],a[172:175]
DT v[190:191],v245 offset:7488
WT lgkmcnt(8)
MF a[176:179],v[168:171],v[88:91],a[176:179]
DT v[128:129],v244 offset:384
MF a[180:183],v[168:171],v[120:123],a[180:183]
DT v[130:131],v244 offset:7552
MF a[184:187],v[172:175],v[88:91],a[184:187]
DT v[132:133],v245 offset:384
BL v225,s[8:11],s39 offen offset:1024 lds
MF a[188:191],v[172:175],v[120:123],a[188:191]
DT v[134:135],v245 offset:7552
WT lgkmcnt(8)
MF a[192:195],v[176:179],v[88:91],a[192:195]
DT v[136:137],v244 offset:14336
MF a[196:199],v[176:179],v[120:123],a[196:199]
DT v[138:139],v244 offset:21504
MF a[200:203],v[180:183],v[88:91],a[200:203]
DT v[140:141],v245 offset:14336
MF a[204:207],v[180:183],v[120:123],a[204:207]
DT v[142:143],v245 offset:21504
BL v226,s[8:11],s39 offen offset:2048 lds
WT lgkmcnt(8)
MF a[208:211],v[184:187],v[88:91],a[208:211]
DT v[144:145],v244 offset:14400
MF a[212:215],v[184:187],v[120:123],a[212:215]
DT v[146:147],v244 offset:21568
MF a[216:219],v[188:191],v[88:91],a[216:219]
DT v[148:149],v245 offset:14400
MF a[220:223],v[188:191],v[120:123],a[220:223]
DT v[150:151],v245 offset:21568
WT lgkmcnt(8)
MF a[224:227],v[128:131],v[88:91],a[224:227]
DT v[152:153],v244 offset:14464
BL v227,s[8:11],s39 offen offset:3072 lds
MF a[228:231],v[128:131],v[120:123],a[228:231]
DT v[154:155],v244 offset:21632
SA m0,m0,4096
MF a[232:235],v[132:135],v[88:91],a[232:235]
DT v[156:157],v245 offset:14464
MF a[236:239],v[132:135],v[120:123],a[236:239]
DT v[158:159],v245 offset:21632
WT lgkmcnt(8)
MF a[128:131],v[136:139],v[92:95],a[128:131]
DT v[160:161],v244 offset:14528
MF a[132:135],v[136:139],v[124:127],a[132:135]
DT v[162:163],v244 offset:21696
BL v228,s[8:11],s39 offen offset:0 lds
MF a[136:139],v[140:143],v[92:95],a[136:139]
DT v[164:165],v245 offset:14528
MF a[140:143],v[140:143],v[124:127],a[140:143]
DT v[166:167],v245 offset:21696
WT lgkmcnt(8)
MF a[144:147],v[144:147],v[92:95],a[144:147]
DT v[168:169],v244 offset:14592
MF a[148:151],v[144:147],v[124:127],a[148:151]
DT v[170:171],v244 offset:21760
MF a[152:155],v[148:151],v[92:95],a[152:155]
DT v[172:173],v245 offset:14592
BL v229,s[8:11],s39 offen offset:1024 lds
MF a[156:159],v[148:151],v[124:127],a[156:159]
DT v[174:175],v245 offset:21760
WT lgkmcnt(8)
MF a[160:163],v[152:155],v[92:95],a[160:163]
DT v[176:177],v244 offset:14656
MF a[164:167],v[152:155],v[124:127],a[164:167]
DT v[178:179],v244 offset:21824
MF a[168:171],v[156:159],v[92:95],a[168:171]
DT v[180:181],v245 offset:14656
MF a[172:175],v[156:159],v[124:127],a[172:175]
DT v[182:183],v245 offset:21824
BL v230,s[8:11],s39 offen offset:2048 lds
WT lgkmcnt(8)
MF a[176:179],v[160:163],v[92:95],a[176:179]
DT v[184:185],v244 offset:14720
MF a[180:183],v[160:163],v[124:127],a[180:183]
DT v[186:187],v244 offset:21888
MF a[184:187],v[164:167],v[92:95],a[184:187]
DT v[188:189],v245 offset:14720
MF a[188:191],v[164:167],v[124:127],a[188:191]
DT v[190:191],v245 offset:21888
BL v231,s[8:11],s39 offen offset:3072 lds
WT lgkmcnt(8)
MF a[192:195],v[168:171],v[92:95],a[192:195]
DT v[128:129],v242 offset:0
SA s37,s37,32768
s_cmp_eq_u32 s37,163840
s_cselect_b32 s37,0,s37
MF a[196:199],v[168:171],v[124:127],a[196:199]
DT v[130:131],v242 offset:7168
MF a[200:203],v[172:175],v[92:95],a[200:203]
DT v[132:133],v243 offset:0
MF a[204:207],v[172:175],v[124:127],a[204:207]
DT v[134:135],v243 offset:7168
WT lgkmcnt(8)
MF a[208:211],v[176:179],v[92:95],a[208:211]
DT v[136:137],v242 offset:64
MF a[212:215],v[176:179],v[124:127],a[212:215]
DT v[138:139],v242 offset:7232
MF a[216:219],v[180:183],v[92:95],a[216:219]
DT v[140:141],v243 offset:64
MF a[220:223],v[180:183],v[124:127],a[220:223]
DT v[142:143],v243 offset:7232
WT lgkmcnt(8)
MF a[224:227],v[184:187],v[92:95],a[224:227]
DT v[144:145],v242 offset:128
MF a[228:231],v[184:187],v[124:127],a[228:231]
DT v[146:147],v242 offset:7296
MF a[232:235],v[188:191],v[92:95],a[232:235]
DT v[148:149],v243 offset:128
MF a[236:239],v[188:191],v[124:127],a[236:239]
DT v[150:151],v243 offset:7296
WT lgkmcnt(8)
MF a[0:3],v[128:131],v[64:67],0
DT v[152:153],v242 offset:192
MF a[4:7],v[128:131],v[96:99],0
DT v[154:155],v242 offset:7360
WT vmcnt(16)
s_barrier
MF a[8:11],v[132:135],v[64:67],0
DT v[156:157],v243 offset:192
MF a[12:15],v[132:135],v[96:99],0
DT v[158:159],v243 offset:7360
SA s38,s38,32768
s_cmp_eq_u32 s38,163840
s_cselect_b32 s38,0,s38
v_add_u32 v244,s38,v240
WT lgkmcnt(8)
MF a[16:19],v[136:139],v[64:67],0
DT v[160:161],v242 offset:256
v_add_u32 v245,s38,v241
MF a[20:23],v[136:139],v[96:99],0
DT v[162:163],v242 offset:7424
MF a[24:27],v[140:143],v[64:67],0
DT v[164:165],v243 offset:256
AR v200,a128
MF a[28:31],v[140:143],v[96:99],0
DT v[166:167],v243 offset:7424
AR v201,a129
WT lgkmcnt(8)
MF a[32:35],v[144:147],v[64:67],0
DT v[168:169],v242 offset:320
AR v202,a130
MF a[36:39],v[144:147],v[96:99],0
DT v[170:171],v242 offset:7488
AR v203,a131
MF a[40:43],v[148:151],v[64:67],0
DT v[172:173],v243 offset:320
AR v204,a136
MF a[44:47],v[148:151],v[96:99],0
DT v[174:175],v243 offset:7488
AR v205,a137
WT lgkmcnt(8)
MF a[48:51],v[152:155],v[64:67],0
DT v[176:177],v242 offset:384
AR v206,a138
MF a[52:55],v[152:155],v[96:99],0
DT v[178:179],v242 offset:7552
AR v207,a139
MF a[56:59],v[156:159],v[64:67],0
DT v[180:181],v243 offset:384
CV v208,v200,v201
MF a[60:63],v[156:159],v[96:99],0
DT v[182:183],v243 offset:7552
CV v209,v202,v203
WT lgkmcnt(8)
MF a[64:67],v[160:163],v[64:67],0
DT v[184:185],v242 offset:14336
CV v210,v204,v205
MF a[68:71],v[160:163],v[96:99],0
DT v[186:187],v242 offset:21504
CV v211,v206,v207
MF a[72:75],v[164:167],v[64:67],0
DT v[188:189],v243 offset:14336
SA s71,s70,0
BS v[208:211],v194,s[20:23],s71 offen sc1
MF a[76:79],v[164:167],v[96:99],0
DT v[190:191],v243 offset:21504
AR v212,a144
WT lgkmcnt(8)
MF a[80:83],v[168:171],v[64:67],0
DT v[128:129],v242 offset:14400
AR v213,a145
MF a[84:87],v[168:171],v[96:99],0
DT v[130:131],v242 offset:21568
AR v214,a146
MF a[88:91],v[172:175],v[64:67],0
DT v[132:133],v243 offset:14400
AR v215,a147
MF a[92:95],v[172:175],v[96:99],0
DT v[134:135],v243 offset:21568
AR v216,a152
WT lgkmcnt(8)
MF a[96:99],v[176:179],v[64:67],0
DT v[136:137],v242 offset:14464
AR v217,a153
MF a[100:103],v[176:179],v[96:99],0
DT v[138:139],v242 offset:21632
AR v218,a154
MF a[104:107],v[180:183],v[64:67],0
DT v[140:141],v243 offset:14464
AR v219,a155
MF a[108:111],v[180:183],v[96:99],0
DT v[142:143],v243 offset:21632
CV v220,v212,v213
WT lgkmcnt(8)
MF a[0:3],v[184:187],v[68:71],a[0:3]
DT v[144:145],v242 offset:14528
CV v221,v214,v215
MF a[4:7],v[184:187],v[100:103],a[4:7]
DT v[146:147],v242 offset:21696
CV v222,v216,v217
MF a[8:11],v[188:191],v[68:71],a[8:11]
DT v[148:149],v243 offset:14528
CV v223,v218,v219
MF a[12:15],v[188:191],v[100:103],a[12:15]
DT v[150:151],v243 offset:21696
SA s71,s70,1024
BS v[220:223],v194,s[20:23],s71 offen sc1
WT lgkmcnt(8)
MF a[16:19],v[128:131],v[68:71],a[16:19]
DT v[152:153],v242 offset:14592
AR v200,a160
MF a[20:23],v[128:131],v[100:103],a[20:23]
DT v[154:155],v242 offset:21760
AR v201,a161
MF a[24:27],v[132:135],v[68:71],a[24:27]
DT v[156:157],v243 offset:14592
AR v202,a162
MF a[28:31],v[132:135],v[100:103],a[28:31]
DT v[158:159],v243 offset:21760
AR v203,a163
WT lgkmcnt(8)
MF a[32:35],v[136:139],v[68:71],a[32:35]
DT v[160:161],v242 offset:14656
AR v204,a168
MF a[36:39],v[136:139],v[100:103],a[36:39]
DT v[162:163],v242 offset:21824
AR v205,a169
MF a[40:43],v[140:143],v[68:71],a[40:43]
DT v[164:165],v243 offset:14656
AR v206,a170
MF a[44:47],v[140:143],v[100:103],a[44:47]
DT v[166:167],v243 offset:21824
AR v207,a171
WT lgkmcnt(8)
MF a[48:51],v[144:147],v[68:71],a[48:51]
DT v[168:169],v242 offset:14720
CV v208,v200,v201
MF a[52:55],v[144:147],v[100:103],a[52:55]
DT v[170:171],v242 offset:21888
CV v209,v202,v203
MF a[56:59],v[148:151],v[68:71],a[56:59]
DT v[172:173],v243 offset:14720
CV v210,v204,v205
MF a[60:63],v[148:151],v[100:103],a[60:63]
DT v[174:175],v243 offset:21888
CV v211,v206,v207
WT lgkmcnt(8)
MF a[64:67],v[152:155],v[68:71],a[64:67]
DT v[176:177],v244 offset:0
SA s71,s70,2048
BS v[208:211],v194,s[20:23],s71 offen sc1
MF a[68:71],v[152:155],v[100:103],a[68:71]
DT v[178:179],v244 offset:7168
AR v212,a176
MF a[72:75],v[156:159],v[68:71],a[72:75]
DT v[180:181],v245 offset:0
AR v213,a177
MF a[76:79],v[156:159],v[100:103],a[76:79]
DT v[182:183],v245 offset:7168
AR v214,a178
WT lgkmcnt(8)
MF a[80:83],v[160:163],v[68:71],a[80:83]
DT v[184:185],v244 offset:64
AR v215,a179
MF a[84:87],v[160:163],v[100:103],a[84:87]
DT v[186:187],v244 offset:7232
AR v216,a184
MF a[88:91],v[164:167],v[68:71],a[88:91]
DT v[188:189],v245 offset:64
AR v217,a185
MF a[92:95],v[164:167],v[100:103],a[92:95]
DT v[190:191],v245 offset:7232
AR v218,a186
WT lgkmcnt(8)
MF a[96:99],v[168:171],v[68:71],a[96:99]
DT v[128:129],v244 offset:128
AR v219,a187
MF a[100:103],v[168:171],v[100:103],a[100:103]
DT v[130:131],v244 offset:7296
CV v220,v212,v213
MF a[104:107],v[172:175],v[68:71],a[104:107]
DT v[132:133],v245 offset:128
CV v221,v214,v215
MF a[108:111],v[172:175],v[100:103],a[108:111]
DT v[134:135],v245 offset:7296
CV v222,v216,v217
WT lgkmcnt(8)
MF a[0:3],v[176:179],v[72:75],a[0:3]
DT v[136:137],v244 offset:192
MF a[4:7],v[176:179],v[104:107],a[4:7]
DT v[138:139],v244 offset:7360
WT vmcnt(11)
s_barrier
MF a[8:11],v[180:183],v[72:75],a[8:11]
DT v[140:141],v245 offset:192
MF a[12:15],v[180:183],v[104:107],a[12:15]
DT v[142:143],v245 offset:7360
SA s38,s38,32768
s_cmp_eq_u32 s38,163840
s_cselect_b32 s38,0,s38
v_add_u32 v242,s38,v240
WT lgkmcnt(8)
MF a[16:19],v[184:187],v[72:75],a[16:19]
DT v[144:145],v244 offset:256
v_add_u32 v243,s38,v241
MF a[20:23],v[184:187],v[104:107],a[20:23]
DT v[146:147],v244 offset:7424
MF a[24:27],v[188:191],v[72:75],a[24:27]
DT v[148:149],v245 offset:256
CV v223,v218,v219
MF a[28:31],v[188:191],v[104:107],a[28:31]
DT v[150:151],v245 offset:7424
SA s71,s70,3072
BS v[220:223],v194,s[20:23],s71 offen sc1
WT lgkmcnt(8)
MF a[32:35],v[128:131],v[72:75],a[32:35]
DT v[152:153],v244 offset:320
AR v200,a192
MF a[36:39],v[128:131],v[104:107],a[36:39]
DT v[154:155],v244 offset:7488
AR v201,a193
MF a[40:43],v[132:135],v[72:75],a[40:43]
DT v[156:157],v245 offset:320
AR v202,a194
MF a[44:47],v[132:135],v[104:107],a[44:47]
DT v[158:159],v245 offset:7488
AR v203,a195
WT lgkmcnt(8)
MF a[48:51],v[136:139],v[72:75],a[48:51]
DT v[160:161],v244 offset:384
AR v204,a200
MF a[52:55],v[136:139],v[104:107],a[52:55]
DT v[162:163],v244 offset:7552
AR v205,a201
MF a[56:59],v[140:143],v[72:75],a[56:59]
DT v[164:165],v245 offset:384
AR v206,a202
MF a[60:63],v[140:143],v[104:107],a[60:63]
DT v[166:167],v245 offset:7552
AR v207,a203
WT lgkmcnt(8)
MF a[64:67],v[144:147],v[72:75],a[64:67]
DT v[168:169],v244 offset:14336
CV v208,v200,v201
MF a[68:71],v[144:147],v[104:107],a[68:71]
DT v[170:171],v244 offset:21504
CV v209,v202,v203
MF a[72:75],v[148:151],v[72:75],a[72:75]
DT v[172:173],v245 offset:14336
CV v210,v204,v205
MF a[76:79],v[148:151],v[104:107],a[76:79]
DT v[174:175],v245 offset:21504
CV v211,v206,v207
WT lgkmcnt(8)
MF a[80:83],v[152:155],v[72:75],a[80:83]
DT v[176:177],v244 offset:14400
SA s71,s70,4096
BS v[208:211],v194,s[20:23],s71 offen sc1
MF a[84:87],v[152:155],v[104:107],a[84:87]
DT v[178:179],v244 offset:21568
AR v212,a208
MF a[88:91],v[156:159],v[72:75],a[88:91]
DT v[180:181],v245 offset:14400
AR v213,a209
MF a[92:95],v[156:159],v[104:107],a[92:95]
DT v[182:183],v245 offset:21568
AR v214,a210
WT lgkmcnt(8)
MF a[96:99],v[160:163],v[72:75],a[96:99]
DT v[184:185],v244 offset:14464
AR v215,a211
MF a[100:103],v[160:163],v[104:107],a[100:103]
DT v[186:187],v244 offset:21632
AR v216,a216
MF a[104:107],v[164:167],v[72:75],a[104:107]
DT v[188:189],v245 offset:14464
AR v217,a217
MF a[108:111],v[164:167],v[104:107],a[108:111]
DT v[190:191],v245 offset:21632
AR v218,a218
WT lgkmcnt(8)
MF a[0:3],v[168:171],v[76:79],a[0:3]
DT v[128:129],v244 offset:14528
AR v219,a219
MF a[4:7],v[168:171],v[108:111],a[4:7]
DT v[130:131],v244 offset:21696
CV v220,v212,v213
MF a[8:11],v[172:175],v[76:79],a[8:11]
DT v[132:133],v245 offset:14528
CV v221,v214,v215
MF a[12:15],v[172:175],v[108:111],a[12:15]
DT v[134:135],v245 offset:21696
CV v222,v216,v217
WT lgkmcnt(8)
MF a[16:19],v[176:179],v[76:79],a[16:19]
DT v[136:137],v244 offset:14592
CV v223,v218,v219
MF a[20:23],v[176:179],v[108:111],a[20:23]
DT v[138:139],v244 offset:21760
SA s71,s70,5120
BS v[220:223],v194,s[20:23],s71 offen sc1
MF a[24:27],v[180:183],v[76:79],a[24:27]
DT v[140:141],v245 offset:14592
AR v200,a224
MF a[28:31],v[180:183],v[108:111],a[28:31]
DT v[142:143],v245 offset:21760
AR v201,a225
WT lgkmcnt(8)
MF a[32:35],v[184:187],v[76:79],a[32:35]
DT v[144:145],v244 offset:14656
AR v202,a226
MF a[36:39],v[184:187],v[108:111],a[36:39]
DT v[146:147],v244 offset:21824
AR v203,a227
MF a[40:43],v[188:191],v[76:79],a[40:43]
DT v[148:149],v245 offset:14656
AR v204,a232
MF a[44:47],v[188:191],v[108:111],a[44:47]
DT v[150:151],v245 offset:21824
AR v205,a233
WT lgkmcnt(8)
MF a[48:51],v[128:131],v[76:79],a[48:51]
DT v[152:153],v244 offset:14720
AR v206,a234
MF a[52:55],v[128:131],v[108:111],a[52:55]
DT v[154:155],v244 offset:21888
AR v207,a235
MF a[56:59],v[132:135],v[76:79],a[56:59]
DT v[156:157],v245 offset:14720
CV v208,v200,v201
MF a[60:63],v[132:135],v[108:111],a[60:63]
DT v[158:159],v245 offset:21888
CV v209,v202,v203
WT lgkmcnt(8)
MF a[64:67],v[136:139],v[76:79],a[64:67]
DT v[160:161],v242 offset:0
CV v210,v204,v205
MF a[68:71],v[136:139],v[108:111],a[68:71]
DT v[162:163],v242 offset:7168
CV v211,v206,v207
MF a[72:75],v[140:143],v[76:79],a[72:75]
DT v[164:165],v243 offset:0
SA s71,s70,6144
BS v[208:211],v194,s[20:23],s71 offen sc1
MF a[76:79],v[140:143],v[108:111],a[76:79]
DT v[166:167],v243 offset:7168
WT lgkmcnt(8)
MF a[80:83],v[144:147],v[76:79],a[80:83]
DT v[168:169],v242 offset:64
MF a[84:87],v[144:147],v[108:111],a[84:87]
DT v[170:171],v242 offset:7232
MF a[88:91],v[148:151],v[76:79],a[88:91]
DT v[172:173],v243 offset:64
MF a[92:95],v[148:151],v[108:111],a[92:95]
DT v[174:175],v243 offset:7232
WT lgkmcnt(8)
MF a[96:99],v[152:155],v[76:79],a[96:99]
DT v[176:177],v242 offset:128
MF a[100:103],v[152:155],v[108:111],a[100:103]
DT v[178:179],v242 offset:7296
MF a[104:107],v[156:159],v[76:79],a[104:107]
DT v[180:181],v243 offset:128
MF a[108:111],v[156:159],v[108:111],a[108:111]
DT v[182:183],v243 offset:7296
WT lgkmcnt(8)
MF a[0:3],v[160:163],v[80:83],a[0:3]
DT v[184:185],v242 offset:192
MF a[4:7],v[160:163],v[112:115],a[4:7]
DT v[186:187],v242 offset:7360
WT vmcnt(7)
s_barrier
MF a[8:11],v[164:167],v[80:83],a[8:11]
DT v[188:189],v243 offset:192
MF a[12:15],v[164:167],v[112:115],a[12:15]
DT v[190:191],v243 offset:7360
SA s38,s38,32768
s_cmp_eq_u32 s38,163840
s_cselect_b32 s38,0,s38
v_add_u32 v244,s38,v240
WT lgkmcnt(8)
MF a[16:19],v[168:171],v[80:83],a[16:19]
DT v[128:129],v242 offset:256
v_add_u32 v245,s38,v241
MF a[20:23],v[168:171],v[112:115],a[20:23]
DT v[130:131],v242 offset:7424
MF a[24:27],v[172:175],v[80:83],a[24:27]
DT v[132:133],v243 offset:256
AR v212,a132
MF a[28:31],v[172:175],v[112:115],a[28:31]
DT v[134:135],v243 offset:7424
AR v213,a133
WT lgkmcnt(8)
MF a[32:35],v[176:179],v[80:83],a[32:35]
DT v[136:137],v242 offset:320
AR v214,a134
MF a[36:39],v[176:179],v[112:115],a[36:39]
DT v[138:139],v242 offset:7488
AR v215,a135
MF a[40:43],v[180:183],v[80:83],a[40:43]
DT v[140:141],v243 offset:320
AR v216,a140
MF a[44:47],v[180:183],v[112:115],a[44:47]
DT v[142:143],v243 offset:7488
AR v217,a141
WT lgkmcnt(8)
MF a[48:51],v[184:187],v[80:83],a[48:51]
DT v[144:145],v242 offset:384
AR v218,a142
MF a[52:55],v[184:187],v[112:115],a[52:55]
DT v[146:147],v242 offset:7552
AR v219,a143
MF a[56:59],v[188:191],v[80:83],a[56:59]
DT v[148:149],v243 offset:384
CV v220,v212,v213
MF a[60:63],v[188:191],v[112:115],a[60:63]
DT v[150:151],v243 offset:7552
CV v221,v214,v215
WT lgkmcnt(8)
MF a[64:67],v[128:131],v[80:83],a[64:67]
DT v[152:153],v242 offset:14336
CV v222,v216,v217
MF a[68:71],v[128:131],v[112:115],a[68:71]
DT v[154:155],v242 offset:21504
CV v223,v218,v219
MF a[72:75],v[132:135],v[80:83],a[72:75]
DT v[156:157],v243 offset:14336
SA s71,s70,14336
BS v[220:223],v194,s[20:23],s71 offen sc1
MF a[76:79],v[132:135],v[112:115],a[76:79]
DT v[158:159],v243 offset:21504
AR v200,a148
WT lgkmcnt(8)
MF a[80:83],v[136:139],v[80:83],a[80:83]
DT v[160:161],v242 offset:14400
AR v201,a149
MF a[84:87],v[136:139],v[112:115],a[84:87]
DT v[162:163],v242 offset:21568
AR v202,a150
MF a[88:91],v[140:143],v[80:83],a[88:91]
DT v[164:165],v243 offset:14400
AR v203,a151
MF a[92:95],v[140:143],v[112:115],a[92:95]
DT v[166:167],v243 offset:21568
AR v204,a156
WT lgkmcnt(8)
MF a[96:99],v[144:147],v[80:83],a[96:99]
DT v[168:169],v242 offset:14464
AR v205,a157
MF a[100:103],v[144:147],v[112:115],a[100:103]
DT v[170:171],v242 offset:21632
AR v206,a158
MF a[104:107],v[148:151],v[80:83],a[104:107]
DT v[172:173],v243 offset:14464
AR v207,a159
MF a[108:111],v[148:151],v[112:115],a[108:111]
DT v[174:175],v243 offset:21632
CV v208,v200,v201
WT lgkmcnt(8)
MF a[0:3],v[152:155],v[84:87],a[0:3]
DT v[176:177],v242 offset:14528
CV v209,v202,v203
MF a[4:7],v[152:155],v[116:119],a[4:7]
DT v[178:179],v242 offset:21696
CV v210,v204,v205
MF a[8:11],v[156:159],v[84:87],a[8:11]
DT v[180:181],v243 offset:14528
CV v211,v206,v207
MF a[12:15],v[156:159],v[116:119],a[12:15]
DT v[182:183],v243 offset:21696
SA s71,s70,15360
BS v[208:211],v194,s[20:23],s71 offen sc1
WT lgkmcnt(8)
MF a[16:19],v[160:163],v[84:87],a[16:19]
DT v[184:185],v242 offset:14592
AR v212,a164
MF a[20:23],v[160:163],v[116:119],a[20:23]
DT v[186:187],v242 offset:21760
AR v213,a165
MF a[24:27],v[164:167],v[84:87],a[24:27]
DT v[188:189],v243 offset:14592
AR v214,a166
MF a[28:31],v[164:167],v[116:119],a[28:31]
DT v[190:191],v243 offset:21760
AR v215,a167
WT lgkmcnt(8)
MF a[32:35],v[168:171],v[84:87],a[32:35]
DT v[128:129],v242 offset:14656
AR v216,a172
MF a[36:39],v[168:171],v[116:119],a[36:39]
DT v[130:131],v242 offset:21824
AR v217,a173
MF a[40:43],v[172:175],v[84:87],a[40:43]
DT v[132:133],v243 offset:14656
AR v218,a174
MF a[44:47],v[172:175],v[116:119],a[44:47]
DT v[134:135],v243 offset:21824
AR v219,a175
WT lgkmcnt(8)
MF a[48:51],v[176:179],v[84:87],a[48:51]
DT v[136:137],v242 offset:14720
CV v220,v212,v213
MF a[52:55],v[176:179],v[116:119],a[52:55]
DT v[138:139],v242 offset:21888
CV v221,v214,v215
MF a[56:59],v[180:183],v[84:87],a[56:59]
DT v[140:141],v243 offset:14720
CV v222,v216,v217
MF a[60:63],v[180:183],v[116:119],a[60:63]
DT v[142:143],v243 offset:21888
CV v223,v218,v219
WT lgkmcnt(8)
MF a[64:67],v[184:187],v[84:87],a[64:67]
DT v[144:145],v244 offset:0
SA s71,s70,16384
BS v[220:223],v194,s[20:23],s71 offen sc1
MF a[68:71],v[184:187],v[116:119],a[68:71]
DT v[146:147],v244 offset:7168
AR v200,a180
MF a[72:75],v[188:191],v[84:87],a[72:75]
DT v[148:149],v245 offset:0
AR v201,a181
MF a[76:79],v[188:191],v[116:119],a[76:79]
DT v[150:151],v245 offset:7168
AR v202,a182
WT lgkmcnt(8)
MF a[80:83],v[128:131],v[84:87],a[80:83]
DT v[152:153],v244 offset:64
AR v203,a183
MF a[84:87],v[128:131],v[116:119],a[84:87]
DT v[154:155],v244 offset:7232
AR v204,a188
MF a[88:91],v[132:135],v[84:87],a[88:91]
DT v[156:157],v245 offset:64
AR v205,a189
MF a[92:95],v[132:135],v[116:119],a[92:95]
DT v[158:159],v245 offset:7232
AR v206,a190
WT lgkmcnt(8)
MF a[96:99],v[136:139],v[84:87],a[96:99]
DT v[160:161],v244 offset:128
AR v207,a191
MF a[100:103],v[136:139],v[116:119],a[100:103]
DT v[162:163],v244 offset:7296
CV v208,v200,v201
MF a[104:107],v[140:143],v[84:87],a[104:107]
DT v[164:165],v245 offset:128
CV v209,v202,v203
MF a[108:111],v[140:143],v[116:119],a[108:111]
DT v[166:167],v245 offset:7296
CV v210,v204,v205
WT lgkmcnt(8)
MF a[0:3],v[144:147],v[88:91],a[0:3]
DT v[168:169],v244 offset:192
MF a[4:7],v[144:147],v[120:123],a[4:7]
DT v[170:171],v244 offset:7360
MF a[8:11],v[148:151],v[88:91],a[8:11]
DT v[172:173],v245 offset:192
MF a[12:15],v[148:151],v[120:123],a[12:15]
DT v[174:175],v245 offset:7360
WT lgkmcnt(8)
MF a[16:19],v[152:155],v[88:91],a[16:19]
DT v[176:177],v244 offset:256
MF a[20:23],v[152:155],v[120:123],a[20:23]
DT v[178:179],v244 offset:7424
MF a[24:27],v[156:159],v[88:91],a[24:27]
DT v[180:181],v245 offset:256
CV v211,v206,v207
MF a[28:31],v[156:159],v[120:123],a[28:31]
DT v[182:183],v245 offset:7424
SA s71,s70,17408
BS v[208:211],v194,s[20:23],s71 offen sc1
WT lgkmcnt(8)
MF a[32:35],v[160:163],v[88:91],a[32:35]
DT v[184:185],v244 offset:320
AR v212,a196
MF a[36:39],v[160:163],v[120:123],a[36:39]
DT v[186:187],v244 offset:7488
AR v213,a197
MF a[40:43],v[164:167],v[88:91],a[40:43]
DT v[188:189],v245 offset:320
AR v214,a198
MF a[44:47],v[164:167],v[120:123],a[44:47]
DT v[190:191],v245 offset:7488
AR v215,a199
WT lgkmcnt(8)
MF a[48:51],v[168:171],v[88:91],a[48:51]
DT v[128:129],v244 offset:384
AR v216,a204
MF a[52:55],v[168:171],v[120:123],a[52:55]
DT v[130:131],v244 offset:7552
AR v217,a205
MF a[56:59],v[172:175],v[88:91],a[56:59]
DT v[132:133],v245 offset:384
AR v218,a206
MF a[60:63],v[172:175],v[120:123],a[60:63]
DT v[134:135],v245 offset:7552
AR v219,a207
WT lgkmcnt(8)
MF a[64:67],v[176:179],v[88:91],a[64:67]
DT v[136:137],v244 offset:14336
CV v220,v212,v213
MF a[68:71],v[176:179],v[120:123],a[68:71]
DT v[138:139],v244 offset:21504
CV v221,v214,v215
MF a[72:75],v[180:183],v[88:91],a[72:75]
DT v[140:141],v245 offset:14336
CV v222,v216,v217
MF a[76:79],v[180:183],v[120:123],a[76:79]
DT v[142:143],v245 offset:21504
CV v223,v218,v219
WT lgkmcnt(8)
MF a[80:83],v[184:187],v[88:91],a[80:83]
DT v[144:145],v244 offset:14400
SA s71,s70,18432
BS v[220:223],v194,s[20:23],s71 offen sc1
MF a[84:87],v[184:187],v[120:123],a[84:87]
DT v[146:147],v244 offset:21568
AR v200,a212
MF a[88:91],v[188:191],v[88:91],a[88:91]
DT v[148:149],v245 offset:14400
AR v201,a213
MF a[92:95],v[188:191],v[120:123],a[92:95]
DT v[150:151],v245 offset:21568
AR v202,a214
WT lgkmcnt(8)
MF a[96:99],v[128:131],v[88:91],a[96:99]
DT v[152:153],v244 offset:14464
AR v203,a215
MF a[100:103],v[128:131],v[120:123],a[100:103]
DT v[154:155],v244 offset:21632
AR v204,a220
MF a[104:107],v[132:135],v[88:91],a[104:107]
DT v[156:157],v245 offset:14464
AR v205,a221
MF a[108:111],v[132:135],v[120:123],a[108:111]
DT v[158:159],v245 offset:21632
AR v206,a222
WT lgkmcnt(8)
MF a[0:3],v[136:139],v[92:95],a[0:3]
DT v[160:161],v244 offset:14528
AR v207,a223
MF a[4:7],v[136:139],v[124:127],a[4:7]
DT v[162:163],v244 offset:21696
CV v208,v200,v201
MF a[8:11],v[140:143],v[92:95],a[8:11]
DT v[164:165],v245 offset:14528
CV v209,v202,v203
MF a[12:15],v[140:143],v[124:127],a[12:15]
DT v[166:167],v245 offset:21696
CV v210,v204,v205
WT lgkmcnt(8)
MF a[16:19],v[144:147],v[92:95],a[16:19]
DT v[168:169],v244 offset:14592
CV v211,v206,v207
MF a[20:23],v[144:147],v[124:127],a[20:23]
DT v[170:171],v244 offset:21760
SA s71,s70,19456
BS v[208:211],v194,s[20:23],s71 offen sc1
MF a[24:27],v[148:151],v[92:95],a[24:27]
DT v[172:173],v245 offset:14592
AR v212,a228
MF a[28:31],v[148:151],v[124:127],a[28:31]
DT v[174:175],v245 offset:21760
AR v213,a229
WT lgkmcnt(8)
MF a[32:35],v[152:155],v[92:95],a[32:35]
DT v[176:177],v244 offset:14656
AR v214,a230
MF a[36:39],v[152:155],v[124:127],a[36:39]
DT v[178:179],v244 offset:21824
AR v215,a231
MF a[40:43],v[156:159],v[92:95],a[40:43]
DT v[180:181],v245 offset:14656
AR v216,a236
MF a[44:47],v[156:159],v[124:127],a[44:47]
DT v[182:183],v245 offset:21824
AR v217,a237
WT lgkmcnt(8)
MF a[48:51],v[160:163],v[92:95],a[48:51]
DT v[184:185],v244 offset:14720
AR v218,a238
MF a[52:55],v[160:163],v[124:127],a[52:55]
DT v[186:187],v244 offset:21888
AR v219,a239
MF a[56:59],v[164:167],v[92:95],a[56:59]
DT v[188:189],v245 offset:14720
CV v220,v212,v213
MF a[60:63],v[164:167],v[124:127],a[60:63]
DT v[190:191],v245 offset:21888
CV v221,v214,v215
WT lgkmcnt(8)
MF a[64:67],v[168:171],v[92:95],a[64:67]
CV v222,v216,v217
CV v223,v218,v219
MF a[68:71],v[168:171],v[124:127],a[68:71]
SA s71,s70,20480
BS v[220:223],v194,s[20:23],s71 offen sc1
MF a[72:75],v[172:175],v[92:95],a[72:75]
MF a[76:79],v[172:175],v[124:127],a[76:79]
WT lgkmcnt(4)
MF a[80:83],v[176:179],v[92:95],a[80:83]
MF a[84:87],v[176:179],v[124:127],a[84:87]
MF a[88:91],v[180:183],v[92:95],a[88:91]
MF a[92:95],v[180:183],v[124:127],a[92:95]
WT lgkmcnt(0)
MF a[96:99],v[184:187],v[92:95],a[96:99]
MF a[100:103],v[184:187],v[124:127],a[100:103]
MF a[104:107],v[188:191],v[92:95],a[104:107]
MF a[108:111],v[188:191],v[124:127],a[108:111]
s_nop 7
AR v200,a0
AR v201,a1
AR v202,a2
AR v203,a3
AR v204,a8
AR v205,a9
AR v206,a10
AR v207,a11
CV v208,v200,v201
CV v209,v202,v203
CV v210,v204,v205
CV v211,v206,v207
SA s71,s70,7168
BS v[208:211],v194,s[20:23],s71 offen sc1
v_and_b32 v1,63,v0
v_lshrrev_b32 v2,6,v0
v_lshlrev_b32 v3,4,v1
v_mul_u32_u24 v4,28672,v2
v_add_u32 v4,v4,v3
v_mov_b32 v16,v4
v_add_u32 v17,13312,v4
v_lshlrev_b32 v4,3,v2
v_add_u32 v4,0,v4
v_lshrrev_b32 v5,4,v1
AR v212,a16
AR v213,a17
AR v214,a18
AR v215,a19
AR v216,a24
AR v217,a25
AR v218,a26
AR v219,a27
CV v220,v212,v213
CV v221,v214,v215
CV v222,v216,v217
CV v223,v218,v219
SA s71,s70,8192
BS v[220:223],v194,s[20:23],s71 offen sc1
v_add_u32 v4,v4,v5
v_and_b32 v5,7,v4
v_lshlrev_b32 v5,1,v5
v_and_b32 v6,15,v1
v_xor_b32 v5,v5,v6
v_lshlrev_b32 v5,4,v5
v_mul_u32_u24 v4,3584,v4
v_add_u32 v4,v4,v5
v_subrev_u32 v18,0,v4
v_lshlrev_b32 v4,3,v2
AR v200,a32
AR v201,a33
AR v202,a34
AR v203,a35
AR v204,a40
AR v205,a41
AR v206,a42
AR v207,a43
CV v208,v200,v201
CV v209,v202,v203
CV v210,v204,v205
CV v211,v206,v207
SA s71,s70,9216
BS v[208:211],v194,s[20:23],s71 offen sc1
v_add_u32 v4,4,v4
v_lshrrev_b32 v5,4,v1
v_add_u32 v4,v4,v5
v_and_b32 v5,7,v4
v_lshlrev_b32 v5,1,v5
v_and_b32 v6,15,v1
v_xor_b32 v5,v5,v6
v_lshlrev_b32 v5,4,v5
v_mul_u32_u24 v4,3584,v4
v_add_u32 v4,v4,v5
AR v212,a48
AR v213,a49
AR v214,a50
AR v215,a51
AR v216,a56
AR v217,a57
AR v218,a58
AR v219,a59
CV v220,v212,v213
CV v221,v214,v215
CV v222,v216,v217
CV v223,v218,v219
SA s71,s70,10240
BS v[220:223],v194,s[20:23],s71 offen sc1
v_subrev_u32 v19,1024,v4
s_mul_i32 s45,s43,114688
SA s45,s45,106954752
SA s8,s4,s45
s_addc_u32 s9,s5,0
s_mov_b32 s10,114688
s_mov_b32 s11,0x20000
s_lshl_b32 s45,s33,8
SA s12,s64,s45
s_addc_u32 s13,s65,0
AR v200,a64
AR v201,a65
AR v202,a66
AR v203,a67
AR v204,a72
AR v205,a73
AR v206,a74
AR v207,a75
CV v208,v200,v201
CV v209,v202,v203
CV v210,v204,v205
CV v211,v206,v207
SA s71,s70,11264
BS v[208:211],v194,s[20:23],s71 offen sc1
s_mov_b32 s14,1605632
s_mov_b32 s15,0x20000
s_sub_u32 s14,s14,s45
SA s16,s66,s45
s_addc_u32 s17,s67,0
s_mov_b32 s18,1605632
s_mov_b32 s19,0x20000
s_sub_u32 s18,s18,s45
s_lshl_b32 s52,s32,11
v_lshrrev_b32 v4,7,v0
AR v212,a80
AR v213,a81
AR v214,a82
AR v215,a83
AR v216,a88
AR v217,a89
AR v218,a90
AR v219,a91
CV v220,v212,v213
CV v221,v214,v215
CV v222,v216,v217
CV v223,v218,v219
SA s71,s70,12288
BS v[220:223],v194,s[20:23],s71 offen sc1
v_lshlrev_b32 v4,12,v4
v_add_u32 v20,v4,v3
v_add_u32 v21,0x10000,v20
v_bfe_u32 v4,v1,4,2
v_lshlrev_b32 v4,2,v4
v_bfe_u32 v5,v1,2,2
v_add_u32 v4,v4,v5
v_and_b32 v5,7,v4
v_lshlrev_b32 v4,8,v4
v_and_b32 v6,3,v1
AR v200,a96
AR v201,a97
AR v202,a98
AR v203,a99
AR v204,a104
AR v205,a105
AR v206,a106
AR v207,a107
CV v208,v200,v201
CV v209,v202,v203
CV v210,v204,v205
CV v211,v206,v207
SA s71,s70,13312
BS v[208:211],v194,s[20:23],s71 offen sc1
v_lshlrev_b32 v6,3,v6
v_add_u32 v4,v4,v6
v_add_u32 v4,81920,v4
v_bfe_u32 v6,v0,6,1
v_lshlrev_b32 v6,2,v6
v_add_u32 v7,0,v6
v_xor_b32 v7,v7,v5
v_lshlrev_b32 v7,5,v7
v_add_u32 v24,v7,v4
v_add_u32 v25,0x10000,v24
AR v212,a4
AR v213,a5
AR v214,a6
AR v215,a7
AR v216,a12
AR v217,a13
AR v218,a14
AR v219,a15
CV v220,v212,v213
CV v221,v214,v215
CV v222,v216,v217
CV v223,v218,v219
SA s71,s70,21504
BS v[220:223],v194,s[20:23],s71 offen sc1
v_add_u32 v7,1,v6
v_xor_b32 v7,v7,v5
v_lshlrev_b32 v7,5,v7
v_add_u32 v26,v7,v4
v_add_u32 v27,0x10000,v26
v_add_u32 v7,2,v6
v_xor_b32 v7,v7,v5
v_lshlrev_b32 v7,5,v7
v_add_u32 v28,v7,v4
v_add_u32 v29,0x10000,v28
AR v200,a20
AR v201,a21
AR v202,a22
AR v203,a23
AR v204,a28
AR v205,a29
AR v206,a30
AR v207,a31
CV v208,v200,v201
CV v209,v202,v203
CV v210,v204,v205
CV v211,v206,v207
SA s71,s70,22528
BS v[208:211],v194,s[20:23],s71 offen sc1
v_add_u32 v7,3,v6
v_xor_b32 v7,v7,v5
v_lshlrev_b32 v7,5,v7
v_add_u32 v30,v7,v4
v_add_u32 v31,0x10000,v30
SA s56,s4,52428800
s_addc_u32 s57,s5,0
s_mov_b32 s58,29360128
s_mov_b32 s59,0x20000
s_mov_b32 s60,s78
AR v212,a36
AR v213,a37
AR v214,a38
AR v215,a39
AR v216,a44
AR v217,a45
AR v218,a46
AR v219,a47
CV v220,v212,v213
CV v221,v214,v215
CV v222,v216,v217
CV v223,v218,v219
SA s71,s70,23552
BS v[220:223],v194,s[20:23],s71 offen sc1
s_mov_b32 s61,s79
s_mov_b32 s62,1835008
s_mov_b32 s63,0x20000
SA s24,s4,104857600
s_addc_u32 s25,s5,0
s_mov_b32 s26,1835008
s_mov_b32 s27,0x20000
SA s36,s4,106954752
s_addc_u32 s37,s5,0
s_mov_b32 s38,1835008
AR v200,a52
AR v201,a53
AR v202,a54
AR v203,a55
AR v204,a60
AR v205,a61
AR v206,a62
AR v207,a63
CV v208,v200,v201
CV v209,v202,v203
CV v210,v204,v205
CV v211,v206,v207
SA s71,s70,24576
BS v[208:211],v194,s[20:23],s71 offen sc1
s_mov_b32 s39,0x20000
v_and_b32 v36,7,v1
v_bfe_u32 v37,v1,3,2
v_lshrrev_b32 v38,5,v1
s_lshl_b32 s45,s43,3
s_lshr_b32 s46,s33,1
SA s45,s45,s46
s_and_b32 s46,s33,1
s_lshl_b32 s46,s46,3
s_mul_i32 s47,s45,14336
AR v212,a68
AR v213,a69
AR v214,a70
AR v215,a71
AR v216,a76
AR v217,a77
AR v218,a78
AR v219,a79
CV v220,v212,v213
CV v221,v214,v215
CV v222,v216,v217
CV v223,v218,v219
SA s71,s70,25600
BS v[220:223],v194,s[20:23],s71 offen sc1
v_lshlrev_b32 v39,4,v37
v_add_u32 v39,v39,v36
v_add_u32 v39,s46,v39
v_lshlrev_b32 v39,4,v39
v_lshlrev_b32 v40,10,v38
v_add_u32 v39,v39,v40
v_add_u32 v39,s47,v39
s_lshl_b32 s47,s43,7
s_lshl_b32 s48,s33,3
SA s47,s47,s48
AR v200,a84
AR v201,a85
AR v202,a86
AR v203,a87
AR v204,a92
AR v205,a93
AR v206,a94
AR v207,a95
CV v208,v200,v201
CV v209,v202,v203
CV v210,v204,v205
CV v211,v206,v207
SA s71,s70,26624
BS v[208:211],v194,s[20:23],s71 offen sc1
v_add_u32 v41,s47,v36
v_mul_u32_u24 v41,896,v41
v_lshlrev_b32 v40,6,v38
v_add_u32 v41,v41,v40
v_lshlrev_b32 v40,3,v37
v_add_u32 v41,v41,v40
SA s45,s32,0
s_lshl_b32 s54,s45,11
s_lshl_b32 s46,s45,7
buffer_load_dwordx2 v[48:49],v41,s[60:63],s46 offen
AR v212,a100
AR v213,a101
AR v214,a102
AR v215,a103
AR v216,a108
AR v217,a109
AR v218,a110
AR v219,a111
CV v220,v212,v213
CV v221,v214,v215
CV v222,v216,v217
CV v223,v218,v219
SA s71,s70,27648
BS v[220:223],v194,s[20:23],s71 offen sc1
buffer_load_dwordx2 v[50:51],v41,s[60:63],s46 offen offset:32
SA s45,s32,4
s_lshl_b32 s55,s45,11
s_lshl_b32 s46,s45,7
s_cmp_lt_u32 s45,7
s_cselect_b32 s55,s55,0x7ff00000
s_cselect_b32 s46,s46,0x7ff00000
buffer_load_dwordx2 v[52:53],v41,s[60:63],s46 offen
buffer_load_dwordx2 v[54:55],v41,s[60:63],s46 offen offset:32
tl_start:
WT vmcnt(0)
s_barrier
s_cmp_lg_u32 s32,0
s_cbranch_scc1 tl_sig1
s_mul_i32 s45,s43,384
SA s45,s45,16384
s_lshl_b32 s46,s33,2
SA s45,s45,s46
v_mov_b32 v42,1
v_mov_b32 v43,s45
s_mov_b64 exec,1
buffer_store_dword v42,v43,s[28:31],0 offen sc1
s_mov_b64 exec,-1
tl_sig1:
s_cmp_ge_u32 s33,14
s_cbranch_scc1 tl_now2
SA m0,s52,81920
s_mov_b32 s53,0
BL v18,s[12:15],s53 offen lds
BL v19,s[12:15],s53 offen offset:1024 lds
SA m0,s52,90112
s_nop 0
BL v18,s[16:19],s53 offen lds
BL v19,s[16:19],s53 offen offset:1024 lds
SA m0,s52,98304
s_mov_b32 s53,114688
BL v18,s[12:15],s53 offen lds
BL v19,s[12:15],s53 offen offset:1024 lds
SA m0,s52,106496
s_nop 0
BL v18,s[16:19],s53 offen lds
BL v19,s[16:19],s53 offen offset:1024 lds
SA m0,s52,114688
s_mov_b32 s53,229376
BL v18,s[12:15],s53 offen lds
BL v19,s[12:15],s53 offen offset:1024 lds
SA m0,s52,122880
s_nop 0
BL v18,s[16:19],s53 offen lds
BL v19,s[16:19],s53 offen offset:1024 lds
SA m0,s52,131072
s_mov_b32 s53,344064
BL v18,s[12:15],s53 offen lds
BL v19,s[12:15],s53 offen offset:1024 lds
SA m0,s52,139264
s_nop 0
BL v18,s[16:19],s53 offen lds
BL v19,s[16:19],s53 offen offset:1024 lds
tl_now2:
s_cmp_lg_u32 s32,0
s_cbranch_scc1 tl_w1
s_mul_i32 s45,s43,384
SA s45,s45,16384
v_lshlrev_b32 v43,2,v0
v_add_u32 v43,s45,v43
s_mov_b32 s46,0
s_mov_b64 exec,65535
tl_p1:
buffer_load_dword v42,v43,s[28:31],0 offen sc1
WT vmcnt(0)
v_cmp_ne_u32 vcc,0,v42
s_nop 0
s_cmp_eq_u32 vcc_lo,65535
s_cbranch_scc1 tl_p1_ok
s_sleep 1
SA s46,s46,1
s_cmp_lt_u32 s46,262144
s_cbranch_scc1 tl_p1
v_mov_b32 v42,47828
v_mov_b32 v43,32000
buffer_store_dword v42,v43,s[28:31],0 offen
tl_p1_ok:
s_mov_b64 exec,-1
tl_w1:
s_barrier
SA s45,s54,0
BL v[64:67],v39,s[56:59],s45 offen
SA s45,s54,1835008
BL v[68:71],v39,s[56:59],s45 offen
SA s45,s54,3670016
BL v[72:75],v39,s[56:59],s45 offen
SA s45,s54,5505024
BL v[76:79],v39,s[56:59],s45 offen
SA s45,s54,7340032
BL v[80:83],v39,s[56:59],s45 offen
SA s45,s54,9175040
BL v[84:87],v39,s[56:59],s45 offen
SA s45,s54,11010048
BL v[88:91],v39,s[56:59],s45 offen
SA s45,s54,12845056
BL v[92:95],v39,s[56:59],s45 offen
SA s45,s54,14680064
BL v[96:99],v39,s[56:59],s45 offen
SA s45,s54,16515072
BL v[100:103],v39,s[56:59],s45 offen
SA s45,s54,18350080
BL v[104:107],v39,s[56:59],s45 offen
SA s45,s54,20185088
BL v[108:111],v39,s[56:59],s45 offen
SA s45,s54,22020096
BL v[112:115],v39,s[56:59],s45 offen
SA s45,s54,23855104
BL v[116:119],v39,s[56:59],s45 offen
SA s45,s54,25690112
BL v[120:123],v39,s[56:59],s45 offen
SA s45,s54,27525120
BL v[124:127],v39,s[56:59],s45 offen
SA s45,s55,0
BL v[128:131],v39,s[56:59],s45 offen
SA s45,s55,1835008
BL v[132:135],v39,s[56:59],s45 offen
SA s45,s55,3670016
BL v[136:139],v39,s[56:59],s45 offen
SA s45,s55,5505024
BL v[140:143],v39,s[56:59],s45 offen
SA s45,s55,7340032
BL v[144:147],v39,s[56:59],s45 offen
SA s45,s55,9175040
BL v[148:151],v39,s[56:59],s45 offen
SA s45,s55,11010048
BL v[152:155],v39,s[56:59],s45 offen
SA s45,s55,12845056
BL v[156:159],v39,s[56:59],s45 offen
SA s45,s55,14680064
BL v[160:163],v39,s[56:59],s45 offen
SA s45,s55,16515072
BL v[164:167],v39,s[56:59],s45 offen
SA s45,s55,18350080
BL v[168:171],v39,s[56:59],s45 offen
SA s45,s55,20185088
BL v[172:175],v39,s[56:59],s45 offen
SA s45,s55,22020096
BL v[176:179],v39,s[56:59],s45 offen
SA s45,s55,23855104
BL v[180:183],v39,s[56:59],s45 offen
SA s45,s55,25690112
BL v[184:187],v39,s[56:59],s45 offen
SA s45,s55,27525120
BL v[188:191],v39,s[56:59],s45 offen
WT vmcnt(28)
v_lshlrev_b32 v192,16,v64
v_and_b32 v193,0xffff0000,v64
v_lshlrev_b32 v194,16,v65
v_and_b32 v195,0xffff0000,v65
v_lshlrev_b32 v196,16,v66
v_and_b32 v197,0xffff0000,v66
v_lshlrev_b32 v198,16,v67
v_and_b32 v199,0xffff0000,v67
v_lshlrev_b32 v44,16,v68
v_and_b32 v45,0xffff0000,v68
v_pk_add_f32 v[192:193],v[192:193],v[44:45]
v_lshlrev_b32 v46,16,v69
v_and_b32 v47,0xffff0000,v69
v_pk_add_f32 v[194:195],v[194:195],v[46:47]
v_lshlrev_b32 v44,16,v70
v_and_b32 v45,0xffff0000,v70
v_pk_add_f32 v[196:197],v[196:197],v[44:45]
v_lshlrev_b32 v46,16,v71
v_and_b32 v47,0xffff0000,v71
v_pk_add_f32 v[198:199],v[198:199],v[46:47]
v_lshlrev_b32 v44,16,v72
v_and_b32 v45,0xffff0000,v72
v_pk_add_f32 v[192:193],v[192:193],v[44:45]
v_lshlrev_b32 v46,16,v73
v_and_b32 v47,0xffff0000,v73
v_pk_add_f32 v[194:195],v[194:195],v[46:47]
v_lshlrev_b32 v44,16,v74
v_and_b32 v45,0xffff0000,v74
v_pk_add_f32 v[196:197],v[196:197],v[44:45]
v_lshlrev_b32 v46,16,v75
v_and_b32 v47,0xffff0000,v75
v_pk_add_f32 v[198:199],v[198:199],v[46:47]
v_lshlrev_b32 v44,16,v76
v_and_b32 v45,0xffff0000,v76
v_pk_add_f32 v[192:193],v[192:193],v[44:45]
v_lshlrev_b32 v46,16,v77
v_and_b32 v47,0xffff0000,v77
v_pk_add_f32 v[194:195],v[194:195],v[46:47]
v_lshlrev_b32 v44,16,v78
v_and_b32 v45,0xffff0000,v78
v_pk_add_f32 v[196:197],v[196:197],v[44:45]
v_lshlrev_b32 v46,16,v79
v_and_b32 v47,0xffff0000,v79
v_pk_add_f32 v[198:199],v[198:199],v[46:47]
WT vmcnt(24)
v_lshlrev_b32 v44,16,v80
v_and_b32 v45,0xffff0000,v80
v_pk_add_f32 v[192:193],v[192:193],v[44:45]
v_lshlrev_b32 v46,16,v81
v_and_b32 v47,0xffff0000,v81
v_pk_add_f32 v[194:195],v[194:195],v[46:47]
v_lshlrev_b32 v44,16,v82
v_and_b32 v45,0xffff0000,v82
v_pk_add_f32 v[196:197],v[196:197],v[44:45]
v_lshlrev_b32 v46,16,v83
v_and_b32 v47,0xffff0000,v83
v_pk_add_f32 v[198:199],v[198:199],v[46:47]
v_lshlrev_b32 v44,16,v84
v_and_b32 v45,0xffff0000,v84
v_pk_add_f32 v[192:193],v[192:193],v[44:45]
v_lshlrev_b32 v46,16,v85
v_and_b32 v47,0xffff0000,v85
v_pk_add_f32 v[194:195],v[194:195],v[46:47]
v_lshlrev_b32 v44,16,v86
v_and_b32 v45,0xffff0000,v86
v_pk_add_f32 v[196:197],v[196:197],v[44:45]
v_lshlrev_b32 v46,16,v87
v_and_b32 v47,0xffff0000,v87
v_pk_add_f32 v[198:199],v[198:199],v[46:47]
v_lshlrev_b32 v44,16,v88
v_and_b32 v45,0xffff0000,v88
v_pk_add_f32 v[192:193],v[192:193],v[44:45]
v_lshlrev_b32 v46,16,v89
v_and_b32 v47,0xffff0000,v89
v_pk_add_f32 v[194:195],v[194:195],v[46:47]
v_lshlrev_b32 v44,16,v90
v_and_b32 v45,0xffff0000,v90
v_pk_add_f32 v[196:197],v[196:197],v[44:45]
v_lshlrev_b32 v46,16,v91
v_and_b32 v47,0xffff0000,v91
v_pk_add_f32 v[198:199],v[198:199],v[46:47]
v_lshlrev_b32 v44,16,v92
v_and_b32 v45,0xffff0000,v92
v_pk_add_f32 v[192:193],v[192:193],v[44:45]
v_lshlrev_b32 v46,16,v93
v_and_b32 v47,0xffff0000,v93
v_pk_add_f32 v[194:195],v[194:195],v[46:47]
v_lshlrev_b32 v44,16,v94
v_and_b32 v45,0xffff0000,v94
v_pk_add_f32 v[196:197],v[196:197],v[44:45]
v_lshlrev_b32 v46,16,v95
v_and_b32 v47,0xffff0000,v95
v_pk_add_f32 v[198:199],v[198:199],v[46:47]
WT vmcnt(20)
v_lshlrev_b32 v44,16,v96
v_and_b32 v45,0xffff0000,v96
v_pk_add_f32 v[192:193],v[192:193],v[44:45]
v_lshlrev_b32 v46,16,v97
v_and_b32 v47,0xffff0000,v97
v_pk_add_f32 v[194:195],v[194:195],v[46:47]
v_lshlrev_b32 v44,16,v98
v_and_b32 v45,0xffff0000,v98
v_pk_add_f32 v[196:197],v[196:197],v[44:45]
v_lshlrev_b32 v46,16,v99
v_and_b32 v47,0xffff0000,v99
v_pk_add_f32 v[198:199],v[198:199],v[46:47]
v_lshlrev_b32 v44,16,v100
v_and_b32 v45,0xffff0000,v100
v_pk_add_f32 v[192:193],v[192:193],v[44:45]
v_lshlrev_b32 v46,16,v101
v_and_b32 v47,0xffff0000,v101
v_pk_add_f32 v[194:195],v[194:195],v[46:47]
v_lshlrev_b32 v44,16,v102
v_and_b32 v45,0xffff0000,v102
v_pk_add_f32 v[196:197],v[196:197],v[44:45]
v_lshlrev_b32 v46,16,v103
v_and_b32 v47,0xffff0000,v103
v_pk_add_f32 v[198:199],v[198:199],v[46:47]
v_lshlrev_b32 v44,16,v104
v_and_b32 v45,0xffff0000,v104
v_pk_add_f32 v[192:193],v[192:193],v[44:45]
v_lshlrev_b32 v46,16,v105
v_and_b32 v47,0xffff0000,v105
v_pk_add_f32 v[194:195],v[194:195],v[46:47]
v_lshlrev_b32 v44,16,v106
v_and_b32 v45,0xffff0000,v106
v_pk_add_f32 v[196:197],v[196:197],v[44:45]
v_lshlrev_b32 v46,16,v107
v_and_b32 v47,0xffff0000,v107
v_pk_add_f32 v[198:199],v[198:199],v[46:47]
v_lshlrev_b32 v44,16,v108
v_and_b32 v45,0xffff0000,v108
v_pk_add_f32 v[192:193],v[192:193],v[44:45]
v_lshlrev_b32 v46,16,v109
v_and_b32 v47,0xffff0000,v109
v_pk_add_f32 v[194:195],v[194:195],v[46:47]
v_lshlrev_b32 v44,16,v110
v_and_b32 v45,0xffff0000,v110
v_pk_add_f32 v[196:197],v[196:197],v[44:45]
v_lshlrev_b32 v46,16,v111
v_and_b32 v47,0xffff0000,v111
v_pk_add_f32 v[198:199],v[198:199],v[46:47]
WT vmcnt(16)
v_lshlrev_b32 v44,16,v112
v_and_b32 v45,0xffff0000,v112
v_pk_add_f32 v[192:193],v[192:193],v[44:45]
v_lshlrev_b32 v46,16,v113
v_and_b32 v47,0xffff0000,v113
v_pk_add_f32 v[194:195],v[194:195],v[46:47]
v_lshlrev_b32 v44,16,v114
v_and_b32 v45,0xffff0000,v114
v_pk_add_f32 v[196:197],v[196:197],v[44:45]
v_lshlrev_b32 v46,16,v115
v_and_b32 v47,0xffff0000,v115
v_pk_add_f32 v[198:199],v[198:199],v[46:47]
v_lshlrev_b32 v44,16,v116
v_and_b32 v45,0xffff0000,v116
v_pk_add_f32 v[192:193],v[192:193],v[44:45]
v_lshlrev_b32 v46,16,v117
v_and_b32 v47,0xffff0000,v117
v_pk_add_f32 v[194:195],v[194:195],v[46:47]
v_lshlrev_b32 v44,16,v118
v_and_b32 v45,0xffff0000,v118
v_pk_add_f32 v[196:197],v[196:197],v[44:45]
v_lshlrev_b32 v46,16,v119
v_and_b32 v47,0xffff0000,v119
v_pk_add_f32 v[198:199],v[198:199],v[46:47]
v_lshlrev_b32 v44,16,v120
v_and_b32 v45,0xffff0000,v120
v_pk_add_f32 v[192:193],v[192:193],v[44:45]
v_lshlrev_b32 v46,16,v121
v_and_b32 v47,0xffff0000,v121
v_pk_add_f32 v[194:195],v[194:195],v[46:47]
v_lshlrev_b32 v44,16,v122
v_and_b32 v45,0xffff0000,v122
v_pk_add_f32 v[196:197],v[196:197],v[44:45]
v_lshlrev_b32 v46,16,v123
v_and_b32 v47,0xffff0000,v123
v_pk_add_f32 v[198:199],v[198:199],v[46:47]
v_lshlrev_b32 v44,16,v124
v_and_b32 v45,0xffff0000,v124
v_pk_add_f32 v[192:193],v[192:193],v[44:45]
v_lshlrev_b32 v46,16,v125
v_and_b32 v47,0xffff0000,v125
v_pk_add_f32 v[194:195],v[194:195],v[46:47]
v_lshlrev_b32 v44,16,v126
v_and_b32 v45,0xffff0000,v126
v_pk_add_f32 v[196:197],v[196:197],v[44:45]
v_lshlrev_b32 v46,16,v127
v_and_b32 v47,0xffff0000,v127
v_pk_add_f32 v[198:199],v[198:199],v[46:47]
v_lshlrev_b32 v44,16,v48
v_and_b32 v45,0xffff0000,v48
FA v192,v192,v44
FA v193,v193,v45
CV v208,v192,v193
v_lshlrev_b32 v192,16,v208
v_and_b32 v193,0xffff0000,v208
v_lshlrev_b32 v44,16,v49
v_and_b32 v45,0xffff0000,v49
FA v194,v194,v44
FA v195,v195,v45
CV v209,v194,v195
v_lshlrev_b32 v194,16,v209
v_and_b32 v195,0xffff0000,v209
v_lshlrev_b32 v44,16,v50
v_and_b32 v45,0xffff0000,v50
FA v196,v196,v44
FA v197,v197,v45
CV v210,v196,v197
v_lshlrev_b32 v196,16,v210
v_and_b32 v197,0xffff0000,v210
v_lshlrev_b32 v44,16,v51
v_and_b32 v45,0xffff0000,v51
FA v198,v198,v44
FA v199,v199,v45
CV v211,v198,v199
v_lshlrev_b32 v198,16,v211
v_and_b32 v199,0xffff0000,v211
WT vmcnt(12)
v_lshlrev_b32 v200,16,v128
v_and_b32 v201,0xffff0000,v128
v_lshlrev_b32 v202,16,v129
v_and_b32 v203,0xffff0000,v129
v_lshlrev_b32 v204,16,v130
v_and_b32 v205,0xffff0000,v130
v_lshlrev_b32 v206,16,v131
v_and_b32 v207,0xffff0000,v131
v_lshlrev_b32 v44,16,v132
v_and_b32 v45,0xffff0000,v132
v_pk_add_f32 v[200:201],v[200:201],v[44:45]
v_lshlrev_b32 v46,16,v133
v_and_b32 v47,0xffff0000,v133
v_pk_add_f32 v[202:203],v[202:203],v[46:47]
v_lshlrev_b32 v44,16,v134
v_and_b32 v45,0xffff0000,v134
v_pk_add_f32 v[204:205],v[204:205],v[44:45]
v_lshlrev_b32 v46,16,v135
v_and_b32 v47,0xffff0000,v135
v_pk_add_f32 v[206:207],v[206:207],v[46:47]
v_lshlrev_b32 v44,16,v136
v_and_b32 v45,0xffff0000,v136
v_pk_add_f32 v[200:201],v[200:201],v[44:45]
v_lshlrev_b32 v46,16,v137
v_and_b32 v47,0xffff0000,v137
v_pk_add_f32 v[202:203],v[202:203],v[46:47]
v_lshlrev_b32 v44,16,v138
v_and_b32 v45,0xffff0000,v138
v_pk_add_f32 v[204:205],v[204:205],v[44:45]
v_lshlrev_b32 v46,16,v139
v_and_b32 v47,0xffff0000,v139
v_pk_add_f32 v[206:207],v[206:207],v[46:47]
v_lshlrev_b32 v44,16,v140
v_and_b32 v45,0xffff0000,v140
v_pk_add_f32 v[200:201],v[200:201],v[44:45]
v_lshlrev_b32 v46,16,v141
v_and_b32 v47,0xffff0000,v141
v_pk_add_f32 v[202:203],v[202:203],v[46:47]
v_lshlrev_b32 v44,16,v142
v_and_b32 v45,0xffff0000,v142
v_pk_add_f32 v[204:205],v[204:205],v[44:45]
v_lshlrev_b32 v46,16,v143
v_and_b32 v47,0xffff0000,v143
v_pk_add_f32 v[206:207],v[206:207],v[46:47]
WT vmcnt(8)
v_lshlrev_b32 v44,16,v144
v_and_b32 v45,0xffff0000,v144
v_pk_add_f32 v[200:201],v[200:201],v[44:45]
v_lshlrev_b32 v46,16,v145
v_and_b32 v47,0xffff0000,v145
v_pk_add_f32 v[202:203],v[202:203],v[46:47]
v_lshlrev_b32 v44,16,v146
v_and_b32 v45,0xffff0000,v146
v_pk_add_f32 v[204:205],v[204:205],v[44:45]
v_lshlrev_b32 v46,16,v147
v_and_b32 v47,0xffff0000,v147
v_pk_add_f32 v[206:207],v[206:207],v[46:47]
v_lshlrev_b32 v44,16,v148
v_and_b32 v45,0xffff0000,v148
v_pk_add_f32 v[200:201],v[200:201],v[44:45]
v_lshlrev_b32 v46,16,v149
v_and_b32 v47,0xffff0000,v149
v_pk_add_f32 v[202:203],v[202:203],v[46:47]
v_lshlrev_b32 v44,16,v150
v_and_b32 v45,0xffff0000,v150
v_pk_add_f32 v[204:205],v[204:205],v[44:45]
v_lshlrev_b32 v46,16,v151
v_and_b32 v47,0xffff0000,v151
v_pk_add_f32 v[206:207],v[206:207],v[46:47]
v_lshlrev_b32 v44,16,v152
v_and_b32 v45,0xffff0000,v152
v_pk_add_f32 v[200:201],v[200:201],v[44:45]
v_lshlrev_b32 v46,16,v153
v_and_b32 v47,0xffff0000,v153
v_pk_add_f32 v[202:203],v[202:203],v[46:47]
v_lshlrev_b32 v44,16,v154
v_and_b32 v45,0xffff0000,v154
v_pk_add_f32 v[204:205],v[204:205],v[44:45]
v_lshlrev_b32 v46,16,v155
v_and_b32 v47,0xffff0000,v155
v_pk_add_f32 v[206:207],v[206:207],v[46:47]
v_lshlrev_b32 v44,16,v156
v_and_b32 v45,0xffff0000,v156
v_pk_add_f32 v[200:201],v[200:201],v[44:45]
v_lshlrev_b32 v46,16,v157
v_and_b32 v47,0xffff0000,v157
v_pk_add_f32 v[202:203],v[202:203],v[46:47]
v_lshlrev_b32 v44,16,v158
v_and_b32 v45,0xffff0000,v158
v_pk_add_f32 v[204:205],v[204:205],v[44:45]
v_lshlrev_b32 v46,16,v159
v_and_b32 v47,0xffff0000,v159
v_pk_add_f32 v[206:207],v[206:207],v[46:47]
WT vmcnt(4)
v_lshlrev_b32 v44,16,v160
v_and_b32 v45,0xffff0000,v160
v_pk_add_f32 v[200:201],v[200:201],v[44:45]
v_lshlrev_b32 v46,16,v161
v_and_b32 v47,0xffff0000,v161
v_pk_add_f32 v[202:203],v[202:203],v[46:47]
v_lshlrev_b32 v44,16,v162
v_and_b32 v45,0xffff0000,v162
v_pk_add_f32 v[204:205],v[204:205],v[44:45]
v_lshlrev_b32 v46,16,v163
v_and_b32 v47,0xffff0000,v163
v_pk_add_f32 v[206:207],v[206:207],v[46:47]
v_lshlrev_b32 v44,16,v164
v_and_b32 v45,0xffff0000,v164
v_pk_add_f32 v[200:201],v[200:201],v[44:45]
v_lshlrev_b32 v46,16,v165
v_and_b32 v47,0xffff0000,v165
v_pk_add_f32 v[202:203],v[202:203],v[46:47]
v_lshlrev_b32 v44,16,v166
v_and_b32 v45,0xffff0000,v166
v_pk_add_f32 v[204:205],v[204:205],v[44:45]
v_lshlrev_b32 v46,16,v167
v_and_b32 v47,0xffff0000,v167
v_pk_add_f32 v[206:207],v[206:207],v[46:47]
v_lshlrev_b32 v44,16,v168
v_and_b32 v45,0xffff0000,v168
v_pk_add_f32 v[200:201],v[200:201],v[44:45]
v_lshlrev_b32 v46,16,v169
v_and_b32 v47,0xffff0000,v169
v_pk_add_f32 v[202:203],v[202:203],v[46:47]
v_lshlrev_b32 v44,16,v170
v_and_b32 v45,0xffff0000,v170
v_pk_add_f32 v[204:205],v[204:205],v[44:45]
v_lshlrev_b32 v46,16,v171
v_and_b32 v47,0xffff0000,v171
v_pk_add_f32 v[206:207],v[206:207],v[46:47]
v_lshlrev_b32 v44,16,v172
v_and_b32 v45,0xffff0000,v172
v_pk_add_f32 v[200:201],v[200:201],v[44:45]
v_lshlrev_b32 v46,16,v173
v_and_b32 v47,0xffff0000,v173
v_pk_add_f32 v[202:203],v[202:203],v[46:47]
v_lshlrev_b32 v44,16,v174
v_and_b32 v45,0xffff0000,v174
v_pk_add_f32 v[204:205],v[204:205],v[44:45]
v_lshlrev_b32 v46,16,v175
v_and_b32 v47,0xffff0000,v175
v_pk_add_f32 v[206:207],v[206:207],v[46:47]
WT vmcnt(0)
v_lshlrev_b32 v44,16,v176
v_and_b32 v45,0xffff0000,v176
v_pk_add_f32 v[200:201],v[200:201],v[44:45]
v_lshlrev_b32 v46,16,v177
v_and_b32 v47,0xffff0000,v177
v_pk_add_f32 v[202:203],v[202:203],v[46:47]
v_lshlrev_b32 v44,16,v178
v_and_b32 v45,0xffff0000,v178
v_pk_add_f32 v[204:205],v[204:205],v[44:45]
v_lshlrev_b32 v46,16,v179
v_and_b32 v47,0xffff0000,v179
v_pk_add_f32 v[206:207],v[206:207],v[46:47]
v_lshlrev_b32 v44,16,v180
v_and_b32 v45,0xffff0000,v180
v_pk_add_f32 v[200:201],v[200:201],v[44:45]
v_lshlrev_b32 v46,16,v181
v_and_b32 v47,0xffff0000,v181
v_pk_add_f32 v[202:203],v[202:203],v[46:47]
v_lshlrev_b32 v44,16,v182
v_and_b32 v45,0xffff0000,v182
v_pk_add_f32 v[204:205],v[204:205],v[44:45]
v_lshlrev_b32 v46,16,v183
v_and_b32 v47,0xffff0000,v183
v_pk_add_f32 v[206:207],v[206:207],v[46:47]
v_lshlrev_b32 v44,16,v184
v_and_b32 v45,0xffff0000,v184
v_pk_add_f32 v[200:201],v[200:201],v[44:45]
v_lshlrev_b32 v46,16,v185
v_and_b32 v47,0xffff0000,v185
v_pk_add_f32 v[202:203],v[202:203],v[46:47]
v_lshlrev_b32 v44,16,v186
v_and_b32 v45,0xffff0000,v186
v_pk_add_f32 v[204:205],v[204:205],v[44:45]
v_lshlrev_b32 v46,16,v187
v_and_b32 v47,0xffff0000,v187
v_pk_add_f32 v[206:207],v[206:207],v[46:47]
v_lshlrev_b32 v44,16,v188
v_and_b32 v45,0xffff0000,v188
v_pk_add_f32 v[200:201],v[200:201],v[44:45]
v_lshlrev_b32 v46,16,v189
v_and_b32 v47,0xffff0000,v189
v_pk_add_f32 v[202:203],v[202:203],v[46:47]
v_lshlrev_b32 v44,16,v190
v_and_b32 v45,0xffff0000,v190
v_pk_add_f32 v[204:205],v[204:205],v[44:45]
v_lshlrev_b32 v46,16,v191
v_and_b32 v47,0xffff0000,v191
v_pk_add_f32 v[206:207],v[206:207],v[46:47]
v_lshlrev_b32 v44,16,v52
v_and_b32 v45,0xffff0000,v52
FA v200,v200,v44
FA v201,v201,v45
CV v212,v200,v201
v_lshlrev_b32 v200,16,v212
v_and_b32 v201,0xffff0000,v212
v_lshlrev_b32 v44,16,v53
v_and_b32 v45,0xffff0000,v53
FA v202,v202,v44
FA v203,v203,v45
CV v213,v202,v203
v_lshlrev_b32 v202,16,v213
v_and_b32 v203,0xffff0000,v213
v_lshlrev_b32 v44,16,v54
v_and_b32 v45,0xffff0000,v54
FA v204,v204,v44
FA v205,v205,v45
CV v214,v204,v205
v_lshlrev_b32 v204,16,v214
v_and_b32 v205,0xffff0000,v214
v_lshlrev_b32 v44,16,v55
v_and_b32 v45,0xffff0000,v55
FA v206,v206,v44
FA v207,v207,v45
CV v215,v206,v207
v_lshlrev_b32 v206,16,v215
v_and_b32 v207,0xffff0000,v215
BS v[208:211],v39,s[24:27],s54 offen sc1
BS v[212:215],v39,s[24:27],s55 offen sc1
FA v216,v192,v193
FM v217,v192,v192
v_fmac_f32 v217,v193,v193
FA v216,v216,v194
v_fmac_f32 v217,v194,v194
FA v216,v216,v195
v_fmac_f32 v217,v195,v195
FA v216,v216,v196
v_fmac_f32 v217,v196,v196
FA v216,v216,v197
v_fmac_f32 v217,v197,v197
FA v216,v216,v198
v_fmac_f32 v217,v198,v198
FA v216,v216,v199
v_fmac_f32 v217,v199,v199
FA v216,v216,v200
v_fmac_f32 v217,v200,v200
FA v216,v216,v201
v_fmac_f32 v217,v201,v201
FA v216,v216,v202
v_fmac_f32 v217,v202,v202
FA v216,v216,v203
v_fmac_f32 v217,v203,v203
FA v216,v216,v204
v_fmac_f32 v217,v204,v204
FA v216,v216,v205
v_fmac_f32 v217,v205,v205
FA v216,v216,v206
v_fmac_f32 v217,v206,v206
FA v216,v216,v207
v_fmac_f32 v217,v207,v207
s_nop 1
v_add_f32_dpp v216,v216,v216 row_ror:8 row_mask:0xf bank_mask:0xf
v_add_f32_dpp v217,v217,v217 row_ror:8 row_mask:0xf bank_mask:0xf
v_mov_b32 v218,v216
v_mov_b32 v219,v217
s_nop 0
v_permlane16_swap_b32 v216,v218
v_permlane16_swap_b32 v217,v219
s_nop 0
FA v216,v216,v218
FA v217,v217,v219
v_mov_b32 v218,v216
v_mov_b32 v219,v217
s_nop 0
v_permlane32_swap_b32 v216,v218
v_permlane32_swap_b32 v217,v219
s_nop 0
FA v216,v216,v218
FA v217,v217,v219
v_lshlrev_b32 v220,3,v36
s_lshl_b32 s45,s32,6
SA s45,s45,0
v_add_u32 v221,s45,v220
s_mov_b64 exec,0xff
ds_write_b64 v221,v[216:217]
s_mov_b64 exec,-1
WT lgkmcnt(0)
s_barrier
v_add_u32 v220,0,v220
ds_read_b64 v[222:223],v220 offset:0
ds_read_b64 v[224:225],v220 offset:64
ds_read_b64 v[226:227],v220 offset:128
ds_read_b64 v[228:229],v220 offset:192
WT lgkmcnt(0)
FA v216,v222,v224
FA v217,v223,v225
FA v218,v226,v228
FA v219,v227,v229
FA v216,v216,v218
FA v217,v217,v219
FM v216,0x3b124925,v216
FM v217,0x3b124925,v217
v_fma_f32 v217,-v216,v216,v217
v_max_f32 v217,0,v217
FA v217,0x3727c5ac,v217
v_rsq_f32 v217,v217
s_nop 0
FS v192,v192,v216
FS v193,v193,v216
FS v194,v194,v216
FS v195,v195,v216
FS v196,v196,v216
FS v197,v197,v216
FS v198,v198,v216
FS v199,v199,v216
FS v200,v200,v216
FS v201,v201,v216
FS v202,v202,v216
FS v203,v203,v216
FS v204,v204,v216
FS v205,v205,v216
FS v206,v206,v216
FS v207,v207,v216
FM v192,v192,v217
FM v193,v193,v217
FM v194,v194,v217
FM v195,v195,v217
FM v196,v196,v217
FM v197,v197,v217
FM v198,v198,v217
FM v199,v199,v217
FM v200,v200,v217
FM v201,v201,v217
FM v202,v202,v217
FM v203,v203,v217
FM v204,v204,v217
FM v205,v205,v217
FM v206,v206,v217
FM v207,v207,v217
CV v208,v192,v193
CV v209,v194,v195
CV v210,v196,v197
CV v211,v198,v199
CV v212,v200,v201
CV v213,v202,v203
CV v214,v204,v205
CV v215,v206,v207
BS v[208:211],v39,s[36:39],s54 offen sc1
BS v[212:215],v39,s[36:39],s55 offen sc1
WT vmcnt(0)
s_barrier
s_cmp_lg_u32 s32,0
s_cbranch_scc1 tl_sig2
s_mul_i32 s45,s43,384
SA s45,s45,16512
s_lshl_b32 s46,s33,2
SA s45,s45,s46
v_mov_b32 v42,1
v_mov_b32 v43,s45
s_mov_b64 exec,1
buffer_store_dword v42,v43,s[28:31],0 offen sc1
s_mov_b64 exec,-1
tl_sig2:
s_cmp_ge_u32 s33,14
s_cbranch_scc1 tl_done
s_cmp_lg_u32 s32,0
s_cbranch_scc1 tl_w2
s_mul_i32 s45,s43,384
SA s45,s45,16512
v_lshlrev_b32 v43,2,v0
v_add_u32 v43,s45,v43
s_mov_b32 s46,0
s_mov_b64 exec,65535
tl_p2:
buffer_load_dword v42,v43,s[28:31],0 offen sc1
WT vmcnt(0)
v_cmp_ne_u32 vcc,0,v42
s_nop 0
s_cmp_eq_u32 vcc_lo,65535
s_cbranch_scc1 tl_p2_ok
s_sleep 1
SA s46,s46,1
s_cmp_lt_u32 s46,262144
s_cbranch_scc1 tl_p2
v_mov_b32 v42,47829
v_mov_b32 v43,32000
buffer_store_dword v42,v43,s[28:31],0 offen
tl_p2_ok:
s_mov_b64 exec,-1
tl_w2:
s_barrier
SA m0,s52,0
s_mov_b32 s53,0
BL v16,s[8:11],s53 offen lds
BL v17,s[8:11],s53 offen offset:1024 lds
SA m0,s52,8192
s_mov_b32 s53,1024
BL v16,s[8:11],s53 offen lds
BL v17,s[8:11],s53 offen offset:1024 lds
SA m0,s52,16384
s_mov_b32 s53,2048
BL v16,s[8:11],s53 offen lds
BL v17,s[8:11],s53 offen offset:1024 lds
SA m0,s52,24576
s_mov_b32 s53,3072
BL v16,s[8:11],s53 offen lds
BL v17,s[8:11],s53 offen offset:1024 lds
SA m0,s52,32768
s_mov_b32 s53,4096
BL v16,s[8:11],s53 offen lds
BL v17,s[8:11],s53 offen offset:1024 lds
s_mul_i32 s45,s43,458752
SA s45,s45,109051904
SA s20,s4,s45
s_addc_u32 s21,s5,0
s_mov_b32 s22,458752
s_mov_b32 s23,0x20000
WT vmcnt(8)
s_barrier
DR v[64:67],v20 offset:0
DT v[80:81],v24 offset:0
DT v[82:83],v24 offset:4096
DT v[96:97],v24 offset:8192
DT v[98:99],v24 offset:12288
DR v[68:71],v20 offset:1024
DR v[72:75],v20 offset:2048
DR v[76:79],v20 offset:3072
DT v[84:85],v26 offset:0
DT v[86:87],v26 offset:4096
DT v[100:101],v26 offset:8192
DT v[102:103],v26 offset:12288
DT v[88:89],v28 offset:0
DT v[90:91],v28 offset:4096
DT v[104:105],v28 offset:8192
DT v[106:107],v28 offset:12288
DT v[92:93],v30 offset:0
DT v[94:95],v30 offset:4096
DT v[108:109],v30 offset:8192
DT v[110:111],v30 offset:12288
WT vmcnt(6) lgkmcnt(0)
s_barrier
MF a[0:3],v[80:83],v[64:67],0
DR v[112:115],v20 offset:8192
MF a[64:67],v[96:99],v[64:67],0
DT v[128:129],v24 offset:16384
MF a[4:7],v[80:83],v[68:71],0
DT v[130:131],v24 offset:20480
MF a[68:71],v[96:99],v[68:71],0
DT v[144:145],v24 offset:24576
MF a[8:11],v[80:83],v[72:75],0
DT v[146:147],v24 offset:28672
MF a[72:75],v[96:99],v[72:75],0
DR v[116:119],v20 offset:9216
MF a[12:15],v[80:83],v[76:79],0
DR v[120:123],v20 offset:10240
MF a[76:79],v[96:99],v[76:79],0
DR v[124:127],v20 offset:11264
MF a[16:19],v[84:87],v[64:67],0
DT v[132:133],v26 offset:16384
MF a[80:83],v[100:103],v[64:67],0
DT v[134:135],v26 offset:20480
MF a[20:23],v[84:87],v[68:71],0
DT v[148:149],v26 offset:24576
MF a[84:87],v[100:103],v[68:71],0
DT v[150:151],v26 offset:28672
MF a[24:27],v[84:87],v[72:75],0
DT v[136:137],v28 offset:16384
MF a[88:91],v[100:103],v[72:75],0
DT v[138:139],v28 offset:20480
MF a[28:31],v[84:87],v[76:79],0
DT v[152:153],v28 offset:24576
MF a[92:95],v[100:103],v[76:79],0
DT v[154:155],v28 offset:28672
MF a[32:35],v[88:91],v[64:67],0
DT v[140:141],v30 offset:16384
MF a[96:99],v[104:107],v[64:67],0
DT v[142:143],v30 offset:20480
MF a[36:39],v[88:91],v[68:71],0
DT v[156:157],v30 offset:24576
MF a[100:103],v[104:107],v[68:71],0
DT v[158:159],v30 offset:28672
MF a[40:43],v[88:91],v[72:75],0
SA m0,s52,40960
s_mov_b32 s53,5120
BL v16,s[8:11],s53 offen lds
MF a[104:107],v[104:107],v[72:75],0
BL v17,s[8:11],s53 offen offset:1024 lds
MF a[44:47],v[88:91],v[76:79],0
SA m0,s52,49152
s_mov_b32 s53,6144
BL v16,s[8:11],s53 offen lds
MF a[108:111],v[104:107],v[76:79],0
MF a[48:51],v[92:95],v[64:67],0
BL v17,s[8:11],s53 offen offset:1024 lds
MF a[112:115],v[108:111],v[64:67],0
MF a[52:55],v[92:95],v[68:71],0
SA m0,s52,147456
s_mov_b32 s53,458752
BL v18,s[12:15],s53 offen lds
MF a[116:119],v[108:111],v[68:71],0
MF a[56:59],v[92:95],v[72:75],0
BL v19,s[12:15],s53 offen offset:1024 lds
MF a[120:123],v[108:111],v[72:75],0
MF a[60:63],v[92:95],v[76:79],0
SA m0,s52,155648
s_nop 0
BL v18,s[16:19],s53 offen lds
MF a[124:127],v[108:111],v[76:79],0
BL v19,s[16:19],s53 offen offset:1024 lds
WT vmcnt(12) lgkmcnt(0)
s_barrier
MF a[0:3],v[128:131],v[112:115],a[0:3]
DR v[64:67],v20 offset:16384
MF a[64:67],v[144:147],v[112:115],a[64:67]
DT v[80:81],v24 offset:32768
MF a[4:7],v[128:131],v[116:119],a[4:7]
DT v[82:83],v24 offset:36864
MF a[68:71],v[144:147],v[116:119],a[68:71]
DT v[96:97],v24 offset:40960
MF a[8:11],v[128:131],v[120:123],a[8:11]
DT v[98:99],v24 offset:45056
MF a[72:75],v[144:147],v[120:123],a[72:75]
DR v[68:71],v20 offset:17408
MF a[12:15],v[128:131],v[124:127],a[12:15]
DR v[72:75],v20 offset:18432
MF a[76:79],v[144:147],v[124:127],a[76:79]
DR v[76:79],v20 offset:19456
MF a[16:19],v[132:135],v[112:115],a[16:19]
DT v[84:85],v26 offset:32768
MF a[80:83],v[148:151],v[112:115],a[80:83]
DT v[86:87],v26 offset:36864
MF a[20:23],v[132:135],v[116:119],a[20:23]
DT v[100:101],v26 offset:40960
MF a[84:87],v[148:151],v[116:119],a[84:87]
DT v[102:103],v26 offset:45056
MF a[24:27],v[132:135],v[120:123],a[24:27]
DT v[88:89],v28 offset:32768
MF a[88:91],v[148:151],v[120:123],a[88:91]
DT v[90:91],v28 offset:36864
MF a[28:31],v[132:135],v[124:127],a[28:31]
DT v[104:105],v28 offset:40960
MF a[92:95],v[148:151],v[124:127],a[92:95]
DT v[106:107],v28 offset:45056
MF a[32:35],v[136:139],v[112:115],a[32:35]
DT v[92:93],v30 offset:32768
MF a[96:99],v[152:155],v[112:115],a[96:99]
DT v[94:95],v30 offset:36864
MF a[36:39],v[136:139],v[116:119],a[36:39]
DT v[108:109],v30 offset:40960
MF a[100:103],v[152:155],v[116:119],a[100:103]
DT v[110:111],v30 offset:45056
MF a[40:43],v[136:139],v[120:123],a[40:43]
SA m0,s52,57344
s_mov_b32 s53,7168
BL v16,s[8:11],s53 offen lds
MF a[104:107],v[152:155],v[120:123],a[104:107]
BL v17,s[8:11],s53 offen offset:1024 lds
MF a[44:47],v[136:139],v[124:127],a[44:47]
SA m0,s52,65536
s_mov_b32 s53,8192
BL v16,s[8:11],s53 offen lds
MF a[108:111],v[152:155],v[124:127],a[108:111]
MF a[48:51],v[140:143],v[112:115],a[48:51]
BL v17,s[8:11],s53 offen offset:1024 lds
MF a[112:115],v[156:159],v[112:115],a[112:115]
MF a[52:55],v[140:143],v[116:119],a[52:55]
SA m0,s52,81920
s_mov_b32 s53,573440
BL v18,s[12:15],s53 offen lds
MF a[116:119],v[156:159],v[116:119],a[116:119]
MF a[56:59],v[140:143],v[120:123],a[56:59]
BL v19,s[12:15],s53 offen offset:1024 lds
MF a[120:123],v[156:159],v[120:123],a[120:123]
MF a[60:63],v[140:143],v[124:127],a[60:63]
SA m0,s52,90112
s_nop 0
BL v18,s[16:19],s53 offen lds
MF a[124:127],v[156:159],v[124:127],a[124:127]
BL v19,s[16:19],s53 offen offset:1024 lds
WT vmcnt(18) lgkmcnt(0)
s_barrier
MF a[0:3],v[80:83],v[64:67],a[0:3]
DR v[112:115],v20 offset:24576
MF a[64:67],v[96:99],v[64:67],a[64:67]
DT v[128:129],v24 offset:49152
MF a[4:7],v[80:83],v[68:71],a[4:7]
DT v[130:131],v24 offset:53248
MF a[68:71],v[96:99],v[68:71],a[68:71]
DT v[144:145],v24 offset:57344
MF a[8:11],v[80:83],v[72:75],a[8:11]
DT v[146:147],v24 offset:61440
MF a[72:75],v[96:99],v[72:75],a[72:75]
DR v[116:119],v20 offset:25600
MF a[12:15],v[80:83],v[76:79],a[12:15]
DR v[120:123],v20 offset:26624
MF a[76:79],v[96:99],v[76:79],a[76:79]
DR v[124:127],v20 offset:27648
MF a[16:19],v[84:87],v[64:67],a[16:19]
DT v[132:133],v26 offset:49152
MF a[80:83],v[100:103],v[64:67],a[80:83]
DT v[134:135],v26 offset:53248
MF a[20:23],v[84:87],v[68:71],a[20:23]
DT v[148:149],v26 offset:57344
MF a[84:87],v[100:103],v[68:71],a[84:87]
DT v[150:151],v26 offset:61440
MF a[24:27],v[84:87],v[72:75],a[24:27]
DT v[136:137],v28 offset:49152
MF a[88:91],v[100:103],v[72:75],a[88:91]
DT v[138:139],v28 offset:53248
MF a[28:31],v[84:87],v[76:79],a[28:31]
DT v[152:153],v28 offset:57344
MF a[92:95],v[100:103],v[76:79],a[92:95]
DT v[154:155],v28 offset:61440
MF a[32:35],v[88:91],v[64:67],a[32:35]
DT v[140:141],v30 offset:49152
MF a[96:99],v[104:107],v[64:67],a[96:99]
DT v[142:143],v30 offset:53248
MF a[36:39],v[88:91],v[68:71],a[36:39]
DT v[156:157],v30 offset:57344
MF a[100:103],v[104:107],v[68:71],a[100:103]
DT v[158:159],v30 offset:61440
MF a[40:43],v[88:91],v[72:75],a[40:43]
SA m0,s52,73728
s_mov_b32 s53,9216
BL v16,s[8:11],s53 offen lds
MF a[104:107],v[104:107],v[72:75],a[104:107]
BL v17,s[8:11],s53 offen offset:1024 lds
MF a[44:47],v[88:91],v[76:79],a[44:47]
SA m0,s52,0
s_mov_b32 s53,10240
BL v16,s[8:11],s53 offen lds
MF a[108:111],v[104:107],v[76:79],a[108:111]
MF a[48:51],v[92:95],v[64:67],a[48:51]
BL v17,s[8:11],s53 offen offset:1024 lds
MF a[112:115],v[108:111],v[64:67],a[112:115]
MF a[52:55],v[92:95],v[68:71],a[52:55]
SA m0,s52,98304
s_mov_b32 s53,688128
BL v18,s[12:15],s53 offen lds
MF a[116:119],v[108:111],v[68:71],a[116:119]
MF a[56:59],v[92:95],v[72:75],a[56:59]
BL v19,s[12:15],s53 offen offset:1024 lds
MF a[120:123],v[108:111],v[72:75],a[120:123]
MF a[60:63],v[92:95],v[76:79],a[60:63]
SA m0,s52,106496
s_nop 0
BL v18,s[16:19],s53 offen lds
MF a[124:127],v[108:111],v[76:79],a[124:127]
BL v19,s[16:19],s53 offen offset:1024 lds
WT vmcnt(16) lgkmcnt(0)
s_barrier
MF a[0:3],v[128:131],v[112:115],a[0:3]
DR v[64:67],v20 offset:32768
MF a[64:67],v[144:147],v[112:115],a[64:67]
DT v[80:81],v25 offset:0
MF a[4:7],v[128:131],v[116:119],a[4:7]
DT v[82:83],v25 offset:4096
MF a[68:71],v[144:147],v[116:119],a[68:71]
DT v[96:97],v25 offset:8192
MF a[8:11],v[128:131],v[120:123],a[8:11]
DT v[98:99],v25 offset:12288
MF a[72:75],v[144:147],v[120:123],a[72:75]
DR v[68:71],v20 offset:33792
MF a[12:15],v[128:131],v[124:127],a[12:15]
DR v[72:75],v20 offset:34816
MF a[76:79],v[144:147],v[124:127],a[76:79]
DR v[76:79],v20 offset:35840
MF a[16:19],v[132:135],v[112:115],a[16:19]
DT v[84:85],v27 offset:0
MF a[80:83],v[148:151],v[112:115],a[80:83]
DT v[86:87],v27 offset:4096
MF a[20:23],v[132:135],v[116:119],a[20:23]
DT v[100:101],v27 offset:8192
MF a[84:87],v[148:151],v[116:119],a[84:87]
DT v[102:103],v27 offset:12288
MF a[24:27],v[132:135],v[120:123],a[24:27]
DT v[88:89],v29 offset:0
MF a[88:91],v[148:151],v[120:123],a[88:91]
DT v[90:91],v29 offset:4096
MF a[28:31],v[132:135],v[124:127],a[28:31]
DT v[104:105],v29 offset:8192
MF a[92:95],v[148:151],v[124:127],a[92:95]
DT v[106:107],v29 offset:12288
MF a[32:35],v[136:139],v[112:115],a[32:35]
DT v[92:93],v31 offset:0
MF a[96:99],v[152:155],v[112:115],a[96:99]
DT v[94:95],v31 offset:4096
MF a[36:39],v[136:139],v[116:119],a[36:39]
DT v[108:109],v31 offset:8192
MF a[100:103],v[152:155],v[116:119],a[100:103]
DT v[110:111],v31 offset:12288
MF a[40:43],v[136:139],v[120:123],a[40:43]
SA m0,s52,8192
s_mov_b32 s53,11264
BL v16,s[8:11],s53 offen lds
MF a[104:107],v[152:155],v[120:123],a[104:107]
BL v17,s[8:11],s53 offen offset:1024 lds
MF a[44:47],v[136:139],v[124:127],a[44:47]
SA m0,s52,16384
s_mov_b32 s53,12288
BL v16,s[8:11],s53 offen lds
MF a[108:111],v[152:155],v[124:127],a[108:111]
MF a[48:51],v[140:143],v[112:115],a[48:51]
BL v17,s[8:11],s53 offen offset:1024 lds
MF a[112:115],v[156:159],v[112:115],a[112:115]
MF a[52:55],v[140:143],v[116:119],a[52:55]
SA m0,s52,114688
s_mov_b32 s53,802816
BL v18,s[12:15],s53 offen lds
MF a[116:119],v[156:159],v[116:119],a[116:119]
MF a[56:59],v[140:143],v[120:123],a[56:59]
BL v19,s[12:15],s53 offen offset:1024 lds
MF a[120:123],v[156:159],v[120:123],a[120:123]
MF a[60:63],v[140:143],v[124:127],a[60:63]
SA m0,s52,122880
s_nop 0
BL v18,s[16:19],s53 offen lds
MF a[124:127],v[156:159],v[124:127],a[124:127]
BL v19,s[16:19],s53 offen offset:1024 lds
WT vmcnt(16) lgkmcnt(0)
s_barrier
MF a[0:3],v[80:83],v[64:67],a[0:3]
DR v[112:115],v20 offset:40960
MF a[64:67],v[96:99],v[64:67],a[64:67]
DT v[128:129],v24 offset:0
MF a[4:7],v[80:83],v[68:71],a[4:7]
DT v[130:131],v24 offset:4096
MF a[68:71],v[96:99],v[68:71],a[68:71]
DT v[144:145],v24 offset:8192
MF a[8:11],v[80:83],v[72:75],a[8:11]
DT v[146:147],v24 offset:12288
MF a[72:75],v[96:99],v[72:75],a[72:75]
DR v[116:119],v20 offset:41984
MF a[12:15],v[80:83],v[76:79],a[12:15]
DR v[120:123],v20 offset:43008
MF a[76:79],v[96:99],v[76:79],a[76:79]
DR v[124:127],v20 offset:44032
MF a[16:19],v[84:87],v[64:67],a[16:19]
DT v[132:133],v26 offset:0
MF a[80:83],v[100:103],v[64:67],a[80:83]
DT v[134:135],v26 offset:4096
MF a[20:23],v[84:87],v[68:71],a[20:23]
DT v[148:149],v26 offset:8192
MF a[84:87],v[100:103],v[68:71],a[84:87]
DT v[150:151],v26 offset:12288
MF a[24:27],v[84:87],v[72:75],a[24:27]
DT v[136:137],v28 offset:0
MF a[88:91],v[100:103],v[72:75],a[88:91]
DT v[138:139],v28 offset:4096
MF a[28:31],v[84:87],v[76:79],a[28:31]
DT v[152:153],v28 offset:8192
MF a[92:95],v[100:103],v[76:79],a[92:95]
DT v[154:155],v28 offset:12288
MF a[32:35],v[88:91],v[64:67],a[32:35]
DT v[140:141],v30 offset:0
MF a[96:99],v[104:107],v[64:67],a[96:99]
DT v[142:143],v30 offset:4096
MF a[36:39],v[88:91],v[68:71],a[36:39]
DT v[156:157],v30 offset:8192
MF a[100:103],v[104:107],v[68:71],a[100:103]
DT v[158:159],v30 offset:12288
MF a[40:43],v[88:91],v[72:75],a[40:43]
SA m0,s52,24576
s_mov_b32 s53,13312
BL v16,s[8:11],s53 offen lds
MF a[104:107],v[104:107],v[72:75],a[104:107]
MF a[44:47],v[88:91],v[76:79],a[44:47]
BL v17,s[8:11],s53 offen offset:1024 lds
MF a[108:111],v[104:107],v[76:79],a[108:111]
MF a[48:51],v[92:95],v[64:67],a[48:51]
SA m0,s52,131072
s_mov_b32 s53,917504
BL v18,s[12:15],s53 offen lds
MF a[112:115],v[108:111],v[64:67],a[112:115]
MF a[52:55],v[92:95],v[68:71],a[52:55]
BL v19,s[12:15],s53 offen offset:1024 lds
MF a[116:119],v[108:111],v[68:71],a[116:119]
MF a[56:59],v[92:95],v[72:75],a[56:59]
SA m0,s52,139264
s_nop 0
BL v18,s[16:19],s53 offen lds
MF a[120:123],v[108:111],v[72:75],a[120:123]
MF a[60:63],v[92:95],v[76:79],a[60:63]
BL v19,s[16:19],s53 offen offset:1024 lds
MF a[124:127],v[108:111],v[76:79],a[124:127]
WT vmcnt(14) lgkmcnt(0)
s_barrier
MF a[0:3],v[128:131],v[112:115],a[0:3]
DR v[64:67],v20 offset:49152
MF a[64:67],v[144:147],v[112:115],a[64:67]
DT v[80:81],v24 offset:16384
MF a[4:7],v[128:131],v[116:119],a[4:7]
DT v[82:83],v24 offset:20480
MF a[68:71],v[144:147],v[116:119],a[68:71]
DT v[96:97],v24 offset:24576
MF a[8:11],v[128:131],v[120:123],a[8:11]
DT v[98:99],v24 offset:28672
MF a[72:75],v[144:147],v[120:123],a[72:75]
DR v[68:71],v20 offset:50176
MF a[12:15],v[128:131],v[124:127],a[12:15]
DR v[72:75],v20 offset:51200
MF a[76:79],v[144:147],v[124:127],a[76:79]
DR v[76:79],v20 offset:52224
MF a[16:19],v[132:135],v[112:115],a[16:19]
DT v[84:85],v26 offset:16384
MF a[80:83],v[148:151],v[112:115],a[80:83]
DT v[86:87],v26 offset:20480
MF a[20:23],v[132:135],v[116:119],a[20:23]
DT v[100:101],v26 offset:24576
MF a[84:87],v[148:151],v[116:119],a[84:87]
DT v[102:103],v26 offset:28672
MF a[24:27],v[132:135],v[120:123],a[24:27]
DT v[88:89],v28 offset:16384
MF a[88:91],v[148:151],v[120:123],a[88:91]
DT v[90:91],v28 offset:20480
MF a[28:31],v[132:135],v[124:127],a[28:31]
DT v[104:105],v28 offset:24576
MF a[92:95],v[148:151],v[124:127],a[92:95]
DT v[106:107],v28 offset:28672
MF a[32:35],v[136:139],v[112:115],a[32:35]
DT v[92:93],v30 offset:16384
MF a[96:99],v[152:155],v[112:115],a[96:99]
DT v[94:95],v30 offset:20480
MF a[36:39],v[136:139],v[116:119],a[36:39]
DT v[108:109],v30 offset:24576
MF a[100:103],v[152:155],v[116:119],a[100:103]
DT v[110:111],v30 offset:28672
MF a[40:43],v[136:139],v[120:123],a[40:43]
SA m0,s52,147456
s_mov_b32 s53,1032192
BL v18,s[12:15],s53 offen lds
MF a[104:107],v[152:155],v[120:123],a[104:107]
MF a[44:47],v[136:139],v[124:127],a[44:47]
BL v19,s[12:15],s53 offen offset:1024 lds
MF a[108:111],v[152:155],v[124:127],a[108:111]
MF a[48:51],v[140:143],v[112:115],a[48:51]
SA m0,s52,155648
s_nop 0
BL v18,s[16:19],s53 offen lds
MF a[112:115],v[156:159],v[112:115],a[112:115]
MF a[52:55],v[140:143],v[116:119],a[52:55]
BL v19,s[16:19],s53 offen offset:1024 lds
MF a[116:119],v[156:159],v[116:119],a[116:119]
MF a[56:59],v[140:143],v[120:123],a[56:59]
MF a[120:123],v[156:159],v[120:123],a[120:123]
MF a[60:63],v[140:143],v[124:127],a[60:63]
MF a[124:127],v[156:159],v[124:127],a[124:127]
WT vmcnt(10) lgkmcnt(0)
s_barrier
MF a[0:3],v[80:83],v[64:67],a[0:3]
DR v[112:115],v20 offset:57344
MF a[64:67],v[96:99],v[64:67],a[64:67]
DT v[128:129],v24 offset:32768
MF a[4:7],v[80:83],v[68:71],a[4:7]
DT v[130:131],v24 offset:36864
MF a[68:71],v[96:99],v[68:71],a[68:71]
DT v[144:145],v24 offset:40960
MF a[8:11],v[80:83],v[72:75],a[8:11]
DT v[146:147],v24 offset:45056
MF a[72:75],v[96:99],v[72:75],a[72:75]
DR v[116:119],v20 offset:58368
MF a[12:15],v[80:83],v[76:79],a[12:15]
DR v[120:123],v20 offset:59392
MF a[76:79],v[96:99],v[76:79],a[76:79]
DR v[124:127],v20 offset:60416
MF a[16:19],v[84:87],v[64:67],a[16:19]
DT v[132:133],v26 offset:32768
MF a[80:83],v[100:103],v[64:67],a[80:83]
DT v[134:135],v26 offset:36864
MF a[20:23],v[84:87],v[68:71],a[20:23]
DT v[148:149],v26 offset:40960
MF a[84:87],v[100:103],v[68:71],a[84:87]
DT v[150:151],v26 offset:45056
MF a[24:27],v[84:87],v[72:75],a[24:27]
DT v[136:137],v28 offset:32768
MF a[88:91],v[100:103],v[72:75],a[88:91]
DT v[138:139],v28 offset:36864
MF a[28:31],v[84:87],v[76:79],a[28:31]
DT v[152:153],v28 offset:40960
MF a[92:95],v[100:103],v[76:79],a[92:95]
DT v[154:155],v28 offset:45056
MF a[32:35],v[88:91],v[64:67],a[32:35]
DT v[140:141],v30 offset:32768
MF a[96:99],v[104:107],v[64:67],a[96:99]
DT v[142:143],v30 offset:36864
MF a[36:39],v[88:91],v[68:71],a[36:39]
DT v[156:157],v30 offset:40960
MF a[100:103],v[104:107],v[68:71],a[100:103]
DT v[158:159],v30 offset:45056
MF a[40:43],v[88:91],v[72:75],a[40:43]
SA m0,s52,81920
s_mov_b32 s53,1146880
BL v18,s[12:15],s53 offen lds
MF a[104:107],v[104:107],v[72:75],a[104:107]
MF a[44:47],v[88:91],v[76:79],a[44:47]
BL v19,s[12:15],s53 offen offset:1024 lds
MF a[108:111],v[104:107],v[76:79],a[108:111]
MF a[48:51],v[92:95],v[64:67],a[48:51]
SA m0,s52,90112
s_nop 0
BL v18,s[16:19],s53 offen lds
MF a[112:115],v[108:111],v[64:67],a[112:115]
MF a[52:55],v[92:95],v[68:71],a[52:55]
BL v19,s[16:19],s53 offen offset:1024 lds
MF a[116:119],v[108:111],v[68:71],a[116:119]
MF a[56:59],v[92:95],v[72:75],a[56:59]
MF a[120:123],v[108:111],v[72:75],a[120:123]
MF a[60:63],v[92:95],v[76:79],a[60:63]
MF a[124:127],v[108:111],v[76:79],a[124:127]
WT vmcnt(8) lgkmcnt(0)
s_barrier
MF a[0:3],v[128:131],v[112:115],a[0:3]
DR v[64:67],v21 offset:0
MF a[64:67],v[144:147],v[112:115],a[64:67]
DT v[80:81],v24 offset:49152
MF a[4:7],v[128:131],v[116:119],a[4:7]
DT v[82:83],v24 offset:53248
MF a[68:71],v[144:147],v[116:119],a[68:71]
DT v[96:97],v24 offset:57344
MF a[8:11],v[128:131],v[120:123],a[8:11]
DT v[98:99],v24 offset:61440
MF a[72:75],v[144:147],v[120:123],a[72:75]
DR v[68:71],v21 offset:1024
MF a[12:15],v[128:131],v[124:127],a[12:15]
DR v[72:75],v21 offset:2048
MF a[76:79],v[144:147],v[124:127],a[76:79]
DR v[76:79],v21 offset:3072
MF a[16:19],v[132:135],v[112:115],a[16:19]
DT v[84:85],v26 offset:49152
MF a[80:83],v[148:151],v[112:115],a[80:83]
DT v[86:87],v26 offset:53248
MF a[20:23],v[132:135],v[116:119],a[20:23]
DT v[100:101],v26 offset:57344
MF a[84:87],v[148:151],v[116:119],a[84:87]
DT v[102:103],v26 offset:61440
MF a[24:27],v[132:135],v[120:123],a[24:27]
DT v[88:89],v28 offset:49152
MF a[88:91],v[148:151],v[120:123],a[88:91]
DT v[90:91],v28 offset:53248
MF a[28:31],v[132:135],v[124:127],a[28:31]
DT v[104:105],v28 offset:57344
MF a[92:95],v[148:151],v[124:127],a[92:95]
DT v[106:107],v28 offset:61440
MF a[32:35],v[136:139],v[112:115],a[32:35]
DT v[92:93],v30 offset:49152
MF a[96:99],v[152:155],v[112:115],a[96:99]
DT v[94:95],v30 offset:53248
MF a[36:39],v[136:139],v[116:119],a[36:39]
DT v[108:109],v30 offset:57344
MF a[100:103],v[152:155],v[116:119],a[100:103]
DT v[110:111],v30 offset:61440
MF a[40:43],v[136:139],v[120:123],a[40:43]
SA m0,s52,98304
s_mov_b32 s53,1261568
BL v18,s[12:15],s53 offen lds
MF a[104:107],v[152:155],v[120:123],a[104:107]
MF a[44:47],v[136:139],v[124:127],a[44:47]
BL v19,s[12:15],s53 offen offset:1024 lds
MF a[108:111],v[152:155],v[124:127],a[108:111]
MF a[48:51],v[140:143],v[112:115],a[48:51]
SA m0,s52,106496
s_nop 0
BL v18,s[16:19],s53 offen lds
MF a[112:115],v[156:159],v[112:115],a[112:115]
MF a[52:55],v[140:143],v[116:119],a[52:55]
BL v19,s[16:19],s53 offen offset:1024 lds
MF a[116:119],v[156:159],v[116:119],a[116:119]
MF a[56:59],v[140:143],v[120:123],a[56:59]
MF a[120:123],v[156:159],v[120:123],a[120:123]
MF a[60:63],v[140:143],v[124:127],a[60:63]
MF a[124:127],v[156:159],v[124:127],a[124:127]
WT vmcnt(8) lgkmcnt(0)
s_barrier
MF a[0:3],v[80:83],v[64:67],a[0:3]
DR v[112:115],v21 offset:8192
MF a[64:67],v[96:99],v[64:67],a[64:67]
DT v[128:129],v25 offset:0
MF a[4:7],v[80:83],v[68:71],a[4:7]
DT v[130:131],v25 offset:4096
MF a[68:71],v[96:99],v[68:71],a[68:71]
DT v[144:145],v25 offset:8192
MF a[8:11],v[80:83],v[72:75],a[8:11]
DT v[146:147],v25 offset:12288
MF a[72:75],v[96:99],v[72:75],a[72:75]
DR v[116:119],v21 offset:9216
MF a[12:15],v[80:83],v[76:79],a[12:15]
DR v[120:123],v21 offset:10240
MF a[76:79],v[96:99],v[76:79],a[76:79]
DR v[124:127],v21 offset:11264
MF a[16:19],v[84:87],v[64:67],a[16:19]
DT v[132:133],v27 offset:0
MF a[80:83],v[100:103],v[64:67],a[80:83]
DT v[134:135],v27 offset:4096
MF a[20:23],v[84:87],v[68:71],a[20:23]
DT v[148:149],v27 offset:8192
MF a[84:87],v[100:103],v[68:71],a[84:87]
DT v[150:151],v27 offset:12288
MF a[24:27],v[84:87],v[72:75],a[24:27]
DT v[136:137],v29 offset:0
MF a[88:91],v[100:103],v[72:75],a[88:91]
DT v[138:139],v29 offset:4096
MF a[28:31],v[84:87],v[76:79],a[28:31]
DT v[152:153],v29 offset:8192
MF a[92:95],v[100:103],v[76:79],a[92:95]
DT v[154:155],v29 offset:12288
MF a[32:35],v[88:91],v[64:67],a[32:35]
DT v[140:141],v31 offset:0
MF a[96:99],v[104:107],v[64:67],a[96:99]
DT v[142:143],v31 offset:4096
MF a[36:39],v[88:91],v[68:71],a[36:39]
DT v[156:157],v31 offset:8192
MF a[100:103],v[104:107],v[68:71],a[100:103]
DT v[158:159],v31 offset:12288
MF a[40:43],v[88:91],v[72:75],a[40:43]
SA m0,s52,114688
s_mov_b32 s53,1376256
BL v18,s[12:15],s53 offen lds
MF a[104:107],v[104:107],v[72:75],a[104:107]
MF a[44:47],v[88:91],v[76:79],a[44:47]
BL v19,s[12:15],s53 offen offset:1024 lds
MF a[108:111],v[104:107],v[76:79],a[108:111]
MF a[48:51],v[92:95],v[64:67],a[48:51]
SA m0,s52,122880
s_nop 0
BL v18,s[16:19],s53 offen lds
MF a[112:115],v[108:111],v[64:67],a[112:115]
MF a[52:55],v[92:95],v[68:71],a[52:55]
BL v19,s[16:19],s53 offen offset:1024 lds
MF a[116:119],v[108:111],v[68:71],a[116:119]
MF a[56:59],v[92:95],v[72:75],a[56:59]
MF a[120:123],v[108:111],v[72:75],a[120:123]
MF a[60:63],v[92:95],v[76:79],a[60:63]
MF a[124:127],v[108:111],v[76:79],a[124:127]
WT vmcnt(8) lgkmcnt(0)
s_barrier
MF a[0:3],v[128:131],v[112:115],a[0:3]
DR v[64:67],v20 offset:0
MF a[64:67],v[144:147],v[112:115],a[64:67]
DT v[80:81],v24 offset:0
MF a[4:7],v[128:131],v[116:119],a[4:7]
DT v[82:83],v24 offset:4096
MF a[68:71],v[144:147],v[116:119],a[68:71]
DT v[96:97],v24 offset:8192
MF a[8:11],v[128:131],v[120:123],a[8:11]
DT v[98:99],v24 offset:12288
MF a[72:75],v[144:147],v[120:123],a[72:75]
DR v[68:71],v20 offset:1024
MF a[12:15],v[128:131],v[124:127],a[12:15]
DR v[72:75],v20 offset:2048
MF a[76:79],v[144:147],v[124:127],a[76:79]
DR v[76:79],v20 offset:3072
MF a[16:19],v[132:135],v[112:115],a[16:19]
DT v[84:85],v26 offset:0
MF a[80:83],v[148:151],v[112:115],a[80:83]
DT v[86:87],v26 offset:4096
MF a[20:23],v[132:135],v[116:119],a[20:23]
DT v[100:101],v26 offset:8192
MF a[84:87],v[148:151],v[116:119],a[84:87]
DT v[102:103],v26 offset:12288
MF a[24:27],v[132:135],v[120:123],a[24:27]
DT v[88:89],v28 offset:0
MF a[88:91],v[148:151],v[120:123],a[88:91]
DT v[90:91],v28 offset:4096
MF a[28:31],v[132:135],v[124:127],a[28:31]
DT v[104:105],v28 offset:8192
MF a[92:95],v[148:151],v[124:127],a[92:95]
DT v[106:107],v28 offset:12288
MF a[32:35],v[136:139],v[112:115],a[32:35]
DT v[92:93],v30 offset:0
MF a[96:99],v[152:155],v[112:115],a[96:99]
DT v[94:95],v30 offset:4096
MF a[36:39],v[136:139],v[116:119],a[36:39]
DT v[108:109],v30 offset:8192
MF a[100:103],v[152:155],v[116:119],a[100:103]
DT v[110:111],v30 offset:12288
MF a[40:43],v[136:139],v[120:123],a[40:43]
SA m0,s52,131072
s_mov_b32 s53,1490944
BL v18,s[12:15],s53 offen lds
MF a[104:107],v[152:155],v[120:123],a[104:107]
MF a[44:47],v[136:139],v[124:127],a[44:47]
BL v19,s[12:15],s53 offen offset:1024 lds
MF a[108:111],v[152:155],v[124:127],a[108:111]
MF a[48:51],v[140:143],v[112:115],a[48:51]
SA m0,s52,139264
s_nop 0
BL v18,s[16:19],s53 offen lds
MF a[112:115],v[156:159],v[112:115],a[112:115]
MF a[52:55],v[140:143],v[116:119],a[52:55]
BL v19,s[16:19],s53 offen offset:1024 lds
MF a[116:119],v[156:159],v[116:119],a[116:119]
MF a[56:59],v[140:143],v[120:123],a[56:59]
MF a[120:123],v[156:159],v[120:123],a[120:123]
MF a[60:63],v[140:143],v[124:127],a[60:63]
MF a[124:127],v[156:159],v[124:127],a[124:127]
WT vmcnt(8) lgkmcnt(0)
s_barrier
MF a[0:3],v[80:83],v[64:67],a[0:3]
DR v[112:115],v20 offset:8192
MF a[64:67],v[96:99],v[64:67],a[64:67]
DT v[128:129],v24 offset:16384
MF a[4:7],v[80:83],v[68:71],a[4:7]
DT v[130:131],v24 offset:20480
MF a[68:71],v[96:99],v[68:71],a[68:71]
DT v[144:145],v24 offset:24576
MF a[8:11],v[80:83],v[72:75],a[8:11]
DT v[146:147],v24 offset:28672
MF a[72:75],v[96:99],v[72:75],a[72:75]
DR v[116:119],v20 offset:9216
MF a[12:15],v[80:83],v[76:79],a[12:15]
DR v[120:123],v20 offset:10240
MF a[76:79],v[96:99],v[76:79],a[76:79]
DR v[124:127],v20 offset:11264
MF a[16:19],v[84:87],v[64:67],a[16:19]
DT v[132:133],v26 offset:16384
MF a[80:83],v[100:103],v[64:67],a[80:83]
DT v[134:135],v26 offset:20480
MF a[20:23],v[84:87],v[68:71],a[20:23]
DT v[148:149],v26 offset:24576
MF a[84:87],v[100:103],v[68:71],a[84:87]
DT v[150:151],v26 offset:28672
MF a[24:27],v[84:87],v[72:75],a[24:27]
DT v[136:137],v28 offset:16384
MF a[88:91],v[100:103],v[72:75],a[88:91]
DT v[138:139],v28 offset:20480
MF a[28:31],v[84:87],v[76:79],a[28:31]
DT v[152:153],v28 offset:24576
MF a[92:95],v[100:103],v[76:79],a[92:95]
DT v[154:155],v28 offset:28672
MF a[32:35],v[88:91],v[64:67],a[32:35]
DT v[140:141],v30 offset:16384
MF a[96:99],v[104:107],v[64:67],a[96:99]
DT v[142:143],v30 offset:20480
MF a[36:39],v[88:91],v[68:71],a[36:39]
DT v[156:157],v30 offset:24576
MF a[100:103],v[104:107],v[68:71],a[100:103]
DT v[158:159],v30 offset:28672
MF a[40:43],v[88:91],v[72:75],a[40:43]
MF a[104:107],v[104:107],v[72:75],a[104:107]
MF a[44:47],v[88:91],v[76:79],a[44:47]
MF a[108:111],v[104:107],v[76:79],a[108:111]
MF a[48:51],v[92:95],v[64:67],a[48:51]
MF a[112:115],v[108:111],v[64:67],a[112:115]
MF a[52:55],v[92:95],v[68:71],a[52:55]
MF a[116:119],v[108:111],v[68:71],a[116:119]
MF a[56:59],v[92:95],v[72:75],a[56:59]
MF a[120:123],v[108:111],v[72:75],a[120:123]
MF a[60:63],v[92:95],v[76:79],a[60:63]
MF a[124:127],v[108:111],v[76:79],a[124:127]
WT vmcnt(4) lgkmcnt(0)
s_barrier
MF a[0:3],v[128:131],v[112:115],a[0:3]
DR v[64:67],v20 offset:16384
MF a[64:67],v[144:147],v[112:115],a[64:67]
DT v[80:81],v24 offset:32768
MF a[4:7],v[128:131],v[116:119],a[4:7]
DT v[82:83],v24 offset:36864
MF a[68:71],v[144:147],v[116:119],a[68:71]
DT v[96:97],v24 offset:40960
MF a[8:11],v[128:131],v[120:123],a[8:11]
DT v[98:99],v24 offset:45056
MF a[72:75],v[144:147],v[120:123],a[72:75]
DR v[68:71],v20 offset:17408
MF a[12:15],v[128:131],v[124:127],a[12:15]
DR v[72:75],v20 offset:18432
MF a[76:79],v[144:147],v[124:127],a[76:79]
DR v[76:79],v20 offset:19456
MF a[16:19],v[132:135],v[112:115],a[16:19]
DT v[84:85],v26 offset:32768
MF a[80:83],v[148:151],v[112:115],a[80:83]
DT v[86:87],v26 offset:36864
MF a[20:23],v[132:135],v[116:119],a[20:23]
DT v[100:101],v26 offset:40960
MF a[84:87],v[148:151],v[116:119],a[84:87]
DT v[102:103],v26 offset:45056
MF a[24:27],v[132:135],v[120:123],a[24:27]
DT v[88:89],v28 offset:32768
MF a[88:91],v[148:151],v[120:123],a[88:91]
DT v[90:91],v28 offset:36864
MF a[28:31],v[132:135],v[124:127],a[28:31]
DT v[104:105],v28 offset:40960
MF a[92:95],v[148:151],v[124:127],a[92:95]
DT v[106:107],v28 offset:45056
MF a[32:35],v[136:139],v[112:115],a[32:35]
DT v[92:93],v30 offset:32768
MF a[96:99],v[152:155],v[112:115],a[96:99]
DT v[94:95],v30 offset:36864
MF a[36:39],v[136:139],v[116:119],a[36:39]
DT v[108:109],v30 offset:40960
MF a[100:103],v[152:155],v[116:119],a[100:103]
DT v[110:111],v30 offset:45056
MF a[40:43],v[136:139],v[120:123],a[40:43]
MF a[104:107],v[152:155],v[120:123],a[104:107]
MF a[44:47],v[136:139],v[124:127],a[44:47]
MF a[108:111],v[152:155],v[124:127],a[108:111]
MF a[48:51],v[140:143],v[112:115],a[48:51]
MF a[112:115],v[156:159],v[112:115],a[112:115]
MF a[52:55],v[140:143],v[116:119],a[52:55]
MF a[116:119],v[156:159],v[116:119],a[116:119]
MF a[56:59],v[140:143],v[120:123],a[56:59]
MF a[120:123],v[156:159],v[120:123],a[120:123]
MF a[60:63],v[140:143],v[124:127],a[60:63]
MF a[124:127],v[156:159],v[124:127],a[124:127]
WT vmcnt(0) lgkmcnt(0)
s_barrier
MF a[0:3],v[80:83],v[64:67],a[0:3]
DR v[112:115],v20 offset:24576
MF a[64:67],v[96:99],v[64:67],a[64:67]
DT v[128:129],v24 offset:49152
MF a[4:7],v[80:83],v[68:71],a[4:7]
DT v[130:131],v24 offset:53248
MF a[68:71],v[96:99],v[68:71],a[68:71]
DT v[144:145],v24 offset:57344
MF a[8:11],v[80:83],v[72:75],a[8:11]
DT v[146:147],v24 offset:61440
MF a[72:75],v[96:99],v[72:75],a[72:75]
DR v[116:119],v20 offset:25600
MF a[12:15],v[80:83],v[76:79],a[12:15]
DR v[120:123],v20 offset:26624
MF a[76:79],v[96:99],v[76:79],a[76:79]
DR v[124:127],v20 offset:27648
MF a[16:19],v[84:87],v[64:67],a[16:19]
DT v[132:133],v26 offset:49152
MF a[80:83],v[100:103],v[64:67],a[80:83]
DT v[134:135],v26 offset:53248
MF a[20:23],v[84:87],v[68:71],a[20:23]
DT v[148:149],v26 offset:57344
MF a[84:87],v[100:103],v[68:71],a[84:87]
DT v[150:151],v26 offset:61440
MF a[24:27],v[84:87],v[72:75],a[24:27]
DT v[136:137],v28 offset:49152
MF a[88:91],v[100:103],v[72:75],a[88:91]
DT v[138:139],v28 offset:53248
MF a[28:31],v[84:87],v[76:79],a[28:31]
DT v[152:153],v28 offset:57344
MF a[92:95],v[100:103],v[76:79],a[92:95]
DT v[154:155],v28 offset:61440
MF a[32:35],v[88:91],v[64:67],a[32:35]
DT v[140:141],v30 offset:49152
MF a[96:99],v[104:107],v[64:67],a[96:99]
DT v[142:143],v30 offset:53248
MF a[36:39],v[88:91],v[68:71],a[36:39]
DT v[156:157],v30 offset:57344
MF a[100:103],v[104:107],v[68:71],a[100:103]
DT v[158:159],v30 offset:61440
MF a[40:43],v[88:91],v[72:75],a[40:43]
MF a[104:107],v[104:107],v[72:75],a[104:107]
MF a[44:47],v[88:91],v[76:79],a[44:47]
MF a[108:111],v[104:107],v[76:79],a[108:111]
MF a[48:51],v[92:95],v[64:67],a[48:51]
MF a[112:115],v[108:111],v[64:67],a[112:115]
MF a[52:55],v[92:95],v[68:71],a[52:55]
MF a[116:119],v[108:111],v[68:71],a[116:119]
MF a[56:59],v[92:95],v[72:75],a[56:59]
MF a[120:123],v[108:111],v[72:75],a[120:123]
MF a[60:63],v[92:95],v[76:79],a[60:63]
MF a[124:127],v[108:111],v[76:79],a[124:127]
WT lgkmcnt(0)
MF a[0:3],v[128:131],v[112:115],a[0:3]
MF a[64:67],v[144:147],v[112:115],a[64:67]
MF a[4:7],v[128:131],v[116:119],a[4:7]
MF a[68:71],v[144:147],v[116:119],a[68:71]
MF a[8:11],v[128:131],v[120:123],a[8:11]
MF a[72:75],v[144:147],v[120:123],a[72:75]
MF a[12:15],v[128:131],v[124:127],a[12:15]
MF a[76:79],v[144:147],v[124:127],a[76:79]
MF a[16:19],v[132:135],v[112:115],a[16:19]
MF a[80:83],v[148:151],v[112:115],a[80:83]
MF a[20:23],v[132:135],v[116:119],a[20:23]
MF a[84:87],v[148:151],v[116:119],a[84:87]
MF a[24:27],v[132:135],v[120:123],a[24:27]
MF a[88:91],v[148:151],v[120:123],a[88:91]
MF a[28:31],v[132:135],v[124:127],a[28:31]
MF a[92:95],v[148:151],v[124:127],a[92:95]
MF a[32:35],v[136:139],v[112:115],a[32:35]
MF a[96:99],v[152:155],v[112:115],a[96:99]
MF a[36:39],v[136:139],v[116:119],a[36:39]
MF a[100:103],v[152:155],v[116:119],a[100:103]
MF a[40:43],v[136:139],v[120:123],a[40:43]
MF a[104:107],v[152:155],v[120:123],a[104:107]
MF a[44:47],v[136:139],v[124:127],a[44:47]
MF a[108:111],v[152:155],v[124:127],a[108:111]
MF a[48:51],v[140:143],v[112:115],a[48:51]
MF a[112:115],v[156:159],v[112:115],a[112:115]
MF a[52:55],v[140:143],v[116:119],a[52:55]
MF a[116:119],v[156:159],v[116:119],a[116:119]
MF a[56:59],v[140:143],v[120:123],a[56:59]
MF a[120:123],v[156:159],v[120:123],a[120:123]
MF a[60:63],v[140:143],v[124:127],a[60:63]
MF a[124:127],v[156:159],v[124:127],a[124:127]
s_nop 7
v_lshrrev_b32 v4,7,v0
v_mul_u32_u24 v4,229376,v4
v_add_u32 v4,v4,v3
v_bfe_u32 v5,v0,6,1
v_lshlrev_b32 v5,11,v5
v_add_u32 v4,v4,v5
s_lshl_b32 s45,s33,12
AR v160,a0
AR v168,a64
AR v161,a1
AR v169,a65
AR v162,a2
AR v170,a66
AR v163,a3
AR v171,a67
AR v164,a16
AR v172,a80
AR v165,a17
AR v173,a81
AR v166,a18
AR v174,a82
AR v167,a19
AR v175,a83
v_max_f32 v160,0,v160
v_max_f32 v161,0,v161
v_max_f32 v162,0,v162
v_max_f32 v163,0,v163
v_max_f32 v164,0,v164
v_max_f32 v165,0,v165
v_max_f32 v166,0,v166
v_max_f32 v167,0,v167
FM v160,v160,v168
FM v161,v161,v169
FM v162,v162,v170
FM v163,v163,v171
FM v164,v164,v172
FM v165,v165,v173
FM v166,v166,v174
FM v167,v167,v175
CV v176,v160,v161
CV v177,v162,v163
CV v178,v164,v165
CV v179,v166,v167
SA s53,s45,0
BS v[176:179],v4,s[20:23],s53 offen sc1
AR v184,a32
AR v192,a96
AR v185,a33
AR v193,a97
AR v186,a34
AR v194,a98
AR v187,a35
AR v195,a99
AR v188,a48
AR v196,a112
AR v189,a49
AR v197,a113
AR v190,a50
AR v198,a114
AR v191,a51
AR v199,a115
v_max_f32 v184,0,v184
v_max_f32 v185,0,v185
v_max_f32 v186,0,v186
v_max_f32 v187,0,v187
v_max_f32 v188,0,v188
v_max_f32 v189,0,v189
v_max_f32 v190,0,v190
v_max_f32 v191,0,v191
FM v184,v184,v192
FM v185,v185,v193
FM v186,v186,v194
FM v187,v187,v195
FM v188,v188,v196
FM v189,v189,v197
FM v190,v190,v198
FM v191,v191,v199
CV v200,v184,v185
CV v201,v186,v187
CV v202,v188,v189
CV v203,v190,v191
SA s53,s45,1024
BS v[200:203],v4,s[20:23],s53 offen sc1
AR v160,a4
AR v168,a68
AR v161,a5
AR v169,a69
AR v162,a6
AR v170,a70
AR v163,a7
AR v171,a71
AR v164,a20
AR v172,a84
AR v165,a21
AR v173,a85
AR v166,a22
AR v174,a86
AR v167,a23
AR v175,a87
v_max_f32 v160,0,v160
v_max_f32 v161,0,v161
v_max_f32 v162,0,v162
v_max_f32 v163,0,v163
v_max_f32 v164,0,v164
v_max_f32 v165,0,v165
v_max_f32 v166,0,v166
v_max_f32 v167,0,v167
FM v160,v160,v168
FM v161,v161,v169
FM v162,v162,v170
FM v163,v163,v171
FM v164,v164,v172
FM v165,v165,v173
FM v166,v166,v174
FM v167,v167,v175
CV v176,v160,v161
CV v177,v162,v163
CV v178,v164,v165
CV v179,v166,v167
SA s53,s45,57344
BS v[176:179],v4,s[20:23],s53 offen sc1
AR v184,a36
AR v192,a100
AR v185,a37
AR v193,a101
AR v186,a38
AR v194,a102
AR v187,a39
AR v195,a103
AR v188,a52
AR v196,a116
AR v189,a53
AR v197,a117
AR v190,a54
AR v198,a118
AR v191,a55
AR v199,a119
v_max_f32 v184,0,v184
v_max_f32 v185,0,v185
v_max_f32 v186,0,v186
v_max_f32 v187,0,v187
v_max_f32 v188,0,v188
v_max_f32 v189,0,v189
v_max_f32 v190,0,v190
v_max_f32 v191,0,v191
FM v184,v184,v192
FM v185,v185,v193
FM v186,v186,v194
FM v187,v187,v195
FM v188,v188,v196
FM v189,v189,v197
FM v190,v190,v198
FM v191,v191,v199
CV v200,v184,v185
CV v201,v186,v187
CV v202,v188,v189
CV v203,v190,v191
SA s53,s45,58368
BS v[200:203],v4,s[20:23],s53 offen sc1
AR v160,a8
AR v168,a72
AR v161,a9
AR v169,a73
AR v162,a10
AR v170,a74
AR v163,a11
AR v171,a75
AR v164,a24
AR v172,a88
AR v165,a25
AR v173,a89
AR v166,a26
AR v174,a90
AR v167,a27
AR v175,a91
v_max_f32 v160,0,v160
v_max_f32 v161,0,v161
v_max_f32 v162,0,v162
v_max_f32 v163,0,v163
v_max_f32 v164,0,v164
v_max_f32 v165,0,v165
v_max_f32 v166,0,v166
v_max_f32 v167,0,v167
FM v160,v160,v168
FM v161,v161,v169
FM v162,v162,v170
FM v163,v163,v171
FM v164,v164,v172
FM v165,v165,v173
FM v166,v166,v174
FM v167,v167,v175
CV v176,v160,v161
CV v177,v162,v163
CV v178,v164,v165
CV v179,v166,v167
SA s53,s45,114688
BS v[176:179],v4,s[20:23],s53 offen sc1
AR v184,a40
AR v192,a104
AR v185,a41
AR v193,a105
AR v186,a42
AR v194,a106
AR v187,a43
AR v195,a107
AR v188,a56
AR v196,a120
AR v189,a57
AR v197,a121
AR v190,a58
AR v198,a122
AR v191,a59
AR v199,a123
v_max_f32 v184,0,v184
v_max_f32 v185,0,v185
v_max_f32 v186,0,v186
v_max_f32 v187,0,v187
v_max_f32 v188,0,v188
v_max_f32 v189,0,v189
v_max_f32 v190,0,v190
v_max_f32 v191,0,v191
FM v184,v184,v192
FM v185,v185,v193
FM v186,v186,v194
FM v187,v187,v195
FM v188,v188,v196
FM v189,v189,v197
FM v190,v190,v198
FM v191,v191,v199
CV v200,v184,v185
CV v201,v186,v187
CV v202,v188,v189
CV v203,v190,v191
SA s53,s45,115712
BS v[200:203],v4,s[20:23],s53 offen sc1
AR v160,a12
AR v168,a76
AR v161,a13
AR v169,a77
AR v162,a14
AR v170,a78
AR v163,a15
AR v171,a79
AR v164,a28
AR v172,a92
AR v165,a29
AR v173,a93
AR v166,a30
AR v174,a94
AR v167,a31
AR v175,a95
v_max_f32 v160,0,v160
v_max_f32 v161,0,v161
v_max_f32 v162,0,v162
v_max_f32 v163,0,v163
v_max_f32 v164,0,v164
v_max_f32 v165,0,v165
v_max_f32 v166,0,v166
v_max_f32 v167,0,v167
FM v160,v160,v168
FM v161,v161,v169
FM v162,v162,v170
FM v163,v163,v171
FM v164,v164,v172
FM v165,v165,v173
FM v166,v166,v174
FM v167,v167,v175
CV v176,v160,v161
CV v177,v162,v163
CV v178,v164,v165
CV v179,v166,v167
SA s53,s45,172032
BS v[176:179],v4,s[20:23],s53 offen sc1
AR v184,a44
AR v192,a108
AR v185,a45
AR v193,a109
AR v186,a46
AR v194,a110
AR v187,a47
AR v195,a111
AR v188,a60
AR v196,a124
AR v189,a61
AR v197,a125
AR v190,a62
AR v198,a126
AR v191,a63
AR v199,a127
v_max_f32 v184,0,v184
v_max_f32 v185,0,v185
v_max_f32 v186,0,v186
v_max_f32 v187,0,v187
v_max_f32 v188,0,v188
v_max_f32 v189,0,v189
v_max_f32 v190,0,v190
v_max_f32 v191,0,v191
FM v184,v184,v192
FM v185,v185,v193
FM v186,v186,v194
FM v187,v187,v195
FM v188,v188,v196
FM v189,v189,v197
FM v190,v190,v198
FM v191,v191,v199
CV v200,v184,v185
CV v201,v186,v187
CV v202,v188,v189
CV v203,v190,v191
SA s53,s45,173056
BS v[200:203],v4,s[20:23],s53 offen sc1
s_cmp_ge_u32 s33,7
s_cselect_b32 s45,1,0
s_lshl_b32 s54,s43,1
SA s54,s54,s45
s_mul_i32 s45,s45,7
s_sub_u32 s55,s33,s45
v_and_b32 v1,63,v0
v_lshlrev_b32 v3,4,v1
v_lshrrev_b32 v4,3,v1
v_bfe_u32 v5,v4,1,2
v_lshlrev_b32 v5,1,v5
v_and_b32 v6,7,v1
v_xor_b32 v5,v5,v6
v_lshlrev_b32 v5,4,v5
v_mul_u32_u24 v4,896,v4
v_add_u32 v4,v4,v5
v_add_u32 v16,0,v4
v_add_u32 v17,6144,v4
v_add_u32 v18,12288,v4
v_add_u32 v19,18432,v4
s_mul_i32 s45,s54,229376
s_mul_i32 s46,s32,14336
SA s45,s45,s46
SA s45,s45,109051904
SA s8,s4,s45
s_addc_u32 s9,s5,0
s_mov_b32 s10,229376
s_mov_b32 s11,0x20000
s_sub_u32 s10,s10,s46
s_mul_i32 s45,s32,401408
s_lshl_b32 s46,s55,7
SA s45,s45,s46
SA s12,s68,s45
s_addc_u32 s13,s69,0
s_mov_b32 s14,1605632
s_mov_b32 s15,0x20000
s_sub_u32 s14,s14,s45
s_mul_i32 s52,s32,40960
v_bfe_u32 v4,v1,4,2
v_lshlrev_b32 v4,2,v4
v_bfe_u32 v5,v1,2,2
v_add_u32 v4,v4,v5
v_bfe_u32 v5,v4,1,2
v_lshlrev_b32 v4,7,v4
v_and_b32 v6,3,v1
v_lshlrev_b32 v6,3,v6
v_add_u32 v4,v4,v6
v_add_u32 v4,s52,v4
v_xor_b32 v7,0,v5
v_lshlrev_b32 v7,5,v7
v_add_u32 v20,v4,v7
v_xor_b32 v7,1,v5
v_lshlrev_b32 v7,5,v7
v_add_u32 v21,v4,v7
v_xor_b32 v7,2,v5
v_lshlrev_b32 v7,5,v7
v_add_u32 v22,v4,v7
v_xor_b32 v7,3,v5
v_lshlrev_b32 v7,5,v7
v_add_u32 v23,v4,v7
WT vmcnt(0)
s_barrier
s_cmp_lg_u32 s32,0
s_cbranch_scc1 tl_sig3
s_mul_i32 s45,s43,384
SA s45,s45,16640
s_lshl_b32 s46,s33,2
SA s45,s45,s46
v_mov_b32 v42,1
v_mov_b32 v43,s45
s_mov_b64 exec,1
buffer_store_dword v42,v43,s[28:31],0 offen sc1
s_mov_b64 exec,-1
tl_sig3:
SA m0,s52,0
s_mov_b32 s53,0
BL v16,s[12:15],s53 offen lds
BL v17,s[12:15],s53 offen offset:1024 lds
BL v18,s[12:15],s53 offen offset:2048 lds
BL v19,s[12:15],s53 offen offset:3072 lds
SA m0,s52,4096
s_mov_b32 s53,28672
BL v16,s[12:15],s53 offen lds
BL v17,s[12:15],s53 offen offset:1024 lds
BL v18,s[12:15],s53 offen offset:2048 lds
BL v19,s[12:15],s53 offen offset:3072 lds
SA m0,s52,8192
s_mov_b32 s53,57344
BL v16,s[12:15],s53 offen lds
BL v17,s[12:15],s53 offen offset:1024 lds
BL v18,s[12:15],s53 offen offset:2048 lds
BL v19,s[12:15],s53 offen offset:3072 lds
SA m0,s52,12288
s_mov_b32 s53,86016
BL v16,s[12:15],s53 offen lds
BL v17,s[12:15],s53 offen offset:1024 lds
BL v18,s[12:15],s53 offen offset:2048 lds
BL v19,s[12:15],s53 offen offset:3072 lds
SA m0,s52,16384
s_mov_b32 s53,114688
BL v16,s[12:15],s53 offen lds
BL v17,s[12:15],s53 offen offset:1024 lds
BL v18,s[12:15],s53 offen offset:2048 lds
BL v19,s[12:15],s53 offen offset:3072 lds
s_cmp_lg_u32 s32,0
s_cbranch_scc1 tl_w3
s_mul_i32 s45,s43,384
SA s45,s45,16640
v_lshlrev_b32 v43,2,v0
v_add_u32 v43,s45,v43
s_mov_b32 s46,0
s_mov_b64 exec,16383
tl_p3:
buffer_load_dword v42,v43,s[28:31],0 offen sc1
WT vmcnt(0)
v_cmp_ne_u32 vcc,0,v42
s_nop 0
s_cmp_eq_u32 vcc_lo,16383
s_cbranch_scc1 tl_p3_ok
s_sleep 1
SA s46,s46,1
s_cmp_lt_u32 s46,262144
s_cbranch_scc1 tl_p3
v_mov_b32 v42,47830
v_mov_b32 v43,32000
buffer_store_dword v42,v43,s[28:31],0 offen
tl_p3_ok:
s_mov_b64 exec,-1
tl_w3:
s_barrier
s_mov_b32 s53,0
BL v[64:67],v3,s[8:11],s53 offen
s_mov_b32 s53,57344
BL v[68:71],v3,s[8:11],s53 offen
s_mov_b32 s53,114688
BL v[72:75],v3,s[8:11],s53 offen
s_mov_b32 s53,172032
BL v[76:79],v3,s[8:11],s53 offen
s_mov_b32 s53,1024
BL v[80:83],v3,s[8:11],s53 offen
s_mov_b32 s53,58368
BL v[84:87],v3,s[8:11],s53 offen
s_mov_b32 s53,115712
BL v[88:91],v3,s[8:11],s53 offen
s_mov_b32 s53,173056
BL v[92:95],v3,s[8:11],s53 offen
s_mov_b32 s53,2048
BL v[96:99],v3,s[8:11],s53 offen
s_mov_b32 s53,59392
BL v[100:103],v3,s[8:11],s53 offen
s_mov_b32 s53,116736
BL v[104:107],v3,s[8:11],s53 offen
s_mov_b32 s53,174080
BL v[108:111],v3,s[8:11],s53 offen
s_mov_b32 s53,3072
BL v[112:115],v3,s[8:11],s53 offen
s_mov_b32 s53,60416
BL v[116:119],v3,s[8:11],s53 offen
s_mov_b32 s53,117760
BL v[120:123],v3,s[8:11],s53 offen
s_mov_b32 s53,175104
BL v[124:127],v3,s[8:11],s53 offen
s_mov_b32 s53,4096
BL v[128:131],v3,s[8:11],s53 offen
s_mov_b32 s53,61440
BL v[132:135],v3,s[8:11],s53 offen
s_mov_b32 s53,118784
BL v[136:139],v3,s[8:11],s53 offen
s_mov_b32 s53,176128
BL v[140:143],v3,s[8:11],s53 offen
s_mov_b32 s53,5120
BL v[144:147],v3,s[8:11],s53 offen
s_mov_b32 s53,62464
BL v[148:151],v3,s[8:11],s53 offen
s_mov_b32 s53,119808
BL v[152:155],v3,s[8:11],s53 offen
s_mov_b32 s53,177152
BL v[156:159],v3,s[8:11],s53 offen
s_mov_b32 s53,6144
BL v[160:163],v3,s[8:11],s53 offen
s_mov_b32 s53,63488
BL v[164:167],v3,s[8:11],s53 offen
s_mov_b32 s53,120832
BL v[168:171],v3,s[8:11],s53 offen
s_mov_b32 s53,178176
BL v[172:175],v3,s[8:11],s53 offen
SA m0,s52,20480
s_mov_b32 s53,143360
BL v16,s[12:15],s53 offen lds
BL v17,s[12:15],s53 offen offset:1024 lds
BL v18,s[12:15],s53 offen offset:2048 lds
BL v19,s[12:15],s53 offen offset:3072 lds
SA s16,s4,104857600
s_addc_u32 s17,s5,0
s_mov_b32 s18,1835008
s_mov_b32 s19,0x20000
s_lshl_b32 s45,s54,2
SA s45,s45,s32
s_mul_i32 s45,s45,14336
s_lshl_b32 s46,s55,11
SA s45,s45,s46
BL v[24:27],v3,s[16:19],s45 offen
BL v[28:31],v3,s[16:19],s45 offen offset:1024
WT vmcnt(30)
DT v[192:193],v20 offset:0
DT v[194:195],v20 offset:2048
DT v[196:197],v21 offset:0
DT v[198:199],v21 offset:2048
DT v[200:201],v22 offset:0
DT v[202:203],v22 offset:2048
DT v[204:205],v23 offset:0
DT v[206:207],v23 offset:2048
WT vmcnt(26) lgkmcnt(0)
MF a[0:3],v[192:195],v[64:67],0
DT v[208:209],v20 offset:4096
MF a[4:7],v[192:195],v[68:71],0
DT v[210:211],v20 offset:6144
MF a[8:11],v[192:195],v[72:75],0
DT v[212:213],v21 offset:4096
MF a[12:15],v[192:195],v[76:79],0
DT v[214:215],v21 offset:6144
MF a[16:19],v[196:199],v[64:67],0
DT v[216:217],v22 offset:4096
MF a[20:23],v[196:199],v[68:71],0
DT v[218:219],v22 offset:6144
MF a[24:27],v[196:199],v[72:75],0
DT v[220:221],v23 offset:4096
MF a[28:31],v[196:199],v[76:79],0
DT v[222:223],v23 offset:6144
MF a[32:35],v[200:203],v[64:67],0
SA m0,s52,24576
s_mov_b32 s53,172032
BL v16,s[12:15],s53 offen lds
MF a[36:39],v[200:203],v[68:71],0
BL v17,s[12:15],s53 offen offset:1024 lds
MF a[40:43],v[200:203],v[72:75],0
BL v18,s[12:15],s53 offen offset:2048 lds
MF a[44:47],v[200:203],v[76:79],0
BL v19,s[12:15],s53 offen offset:3072 lds
MF a[48:51],v[204:207],v[64:67],0
s_mov_b32 s53,7168
BL v[176:179],v3,s[8:11],s53 offen
MF a[52:55],v[204:207],v[68:71],0
s_mov_b32 s53,64512
BL v[180:183],v3,s[8:11],s53 offen
MF a[56:59],v[204:207],v[72:75],0
s_mov_b32 s53,121856
BL v[184:187],v3,s[8:11],s53 offen
MF a[60:63],v[204:207],v[76:79],0
s_mov_b32 s53,179200
BL v[188:191],v3,s[8:11],s53 offen
WT vmcnt(30) lgkmcnt(0)
MF a[0:3],v[208:211],v[80:83],a[0:3]
DT v[192:193],v20 offset:8192
MF a[4:7],v[208:211],v[84:87],a[4:7]
DT v[194:195],v20 offset:10240
MF a[8:11],v[208:211],v[88:91],a[8:11]
DT v[196:197],v21 offset:8192
MF a[12:15],v[208:211],v[92:95],a[12:15]
DT v[198:199],v21 offset:10240
MF a[16:19],v[212:215],v[80:83],a[16:19]
DT v[200:201],v22 offset:8192
MF a[20:23],v[212:215],v[84:87],a[20:23]
DT v[202:203],v22 offset:10240
MF a[24:27],v[212:215],v[88:91],a[24:27]
DT v[204:205],v23 offset:8192
MF a[28:31],v[212:215],v[92:95],a[28:31]
DT v[206:207],v23 offset:10240
MF a[32:35],v[216:219],v[80:83],a[32:35]
SA m0,s52,28672
s_mov_b32 s53,200704
BL v16,s[12:15],s53 offen lds
MF a[36:39],v[216:219],v[84:87],a[36:39]
BL v17,s[12:15],s53 offen offset:1024 lds
MF a[40:43],v[216:219],v[88:91],a[40:43]
BL v18,s[12:15],s53 offen offset:2048 lds
MF a[44:47],v[216:219],v[92:95],a[44:47]
BL v19,s[12:15],s53 offen offset:3072 lds
MF a[48:51],v[220:223],v[80:83],a[48:51]
s_mov_b32 s53,8192
BL v[64:67],v3,s[8:11],s53 offen
MF a[52:55],v[220:223],v[84:87],a[52:55]
s_mov_b32 s53,65536
BL v[68:71],v3,s[8:11],s53 offen
MF a[56:59],v[220:223],v[88:91],a[56:59]
s_mov_b32 s53,122880
BL v[72:75],v3,s[8:11],s53 offen
MF a[60:63],v[220:223],v[92:95],a[60:63]
s_mov_b32 s53,180224
BL v[76:79],v3,s[8:11],s53 offen
WT vmcnt(34) lgkmcnt(0)
MF a[0:3],v[192:195],v[96:99],a[0:3]
DT v[208:209],v20 offset:12288
MF a[4:7],v[192:195],v[100:103],a[4:7]
DT v[210:211],v20 offset:14336
MF a[8:11],v[192:195],v[104:107],a[8:11]
DT v[212:213],v21 offset:12288
MF a[12:15],v[192:195],v[108:111],a[12:15]
DT v[214:215],v21 offset:14336
MF a[16:19],v[196:199],v[96:99],a[16:19]
DT v[216:217],v22 offset:12288
MF a[20:23],v[196:199],v[100:103],a[20:23]
DT v[218:219],v22 offset:14336
MF a[24:27],v[196:199],v[104:107],a[24:27]
DT v[220:221],v23 offset:12288
MF a[28:31],v[196:199],v[108:111],a[28:31]
DT v[222:223],v23 offset:14336
MF a[32:35],v[200:203],v[96:99],a[32:35]
SA m0,s52,32768
s_mov_b32 s53,229376
BL v16,s[12:15],s53 offen lds
MF a[36:39],v[200:203],v[100:103],a[36:39]
BL v17,s[12:15],s53 offen offset:1024 lds
MF a[40:43],v[200:203],v[104:107],a[40:43]
BL v18,s[12:15],s53 offen offset:2048 lds
MF a[44:47],v[200:203],v[108:111],a[44:47]
BL v19,s[12:15],s53 offen offset:3072 lds
MF a[48:51],v[204:207],v[96:99],a[48:51]
s_mov_b32 s53,9216
BL v[80:83],v3,s[8:11],s53 offen
MF a[52:55],v[204:207],v[100:103],a[52:55]
s_mov_b32 s53,66560
BL v[84:87],v3,s[8:11],s53 offen
MF a[56:59],v[204:207],v[104:107],a[56:59]
s_mov_b32 s53,123904
BL v[88:91],v3,s[8:11],s53 offen
MF a[60:63],v[204:207],v[108:111],a[60:63]
s_mov_b32 s53,181248
BL v[92:95],v3,s[8:11],s53 offen
WT vmcnt(38) lgkmcnt(0)
MF a[0:3],v[208:211],v[112:115],a[0:3]
DT v[192:193],v20 offset:16384
MF a[4:7],v[208:211],v[116:119],a[4:7]
DT v[194:195],v20 offset:18432
MF a[8:11],v[208:211],v[120:123],a[8:11]
DT v[196:197],v21 offset:16384
MF a[12:15],v[208:211],v[124:127],a[12:15]
DT v[198:199],v21 offset:18432
MF a[16:19],v[212:215],v[112:115],a[16:19]
DT v[200:201],v22 offset:16384
MF a[20:23],v[212:215],v[116:119],a[20:23]
DT v[202:203],v22 offset:18432
MF a[24:27],v[212:215],v[120:123],a[24:27]
DT v[204:205],v23 offset:16384
MF a[28:31],v[212:215],v[124:127],a[28:31]
DT v[206:207],v23 offset:18432
MF a[32:35],v[216:219],v[112:115],a[32:35]
SA m0,s52,36864
s_mov_b32 s53,258048
BL v16,s[12:15],s53 offen lds
MF a[36:39],v[216:219],v[116:119],a[36:39]
BL v17,s[12:15],s53 offen offset:1024 lds
MF a[40:43],v[216:219],v[120:123],a[40:43]
BL v18,s[12:15],s53 offen offset:2048 lds
MF a[44:47],v[216:219],v[124:127],a[44:47]
BL v19,s[12:15],s53 offen offset:3072 lds
MF a[48:51],v[220:223],v[112:115],a[48:51]
s_mov_b32 s53,10240
BL v[96:99],v3,s[8:11],s53 offen
MF a[52:55],v[220:223],v[116:119],a[52:55]
s_mov_b32 s53,67584
BL v[100:103],v3,s[8:11],s53 offen
MF a[56:59],v[220:223],v[120:123],a[56:59]
s_mov_b32 s53,124928
BL v[104:107],v3,s[8:11],s53 offen
MF a[60:63],v[220:223],v[124:127],a[60:63]
s_mov_b32 s53,182272
BL v[108:111],v3,s[8:11],s53 offen
WT vmcnt(34) lgkmcnt(0)
MF a[0:3],v[192:195],v[128:131],a[0:3]
DT v[208:209],v20 offset:20480
MF a[4:7],v[192:195],v[132:135],a[4:7]
DT v[210:211],v20 offset:22528
MF a[8:11],v[192:195],v[136:139],a[8:11]
DT v[212:213],v21 offset:20480
MF a[12:15],v[192:195],v[140:143],a[12:15]
DT v[214:215],v21 offset:22528
MF a[16:19],v[196:199],v[128:131],a[16:19]
DT v[216:217],v22 offset:20480
MF a[20:23],v[196:199],v[132:135],a[20:23]
DT v[218:219],v22 offset:22528
MF a[24:27],v[196:199],v[136:139],a[24:27]
DT v[220:221],v23 offset:20480
MF a[28:31],v[196:199],v[140:143],a[28:31]
DT v[222:223],v23 offset:22528
MF a[32:35],v[200:203],v[128:131],a[32:35]
SA m0,s52,0
s_mov_b32 s53,286720
BL v16,s[12:15],s53 offen lds
MF a[36:39],v[200:203],v[132:135],a[36:39]
BL v17,s[12:15],s53 offen offset:1024 lds
MF a[40:43],v[200:203],v[136:139],a[40:43]
BL v18,s[12:15],s53 offen offset:2048 lds
MF a[44:47],v[200:203],v[140:143],a[44:47]
BL v19,s[12:15],s53 offen offset:3072 lds
MF a[48:51],v[204:207],v[128:131],a[48:51]
s_mov_b32 s53,11264
BL v[112:115],v3,s[8:11],s53 offen
MF a[52:55],v[204:207],v[132:135],a[52:55]
s_mov_b32 s53,68608
BL v[116:119],v3,s[8:11],s53 offen
MF a[56:59],v[204:207],v[136:139],a[56:59]
s_mov_b32 s53,125952
BL v[120:123],v3,s[8:11],s53 offen
MF a[60:63],v[204:207],v[140:143],a[60:63]
s_mov_b32 s53,183296
BL v[124:127],v3,s[8:11],s53 offen
WT vmcnt(36) lgkmcnt(0)
MF a[0:3],v[208:211],v[144:147],a[0:3]
DT v[192:193],v20 offset:24576
MF a[4:7],v[208:211],v[148:151],a[4:7]
DT v[194:195],v20 offset:26624
MF a[8:11],v[208:211],v[152:155],a[8:11]
DT v[196:197],v21 offset:24576
MF a[12:15],v[208:211],v[156:159],a[12:15]
DT v[198:199],v21 offset:26624
MF a[16:19],v[212:215],v[144:147],a[16:19]
DT v[200:201],v22 offset:24576
MF a[20:23],v[212:215],v[148:151],a[20:23]
DT v[202:203],v22 offset:26624
MF a[24:27],v[212:215],v[152:155],a[24:27]
DT v[204:205],v23 offset:24576
MF a[28:31],v[212:215],v[156:159],a[28:31]
DT v[206:207],v23 offset:26624
MF a[32:35],v[216:219],v[144:147],a[32:35]
SA m0,s52,4096
s_mov_b32 s53,315392
BL v16,s[12:15],s53 offen lds
MF a[36:39],v[216:219],v[148:151],a[36:39]
BL v17,s[12:15],s53 offen offset:1024 lds
MF a[40:43],v[216:219],v[152:155],a[40:43]
BL v18,s[12:15],s53 offen offset:2048 lds
MF a[44:47],v[216:219],v[156:159],a[44:47]
BL v19,s[12:15],s53 offen offset:3072 lds
MF a[48:51],v[220:223],v[144:147],a[48:51]
s_mov_b32 s53,12288
BL v[128:131],v3,s[8:11],s53 offen
MF a[52:55],v[220:223],v[148:151],a[52:55]
s_mov_b32 s53,69632
BL v[132:135],v3,s[8:11],s53 offen
MF a[56:59],v[220:223],v[152:155],a[56:59]
s_mov_b32 s53,126976
BL v[136:139],v3,s[8:11],s53 offen
MF a[60:63],v[220:223],v[156:159],a[60:63]
s_mov_b32 s53,184320
BL v[140:143],v3,s[8:11],s53 offen
WT vmcnt(36) lgkmcnt(0)
MF a[0:3],v[192:195],v[160:163],a[0:3]
DT v[208:209],v20 offset:28672
MF a[4:7],v[192:195],v[164:167],a[4:7]
DT v[210:211],v20 offset:30720
MF a[8:11],v[192:195],v[168:171],a[8:11]
DT v[212:213],v21 offset:28672
MF a[12:15],v[192:195],v[172:175],a[12:15]
DT v[214:215],v21 offset:30720
MF a[16:19],v[196:199],v[160:163],a[16:19]
DT v[216:217],v22 offset:28672
MF a[20:23],v[196:199],v[164:167],a[20:23]
DT v[218:219],v22 offset:30720
MF a[24:27],v[196:199],v[168:171],a[24:27]
DT v[220:221],v23 offset:28672
MF a[28:31],v[196:199],v[172:175],a[28:31]
DT v[222:223],v23 offset:30720
MF a[32:35],v[200:203],v[160:163],a[32:35]
SA m0,s52,8192
s_mov_b32 s53,344064
BL v16,s[12:15],s53 offen lds
MF a[36:39],v[200:203],v[164:167],a[36:39]
BL v17,s[12:15],s53 offen offset:1024 lds
MF a[40:43],v[200:203],v[168:171],a[40:43]
BL v18,s[12:15],s53 offen offset:2048 lds
MF a[44:47],v[200:203],v[172:175],a[44:47]
BL v19,s[12:15],s53 offen offset:3072 lds
MF a[48:51],v[204:207],v[160:163],a[48:51]
s_mov_b32 s53,13312
BL v[144:147],v3,s[8:11],s53 offen
MF a[52:55],v[204:207],v[164:167],a[52:55]
s_mov_b32 s53,70656
BL v[148:151],v3,s[8:11],s53 offen
MF a[56:59],v[204:207],v[168:171],a[56:59]
s_mov_b32 s53,128000
BL v[152:155],v3,s[8:11],s53 offen
MF a[60:63],v[204:207],v[172:175],a[60:63]
s_mov_b32 s53,185344
BL v[156:159],v3,s[8:11],s53 offen
WT vmcnt(36) lgkmcnt(0)
MF a[0:3],v[208:211],v[176:179],a[0:3]
DT v[192:193],v20 offset:32768
MF a[4:7],v[208:211],v[180:183],a[4:7]
DT v[194:195],v20 offset:34816
MF a[8:11],v[208:211],v[184:187],a[8:11]
DT v[196:197],v21 offset:32768
MF a[12:15],v[208:211],v[188:191],a[12:15]
DT v[198:199],v21 offset:34816
MF a[16:19],v[212:215],v[176:179],a[16:19]
DT v[200:201],v22 offset:32768
MF a[20:23],v[212:215],v[180:183],a[20:23]
DT v[202:203],v22 offset:34816
MF a[24:27],v[212:215],v[184:187],a[24:27]
DT v[204:205],v23 offset:32768
MF a[28:31],v[212:215],v[188:191],a[28:31]
DT v[206:207],v23 offset:34816
MF a[32:35],v[216:219],v[176:179],a[32:35]
SA m0,s52,12288
s_mov_b32 s53,372736
BL v16,s[12:15],s53 offen lds
MF a[36:39],v[216:219],v[180:183],a[36:39]
BL v17,s[12:15],s53 offen offset:1024 lds
MF a[40:43],v[216:219],v[184:187],a[40:43]
BL v18,s[12:15],s53 offen offset:2048 lds
MF a[44:47],v[216:219],v[188:191],a[44:47]
BL v19,s[12:15],s53 offen offset:3072 lds
MF a[48:51],v[220:223],v[176:179],a[48:51]
MF a[52:55],v[220:223],v[180:183],a[52:55]
MF a[56:59],v[220:223],v[184:187],a[56:59]
MF a[60:63],v[220:223],v[188:191],a[60:63]
WT vmcnt(32) lgkmcnt(0)
MF a[0:3],v[192:195],v[64:67],a[0:3]
DT v[208:209],v20 offset:36864
MF a[4:7],v[192:195],v[68:71],a[4:7]
DT v[210:211],v20 offset:38912
MF a[8:11],v[192:195],v[72:75],a[8:11]
DT v[212:213],v21 offset:36864
MF a[12:15],v[192:195],v[76:79],a[12:15]
DT v[214:215],v21 offset:38912
MF a[16:19],v[196:199],v[64:67],a[16:19]
DT v[216:217],v22 offset:36864
MF a[20:23],v[196:199],v[68:71],a[20:23]
DT v[218:219],v22 offset:38912
MF a[24:27],v[196:199],v[72:75],a[24:27]
DT v[220:221],v23 offset:36864
MF a[28:31],v[196:199],v[76:79],a[28:31]
DT v[222:223],v23 offset:38912
MF a[32:35],v[200:203],v[64:67],a[32:35]
MF a[36:39],v[200:203],v[68:71],a[36:39]
MF a[40:43],v[200:203],v[72:75],a[40:43]
MF a[44:47],v[200:203],v[76:79],a[44:47]
MF a[48:51],v[204:207],v[64:67],a[48:51]
MF a[52:55],v[204:207],v[68:71],a[52:55]
MF a[56:59],v[204:207],v[72:75],a[56:59]
MF a[60:63],v[204:207],v[76:79],a[60:63]
WT vmcnt(24) lgkmcnt(0)
MF a[0:3],v[208:211],v[80:83],a[0:3]
DT v[192:193],v20 offset:0
MF a[4:7],v[208:211],v[84:87],a[4:7]
DT v[194:195],v20 offset:2048
MF a[8:11],v[208:211],v[88:91],a[8:11]
DT v[196:197],v21 offset:0
MF a[12:15],v[208:211],v[92:95],a[12:15]
DT v[198:199],v21 offset:2048
MF a[16:19],v[212:215],v[80:83],a[16:19]
DT v[200:201],v22 offset:0
MF a[20:23],v[212:215],v[84:87],a[20:23]
DT v[202:203],v22 offset:2048
MF a[24:27],v[212:215],v[88:91],a[24:27]
DT v[204:205],v23 offset:0
MF a[28:31],v[212:215],v[92:95],a[28:31]
DT v[206:207],v23 offset:2048
MF a[32:35],v[216:219],v[80:83],a[32:35]
MF a[36:39],v[216:219],v[84:87],a[36:39]
MF a[40:43],v[216:219],v[88:91],a[40:43]
MF a[44:47],v[216:219],v[92:95],a[44:47]
MF a[48:51],v[220:223],v[80:83],a[48:51]
MF a[52:55],v[220:223],v[84:87],a[52:55]
MF a[56:59],v[220:223],v[88:91],a[56:59]
MF a[60:63],v[220:223],v[92:95],a[60:63]
WT vmcnt(16) lgkmcnt(0)
MF a[0:3],v[192:195],v[96:99],a[0:3]
DT v[208:209],v20 offset:4096
MF a[4:7],v[192:195],v[100:103],a[4:7]
DT v[210:211],v20 offset:6144
MF a[8:11],v[192:195],v[104:107],a[8:11]
DT v[212:213],v21 offset:4096
MF a[12:15],v[192:195],v[108:111],a[12:15]
DT v[214:215],v21 offset:6144
MF a[16:19],v[196:199],v[96:99],a[16:19]
DT v[216:217],v22 offset:4096
MF a[20:23],v[196:199],v[100:103],a[20:23]
DT v[218:219],v22 offset:6144
MF a[24:27],v[196:199],v[104:107],a[24:27]
DT v[220:221],v23 offset:4096
MF a[28:31],v[196:199],v[108:111],a[28:31]
DT v[222:223],v23 offset:6144
MF a[32:35],v[200:203],v[96:99],a[32:35]
MF a[36:39],v[200:203],v[100:103],a[36:39]
MF a[40:43],v[200:203],v[104:107],a[40:43]
MF a[44:47],v[200:203],v[108:111],a[44:47]
MF a[48:51],v[204:207],v[96:99],a[48:51]
MF a[52:55],v[204:207],v[100:103],a[52:55]
MF a[56:59],v[204:207],v[104:107],a[56:59]
MF a[60:63],v[204:207],v[108:111],a[60:63]
WT vmcnt(8) lgkmcnt(0)
MF a[0:3],v[208:211],v[112:115],a[0:3]
DT v[192:193],v20 offset:8192
MF a[4:7],v[208:211],v[116:119],a[4:7]
DT v[194:195],v20 offset:10240
MF a[8:11],v[208:211],v[120:123],a[8:11]
DT v[196:197],v21 offset:8192
MF a[12:15],v[208:211],v[124:127],a[12:15]
DT v[198:199],v21 offset:10240
MF a[16:19],v[212:215],v[112:115],a[16:19]
DT v[200:201],v22 offset:8192
MF a[20:23],v[212:215],v[116:119],a[20:23]
DT v[202:203],v22 offset:10240
MF a[24:27],v[212:215],v[120:123],a[24:27]
DT v[204:205],v23 offset:8192
MF a[28:31],v[212:215],v[124:127],a[28:31]
DT v[206:207],v23 offset:10240
MF a[32:35],v[216:219],v[112:115],a[32:35]
MF a[36:39],v[216:219],v[116:119],a[36:39]
MF a[40:43],v[216:219],v[120:123],a[40:43]
MF a[44:47],v[216:219],v[124:127],a[44:47]
MF a[48:51],v[220:223],v[112:115],a[48:51]
MF a[52:55],v[220:223],v[116:119],a[52:55]
MF a[56:59],v[220:223],v[120:123],a[56:59]
MF a[60:63],v[220:223],v[124:127],a[60:63]
WT vmcnt(0) lgkmcnt(0)
MF a[0:3],v[192:195],v[128:131],a[0:3]
DT v[208:209],v20 offset:12288
MF a[4:7],v[192:195],v[132:135],a[4:7]
DT v[210:211],v20 offset:14336
MF a[8:11],v[192:195],v[136:139],a[8:11]
DT v[212:213],v21 offset:12288
MF a[12:15],v[192:195],v[140:143],a[12:15]
DT v[214:215],v21 offset:14336
MF a[16:19],v[196:199],v[128:131],a[16:19]
DT v[216:217],v22 offset:12288
MF a[20:23],v[196:199],v[132:135],a[20:23]
DT v[218:219],v22 offset:14336
MF a[24:27],v[196:199],v[136:139],a[24:27]
DT v[220:221],v23 offset:12288
MF a[28:31],v[196:199],v[140:143],a[28:31]
DT v[222:223],v23 offset:14336
MF a[32:35],v[200:203],v[128:131],a[32:35]
MF a[36:39],v[200:203],v[132:135],a[36:39]
MF a[40:43],v[200:203],v[136:139],a[40:43]
MF a[44:47],v[200:203],v[140:143],a[44:47]
MF a[48:51],v[204:207],v[128:131],a[48:51]
MF a[52:55],v[204:207],v[132:135],a[52:55]
MF a[56:59],v[204:207],v[136:139],a[56:59]
MF a[60:63],v[204:207],v[140:143],a[60:63]
WT lgkmcnt(0)
MF a[0:3],v[208:211],v[144:147],a[0:3]
MF a[4:7],v[208:211],v[148:151],a[4:7]
MF a[8:11],v[208:211],v[152:155],a[8:11]
MF a[12:15],v[208:211],v[156:159],a[12:15]
MF a[16:19],v[212:215],v[144:147],a[16:19]
MF a[20:23],v[212:215],v[148:151],a[20:23]
MF a[24:27],v[212:215],v[152:155],a[24:27]
MF a[28:31],v[212:215],v[156:159],a[28:31]
MF a[32:35],v[216:219],v[144:147],a[32:35]
MF a[36:39],v[216:219],v[148:151],a[36:39]
MF a[40:43],v[216:219],v[152:155],a[40:43]
MF a[44:47],v[216:219],v[156:159],a[44:47]
MF a[48:51],v[220:223],v[144:147],a[48:51]
MF a[52:55],v[220:223],v[148:151],a[52:55]
MF a[56:59],v[220:223],v[152:155],a[56:59]
MF a[60:63],v[220:223],v[156:159],a[60:63]
s_nop 7
s_barrier
s_lshl_b32 s45,s32,14
v_add_u32 v4,s45,v3
ds_write_b128 v4,a[0:3] offset:0
ds_write_b128 v4,a[4:7] offset:1024
ds_write_b128 v4,a[8:11] offset:2048
ds_write_b128 v4,a[12:15] offset:3072
ds_write_b128 v4,a[16:19] offset:4096
ds_write_b128 v4,a[20:23] offset:5120
ds_write_b128 v4,a[24:27] offset:6144
ds_write_b128 v4,a[28:31] offset:7168
ds_write_b128 v4,a[32:35] offset:8192
ds_write_b128 v4,a[36:39] offset:9216
ds_write_b128 v4,a[40:43] offset:10240
ds_write_b128 v4,a[44:47] offset:11264
ds_write_b128 v4,a[48:51] offset:12288
ds_write_b128 v4,a[52:55] offset:13312
ds_write_b128 v4,a[56:59] offset:14336
ds_write_b128 v4,a[60:63] offset:15360
WT lgkmcnt(0)
s_barrier
s_lshl_b32 s45,s32,10
v_add_u32 v4,s45,v3
DR v[64:67],v4 offset:0
DR v[68:71],v4 offset:16384
DR v[72:75],v4 offset:32768
DR v[76:79],v4 offset:49152
DR v[80:83],v4 offset:4096
DR v[84:87],v4 offset:20480
DR v[88:91],v4 offset:36864
DR v[92:95],v4 offset:53248
DR v[96:99],v4 offset:8192
DR v[100:103],v4 offset:24576
DR v[104:107],v4 offset:40960
DR v[108:111],v4 offset:57344
DR v[112:115],v4 offset:12288
DR v[116:119],v4 offset:28672
DR v[120:123],v4 offset:45056
DR v[124:127],v4 offset:61440
s_mov_b32 s20,s80
s_mov_b32 s21,s81
s_mov_b32 s22,1835008
s_mov_b32 s23,0x20000
s_lshl_b32 s45,s54,6
s_lshl_b32 s46,s32,4
SA s45,s45,s46
v_and_b32 v4,15,v1
v_add_u32 v4,s45,v4
v_mul_u32_u24 v4,896,v4
v_bfe_u32 v5,v1,4,1
v_lshlrev_b32 v5,5,v5
v_add_u32 v4,v4,v5
v_bfe_u32 v5,v1,5,1
v_lshlrev_b32 v5,4,v5
v_add_u32 v4,v4,v5
s_lshl_b32 s46,s55,7
WT vmcnt(0) lgkmcnt(0)
FA v64,v64,v68
FA v72,v72,v76
FA v65,v65,v69
FA v73,v73,v77
FA v66,v66,v70
FA v74,v74,v78
FA v67,v67,v71
FA v75,v75,v79
FA v64,v64,v72
FA v65,v65,v73
FA v66,v66,v74
FA v67,v67,v75
v_lshlrev_b32 v10,16,v24
v_and_b32 v11,0xffff0000,v24
FA v64,v64,v10
FA v65,v65,v11
v_lshlrev_b32 v10,16,v25
v_and_b32 v11,0xffff0000,v25
FA v66,v66,v10
FA v67,v67,v11
FA v80,v80,v84
FA v88,v88,v92
FA v81,v81,v85
FA v89,v89,v93
FA v82,v82,v86
FA v90,v90,v94
FA v83,v83,v87
FA v91,v91,v95
FA v80,v80,v88
FA v81,v81,v89
FA v82,v82,v90
FA v83,v83,v91
v_lshlrev_b32 v10,16,v26
v_and_b32 v11,0xffff0000,v26
FA v80,v80,v10
FA v81,v81,v11
v_lshlrev_b32 v10,16,v27
v_and_b32 v11,0xffff0000,v27
FA v82,v82,v10
FA v83,v83,v11
FA v96,v96,v100
FA v104,v104,v108
FA v97,v97,v101
FA v105,v105,v109
FA v98,v98,v102
FA v106,v106,v110
FA v99,v99,v103
FA v107,v107,v111
FA v96,v96,v104
FA v97,v97,v105
FA v98,v98,v106
FA v99,v99,v107
v_lshlrev_b32 v10,16,v28
v_and_b32 v11,0xffff0000,v28
FA v96,v96,v10
FA v97,v97,v11
v_lshlrev_b32 v10,16,v29
v_and_b32 v11,0xffff0000,v29
FA v98,v98,v10
FA v99,v99,v11
FA v112,v112,v116
FA v120,v120,v124
FA v113,v113,v117
FA v121,v121,v125
FA v114,v114,v118
FA v122,v122,v126
FA v115,v115,v119
FA v123,v123,v127
FA v112,v112,v120
FA v113,v113,v121
FA v114,v114,v122
FA v115,v115,v123
v_lshlrev_b32 v10,16,v30
v_and_b32 v11,0xffff0000,v30
FA v112,v112,v10
FA v113,v113,v11
v_lshlrev_b32 v10,16,v31
v_and_b32 v11,0xffff0000,v31
FA v114,v114,v10
FA v115,v115,v11
CV v32,v64,v65
CV v33,v66,v67
CV v34,v80,v81
CV v35,v82,v83
s_nop 1
v_permlane16_swap_b32 v32,v34
v_permlane16_swap_b32 v33,v35
s_nop 1
BS v[32:35],v4,s[20:23],s46 offen offset:0
CV v36,v96,v97
CV v37,v98,v99
CV v38,v112,v113
CV v39,v114,v115
s_nop 1
v_permlane16_swap_b32 v36,v38
v_permlane16_swap_b32 v37,v39
s_nop 1
BS v[36:39],v4,s[20:23],s46 offen offset:64
tl_done:
s_endpgm
tl_end:
k2_kernel_slow5:
s_nop 15
v_max3_f32 v200,v64,v65,v66
v_max3_f32 v200,v200,v67,v72
v_max3_f32 v200,v200,v73,v74
v_max3_f32 v200,v200,v75,v80
v_max3_f32 v200,v200,v81,v82
v_max3_f32 v200,v200,v83,v88
v_max3_f32 v200,v200,v89,v90
v_max_f32 v200,v200,v91
v_mov_b32 v202,v200
s_nop 1
v_permlane16_swap_b32 v200,v202
s_nop 1
v_max_f32 v200,v200,v202
v_mov_b32 v202,v200
s_nop 1
v_permlane32_swap_b32 v200,v202
s_nop 1
v_max_f32 v200,v200,v202
v_max_f32 v200,0,v200
FA v188,v188,v200
FS v160,v160,v200
FS v161,v161,v200
FS v162,v162,v200
FS v163,v163,v200
FS v64,v64,v200
FS v65,v65,v200
FS v66,v66,v200
FS v67,v67,v200
FS v72,v72,v200
FS v73,v73,v200
FS v74,v74,v200
FS v75,v75,v200
FS v80,v80,v200
FS v81,v81,v200
FS v82,v82,v200
FS v83,v83,v200
FS v88,v88,v200
FS v89,v89,v200
FS v90,v90,v200
FS v91,v91,v200
FS v96,v96,v200
FS v97,v97,v200
FS v98,v98,v200
FS v99,v99,v200
FS v104,v104,v200
FS v105,v105,v200
FS v106,v106,v200
FS v107,v107,v200
FS v112,v112,v200
FS v113,v113,v200
FS v114,v114,v200
FS v115,v115,v200
FS v120,v120,v200
FS v121,v121,v200
FS v122,v122,v200
FS v123,v123,v200
FS v203,0,v200
EX v203,v203
s_nop 0
FM v184,v184,v203
AR v204,a0
FM v204,v204,v203
AW a0,v204
AR v204,a1
FM v204,v204,v203
AW a1,v204
AR v204,a2
FM v204,v204,v203
AW a2,v204
AR v204,a3
FM v204,v204,v203
AW a3,v204
AR v204,a8
FM v204,v204,v203
AW a8,v204
AR v204,a9
FM v204,v204,v203
AW a9,v204
AR v204,a10
FM v204,v204,v203
AW a10,v204
AR v204,a11
FM v204,v204,v203
AW a11,v204
AR v204,a16
FM v204,v204,v203
AW a16,v204
AR v204,a17
FM v204,v204,v203
AW a17,v204
AR v204,a18
FM v204,v204,v203
AW a18,v204
AR v204,a19
FM v204,v204,v203
AW a19,v204
AR v204,a24
FM v204,v204,v203
AW a24,v204
AR v204,a25
FM v204,v204,v203
AW a25,v204
AR v204,a26
FM v204,v204,v203
AW a26,v204
AR v204,a27
FM v204,v204,v203
AW a27,v204
AR v204,a32
FM v204,v204,v203
AW a32,v204
AR v204,a33
FM v204,v204,v203
AW a33,v204
AR v204,a34
FM v204,v204,v203
AW a34,v204
AR v204,a35
FM v204,v204,v203
AW a35,v204
AR v204,a40
FM v204,v204,v203
AW a40,v204
AR v204,a41
FM v204,v204,v203
AW a41,v204
AR v204,a42
FM v204,v204,v203
AW a42,v204
AR v204,a43
FM v204,v204,v203
AW a43,v204
AR v204,a48
FM v204,v204,v203
AW a48,v204
AR v204,a49
FM v204,v204,v203
AW a49,v204
AR v204,a50
FM v204,v204,v203
AW a50,v204
AR v204,a51
FM v204,v204,v203
AW a51,v204
AR v204,a56
FM v204,v204,v203
AW a56,v204
AR v204,a57
FM v204,v204,v203
AW a57,v204
AR v204,a58
FM v204,v204,v203
AW a58,v204
AR v204,a59
FM v204,v204,v203
AW a59,v204
AR v204,a64
FM v204,v204,v203
AW a64,v204
AR v204,a65
FM v204,v204,v203
AW a65,v204
AR v204,a66
FM v204,v204,v203
AW a66,v204
AR v204,a67
FM v204,v204,v203
AW a67,v204
AR v204,a72
FM v204,v204,v203
AW a72,v204
AR v204,a73
FM v204,v204,v203
AW a73,v204
AR v204,a74
FM v204,v204,v203
AW a74,v204
AR v204,a75
FM v204,v204,v203
AW a75,v204
AR v204,a80
FM v204,v204,v203
AW a80,v204
AR v204,a81
FM v204,v204,v203
AW a81,v204
AR v204,a82
FM v204,v204,v203
AW a82,v204
AR v204,a83
FM v204,v204,v203
AW a83,v204
AR v204,a88
FM v204,v204,v203
AW a88,v204
AR v204,a89
FM v204,v204,v203
AW a89,v204
AR v204,a90
FM v204,v204,v203
AW a90,v204
AR v204,a91
FM v204,v204,v203
AW a91,v204
AR v204,a96
FM v204,v204,v203
AW a96,v204
AR v204,a97
FM v204,v204,v203
AW a97,v204
AR v204,a98
FM v204,v204,v203
AW a98,v204
AR v204,a99
FM v204,v204,v203
AW a99,v204
AR v204,a104
FM v204,v204,v203
AW a104,v204
AR v204,a105
FM v204,v204,v203
AW a105,v204
AR v204,a106
FM v204,v204,v203
AW a106,v204
AR v204,a107
FM v204,v204,v203
AW a107,v204
AR v204,a112
FM v204,v204,v203
AW a112,v204
AR v204,a113
FM v204,v204,v203
AW a113,v204
AR v204,a114
FM v204,v204,v203
AW a114,v204
AR v204,a115
FM v204,v204,v203
AW a115,v204
AR v204,a120
FM v204,v204,v203
AW a120,v204
AR v204,a121
FM v204,v204,v203
AW a121,v204
AR v204,a122
FM v204,v204,v203
AW a122,v204
AR v204,a123
FM v204,v204,v203
AW a123,v204
v_max3_f32 v201,v68,v69,v70
v_max3_f32 v201,v201,v71,v76
v_max3_f32 v201,v201,v77,v78
v_max3_f32 v201,v201,v79,v84
v_max3_f32 v201,v201,v85,v86
v_max3_f32 v201,v201,v87,v92
v_max3_f32 v201,v201,v93,v94
v_max_f32 v201,v201,v95
v_mov_b32 v202,v201
s_nop 1
v_permlane16_swap_b32 v201,v202
s_nop 1
v_max_f32 v201,v201,v202
v_mov_b32 v202,v201
s_nop 1
v_permlane32_swap_b32 v201,v202
s_nop 1
v_max_f32 v201,v201,v202
v_max_f32 v201,0,v201
FA v189,v189,v201
FS v164,v164,v201
FS v165,v165,v201
FS v166,v166,v201
FS v167,v167,v201
FS v68,v68,v201
FS v69,v69,v201
FS v70,v70,v201
FS v71,v71,v201
FS v76,v76,v201
FS v77,v77,v201
FS v78,v78,v201
FS v79,v79,v201
FS v84,v84,v201
FS v85,v85,v201
FS v86,v86,v201
FS v87,v87,v201
FS v92,v92,v201
FS v93,v93,v201
FS v94,v94,v201
FS v95,v95,v201
FS v100,v100,v201
FS v101,v101,v201
FS v102,v102,v201
FS v103,v103,v201
FS v108,v108,v201
FS v109,v109,v201
FS v110,v110,v201
FS v111,v111,v201
FS v116,v116,v201
FS v117,v117,v201
FS v118,v118,v201
FS v119,v119,v201
FS v124,v124,v201
FS v125,v125,v201
FS v126,v126,v201
FS v127,v127,v201
FS v203,0,v201
EX v203,v203
s_nop 0
FM v185,v185,v203
AR v204,a4
FM v204,v204,v203
AW a4,v204
AR v204,a5
FM v204,v204,v203
AW a5,v204
AR v204,a6
FM v204,v204,v203
AW a6,v204
AR v204,a7
FM v204,v204,v203
AW a7,v204
AR v204,a12
FM v204,v204,v203
AW a12,v204
AR v204,a13
FM v204,v204,v203
AW a13,v204
AR v204,a14
FM v204,v204,v203
AW a14,v204
AR v204,a15
FM v204,v204,v203
AW a15,v204
AR v204,a20
FM v204,v204,v203
AW a20,v204
AR v204,a21
FM v204,v204,v203
AW a21,v204
AR v204,a22
FM v204,v204,v203
AW a22,v204
AR v204,a23
FM v204,v204,v203
AW a23,v204
AR v204,a28
FM v204,v204,v203
AW a28,v204
AR v204,a29
FM v204,v204,v203
AW a29,v204
AR v204,a30
FM v204,v204,v203
AW a30,v204
AR v204,a31
FM v204,v204,v203
AW a31,v204
AR v204,a36
FM v204,v204,v203
AW a36,v204
AR v204,a37
FM v204,v204,v203
AW a37,v204
AR v204,a38
FM v204,v204,v203
AW a38,v204
AR v204,a39
FM v204,v204,v203
AW a39,v204
AR v204,a44
FM v204,v204,v203
AW a44,v204
AR v204,a45
FM v204,v204,v203
AW a45,v204
AR v204,a46
FM v204,v204,v203
AW a46,v204
AR v204,a47
FM v204,v204,v203
AW a47,v204
AR v204,a52
FM v204,v204,v203
AW a52,v204
AR v204,a53
FM v204,v204,v203
AW a53,v204
AR v204,a54
FM v204,v204,v203
AW a54,v204
AR v204,a55
FM v204,v204,v203
AW a55,v204
AR v204,a60
FM v204,v204,v203
AW a60,v204
AR v204,a61
FM v204,v204,v203
AW a61,v204
AR v204,a62
FM v204,v204,v203
AW a62,v204
AR v204,a63
FM v204,v204,v203
AW a63,v204
AR v204,a68
FM v204,v204,v203
AW a68,v204
AR v204,a69
FM v204,v204,v203
AW a69,v204
AR v204,a70
FM v204,v204,v203
AW a70,v204
AR v204,a71
FM v204,v204,v203
AW a71,v204
AR v204,a76
FM v204,v204,v203
AW a76,v204
AR v204,a77
FM v204,v204,v203
AW a77,v204
AR v204,a78
FM v204,v204,v203
AW a78,v204
AR v204,a79
FM v204,v204,v203
AW a79,v204
AR v204,a84
FM v204,v204,v203
AW a84,v204
AR v204,a85
FM v204,v204,v203
AW a85,v204
AR v204,a86
FM v204,v204,v203
AW a86,v204
AR v204,a87
FM v204,v204,v203
AW a87,v204
AR v204,a92
FM v204,v204,v203
AW a92,v204
AR v204,a93
FM v204,v204,v203
AW a93,v204
AR v204,a94
FM v204,v204,v203
AW a94,v204
AR v204,a95
FM v204,v204,v203
AW a95,v204
AR v204,a100
FM v204,v204,v203
AW a100,v204
AR v204,a101
FM v204,v204,v203
AW a101,v204
AR v204,a102
FM v204,v204,v203
AW a102,v204
AR v204,a103
FM v204,v204,v203
AW a103,v204
AR v204,a108
FM v204,v204,v203
AW a108,v204
AR v204,a109
FM v204,v204,v203
AW a109,v204
AR v204,a110
FM v204,v204,v203
AW a110,v204
AR v204,a111
FM v204,v204,v203
AW a111,v204
AR v204,a116
FM v204,v204,v203
AW a116,v204
AR v204,a117
FM v204,v204,v203
AW a117,v204
AR v204,a118
FM v204,v204,v203
AW a118,v204
AR v204,a119
FM v204,v204,v203
AW a119,v204
AR v204,a124
FM v204,v204,v203
AW a124,v204
AR v204,a125
FM v204,v204,v203
AW a125,v204
AR v204,a126
FM v204,v204,v203
AW a126,v204
AR v204,a127
FM v204,v204,v203
AW a127,v204
EX v168,v64
EX v169,v65
EX v170,v66
EX v171,v67
FA v186,v168,v169
CV v128,v168,v169
FA v186,v186,v170
CV v129,v170,v171
FA v186,v186,v171
EX v172,v68
EX v173,v69
EX v174,v70
EX v175,v71
FA v187,v172,v173
CV v132,v172,v173
FA v187,v187,v174
CV v133,v174,v175
FA v187,v187,v175
EX v176,v72
EX v177,v73
EX v178,v74
EX v179,v75
FA v186,v186,v176
FA v186,v186,v177
CV v130,v176,v177
FA v186,v186,v178
CV v131,v178,v179
FA v186,v186,v179
EX v180,v76
EX v181,v77
EX v182,v78
EX v183,v79
FA v187,v187,v180
FA v187,v187,v181
CV v134,v180,v181
FA v187,v187,v182
CV v135,v182,v183
FA v187,v187,v183
EX v168,v80
EX v169,v81
EX v170,v82
EX v171,v83
FA v186,v186,v168
FA v186,v186,v169
CV v136,v168,v169
FA v186,v186,v170
CV v137,v170,v171
FA v186,v186,v171
EX v172,v84
EX v173,v85
EX v174,v86
EX v175,v87
FA v187,v187,v172
FA v187,v187,v173
CV v140,v172,v173
FA v187,v187,v174
CV v141,v174,v175
FA v187,v187,v175
EX v176,v88
EX v177,v89
EX v178,v90
EX v179,v91
FA v186,v186,v176
FA v186,v186,v177
CV v138,v176,v177
FA v186,v186,v178
CV v139,v178,v179
FA v186,v186,v179
EX v180,v92
EX v181,v93
EX v182,v94
EX v183,v95
FA v187,v187,v180
FA v187,v187,v181
CV v142,v180,v181
FA v187,v187,v182
CV v143,v182,v183
FA v187,v187,v183
s_nop 2
s_branch k2_kernel_back6
k2_kernel_slow9:
s_nop 15
v_max3_f32 v200,v96,v97,v98
v_max3_f32 v200,v200,v99,v104
v_max3_f32 v200,v200,v105,v106
v_max3_f32 v200,v200,v107,v112
v_max3_f32 v200,v200,v113,v114
v_max3_f32 v200,v200,v115,v120
v_max3_f32 v200,v200,v121,v122
v_max_f32 v200,v200,v123
v_mov_b32 v202,v200
s_nop 1
v_permlane16_swap_b32 v200,v202
s_nop 1
v_max_f32 v200,v200,v202
v_mov_b32 v202,v200
s_nop 1
v_permlane32_swap_b32 v200,v202
s_nop 1
v_max_f32 v200,v200,v202
v_max_f32 v200,0,v200
FA v188,v188,v200
FS v160,v160,v200
FS v161,v161,v200
FS v162,v162,v200
FS v163,v163,v200
FS v96,v96,v200
FS v97,v97,v200
FS v98,v98,v200
FS v99,v99,v200
FS v104,v104,v200
FS v105,v105,v200
FS v106,v106,v200
FS v107,v107,v200
FS v112,v112,v200
FS v113,v113,v200
FS v114,v114,v200
FS v115,v115,v200
FS v120,v120,v200
FS v121,v121,v200
FS v122,v122,v200
FS v123,v123,v200
FS v64,v64,v200
FS v65,v65,v200
FS v66,v66,v200
FS v67,v67,v200
FS v72,v72,v200
FS v73,v73,v200
FS v74,v74,v200
FS v75,v75,v200
FS v80,v80,v200
FS v81,v81,v200
FS v82,v82,v200
FS v83,v83,v200
FS v88,v88,v200
FS v89,v89,v200
FS v90,v90,v200
FS v91,v91,v200
FS v203,0,v200
EX v203,v203
s_nop 0
FM v184,v184,v203
AR v204,a0
FM v204,v204,v203
AW a0,v204
AR v204,a1
FM v204,v204,v203
AW a1,v204
AR v204,a2
FM v204,v204,v203
AW a2,v204
AR v204,a3
FM v204,v204,v203
AW a3,v204
AR v204,a8
FM v204,v204,v203
AW a8,v204
AR v204,a9
FM v204,v204,v203
AW a9,v204
AR v204,a10
FM v204,v204,v203
AW a10,v204
AR v204,a11
FM v204,v204,v203
AW a11,v204
AR v204,a16
FM v204,v204,v203
AW a16,v204
AR v204,a17
FM v204,v204,v203
AW a17,v204
AR v204,a18
FM v204,v204,v203
AW a18,v204
AR v204,a19
FM v204,v204,v203
AW a19,v204
AR v204,a24
FM v204,v204,v203
AW a24,v204
AR v204,a25
FM v204,v204,v203
AW a25,v204
AR v204,a26
FM v204,v204,v203
AW a26,v204
AR v204,a27
FM v204,v204,v203
AW a27,v204
AR v204,a32
FM v204,v204,v203
AW a32,v204
AR v204,a33
FM v204,v204,v203
AW a33,v204
AR v204,a34
FM v204,v204,v203
AW a34,v204
AR v204,a35
FM v204,v204,v203
AW a35,v204
AR v204,a40
FM v204,v204,v203
AW a40,v204
AR v204,a41
FM v204,v204,v203
AW a41,v204
AR v204,a42
FM v204,v204,v203
AW a42,v204
AR v204,a43
FM v204,v204,v203
AW a43,v204
AR v204,a48
FM v204,v204,v203
AW a48,v204
AR v204,a49
FM v204,v204,v203
AW a49,v204
AR v204,a50
FM v204,v204,v203
AW a50,v204
AR v204,a51
FM v204,v204,v203
AW a51,v204
AR v204,a56
FM v204,v204,v203
AW a56,v204
AR v204,a57
FM v204,v204,v203
AW a57,v204
AR v204,a58
FM v204,v204,v203
AW a58,v204
AR v204,a59
FM v204,v204,v203
AW a59,v204
AR v204,a64
FM v204,v204,v203
AW a64,v204
AR v204,a65
FM v204,v204,v203
AW a65,v204
AR v204,a66
FM v204,v204,v203
AW a66,v204
AR v204,a67
FM v204,v204,v203
AW a67,v204
AR v204,a72
FM v204,v204,v203
AW a72,v204
AR v204,a73
FM v204,v204,v203
AW a73,v204
AR v204,a74
FM v204,v204,v203
AW a74,v204
AR v204,a75
FM v204,v204,v203
AW a75,v204
AR v204,a80
FM v204,v204,v203
AW a80,v204
AR v204,a81
FM v204,v204,v203
AW a81,v204
AR v204,a82
FM v204,v204,v203
AW a82,v204
AR v204,a83
FM v204,v204,v203
AW a83,v204
AR v204,a88
FM v204,v204,v203
AW a88,v204
AR v204,a89
FM v204,v204,v203
AW a89,v204
AR v204,a90
FM v204,v204,v203
AW a90,v204
AR v204,a91
FM v204,v204,v203
AW a91,v204
AR v204,a96
FM v204,v204,v203
AW a96,v204
AR v204,a97
FM v204,v204,v203
AW a97,v204
AR v204,a98
FM v204,v204,v203
AW a98,v204
AR v204,a99
FM v204,v204,v203
AW a99,v204
AR v204,a104
FM v204,v204,v203
AW a104,v204
AR v204,a105
FM v204,v204,v203
AW a105,v204
AR v204,a106
FM v204,v204,v203
AW a106,v204
AR v204,a107
FM v204,v204,v203
AW a107,v204
AR v204,a112
FM v204,v204,v203
AW a112,v204
AR v204,a113
FM v204,v204,v203
AW a113,v204
AR v204,a114
FM v204,v204,v203
AW a114,v204
AR v204,a115
FM v204,v204,v203
AW a115,v204
AR v204,a120
FM v204,v204,v203
AW a120,v204
AR v204,a121
FM v204,v204,v203
AW a121,v204
AR v204,a122
FM v204,v204,v203
AW a122,v204
AR v204,a123
FM v204,v204,v203
AW a123,v204
v_max3_f32 v201,v100,v101,v102
v_max3_f32 v201,v201,v103,v108
v_max3_f32 v201,v201,v109,v110
v_max3_f32 v201,v201,v111,v116
v_max3_f32 v201,v201,v117,v118
v_max3_f32 v201,v201,v119,v124
v_max3_f32 v201,v201,v125,v126
v_max_f32 v201,v201,v127
v_mov_b32 v202,v201
s_nop 1
v_permlane16_swap_b32 v201,v202
s_nop 1
v_max_f32 v201,v201,v202
v_mov_b32 v202,v201
s_nop 1
v_permlane32_swap_b32 v201,v202
s_nop 1
v_max_f32 v201,v201,v202
v_max_f32 v201,0,v201
FA v189,v189,v201
FS v164,v164,v201
FS v165,v165,v201
FS v166,v166,v201
FS v167,v167,v201
FS v100,v100,v201
FS v101,v101,v201
FS v102,v102,v201
FS v103,v103,v201
FS v108,v108,v201
FS v109,v109,v201
FS v110,v110,v201
FS v111,v111,v201
FS v116,v116,v201
FS v117,v117,v201
FS v118,v118,v201
FS v119,v119,v201
FS v124,v124,v201
FS v125,v125,v201
FS v126,v126,v201
FS v127,v127,v201
FS v68,v68,v201
FS v69,v69,v201
FS v70,v70,v201
FS v71,v71,v201
FS v76,v76,v201
FS v77,v77,v201
FS v78,v78,v201
FS v79,v79,v201
FS v84,v84,v201
FS v85,v85,v201
FS v86,v86,v201
FS v87,v87,v201
FS v92,v92,v201
FS v93,v93,v201
FS v94,v94,v201
FS v95,v95,v201
FS v203,0,v201
EX v203,v203
s_nop 0
FM v185,v185,v203
AR v204,a4
FM v204,v204,v203
AW a4,v204
AR v204,a5
FM v204,v204,v203
AW a5,v204
AR v204,a6
FM v204,v204,v203
AW a6,v204
AR v204,a7
FM v204,v204,v203
AW a7,v204
AR v204,a12
FM v204,v204,v203
AW a12,v204
AR v204,a13
FM v204,v204,v203
AW a13,v204
AR v204,a14
FM v204,v204,v203
AW a14,v204
AR v204,a15
FM v204,v204,v203
AW a15,v204
AR v204,a20
FM v204,v204,v203
AW a20,v204
AR v204,a21
FM v204,v204,v203
AW a21,v204
AR v204,a22
FM v204,v204,v203
AW a22,v204
AR v204,a23
FM v204,v204,v203
AW a23,v204
AR v204,a28
FM v204,v204,v203
AW a28,v204
AR v204,a29
FM v204,v204,v203
AW a29,v204
AR v204,a30
FM v204,v204,v203
AW a30,v204
AR v204,a31
FM v204,v204,v203
AW a31,v204
AR v204,a36
FM v204,v204,v203
AW a36,v204
AR v204,a37
FM v204,v204,v203
AW a37,v204
AR v204,a38
FM v204,v204,v203
AW a38,v204
AR v204,a39
FM v204,v204,v203
AW a39,v204
AR v204,a44
FM v204,v204,v203
AW a44,v204
AR v204,a45
FM v204,v204,v203
AW a45,v204
AR v204,a46
FM v204,v204,v203
AW a46,v204
AR v204,a47
FM v204,v204,v203
AW a47,v204
AR v204,a52
FM v204,v204,v203
AW a52,v204
AR v204,a53
FM v204,v204,v203
AW a53,v204
AR v204,a54
FM v204,v204,v203
AW a54,v204
AR v204,a55
FM v204,v204,v203
AW a55,v204
AR v204,a60
FM v204,v204,v203
AW a60,v204
AR v204,a61
FM v204,v204,v203
AW a61,v204
AR v204,a62
FM v204,v204,v203
AW a62,v204
AR v204,a63
FM v204,v204,v203
AW a63,v204
AR v204,a68
FM v204,v204,v203
AW a68,v204
AR v204,a69
FM v204,v204,v203
AW a69,v204
AR v204,a70
FM v204,v204,v203
AW a70,v204
AR v204,a71
FM v204,v204,v203
AW a71,v204
AR v204,a76
FM v204,v204,v203
AW a76,v204
AR v204,a77
FM v204,v204,v203
AW a77,v204
AR v204,a78
FM v204,v204,v203
AW a78,v204
AR v204,a79
FM v204,v204,v203
AW a79,v204
AR v204,a84
FM v204,v204,v203
AW a84,v204
AR v204,a85
FM v204,v204,v203
AW a85,v204
AR v204,a86
FM v204,v204,v203
AW a86,v204
AR v204,a87
FM v204,v204,v203
AW a87,v204
AR v204,a92
FM v204,v204,v203
AW a92,v204
AR v204,a93
FM v204,v204,v203
AW a93,v204
AR v204,a94
FM v204,v204,v203
AW a94,v204
AR v204,a95
FM v204,v204,v203
AW a95,v204
AR v204,a100
FM v204,v204,v203
AW a100,v204
AR v204,a101
FM v204,v204,v203
AW a101,v204
AR v204,a102
FM v204,v204,v203
AW a102,v204
AR v204,a103
FM v204,v204,v203
AW a103,v204
AR v204,a108
FM v204,v204,v203
AW a108,v204
AR v204,a109
FM v204,v204,v203
AW a109,v204
AR v204,a110
FM v204,v204,v203
AW a110,v204
AR v204,a111
FM v204,v204,v203
AW a111,v204
AR v204,a116
FM v204,v204,v203
AW a116,v204
AR v204,a117
FM v204,v204,v203
AW a117,v204
AR v204,a118
FM v204,v204,v203
AW a118,v204
AR v204,a119
FM v204,v204,v203
AW a119,v204
AR v204,a124
FM v204,v204,v203
AW a124,v204
AR v204,a125
FM v204,v204,v203
AW a125,v204
AR v204,a126
FM v204,v204,v203
AW a126,v204
AR v204,a127
FM v204,v204,v203
AW a127,v204
EX v168,v96
EX v169,v97
EX v170,v98
EX v171,v99
FA v186,v168,v169
CV v144,v168,v169
FA v186,v186,v170
CV v145,v170,v171
FA v186,v186,v171
EX v172,v100
EX v173,v101
EX v174,v102
EX v175,v103
FA v187,v172,v173
CV v148,v172,v173
FA v187,v187,v174
CV v149,v174,v175
FA v187,v187,v175
EX v176,v104
EX v177,v105
EX v178,v106
EX v179,v107
FA v186,v186,v176
FA v186,v186,v177
CV v146,v176,v177
FA v186,v186,v178
CV v147,v178,v179
FA v186,v186,v179
EX v180,v108
EX v181,v109
EX v182,v110
EX v183,v111
FA v187,v187,v180
FA v187,v187,v181
CV v150,v180,v181
FA v187,v187,v182
CV v151,v182,v183
FA v187,v187,v183
EX v168,v112
EX v169,v113
EX v170,v114
EX v171,v115
FA v186,v186,v168
FA v186,v186,v169
CV v152,v168,v169
FA v186,v186,v170
CV v153,v170,v171
FA v186,v186,v171
EX v172,v116
EX v173,v117
EX v174,v118
EX v175,v119
FA v187,v187,v172
FA v187,v187,v173
CV v156,v172,v173
FA v187,v187,v174
CV v157,v174,v175
FA v187,v187,v175
EX v176,v120
EX v177,v121
EX v178,v122
EX v179,v123
FA v186,v186,v176
FA v186,v186,v177
CV v154,v176,v177
FA v186,v186,v178
CV v155,v178,v179
FA v186,v186,v179
EX v180,v124
EX v181,v125
EX v182,v126
EX v183,v127
FA v187,v187,v180
FA v187,v187,v181
CV v158,v180,v181
FA v187,v187,v182
CV v159,v182,v183
FA v187,v187,v183
s_nop 2
s_branch k2_kernel_back10
k2_kernel_slow14:
s_nop 15
v_max3_f32 v200,v64,v65,v66
v_max3_f32 v200,v200,v67,v72
v_max3_f32 v200,v200,v73,v74
v_max3_f32 v200,v200,v75,v80
v_max3_f32 v200,v200,v81,v82
v_max3_f32 v200,v200,v83,v88
v_max3_f32 v200,v200,v89,v90
v_max_f32 v200,v200,v91
v_mov_b32 v202,v200
s_nop 1
v_permlane16_swap_b32 v200,v202
s_nop 1
v_max_f32 v200,v200,v202
v_mov_b32 v202,v200
s_nop 1
v_permlane32_swap_b32 v200,v202
s_nop 1
v_max_f32 v200,v200,v202
v_max_f32 v200,0,v200
FA v188,v188,v200
FS v160,v160,v200
FS v161,v161,v200
FS v162,v162,v200
FS v163,v163,v200
FS v64,v64,v200
FS v65,v65,v200
FS v66,v66,v200
FS v67,v67,v200
FS v72,v72,v200
FS v73,v73,v200
FS v74,v74,v200
FS v75,v75,v200
FS v80,v80,v200
FS v81,v81,v200
FS v82,v82,v200
FS v83,v83,v200
FS v88,v88,v200
FS v89,v89,v200
FS v90,v90,v200
FS v91,v91,v200
FS v96,v96,v200
FS v97,v97,v200
FS v98,v98,v200
FS v99,v99,v200
FS v104,v104,v200
FS v105,v105,v200
FS v106,v106,v200
FS v107,v107,v200
FS v112,v112,v200
FS v113,v113,v200
FS v114,v114,v200
FS v115,v115,v200
FS v120,v120,v200
FS v121,v121,v200
FS v122,v122,v200
FS v123,v123,v200
FS v203,0,v200
EX v203,v203
s_nop 0
FM v184,v184,v203
AR v204,a0
FM v204,v204,v203
AW a0,v204
AR v204,a1
FM v204,v204,v203
AW a1,v204
AR v204,a2
FM v204,v204,v203
AW a2,v204
AR v204,a3
FM v204,v204,v203
AW a3,v204
AR v204,a8
FM v204,v204,v203
AW a8,v204
AR v204,a9
FM v204,v204,v203
AW a9,v204
AR v204,a10
FM v204,v204,v203
AW a10,v204
AR v204,a11
FM v204,v204,v203
AW a11,v204
AR v204,a16
FM v204,v204,v203
AW a16,v204
AR v204,a17
FM v204,v204,v203
AW a17,v204
AR v204,a18
FM v204,v204,v203
AW a18,v204
AR v204,a19
FM v204,v204,v203
AW a19,v204
AR v204,a24
FM v204,v204,v203
AW a24,v204
AR v204,a25
FM v204,v204,v203
AW a25,v204
AR v204,a26
FM v204,v204,v203
AW a26,v204
AR v204,a27
FM v204,v204,v203
AW a27,v204
AR v204,a32
FM v204,v204,v203
AW a32,v204
AR v204,a33
FM v204,v204,v203
AW a33,v204
AR v204,a34
FM v204,v204,v203
AW a34,v204
AR v204,a35
FM v204,v204,v203
AW a35,v204
AR v204,a40
FM v204,v204,v203
AW a40,v204
AR v204,a41
FM v204,v204,v203
AW a41,v204
AR v204,a42
FM v204,v204,v203
AW a42,v204
AR v204,a43
FM v204,v204,v203
AW a43,v204
AR v204,a48
FM v204,v204,v203
AW a48,v204
AR v204,a49
FM v204,v204,v203
AW a49,v204
AR v204,a50
FM v204,v204,v203
AW a50,v204
AR v204,a51
FM v204,v204,v203
AW a51,v204
AR v204,a56
FM v204,v204,v203
AW a56,v204
AR v204,a57
FM v204,v204,v203
AW a57,v204
AR v204,a58
FM v204,v204,v203
AW a58,v204
AR v204,a59
FM v204,v204,v203
AW a59,v204
AR v204,a64
FM v204,v204,v203
AW a64,v204
AR v204,a65
FM v204,v204,v203
AW a65,v204
AR v204,a66
FM v204,v204,v203
AW a66,v204
AR v204,a67
FM v204,v204,v203
AW a67,v204
AR v204,a72
FM v204,v204,v203
AW a72,v204
AR v204,a73
FM v204,v204,v203
AW a73,v204
AR v204,a74
FM v204,v204,v203
AW a74,v204
AR v204,a75
FM v204,v204,v203
AW a75,v204
AR v204,a80
FM v204,v204,v203
AW a80,v204
AR v204,a81
FM v204,v204,v203
AW a81,v204
AR v204,a82
FM v204,v204,v203
AW a82,v204
AR v204,a83
FM v204,v204,v203
AW a83,v204
AR v204,a88
FM v204,v204,v203
AW a88,v204
AR v204,a89
FM v204,v204,v203
AW a89,v204
AR v204,a90
FM v204,v204,v203
AW a90,v204
AR v204,a91
FM v204,v204,v203
AW a91,v204
AR v204,a96
FM v204,v204,v203
AW a96,v204
AR v204,a97
FM v204,v204,v203
AW a97,v204
AR v204,a98
FM v204,v204,v203
AW a98,v204
AR v204,a99
FM v204,v204,v203
AW a99,v204
AR v204,a104
FM v204,v204,v203
AW a104,v204
AR v204,a105
FM v204,v204,v203
AW a105,v204
AR v204,a106
FM v204,v204,v203
AW a106,v204
AR v204,a107
FM v204,v204,v203
AW a107,v204
AR v204,a112
FM v204,v204,v203
AW a112,v204
AR v204,a113
FM v204,v204,v203
AW a113,v204
AR v204,a114
FM v204,v204,v203
AW a114,v204
AR v204,a115
FM v204,v204,v203
AW a115,v204
AR v204,a120
FM v204,v204,v203
AW a120,v204
AR v204,a121
FM v204,v204,v203
AW a121,v204
AR v204,a122
FM v204,v204,v203
AW a122,v204
AR v204,a123
FM v204,v204,v203
AW a123,v204
v_max3_f32 v201,v68,v69,v70
v_max3_f32 v201,v201,v71,v76
v_max3_f32 v201,v201,v77,v78
v_max3_f32 v201,v201,v79,v84
v_max3_f32 v201,v201,v85,v86
v_max3_f32 v201,v201,v87,v92
v_max3_f32 v201,v201,v93,v94
v_max_f32 v201,v201,v95
v_mov_b32 v202,v201
s_nop 1
v_permlane16_swap_b32 v201,v202
s_nop 1
v_max_f32 v201,v201,v202
v_mov_b32 v202,v201
s_nop 1
v_permlane32_swap_b32 v201,v202
s_nop 1
v_max_f32 v201,v201,v202
v_max_f32 v201,0,v201
FA v189,v189,v201
FS v164,v164,v201
FS v165,v165,v201
FS v166,v166,v201
FS v167,v167,v201
FS v68,v68,v201
FS v69,v69,v201
FS v70,v70,v201
FS v71,v71,v201
FS v76,v76,v201
FS v77,v77,v201
FS v78,v78,v201
FS v79,v79,v201
FS v84,v84,v201
FS v85,v85,v201
FS v86,v86,v201
FS v87,v87,v201
FS v92,v92,v201
FS v93,v93,v201
FS v94,v94,v201
FS v95,v95,v201
FS v100,v100,v201
FS v101,v101,v201
FS v102,v102,v201
FS v103,v103,v201
FS v108,v108,v201
FS v109,v109,v201
FS v110,v110,v201
FS v111,v111,v201
FS v116,v116,v201
FS v117,v117,v201
FS v118,v118,v201
FS v119,v119,v201
FS v124,v124,v201
FS v125,v125,v201
FS v126,v126,v201
FS v127,v127,v201
FS v203,0,v201
EX v203,v203
s_nop 0
FM v185,v185,v203
AR v204,a4
FM v204,v204,v203
AW a4,v204
AR v204,a5
FM v204,v204,v203
AW a5,v204
AR v204,a6
FM v204,v204,v203
AW a6,v204
AR v204,a7
FM v204,v204,v203
AW a7,v204
AR v204,a12
FM v204,v204,v203
AW a12,v204
AR v204,a13
FM v204,v204,v203
AW a13,v204
AR v204,a14
FM v204,v204,v203
AW a14,v204
AR v204,a15
FM v204,v204,v203
AW a15,v204
AR v204,a20
FM v204,v204,v203
AW a20,v204
AR v204,a21
FM v204,v204,v203
AW a21,v204
AR v204,a22
FM v204,v204,v203
AW a22,v204
AR v204,a23
FM v204,v204,v203
AW a23,v204
AR v204,a28
FM v204,v204,v203
AW a28,v204
AR v204,a29
FM v204,v204,v203
AW a29,v204
AR v204,a30
FM v204,v204,v203
AW a30,v204
AR v204,a31
FM v204,v204,v203
AW a31,v204
AR v204,a36
FM v204,v204,v203
AW a36,v204
AR v204,a37
FM v204,v204,v203
AW a37,v204
AR v204,a38
FM v204,v204,v203
AW a38,v204
AR v204,a39
FM v204,v204,v203
AW a39,v204
AR v204,a44
FM v204,v204,v203
AW a44,v204
AR v204,a45
FM v204,v204,v203
AW a45,v204
AR v204,a46
FM v204,v204,v203
AW a46,v204
AR v204,a47
FM v204,v204,v203
AW a47,v204
AR v204,a52
FM v204,v204,v203
AW a52,v204
AR v204,a53
FM v204,v204,v203
AW a53,v204
AR v204,a54
FM v204,v204,v203
AW a54,v204
AR v204,a55
FM v204,v204,v203
AW a55,v204
AR v204,a60
FM v204,v204,v203
AW a60,v204
AR v204,a61
FM v204,v204,v203
AW a61,v204
AR v204,a62
FM v204,v204,v203
AW a62,v204
AR v204,a63
FM v204,v204,v203
AW a63,v204
AR v204,a68
FM v204,v204,v203
AW a68,v204
AR v204,a69
FM v204,v204,v203
AW a69,v204
AR v204,a70
FM v204,v204,v203
AW a70,v204
AR v204,a71
FM v204,v204,v203
AW a71,v204
AR v204,a76
FM v204,v204,v203
AW a76,v204
AR v204,a77
FM v204,v204,v203
AW a77,v204
AR v204,a78
FM v204,v204,v203
AW a78,v204
AR v204,a79
FM v204,v204,v203
AW a79,v204
AR v204,a84
FM v204,v204,v203
AW a84,v204
AR v204,a85
FM v204,v204,v203
AW a85,v204
AR v204,a86
FM v204,v204,v203
AW a86,v204
AR v204,a87
FM v204,v204,v203
AW a87,v204
AR v204,a92
FM v204,v204,v203
AW a92,v204
AR v204,a93
FM v204,v204,v203
AW a93,v204
AR v204,a94
FM v204,v204,v203
AW a94,v204
AR v204,a95
FM v204,v204,v203
AW a95,v204
AR v204,a100
FM v204,v204,v203
AW a100,v204
AR v204,a101
FM v204,v204,v203
AW a101,v204
AR v204,a102
FM v204,v204,v203
AW a102,v204
AR v204,a103
FM v204,v204,v203
AW a103,v204
AR v204,a108
FM v204,v204,v203
AW a108,v204
AR v204,a109
FM v204,v204,v203
AW a109,v204
AR v204,a110
FM v204,v204,v203
AW a110,v204
AR v204,a111
FM v204,v204,v203
AW a111,v204
AR v204,a116
FM v204,v204,v203
AW a116,v204
AR v204,a117
FM v204,v204,v203
AW a117,v204
AR v204,a118
FM v204,v204,v203
AW a118,v204
AR v204,a119
FM v204,v204,v203
AW a119,v204
AR v204,a124
FM v204,v204,v203
AW a124,v204
AR v204,a125
FM v204,v204,v203
AW a125,v204
AR v204,a126
FM v204,v204,v203
AW a126,v204
AR v204,a127
FM v204,v204,v203
AW a127,v204
EX v168,v64
EX v169,v65
EX v170,v66
EX v171,v67
FA v186,v168,v169
CV v128,v168,v169
FA v186,v186,v170
CV v129,v170,v171
FA v186,v186,v171
EX v172,v68
EX v173,v69
EX v174,v70
EX v175,v71
FA v187,v172,v173
CV v132,v172,v173
FA v187,v187,v174
CV v133,v174,v175
FA v187,v187,v175
EX v176,v72
EX v177,v73
EX v178,v74
EX v179,v75
FA v186,v186,v176
FA v186,v186,v177
CV v130,v176,v177
FA v186,v186,v178
CV v131,v178,v179
FA v186,v186,v179
EX v180,v76
EX v181,v77
EX v182,v78
EX v183,v79
FA v187,v187,v180
FA v187,v187,v181
CV v134,v180,v181
FA v187,v187,v182
CV v135,v182,v183
FA v187,v187,v183
EX v168,v80
EX v169,v81
EX v170,v82
EX v171,v83
FA v186,v186,v168
FA v186,v186,v169
CV v136,v168,v169
FA v186,v186,v170
CV v137,v170,v171
FA v186,v186,v171
EX v172,v84
EX v173,v85
EX v174,v86
EX v175,v87
FA v187,v187,v172
FA v187,v187,v173
CV v140,v172,v173
FA v187,v187,v174
CV v141,v174,v175
FA v187,v187,v175
EX v176,v88
EX v177,v89
EX v178,v90
EX v179,v91
FA v186,v186,v176
FA v186,v186,v177
CV v138,v176,v177
FA v186,v186,v178
CV v139,v178,v179
FA v186,v186,v179
EX v180,v92
EX v181,v93
EX v182,v94
EX v183,v95
FA v187,v187,v180
FA v187,v187,v181
CV v142,v180,v181
FA v187,v187,v182
CV v143,v182,v183
FA v187,v187,v183
s_nop 2
s_branch k2_kernel_back15
k2_kernel_slow19:
s_nop 15
v_max3_f32 v200,v96,v97,v98
v_max3_f32 v200,v200,v99,v104
v_max3_f32 v200,v200,v105,v106
v_max3_f32 v200,v200,v107,v112
v_max3_f32 v200,v200,v113,v114
v_max3_f32 v200,v200,v115,v120
v_max3_f32 v200,v200,v121,v122
v_max_f32 v200,v200,v123
v_mov_b32 v202,v200
s_nop 1
v_permlane16_swap_b32 v200,v202
s_nop 1
v_max_f32 v200,v200,v202
v_mov_b32 v202,v200
s_nop 1
v_permlane32_swap_b32 v200,v202
s_nop 1
v_max_f32 v200,v200,v202
v_max_f32 v200,0,v200
FA v188,v188,v200
FS v160,v160,v200
FS v161,v161,v200
FS v162,v162,v200
FS v163,v163,v200
FS v96,v96,v200
FS v97,v97,v200
FS v98,v98,v200
FS v99,v99,v200
FS v104,v104,v200
FS v105,v105,v200
FS v106,v106,v200
FS v107,v107,v200
FS v112,v112,v200
FS v113,v113,v200
FS v114,v114,v200
FS v115,v115,v200
FS v120,v120,v200
FS v121,v121,v200
FS v122,v122,v200
FS v123,v123,v200
FS v64,v64,v200
FS v65,v65,v200
FS v66,v66,v200
FS v67,v67,v200
FS v72,v72,v200
FS v73,v73,v200
FS v74,v74,v200
FS v75,v75,v200
FS v80,v80,v200
FS v81,v81,v200
FS v82,v82,v200
FS v83,v83,v200
FS v88,v88,v200
FS v89,v89,v200
FS v90,v90,v200
FS v91,v91,v200
FS v203,0,v200
EX v203,v203
s_nop 0
FM v184,v184,v203
AR v204,a0
FM v204,v204,v203
AW a0,v204
AR v204,a1
FM v204,v204,v203
AW a1,v204
AR v204,a2
FM v204,v204,v203
AW a2,v204
AR v204,a3
FM v204,v204,v203
AW a3,v204
AR v204,a8
FM v204,v204,v203
AW a8,v204
AR v204,a9
FM v204,v204,v203
AW a9,v204
AR v204,a10
FM v204,v204,v203
AW a10,v204
AR v204,a11
FM v204,v204,v203
AW a11,v204
AR v204,a16
FM v204,v204,v203
AW a16,v204
AR v204,a17
FM v204,v204,v203
AW a17,v204
AR v204,a18
FM v204,v204,v203
AW a18,v204
AR v204,a19
FM v204,v204,v203
AW a19,v204
AR v204,a24
FM v204,v204,v203
AW a24,v204
AR v204,a25
FM v204,v204,v203
AW a25,v204
AR v204,a26
FM v204,v204,v203
AW a26,v204
AR v204,a27
FM v204,v204,v203
AW a27,v204
AR v204,a32
FM v204,v204,v203
AW a32,v204
AR v204,a33
FM v204,v204,v203
AW a33,v204
AR v204,a34
FM v204,v204,v203
AW a34,v204
AR v204,a35
FM v204,v204,v203
AW a35,v204
AR v204,a40
FM v204,v204,v203
AW a40,v204
AR v204,a41
FM v204,v204,v203
AW a41,v204
AR v204,a42
FM v204,v204,v203
AW a42,v204
AR v204,a43
FM v204,v204,v203
AW a43,v204
AR v204,a48
FM v204,v204,v203
AW a48,v204
AR v204,a49
FM v204,v204,v203
AW a49,v204
AR v204,a50
FM v204,v204,v203
AW a50,v204
AR v204,a51
FM v204,v204,v203
AW a51,v204
AR v204,a56
FM v204,v204,v203
AW a56,v204
AR v204,a57
FM v204,v204,v203
AW a57,v204
AR v204,a58
FM v204,v204,v203
AW a58,v204
AR v204,a59
FM v204,v204,v203
AW a59,v204
AR v204,a64
FM v204,v204,v203
AW a64,v204
AR v204,a65
FM v204,v204,v203
AW a65,v204
AR v204,a66
FM v204,v204,v203
AW a66,v204
AR v204,a67
FM v204,v204,v203
AW a67,v204
AR v204,a72
FM v204,v204,v203
AW a72,v204
AR v204,a73
FM v204,v204,v203
AW a73,v204
AR v204,a74
FM v204,v204,v203
AW a74,v204
AR v204,a75
FM v204,v204,v203
AW a75,v204
AR v204,a80
FM v204,v204,v203
AW a80,v204
AR v204,a81
FM v204,v204,v203
AW a81,v204
AR v204,a82
FM v204,v204,v203
AW a82,v204
AR v204,a83
FM v204,v204,v203
AW a83,v204
AR v204,a88
FM v204,v204,v203
AW a88,v204
AR v204,a89
FM v204,v204,v203
AW a89,v204
AR v204,a90
FM v204,v204,v203
AW a90,v204
AR v204,a91
FM v204,v204,v203
AW a91,v204
AR v204,a96
FM v204,v204,v203
AW a96,v204
AR v204,a97
FM v204,v204,v203
AW a97,v204
AR v204,a98
FM v204,v204,v203
AW a98,v204
AR v204,a99
FM v204,v204,v203
AW a99,v204
AR v204,a104
FM v204,v204,v203
AW a104,v204
AR v204,a105
FM v204,v204,v203
AW a105,v204
AR v204,a106
FM v204,v204,v203
AW a106,v204
AR v204,a107
FM v204,v204,v203
AW a107,v204
AR v204,a112
FM v204,v204,v203
AW a112,v204
AR v204,a113
FM v204,v204,v203
AW a113,v204
AR v204,a114
FM v204,v204,v203
AW a114,v204
AR v204,a115
FM v204,v204,v203
AW a115,v204
AR v204,a120
FM v204,v204,v203
AW a120,v204
AR v204,a121
FM v204,v204,v203
AW a121,v204
AR v204,a122
FM v204,v204,v203
AW a122,v204
AR v204,a123
FM v204,v204,v203
AW a123,v204
v_max3_f32 v201,v100,v101,v102
v_max3_f32 v201,v201,v103,v108
v_max3_f32 v201,v201,v109,v110
v_max3_f32 v201,v201,v111,v116
v_max3_f32 v201,v201,v117,v118
v_max3_f32 v201,v201,v119,v124
v_max3_f32 v201,v201,v125,v126
v_max_f32 v201,v201,v127
v_mov_b32 v202,v201
s_nop 1
v_permlane16_swap_b32 v201,v202
s_nop 1
v_max_f32 v201,v201,v202
v_mov_b32 v202,v201
s_nop 1
v_permlane32_swap_b32 v201,v202
s_nop 1
v_max_f32 v201,v201,v202
v_max_f32 v201,0,v201
FA v189,v189,v201
FS v164,v164,v201
FS v165,v165,v201
FS v166,v166,v201
FS v167,v167,v201
FS v100,v100,v201
FS v101,v101,v201
FS v102,v102,v201
FS v103,v103,v201
FS v108,v108,v201
FS v109,v109,v201
FS v110,v110,v201
FS v111,v111,v201
FS v116,v116,v201
FS v117,v117,v201
FS v118,v118,v201
FS v119,v119,v201
FS v124,v124,v201
FS v125,v125,v201
FS v126,v126,v201
FS v127,v127,v201
FS v68,v68,v201
FS v69,v69,v201
FS v70,v70,v201
FS v71,v71,v201
FS v76,v76,v201
FS v77,v77,v201
FS v78,v78,v201
FS v79,v79,v201
FS v84,v84,v201
FS v85,v85,v201
FS v86,v86,v201
FS v87,v87,v201
FS v92,v92,v201
FS v93,v93,v201
FS v94,v94,v201
FS v95,v95,v201
FS v203,0,v201
EX v203,v203
s_nop 0
FM v185,v185,v203
AR v204,a4
FM v204,v204,v203
AW a4,v204
AR v204,a5
FM v204,v204,v203
AW a5,v204
AR v204,a6
FM v204,v204,v203
AW a6,v204
AR v204,a7
FM v204,v204,v203
AW a7,v204
AR v204,a12
FM v204,v204,v203
AW a12,v204
AR v204,a13
FM v204,v204,v203
AW a13,v204
AR v204,a14
FM v204,v204,v203
AW a14,v204
AR v204,a15
FM v204,v204,v203
AW a15,v204
AR v204,a20
FM v204,v204,v203
AW a20,v204
AR v204,a21
FM v204,v204,v203
AW a21,v204
AR v204,a22
FM v204,v204,v203
AW a22,v204
AR v204,a23
FM v204,v204,v203
AW a23,v204
AR v204,a28
FM v204,v204,v203
AW a28,v204
AR v204,a29
FM v204,v204,v203
AW a29,v204
AR v204,a30
FM v204,v204,v203
AW a30,v204
AR v204,a31
FM v204,v204,v203
AW a31,v204
AR v204,a36
FM v204,v204,v203
AW a36,v204
AR v204,a37
FM v204,v204,v203
AW a37,v204
AR v204,a38
FM v204,v204,v203
AW a38,v204
AR v204,a39
FM v204,v204,v203
AW a39,v204
AR v204,a44
FM v204,v204,v203
AW a44,v204
AR v204,a45
FM v204,v204,v203
AW a45,v204
AR v204,a46
FM v204,v204,v203
AW a46,v204
AR v204,a47
FM v204,v204,v203
AW a47,v204
AR v204,a52
FM v204,v204,v203
AW a52,v204
AR v204,a53
FM v204,v204,v203
AW a53,v204
AR v204,a54
FM v204,v204,v203
AW a54,v204
AR v204,a55
FM v204,v204,v203
AW a55,v204
AR v204,a60
FM v204,v204,v203
AW a60,v204
AR v204,a61
FM v204,v204,v203
AW a61,v204
AR v204,a62
FM v204,v204,v203
AW a62,v204
AR v204,a63
FM v204,v204,v203
AW a63,v204
AR v204,a68
FM v204,v204,v203
AW a68,v204
AR v204,a69
FM v204,v204,v203
AW a69,v204
AR v204,a70
FM v204,v204,v203
AW a70,v204
AR v204,a71
FM v204,v204,v203
AW a71,v204
AR v204,a76
FM v204,v204,v203
AW a76,v204
AR v204,a77
FM v204,v204,v203
AW a77,v204
AR v204,a78
FM v204,v204,v203
AW a78,v204
AR v204,a79
FM v204,v204,v203
AW a79,v204
AR v204,a84
FM v204,v204,v203
AW a84,v204
AR v204,a85
FM v204,v204,v203
AW a85,v204
AR v204,a86
FM v204,v204,v203
AW a86,v204
AR v204,a87
FM v204,v204,v203
AW a87,v204
AR v204,a92
FM v204,v204,v203
AW a92,v204
AR v204,a93
FM v204,v204,v203
AW a93,v204
AR v204,a94
FM v204,v204,v203
AW a94,v204
AR v204,a95
FM v204,v204,v203
AW a95,v204
AR v204,a100
FM v204,v204,v203
AW a100,v204
AR v204,a101
FM v204,v204,v203
AW a101,v204
AR v204,a102
FM v204,v204,v203
AW a102,v204
AR v204,a103
FM v204,v204,v203
AW a103,v204
AR v204,a108
FM v204,v204,v203
AW a108,v204
AR v204,a109
FM v204,v204,v203
AW a109,v204
AR v204,a110
FM v204,v204,v203
AW a110,v204
AR v204,a111
FM v204,v204,v203
AW a111,v204
AR v204,a116
FM v204,v204,v203
AW a116,v204
AR v204,a117
FM v204,v204,v203
AW a117,v204
AR v204,a118
FM v204,v204,v203
AW a118,v204
AR v204,a119
FM v204,v204,v203
AW a119,v204
AR v204,a124
FM v204,v204,v203
AW a124,v204
AR v204,a125
FM v204,v204,v203
AW a125,v204
AR v204,a126
FM v204,v204,v203
AW a126,v204
AR v204,a127
FM v204,v204,v203
AW a127,v204
EX v168,v96
EX v169,v97
EX v170,v98
EX v171,v99
FA v186,v168,v169
CV v144,v168,v169
FA v186,v186,v170
CV v145,v170,v171
FA v186,v186,v171
EX v172,v100
EX v173,v101
EX v174,v102
EX v175,v103
FA v187,v172,v173
CV v148,v172,v173
FA v187,v187,v174
CV v149,v174,v175
FA v187,v187,v175
EX v176,v104
EX v177,v105
EX v178,v106
EX v179,v107
FA v186,v186,v176
FA v186,v186,v177
CV v146,v176,v177
FA v186,v186,v178
CV v147,v178,v179
FA v186,v186,v179
EX v180,v108
EX v181,v109
EX v182,v110
EX v183,v111
FA v187,v187,v180
FA v187,v187,v181
CV v150,v180,v181
FA v187,v187,v182
CV v151,v182,v183
FA v187,v187,v183
EX v168,v112
EX v169,v113
EX v170,v114
EX v171,v115
FA v186,v186,v168
FA v186,v186,v169
CV v152,v168,v169
FA v186,v186,v170
CV v153,v170,v171
FA v186,v186,v171
EX v172,v116
EX v173,v117
EX v174,v118
EX v175,v119
FA v187,v187,v172
FA v187,v187,v173
CV v156,v172,v173
FA v187,v187,v174
CV v157,v174,v175
FA v187,v187,v175
EX v176,v120
EX v177,v121
EX v178,v122
EX v179,v123
FA v186,v186,v176
FA v186,v186,v177
CV v154,v176,v177
FA v186,v186,v178
CV v155,v178,v179
FA v186,v186,v179
EX v180,v124
EX v181,v125
EX v182,v126
EX v183,v127
FA v187,v187,v180
FA v187,v187,v181
CV v158,v180,v181
FA v187,v187,v182
CV v159,v182,v183
FA v187,v187,v183
s_nop 2
s_branch k2_kernel_back20
k2_kernel_end:
s_endpgm
.section .rodata,"a"
.p2align 6
.amdhsa_kernel k2_kernel
  .amdhsa_next_free_vgpr 512
  .amdhsa_next_free_sgpr 102
  .amdhsa_accum_offset 256
  .amdhsa_group_segment_fixed_size 0
  .amdhsa_kernarg_size 104
  .amdhsa_user_sgpr_count 2
  .amdhsa_user_sgpr_kernarg_segment_ptr 1
  .amdhsa_system_sgpr_workgroup_id_x 1
  .amdhsa_float_denorm_mode_32 3
.end_amdhsa_kernel
.text
```
